```python
import torch

def _softmax(x, axis=-1):
    return torch.softmax(x, dim=axis)
def _gelu(x):
    return torch.nn.functional.gelu(x, approximate="tanh")
def _silu(x):
    return torch.nn.functional.silu(x)
def _sigmoid(x):
    return torch.sigmoid(x)
def _layernorm(x, axis=-1, eps=1e-5):
    m = x.mean(dim=axis, keepdim=True)
    v = x.var(dim=axis, keepdim=True, unbiased=False)
    return (x - m) / torch.sqrt(v + eps)
def _scatter_add(tgt, idx, src, axis=0):
    return tgt.clone().index_add_(axis, idx, src)
def _segment_sum(src, seg, n):
    out = torch.zeros((n,) + src.shape[1:], dtype=src.dtype)
    return out.index_add_(0, seg, src)
def _pad(x, pw):
    flat = tuple(v for pair in reversed(pw) for v in pair)
    return torch.nn.functional.pad(x, flat)

kernel_name = 'recurrent_scan__spectral_fnet__swiglu_ffn__prompt'

def setup_inputs():

    _w = (lambda a: (lambda t: t.to(torch.bfloat16) if t.is_floating_point() else t)(torch.as_tensor(a)))
    def _A_setup():
        B, S, D = 1, 2048, 576
        ns = torch.arange(S)[:, None] * torch.arange(S)[None, :]
        nd = torch.arange(D)[:, None] * torch.arange(D)[None, :]
        Ws_re = torch.cos(-2.0 * torch.pi * ns / S).to(float)
        Ws_im = torch.sin(-2.0 * torch.pi * ns / S).to(float)
        Wd_re = torch.cos(-2.0 * torch.pi * nd / D).to(float)
        Wd_im = torch.sin(-2.0 * torch.pi * nd / D).to(float)
        return {
            "x": _w((lambda *s: torch.randn(*s, dtype=torch.bfloat16) * 0.05)(B, S, D)),
            "dft_seq_re": _w(Ws_re),
            "dft_seq_im": _w(Ws_im),
            "dft_hid_re": _w(Wd_re),
            "dft_hid_im": _w(Wd_im),
        }
    _A_in = _A_setup()

    def _B_setup():
        B, S, D, F = 1, 2048, 576, 4608
        return {
            "x": _w((lambda *s: torch.randn(*s, dtype=torch.bfloat16) * 0.05)(B, S, D)),
            "w_gate": _w((lambda *s: torch.randn(*s, dtype=torch.bfloat16) * 0.05)(D, F)),
            "w_up": _w((lambda *s: torch.randn(*s, dtype=torch.bfloat16) * 0.05)(D, F)),
            "w_down": _w((lambda *s: torch.randn(*s, dtype=torch.bfloat16) * 0.05)(F, D)),
        }
    _B_in = _B_setup()

    return {
        "A_x": _A_in["x"],
        "A_dft_seq_re": _A_in["dft_seq_re"],
        "A_dft_seq_im": _A_in["dft_seq_im"],
        "A_dft_hid_re": _A_in["dft_hid_re"],
        "A_dft_hid_im": _A_in["dft_hid_im"],
        "B_x": _B_in["x"],
        "B_w_gate": _B_in["w_gate"],
        "B_w_up": _B_in["w_up"],
        "B_w_down": _B_in["w_down"],
    }

def reference(A_x, A_dft_seq_re, A_dft_seq_im, A_dft_hid_re, A_dft_hid_im, B_x, B_w_gate, B_w_up, B_w_down):
    def _A_ref(x, dft_seq_re, dft_seq_im, dft_hid_re, dft_hid_im):
        a = torch.einsum("bsd,ed->bse", x, dft_hid_re)
        b = torch.einsum("bsd,ed->bse", x, dft_hid_im)
        y = torch.einsum("ts,bse->bte", dft_seq_re, a) - torch.einsum("ts,bse->bte", dft_seq_im, b)
        return y

    def _B_ref(x, w_gate, w_up, w_down):
        g = _silu(x @ w_gate)
        u = x @ w_up
        return (g * u) @ w_down

    x = A_x
    xn = _layernorm(x, axis=-1)
    s = _A_ref(xn, A_dft_seq_re, A_dft_seq_im, A_dft_hid_re, A_dft_hid_im)
    g = _silu(_B_ref(xn, B_w_gate, B_w_up, B_w_down))
    return x + s * g
```

```asm
; @launch kernel=prep_kernel grid=(528,1,1) block=(256,1,1) lds=10496
; @launch kernel=main_kernel grid=(256,1,1) block=(256,1,1) lds=156672
; @launch kernel=final_kernel grid=(256,1,1) block=(576,1,1) lds=0
.amdgcn_target "amdgcn-amd-amdhsa--gfx950"
.text
.globl prep_kernel
.p2align 8
.type prep_kernel,@function
prep_kernel:
s_cmp_ge_u32 s2, 528
s_cbranch_scc1 K1_end
s_load_dwordx2 s[4:5], s[0:1], 0
s_load_dwordx2 s[6:7], s[0:1], 88
s_load_dwordx4 s[40:43], s[0:1], 8
s_load_dwordx2 s[44:45], s[0:1], 48
s_load_dwordx2 s[60:61], s[0:1], 56
v_lshrrev_b32 v1, 6, v0
v_and_b32 v0, 63, v0
v_readfirstlane_b32 s20, v1
v_and_b32 v2, 31, v0
v_lshrrev_b32 v3, 5, v0
s_waitcnt lgkmcnt(0)
s_mov_b32 s8, s4
s_mov_b32 s9, s5
s_mov_b32 s10, 0x240000
s_mov_b32 s11, 0x00020000
s_mov_b32 s12, s6
s_mov_b32 s13, s7
s_mov_b32 s14, 0x4000000
s_mov_b32 s15, 0x00020000
s_cmp_ge_u32 s2, 256
s_cbranch_scc1 K1_typeB_rows
s_lshl_b32 s21, s2, 3
s_lshl_b32 s22, s20, 1
s_add_u32 s21, s21, s22
s_add_u32 s22, s21, 1
s_branch K1_rows_done
K1_typeB_rows:
s_sub_u32 s23, s2, 256
s_lshl_b32 s23, s23, 2
s_add_u32 s23, s23, s20
s_cmp_gt_u32 s23, 1024
s_cbranch_scc1 K1_zero
s_mov_b32 s21, s23
s_sub_u32 s22, 2048, s23
s_and_b32 s22, s22, 2047
K1_rows_done:
v_mov_b32 v4, s21
v_mov_b32 v5, s22
v_cmp_eq_u32 vcc, 1, v3
s_nop 1
v_cndmask_b32 v4, v4, v5, vcc
s_movk_i32 s24, 1152
v_mul_lo_u32 v5, v4, s24
v_lshlrev_b32 v6, 4, v2
v_add_u32 v5, v5, v6
v_cmp_gt_u32 s[26:27], 8, v2
v_add_u32 v7, 1024, v5
v_mov_b32 v8, 0x7fffffff
v_cndmask_b32 v7, v8, v7, s[26:27]
buffer_load_dwordx4 v[8:11], v5, s[8:11], 0 offen
buffer_load_dwordx4 v[12:15], v5, s[8:11], 0 offen offset:512
buffer_load_dwordx4 v[16:19], v7, s[8:11], 0 offen
s_lshl_b32 s46, s2, 2
s_add_u32 s46, s46, s20
s_sub_u32 s47, s46, 1088
s_lshl_b32 s47, s47, 12
s_add_u32 s47, s47, 3072
s_lshl_b32 s48, s46, 12
s_cmp_lt_u32 s46, 1088
s_cselect_b32 s47, s48, s47
s_cselect_b32 s52, s40, s42
s_cselect_b32 s53, s41, s43
s_mov_b32 s54, 0x800000
s_mov_b32 s55, 0x00020000
v_lshlrev_b32 v84, 4, v0
v_add_u32 v85, s47, v84
buffer_load_dwordx4 v[88:91], v85, s[52:55], 0 offen
s_mul_i32 s47, s46, 911
s_lshr_b32 s47, s47, 16
s_mul_i32 s48, s47, 72
s_sub_u32 s48, s46, s48
s_mul_i32 s49, s47, 5
s_lshl_b32 s50, s47, 2
s_add_u32 s50, s50, 12
s_cmp_lt_u32 s47, 12
s_cselect_b32 s49, s49, s50
s_lshl_b32 s49, s49, 7
s_mul_i32 s48, s48, 73728
s_add_u32 s49, s49, s48
s_sub_u32 s50, s46, 119
s_lshl_b32 s50, s50, 12
s_add_u32 s50, s50, 3072
s_cmp_lt_u32 s46, 1207
s_cselect_b32 s50, s50, 0x7ff00000
v_lshrrev_b32 v86, 3, v0
v_and_b32 v87, 7, v0
s_movk_i32 s48, 9216
v_mul_lo_u32 v86, v86, s48
v_lshlrev_b32 v87, 4, v87
v_add_u32 v86, v86, v87
s_cmp_lt_u32 s46, 1080
s_cselect_b32 s49, s49, s50
s_cselect_b32 s56, s44, s42
s_cselect_b32 s57, s45, s43
s_cselect_b32 s58, 0x510000, s54
s_mov_b32 s59, 0x00020000
s_cselect_b64 vcc, -1, 0
v_cndmask_b32 v86, v84, v86, vcc
v_add_u32 v86, s49, v86
buffer_load_dwordx4 v[92:95], v86, s[56:59], 0 offen
s_sub_u32 s62, s46, 1032
s_mul_i32 s47, s62, 911
s_lshr_b32 s47, s47, 16
s_mul_i32 s48, s47, 72
s_sub_u32 s48, s62, s48
s_mul_i32 s49, s47, 5
s_lshl_b32 s50, s47, 2
s_add_u32 s50, s50, 12
s_cmp_lt_u32 s47, 12
s_cselect_b32 s49, s49, s50
s_lshl_b32 s49, s49, 7
s_mul_i32 s48, s48, 73728
s_add_u32 s49, s49, s48
s_cmp_lt_u32 s62, 1080
s_cselect_b32 s49, s49, 0x7ff00000
s_mov_b32 s76, s60
s_mov_b32 s77, s61
s_mov_b32 s78, 0x510000
s_mov_b32 s79, 0x00020000
v_lshrrev_b32 v96, 3, v0
v_and_b32 v97, 7, v0
s_movk_i32 s48, 9216
v_mul_lo_u32 v96, v96, s48
v_lshlrev_b32 v97, 4, v97
v_add_u32 v96, v96, v97
v_add_u32 v96, s49, v96
buffer_load_dwordx4 v[100:103], v96, s[76:79], 0 offen
s_getpc_b64 s[86:87]
K1_pc:
s_mov_b32 s88, main_kernel-K1_pc
s_mov_b32 s89, K2_tail320-K1_pc-4
s_bitcmp1_b32 s2, 3
s_cselect_b32 s88, K2_dft-K1_pc, s88
s_cselect_b32 s89, K2_dft2-K1_pc-4, s89
v_lshlrev_b32 v80, 7, v0
s_lshl_b32 s90, s20, 13
s_add_u32 s88, s88, s90
s_cmp_ge_u32 s2, 16
s_cselect_b32 s89, 0, s89
v_add_u32 v80, s88, v80
v_min_u32 v80, s89, v80
v_add_co_u32 v80, s[90:91], s86, v80
v_mov_b32 v81, s87
s_nop 0
v_addc_co_u32 v81, s[90:91], 0, v81, s[90:91]
global_load_dword v82, v[80:81], off
v_mov_b32 v60, 0
v_mov_b32 v61, 0
v_mov_b32 v62, 0
v_mov_b32 v63, 0
v_mov_b32 v64, 0
v_mov_b32 v65, 0
v_mov_b32 v66, 0
v_mov_b32 v67, 0
v_mov_b32 v68, 0
v_mov_b32 v69, 0
v_mov_b32 v70, 0
v_mov_b32 v71, 0
v_mov_b32 v72, 0
v_mov_b32 v73, 0
v_mov_b32 v74, 0
v_mov_b32 v75, 0
v_mov_b32 v76, 0
v_mov_b32 v77, 0
v_mov_b32 v78, 0
v_mov_b32 v79, 0
s_waitcnt vmcnt(6)
v_lshlrev_b32 v20, 16, v8
v_and_b32 v21, 0xffff0000, v8
v_lshlrev_b32 v22, 16, v9
v_and_b32 v23, 0xffff0000, v9
v_lshlrev_b32 v24, 16, v10
v_and_b32 v25, 0xffff0000, v10
v_lshlrev_b32 v26, 16, v11
v_and_b32 v27, 0xffff0000, v11
s_waitcnt vmcnt(5)
v_lshlrev_b32 v28, 16, v12
v_and_b32 v29, 0xffff0000, v12
v_lshlrev_b32 v30, 16, v13
v_and_b32 v31, 0xffff0000, v13
v_lshlrev_b32 v32, 16, v14
v_and_b32 v33, 0xffff0000, v14
v_lshlrev_b32 v34, 16, v15
v_and_b32 v35, 0xffff0000, v15
s_waitcnt vmcnt(4)
v_lshlrev_b32 v36, 16, v16
v_and_b32 v37, 0xffff0000, v16
v_lshlrev_b32 v38, 16, v17
v_and_b32 v39, 0xffff0000, v17
v_lshlrev_b32 v40, 16, v18
v_and_b32 v41, 0xffff0000, v18
v_lshlrev_b32 v42, 16, v19
v_and_b32 v43, 0xffff0000, v19
v_add_f32 v44, v20, v21
v_add_f32 v45, v22, v23
v_add_f32 v46, v24, v25
v_add_f32 v47, v26, v27
v_add_f32 v44, v44, v28
v_add_f32 v45, v45, v29
v_add_f32 v46, v46, v30
v_add_f32 v47, v47, v31
v_add_f32 v44, v44, v32
v_add_f32 v45, v45, v33
v_add_f32 v46, v46, v34
v_add_f32 v47, v47, v35
v_add_f32 v44, v44, v36
v_add_f32 v45, v45, v37
v_add_f32 v46, v46, v38
v_add_f32 v47, v47, v39
v_add_f32 v44, v44, v40
v_add_f32 v45, v45, v41
v_add_f32 v46, v46, v42
v_add_f32 v47, v47, v43
v_add_f32 v44, v44, v45
v_add_f32 v46, v46, v47
v_add_f32 v44, v44, v46
s_nop 1
v_add_f32_dpp v44, v44, v44 quad_perm:[1,0,3,2] row_mask:0xf bank_mask:0xf
s_nop 1
v_add_f32_dpp v44, v44, v44 quad_perm:[2,3,0,1] row_mask:0xf bank_mask:0xf
s_nop 1
v_add_f32_dpp v44, v44, v44 row_half_mirror row_mask:0xf bank_mask:0xf
s_nop 1
v_add_f32_dpp v44, v44, v44 row_mirror row_mask:0xf bank_mask:0xf
v_mov_b32 v45, v44
s_nop 1
v_permlane16_swap_b32 v44, v45
v_add_f32 v44, v44, v45
s_mov_b32 s25, 0x3ae38e39
v_mul_f32 v44, s25, v44
v_mov_b32 v46, 0
v_mov_b32 v47, 0
v_sub_f32 v48, v20, v44
v_fmac_f32 v46, v48, v48
v_sub_f32 v49, v21, v44
v_fmac_f32 v47, v49, v49
v_sub_f32 v50, v22, v44
v_fmac_f32 v46, v50, v50
v_sub_f32 v51, v23, v44
v_fmac_f32 v47, v51, v51
v_sub_f32 v48, v24, v44
v_fmac_f32 v46, v48, v48
v_sub_f32 v49, v25, v44
v_fmac_f32 v47, v49, v49
v_sub_f32 v50, v26, v44
v_fmac_f32 v46, v50, v50
v_sub_f32 v51, v27, v44
v_fmac_f32 v47, v51, v51
v_sub_f32 v48, v28, v44
v_fmac_f32 v46, v48, v48
v_sub_f32 v49, v29, v44
v_fmac_f32 v47, v49, v49
v_sub_f32 v50, v30, v44
v_fmac_f32 v46, v50, v50
v_sub_f32 v51, v31, v44
v_fmac_f32 v47, v51, v51
v_sub_f32 v48, v32, v44
v_fmac_f32 v46, v48, v48
v_sub_f32 v49, v33, v44
v_fmac_f32 v47, v49, v49
v_sub_f32 v50, v34, v44
v_fmac_f32 v46, v50, v50
v_sub_f32 v51, v35, v44
v_fmac_f32 v47, v51, v51
s_mov_b64 exec, s[26:27]
v_sub_f32 v48, v36, v44
v_fmac_f32 v46, v48, v48
v_sub_f32 v49, v37, v44
v_fmac_f32 v47, v49, v49
v_sub_f32 v50, v38, v44
v_fmac_f32 v46, v50, v50
v_sub_f32 v51, v39, v44
v_fmac_f32 v47, v51, v51
v_sub_f32 v48, v40, v44
v_fmac_f32 v46, v48, v48
v_sub_f32 v49, v41, v44
v_fmac_f32 v47, v49, v49
v_sub_f32 v50, v42, v44
v_fmac_f32 v46, v50, v50
v_sub_f32 v51, v43, v44
v_fmac_f32 v47, v51, v51
s_mov_b64 exec, -1
v_add_f32 v46, v46, v47
s_nop 1
v_add_f32_dpp v46, v46, v46 quad_perm:[1,0,3,2] row_mask:0xf bank_mask:0xf
s_nop 1
v_add_f32_dpp v46, v46, v46 quad_perm:[2,3,0,1] row_mask:0xf bank_mask:0xf
s_nop 1
v_add_f32_dpp v46, v46, v46 row_half_mirror row_mask:0xf bank_mask:0xf
s_nop 1
v_add_f32_dpp v46, v46, v46 row_mirror row_mask:0xf bank_mask:0xf
v_mov_b32 v47, v46
s_nop 1
v_permlane16_swap_b32 v46, v47
v_add_f32 v46, v46, v47
v_mul_f32 v46, s25, v46
v_cvt_pk_bf16_f32 v46, v46, v44
v_and_b32 v44, 0xffff0000, v46
v_lshlrev_b32 v46, 16, v46
v_add_f32 v46, 0x3727c5ac, v46
v_cvt_pk_bf16_f32 v46, v46, v46
v_lshlrev_b32 v46, 16, v46
v_sqrt_f32 v46, v46
s_nop 0
v_cvt_pk_bf16_f32 v46, v46, v46
v_lshlrev_b32 v46, 16, v46
v_rcp_f32 v46, v46
v_sub_f32 v20, v20, v44
v_sub_f32 v21, v21, v44
v_sub_f32 v22, v22, v44
v_sub_f32 v23, v23, v44
v_sub_f32 v24, v24, v44
v_sub_f32 v25, v25, v44
v_sub_f32 v26, v26, v44
v_sub_f32 v27, v27, v44
v_sub_f32 v28, v28, v44
v_sub_f32 v29, v29, v44
v_sub_f32 v30, v30, v44
v_sub_f32 v31, v31, v44
v_sub_f32 v32, v32, v44
v_sub_f32 v33, v33, v44
v_sub_f32 v34, v34, v44
v_sub_f32 v35, v35, v44
v_sub_f32 v36, v36, v44
v_sub_f32 v37, v37, v44
v_sub_f32 v38, v38, v44
v_sub_f32 v39, v39, v44
v_sub_f32 v40, v40, v44
v_sub_f32 v41, v41, v44
v_sub_f32 v42, v42, v44
v_sub_f32 v43, v43, v44
v_cvt_pk_bf16_f32 v8, v20, v21
v_cvt_pk_bf16_f32 v9, v22, v23
v_cvt_pk_bf16_f32 v10, v24, v25
v_cvt_pk_bf16_f32 v11, v26, v27
v_cvt_pk_bf16_f32 v12, v28, v29
v_cvt_pk_bf16_f32 v13, v30, v31
v_cvt_pk_bf16_f32 v14, v32, v33
v_cvt_pk_bf16_f32 v15, v34, v35
v_cvt_pk_bf16_f32 v16, v36, v37
v_cvt_pk_bf16_f32 v17, v38, v39
v_cvt_pk_bf16_f32 v18, v40, v41
v_cvt_pk_bf16_f32 v19, v42, v43
v_lshlrev_b32 v20, 16, v8
v_and_b32 v21, 0xffff0000, v8
v_lshlrev_b32 v22, 16, v9
v_and_b32 v23, 0xffff0000, v9
v_lshlrev_b32 v24, 16, v10
v_and_b32 v25, 0xffff0000, v10
v_lshlrev_b32 v26, 16, v11
v_and_b32 v27, 0xffff0000, v11
v_lshlrev_b32 v28, 16, v12
v_and_b32 v29, 0xffff0000, v12
v_lshlrev_b32 v30, 16, v13
v_and_b32 v31, 0xffff0000, v13
v_lshlrev_b32 v32, 16, v14
v_and_b32 v33, 0xffff0000, v14
v_lshlrev_b32 v34, 16, v15
v_and_b32 v35, 0xffff0000, v15
v_lshlrev_b32 v36, 16, v16
v_and_b32 v37, 0xffff0000, v16
v_lshlrev_b32 v38, 16, v17
v_and_b32 v39, 0xffff0000, v17
v_lshlrev_b32 v40, 16, v18
v_and_b32 v41, 0xffff0000, v18
v_lshlrev_b32 v42, 16, v19
v_and_b32 v43, 0xffff0000, v19
v_mul_f32 v20, v20, v46
v_mul_f32 v21, v21, v46
v_mul_f32 v22, v22, v46
v_mul_f32 v23, v23, v46
v_mul_f32 v24, v24, v46
v_mul_f32 v25, v25, v46
v_mul_f32 v26, v26, v46
v_mul_f32 v27, v27, v46
v_mul_f32 v28, v28, v46
v_mul_f32 v29, v29, v46
v_mul_f32 v30, v30, v46
v_mul_f32 v31, v31, v46
v_mul_f32 v32, v32, v46
v_mul_f32 v33, v33, v46
v_mul_f32 v34, v34, v46
v_mul_f32 v35, v35, v46
v_mul_f32 v36, v36, v46
v_mul_f32 v37, v37, v46
v_mul_f32 v38, v38, v46
v_mul_f32 v39, v39, v46
v_mul_f32 v40, v40, v46
v_mul_f32 v41, v41, v46
v_mul_f32 v42, v42, v46
v_mul_f32 v43, v43, v46
v_cvt_pk_bf16_f32 v8, v20, v21
v_cvt_pk_bf16_f32 v9, v22, v23
v_cvt_pk_bf16_f32 v10, v24, v25
v_cvt_pk_bf16_f32 v11, v26, v27
v_cvt_pk_bf16_f32 v12, v28, v29
v_cvt_pk_bf16_f32 v13, v30, v31
v_cvt_pk_bf16_f32 v14, v32, v33
v_cvt_pk_bf16_f32 v15, v34, v35
v_cvt_pk_bf16_f32 v16, v36, v37
v_cvt_pk_bf16_f32 v17, v38, v39
v_cvt_pk_bf16_f32 v18, v40, v41
v_cvt_pk_bf16_f32 v19, v42, v43
s_cmp_ge_u32 s2, 256
s_cbranch_scc1 K1_typeB
v_lshrrev_b32 v20, 6, v4
s_mov_b32 s24, 73728
v_mul_lo_u32 v20, v20, s24
v_lshrrev_b32 v21, 2, v2
v_lshlrev_b32 v21, 12, v21
v_add_u32 v20, v20, v21
v_bfe_u32 v21, v4, 4, 2
v_lshlrev_b32 v21, 10, v21
v_add_u32 v20, v20, v21
v_and_b32 v21, 3, v2
v_lshlrev_b32 v21, 8, v21
v_add_u32 v20, v20, v21
v_and_b32 v21, 15, v4
v_lshlrev_b32 v21, 4, v21
v_add_u32 v20, v20, v21
s_mov_b32 s28, 32768
s_mov_b32 s29, 65536
s_mov_b32 s30, 0
buffer_store_dwordx4 v[8:11], v20, s[12:15], s30 offen
buffer_store_dwordx4 v[12:15], v20, s[12:15], s28 offen
s_mov_b64 exec, s[26:27]
buffer_store_dwordx4 v[16:19], v20, s[12:15], s29 offen
s_endpgm
K1_typeB:
s_mul_i32 s28, s20, 2304
s_movk_i32 s24, 1152
v_mul_lo_u32 v20, v3, s24
v_lshlrev_b32 v21, 4, v2
v_add_u32 v20, v20, v21
v_add_u32 v20, s28, v20
ds_write_b128 v20, v[8:11]
ds_write_b128 v20, v[12:15] offset:512
s_mov_b64 exec, s[26:27]
ds_write_b128 v20, v[16:19] offset:1024
s_mov_b64 exec, -1
v_lshlrev_b32 v21, 1, v0
v_add_u32 v22, s28, v21
v_sub_u32 v23, 640, v21
v_add_u32 v23, s28, v23
s_waitcnt lgkmcnt(0)
ds_read_u16_d16_hi v60, v22 offset:0
ds_read_u16_d16_hi v65, v22 offset:1152
ds_read_u16_d16_hi v70, v23 offset:512
ds_read_u16_d16_hi v75, v23 offset:1664
ds_read_u16_d16_hi v61, v22 offset:128
ds_read_u16_d16_hi v66, v22 offset:1280
ds_read_u16_d16_hi v71, v23 offset:384
ds_read_u16_d16_hi v76, v23 offset:1536
ds_read_u16_d16_hi v62, v22 offset:256
ds_read_u16_d16_hi v67, v22 offset:1408
ds_read_u16_d16_hi v72, v23 offset:256
ds_read_u16_d16_hi v77, v23 offset:1408
ds_read_u16_d16_hi v63, v22 offset:384
ds_read_u16_d16_hi v68, v22 offset:1536
ds_read_u16_d16_hi v73, v23 offset:128
ds_read_u16_d16_hi v78, v23 offset:1280
ds_read_u16_d16_hi v64, v22 offset:512
ds_read_u16_d16_hi v69, v22 offset:1664
ds_read_u16_d16_hi v74, v23 offset:0
ds_read_u16_d16_hi v79, v23 offset:1152
s_and_b32 s29, s23, 1023
s_cmp_lg_u32 s29, 0
s_cselect_b32 s29, 1.0, 0
v_cmp_ne_u32 s[30:31], 0, v0
v_cmp_gt_u32 s[32:33], 32, v0
v_cmp_ge_u32 s[34:35], 32, v0
s_mul_i32 s36, s23, 640
s_add_u32 s37, s36, 3145728
s_add_u32 s36, s36, 2359296
s_waitcnt lgkmcnt(15)
v_fma_f32 v24, v65, s29, v60
s_waitcnt lgkmcnt(15)
v_fma_f32 v25, v75, s29, v70
v_sub_f32 v26, v60, v65
v_sub_f32 v27, v70, v75
v_cndmask_b32 v25, 0, v25, s[30:31]
v_add_f32 v24, v24, v25
v_sub_f32 v26, v26, v27
v_cndmask_b32 v26, 0, v26, s[30:31]
v_cvt_pk_bf16_f32 v24, v24, v26
buffer_store_short v24, v21, s[12:15], s36 offen offset:0
buffer_store_short_d16_hi v24, v21, s[12:15], s37 offen offset:0
s_waitcnt lgkmcnt(14)
v_fma_f32 v28, v66, s29, v61
s_waitcnt lgkmcnt(12)
v_fma_f32 v29, v76, s29, v71
v_sub_f32 v30, v61, v66
v_sub_f32 v31, v71, v76
v_add_f32 v28, v28, v29
v_sub_f32 v30, v30, v31
v_cvt_pk_bf16_f32 v28, v28, v30
buffer_store_short v28, v21, s[12:15], s36 offen offset:128
buffer_store_short_d16_hi v28, v21, s[12:15], s37 offen offset:128
s_waitcnt lgkmcnt(10)
v_fma_f32 v32, v67, s29, v62
s_waitcnt lgkmcnt(8)
v_fma_f32 v33, v77, s29, v72
v_sub_f32 v34, v62, v67
v_sub_f32 v35, v72, v77
v_add_f32 v32, v32, v33
v_sub_f32 v34, v34, v35
v_cvt_pk_bf16_f32 v32, v32, v34
buffer_store_short v32, v21, s[12:15], s36 offen offset:256
buffer_store_short_d16_hi v32, v21, s[12:15], s37 offen offset:256
s_waitcnt lgkmcnt(6)
v_fma_f32 v36, v68, s29, v63
s_waitcnt lgkmcnt(4)
v_fma_f32 v37, v78, s29, v73
v_sub_f32 v38, v63, v68
v_sub_f32 v39, v73, v78
v_add_f32 v36, v36, v37
v_sub_f32 v38, v38, v39
v_cvt_pk_bf16_f32 v36, v36, v38
buffer_store_short v36, v21, s[12:15], s36 offen offset:384
buffer_store_short_d16_hi v36, v21, s[12:15], s37 offen offset:384
s_waitcnt lgkmcnt(2)
v_fma_f32 v40, v69, s29, v64
s_waitcnt lgkmcnt(0)
v_fma_f32 v41, v79, s29, v74
v_sub_f32 v42, v64, v69
v_sub_f32 v43, v74, v79
v_cndmask_b32 v41, 0, v41, s[32:33]
v_add_f32 v40, v40, v41
v_sub_f32 v42, v42, v43
v_cndmask_b32 v40, 0, v40, s[34:35]
v_cndmask_b32 v42, 0, v42, s[32:33]
v_cvt_pk_bf16_f32 v40, v40, v42
buffer_store_short v40, v21, s[12:15], s36 offen offset:512
buffer_store_short_d16_hi v40, v21, s[12:15], s37 offen offset:512
s_endpgm
K1_zero:
v_mov_b32 v20, 0
v_lshlrev_b32 v21, 1, v0
s_mul_i32 s36, s23, 640
s_add_u32 s37, s36, 3145728
s_add_u32 s36, s36, 2359296
buffer_store_short v20, v21, s[12:15], s36 offen offset:0
buffer_store_short v20, v21, s[12:15], s37 offen offset:0
buffer_store_short v20, v21, s[12:15], s36 offen offset:128
buffer_store_short v20, v21, s[12:15], s37 offen offset:128
buffer_store_short v20, v21, s[12:15], s36 offen offset:256
buffer_store_short v20, v21, s[12:15], s37 offen offset:256
buffer_store_short v20, v21, s[12:15], s36 offen offset:384
buffer_store_short v20, v21, s[12:15], s37 offen offset:384
buffer_store_short v20, v21, s[12:15], s36 offen offset:512
buffer_store_short v20, v21, s[12:15], s37 offen offset:512
K1_end:
s_endpgm
.globl main_kernel
.p2align 8
.type main_kernel,@function
main_kernel:
s_cmp_ge_u32 s2, 256
s_cbranch_scc1 K2_end
s_load_dwordx2 s[4:5], s[0:1], 88
s_load_dwordx4 s[40:43], s[0:1], 48
s_load_dwordx2 s[44:45], s[0:1], 64
s_load_dwordx4 s[48:51], s[0:1], 8
s_load_dwordx4 s[52:55], s[0:1], 24
v_lshrrev_b32 v1, 6, v0
v_and_b32 v0, 63, v0
v_readfirstlane_b32 s24, v1
s_and_b32 s3, s2, 7
s_lshr_b32 s46, s2, 3
s_and_b32 s28, s3, 1
s_lshl_b32 s28, s28, 3
s_and_b32 s47, s46, 7
s_add_u32 s28, s28, s47
s_lshr_b32 s27, s3, 1
s_lshl_b32 s27, s27, 2
s_lshr_b32 s47, s46, 3
s_add_u32 s27, s27, s47
s_lshr_b32 s46, s27, 2
s_and_b32 s47, s27, 3
s_mul_i32 s27, s46, 3
s_add_u32 s27, s27, s47
s_add_u32 s46, s46, 12
s_cmp_eq_u32 s47, 3
s_cselect_b32 s27, s46, s27
s_lshr_b32 s25, s24, 1
s_and_b32 s26, s24, 1
s_mov_b32 s33, 0xbfb8aa3b
v_lshrrev_b32 v13, 4, v0
v_bfe_u32 v14, v0, 2, 2
v_and_b32 v15, 3, v0
v_lshlrev_b32 v11, 4, v0
v_lshrrev_b32 v1, 1, v14
v_lshlrev_b32 v1, 1, v1
v_and_b32 v9, 1, v13
v_lshlrev_b32 v9, 2, v9
v_add_u32 v9, v9, v1
v_lshrrev_b32 v12, 1, v15
s_lshl_b32 s3, s26, 2
v_add_u32 v12, s3, v12
v_xor_b32 v12, v12, v9
v_lshlrev_b32 v12, 4, v12
v_and_b32 v1, 1, v15
v_lshlrev_b32 v1, 3, v1
v_add_u32 v12, v12, v1
v_lshlrev_b32 v8, 2, v13
v_add_u32 v8, v8, v14
v_lshlrev_b32 v8, 7, v8
v_add_u32 v8, v8, v12
v_xor_b32 v9, 32, v8
v_lshlrev_b32 v5, 3, v13
v_add_u32 v5, v5, v14
v_lshlrev_b32 v5, 7, v5
v_add_u32 v5, v5, v12
v_add_u32 v6, 0x10000, v5
v_lshrrev_b32 v13, 3, v0
v_and_b32 v14, 7, v0
v_bfe_u32 v15, v13, 1, 2
v_lshlrev_b32 v15, 1, v15
v_xor_b32 v15, v14, v15
v_lshlrev_b32 v15, 4, v15
s_movk_i32 s3, 1152
v_mul_lo_u32 v10, v13, s3
v_add_u32 v10, v10, v15
v_bfe_u32 v15, v13, 1, 1
v_lshlrev_b32 v15, 1, v15
v_xor_b32 v15, v14, v15
v_lshlrev_b32 v15, 4, v15
s_and_b32 s3, s24, 1
s_lshl_b32 s3, s3, 6
v_xor_b32 v15, s3, v15
s_movk_i32 s3, 9216
v_mul_lo_u32 v13, v13, s3
v_add_u32 v2, v13, v15
v_add_u32 v4, 145408, v2
v_xor_b32 v15, 64, v15
v_add_u32 v3, v13, v15
v_add_u32 v3, 72704, v3
v_xor_b32 v13, 32, v5
v_add_u32 v14, 0x10000, v13
s_lshl_b32 s34, s24, 10
s_mul_i32 s36, s27, 2359296
s_lshl_b32 s3, s28, 1
s_add_u32 s3, s3, s25
s_mul_i32 s3, s3, 73728
s_add_u32 s36, s36, s3
s_lshl_b32 s46, s26, 12
s_add_u32 s36, s36, s46
s_add_u32 s36, s36, 4194304
s_getpc_b64 s[96:97]
K2_pc:
s_waitcnt lgkmcnt(0)
s_mov_b32 s8, s4
s_mov_b32 s9, s5
s_mov_b32 s10, 0x4000000
s_mov_b32 s11, 0x00020000
s_cmp_eq_u32 s27, 15
s_cbranch_scc1 K2_dft
s_mov_b32 s12, s40
s_mov_b32 s13, s41
s_mov_b32 s14, 0x510000
s_mov_b32 s15, 0x00020000
s_mov_b32 s16, s42
s_mov_b32 s17, s43
s_mov_b32 s18, 0x510000
s_mov_b32 s19, 0x00020000
s_mov_b32 s20, s44
s_mov_b32 s21, s45
s_mov_b32 s22, 0x510000
s_mov_b32 s23, 0x00020000
s_mul_i32 s46, s27, 5
s_lshl_b32 s47, s27, 2
s_add_u32 s47, s47, 12
s_cmp_lt_u32 s27, 12
s_cselect_b32 s46, s46, s47
s_cmp_lt_u32 s27, 12
s_cselect_b32 s32, 4, 3
s_mul_i32 s30, s24, 221184
s_lshl_b32 s47, s46, 7
s_add_u32 s30, s30, s47
s_mul_i32 s29, s24, 3072
s_lshl_b32 s47, s46, 6
s_lshl_b32 s56, s24, 3
s_add_u32 s47, s47, s56
s_mul_i32 s35, s47, 1152
s_lshl_b32 s37, s28, 1
s_add_u32 s37, s37, s25
s_mul_i32 s37, s37, 73728
s_lshl_b32 s39, s26, 11
s_add_u32 s37, s37, s39
s_mul_i32 s38, s25, 12288
s_add_u32 s38, s38, s39
s_add_u32 s38, s38, 73728
s_add_u32 m0, s29, 0
s_add_u32 s31, s30, 0
buffer_load_dwordx4 v2, s[12:15], s31 offen offset:0 lds
buffer_load_dwordx4 v3, s[12:15], s31 offen offset:1024 lds
buffer_load_dwordx4 v4, s[12:15], s31 offen offset:2048 lds
s_add_u32 m0, s38, 0
s_add_u32 s39, s37, 0
buffer_load_dwordx4 v11, s[8:11], s39 offen offset:0 lds
buffer_load_dwordx4 v11, s[8:11], s39 offen offset:1024 lds
s_add_u32 m0, s38, 4096
s_add_u32 s39, s37, 4096
buffer_load_dwordx4 v11, s[8:11], s39 offen offset:0 lds
buffer_load_dwordx4 v11, s[8:11], s39 offen offset:1024 lds
s_add_u32 m0, s38, 8192
s_add_u32 s39, s37, 8192
buffer_load_dwordx4 v11, s[8:11], s39 offen offset:0 lds
buffer_load_dwordx4 v11, s[8:11], s39 offen offset:1024 lds
s_add_u32 m0, s29, 12288
s_add_u32 s31, s30, 884736
buffer_load_dwordx4 v2, s[12:15], s31 offen offset:0 lds
buffer_load_dwordx4 v3, s[12:15], s31 offen offset:1024 lds
buffer_load_dwordx4 v4, s[12:15], s31 offen offset:2048 lds
s_add_u32 m0, s38, 24576
s_add_u32 s39, s37, 12288
buffer_load_dwordx4 v11, s[8:11], s39 offen offset:0 lds
buffer_load_dwordx4 v11, s[8:11], s39 offen offset:1024 lds
s_add_u32 m0, s38, 28672
s_add_u32 s39, s37, 16384
buffer_load_dwordx4 v11, s[8:11], s39 offen offset:0 lds
buffer_load_dwordx4 v11, s[8:11], s39 offen offset:1024 lds
s_add_u32 m0, s38, 32768
s_add_u32 s39, s37, 20480
buffer_load_dwordx4 v11, s[8:11], s39 offen offset:0 lds
buffer_load_dwordx4 v11, s[8:11], s39 offen offset:1024 lds
v_lshlrev_b32 v219, 7, v0
s_lshl_b32 s3, s24, 13
v_add_u32 v219, s3, v219
v_add_u32 v216, K2_g0-K2_pc, v219
v_min_u32 v216, K2_tail320-K2_pc-4, v216
v_add_co_u32 v216, s[98:99], s96, v216
v_mov_b32 v217, s97
s_nop 0
v_addc_co_u32 v217, s[98:99], 0, v217, s[98:99]
global_load_dword v218, v[216:217], off
s_mov_b32 s100, K2_tail320-K2_pc
s_mov_b32 s101, K2_ffn4-K2_pc-4
s_cmp_ge_u32 s27, 12
s_cselect_b32 s100, K2_ffn4-K2_pc, s100
s_cselect_b32 s101, K2_dft-K2_pc-4, s101
v_add_u32 v216, s100, v219
v_min_u32 v216, s101, v216
v_add_co_u32 v216, s[98:99], s96, v216
v_mov_b32 v217, s97
s_nop 0
v_addc_co_u32 v217, s[98:99], 0, v217, s[98:99]
v_add_u32 v220, final_kernel-K2_pc, v219
v_min_u32 v220, K3_end-K2_pc-4, v220
v_add_co_u32 v220, s[98:99], s96, v220
v_mov_b32 v221, s97
s_nop 0
v_addc_co_u32 v221, s[98:99], 0, v221, s[98:99]
s_lshl_b32 s3, s28, 1
s_add_u32 s3, s3, s25
s_mul_i32 s3, s3, 73728
s_add_u32 m0, s38, 49152
s_add_u32 s39, s37, 24576
buffer_load_dwordx4 v11, s[8:11], s39 offen offset:0 lds
buffer_load_dwordx4 v11, s[8:11], s39 offen offset:1024 lds
s_add_u32 m0, s38, 53248
s_add_u32 s39, s37, 28672
buffer_load_dwordx4 v11, s[8:11], s39 offen offset:0 lds
buffer_load_dwordx4 v11, s[8:11], s39 offen offset:1024 lds
s_add_u32 m0, s38, 57344
s_add_u32 s39, s37, 32768
buffer_load_dwordx4 v11, s[8:11], s39 offen offset:0 lds
buffer_load_dwordx4 v11, s[8:11], s39 offen offset:1024 lds
s_add_u32 m0, s29, 24576
s_add_u32 s31, s30, 1769472
buffer_load_dwordx4 v2, s[12:15], s31 offen offset:0 lds
buffer_load_dwordx4 v3, s[12:15], s31 offen offset:1024 lds
buffer_load_dwordx4 v4, s[12:15], s31 offen offset:2048 lds
s_add_u32 m0, s29, 36864
s_add_u32 s31, s30, 2654208
buffer_load_dwordx4 v2, s[12:15], s31 offen offset:0 lds
buffer_load_dwordx4 v3, s[12:15], s31 offen offset:1024 lds
buffer_load_dwordx4 v4, s[12:15], s31 offen offset:2048 lds
s_mul_i32 s3, s25, 12288
s_add_u32 s3, s3, 73728
v_add_u32 v48, s3, v11
s_and_b32 s56, s28, 7
s_lshl_b32 s56, s56, 2
s_add_u32 s56, s56, s24
s_add_u32 s57, s32, 1
s_mul_i32 s57, s57, 2304
s_mul_i32 s56, s56, s57
s_mul_i32 s57, s46, 73728
s_add_u32 s56, s56, s57
v_add_u32 v192, s56, v11
v_add_u32 v193, 4096, v192
v_add_u32 v194, 8192, v192
s_mul_i32 s3, s25, 40960
s_lshl_b32 s46, s26, 10
s_add_u32 s3, s3, s46
s_add_u32 s3, s3, 73728
v_add_u32 v7, s3, v11
s_waitcnt vmcnt(13)
s_waitcnt vmcnt(13)
s_barrier
ds_read_b128 a[0:3], v48 offset:0
ds_read_b128 a[16:19], v48 offset:4096
ds_read_b128 a[32:35], v48 offset:8192
ds_read_b128 a[4:7], v48 offset:1024
ds_read_b128 a[20:23], v48 offset:5120
ds_read_b128 a[36:39], v48 offset:9216
ds_read_b128 a[8:11], v48 offset:2048
ds_read_b128 a[24:27], v48 offset:6144
ds_read_b128 a[40:43], v48 offset:10240
ds_read_b128 a[12:15], v48 offset:3072
ds_read_b128 a[28:31], v48 offset:7168
ds_read_b128 a[44:47], v48 offset:11264
ds_read_b64_tr_b16 v[80:81], v5 offset:0
ds_read_b64_tr_b16 v[82:83], v5 offset:512
ds_read_b64_tr_b16 v[84:85], v5 offset:4096
ds_read_b64_tr_b16 v[86:87], v5 offset:4608
ds_read_b64_tr_b16 v[88:89], v5 offset:8192
ds_read_b64_tr_b16 v[90:91], v5 offset:8704
ds_read_b64_tr_b16 v[92:93], v13 offset:0
ds_read_b64_tr_b16 v[94:95], v13 offset:512
ds_read_b64_tr_b16 v[96:97], v13 offset:4096
ds_read_b64_tr_b16 v[98:99], v13 offset:4608
s_waitcnt lgkmcnt(0)
s_barrier
K2_g0:
v_mfma_f32_16x16x32_bf16 v[16:19], v[80:83], a[0:3], 0
ds_read_b64_tr_b16 v[100:101], v13 offset:8192
s_add_u32 m0, s38, 0
s_add_u32 s39, s37, 36864
buffer_load_dwordx4 v11, s[8:11], s39 offen offset:0 lds
buffer_load_dwordx4 v11, s[8:11], s39 offen offset:1024 lds
v_mfma_f32_16x16x32_bf16 v[16:19], v[84:87], a[16:19], v[16:19]
s_add_u32 m0, s38, 4096
s_add_u32 s39, s37, 40960
buffer_load_dwordx4 v11, s[8:11], s39 offen offset:0 lds
buffer_load_dwordx4 v11, s[8:11], s39 offen offset:1024 lds
ds_read_b128 a[48:51], v48 offset:24576
ds_read_b128 a[64:67], v48 offset:28672
v_mfma_f32_16x16x32_bf16 v[16:19], v[88:91], a[32:35], v[16:19]
ds_read_b64_tr_b16 v[102:103], v13 offset:8704
s_add_u32 m0, s38, 8192
s_add_u32 s39, s37, 45056
buffer_load_dwordx4 v11, s[8:11], s39 offen offset:0 lds
buffer_load_dwordx4 v11, s[8:11], s39 offen offset:1024 lds
v_mfma_f32_16x16x32_bf16 v[24:27], v[80:83], a[4:7], 0
ds_read_b128 a[80:83], v48 offset:32768
ds_read_b128 a[52:55], v48 offset:25600
v_mfma_f32_16x16x32_bf16 v[24:27], v[84:87], a[20:23], v[24:27]
ds_read_b64_tr_b16 v[104:105], v5 offset:12288
v_mfma_f32_16x16x32_bf16 v[24:27], v[88:91], a[36:39], v[24:27]
ds_read_b128 a[68:71], v48 offset:29696
ds_read_b128 a[84:87], v48 offset:33792
v_mfma_f32_16x16x32_bf16 v[32:35], v[80:83], a[8:11], 0
ds_read_b64_tr_b16 v[106:107], v5 offset:12800
v_mfma_f32_16x16x32_bf16 v[32:35], v[84:87], a[24:27], v[32:35]
ds_read_b128 a[56:59], v48 offset:26624
ds_read_b128 a[72:75], v48 offset:30720
v_mfma_f32_16x16x32_bf16 v[32:35], v[88:91], a[40:43], v[32:35]
ds_read_b64_tr_b16 v[108:109], v5 offset:16384
v_mfma_f32_16x16x32_bf16 v[40:43], v[80:83], a[12:15], 0
s_add_u32 m0, s29, 49152
s_add_u32 s31, s30, 3538944
buffer_load_dwordx4 v2, s[12:15], s31 offen offset:0 lds
ds_read_b128 a[88:91], v48 offset:34816
ds_read_b128 a[60:63], v48 offset:27648
v_mfma_f32_16x16x32_bf16 v[40:43], v[84:87], a[28:31], v[40:43]
ds_read_b64_tr_b16 v[110:111], v5 offset:16896
v_mfma_f32_16x16x32_bf16 v[40:43], v[88:91], a[44:47], v[40:43]
buffer_load_dwordx4 v3, s[12:15], s31 offen offset:1024 lds
ds_read_b128 a[76:79], v48 offset:31744
ds_read_b128 a[92:95], v48 offset:35840
v_mfma_f32_16x16x32_bf16 v[20:23], v[92:95], a[0:3], 0
ds_read_b64_tr_b16 v[80:81], v5 offset:20480
v_mfma_f32_16x16x32_bf16 v[20:23], v[96:99], a[16:19], v[20:23]
buffer_load_dwordx4 v4, s[12:15], s31 offen offset:2048 lds
s_waitcnt lgkmcnt(15)
v_mfma_f32_16x16x32_bf16 v[20:23], v[100:103], a[32:35], v[20:23]
ds_read_b64_tr_b16 v[82:83], v5 offset:20992
v_mfma_f32_16x16x32_bf16 v[28:31], v[92:95], a[4:7], 0
s_add_u32 m0, s29, 61440
s_add_u32 s31, s30, 4423680
v_mfma_f32_16x16x32_bf16 v[28:31], v[96:99], a[20:23], v[28:31]
ds_read_b64_tr_b16 v[84:85], v13 offset:12288
v_mfma_f32_16x16x32_bf16 v[28:31], v[100:103], a[36:39], v[28:31]
buffer_load_dwordx4 v2, s[12:15], s31 offen offset:0 lds
v_mfma_f32_16x16x32_bf16 v[36:39], v[92:95], a[8:11], 0
ds_read_b64_tr_b16 v[86:87], v13 offset:12800
v_mfma_f32_16x16x32_bf16 v[36:39], v[96:99], a[24:27], v[36:39]
buffer_load_dwordx4 v3, s[12:15], s31 offen offset:1024 lds
v_mfma_f32_16x16x32_bf16 v[36:39], v[100:103], a[40:43], v[36:39]
ds_read_b64_tr_b16 v[88:89], v13 offset:16384
v_mfma_f32_16x16x32_bf16 v[44:47], v[92:95], a[12:15], 0
buffer_load_dwordx4 v4, s[12:15], s31 offen offset:2048 lds
v_mfma_f32_16x16x32_bf16 v[44:47], v[96:99], a[28:31], v[44:47]
ds_read_b64_tr_b16 v[90:91], v13 offset:16896
v_mfma_f32_16x16x32_bf16 v[44:47], v[100:103], a[44:47], v[44:47]
s_waitcnt lgkmcnt(6)
v_accvgpr_read_b32 v49, a92
s_waitcnt vmcnt(18)
s_waitcnt vmcnt(15)
s_barrier
v_mfma_f32_16x16x32_bf16 v[16:19], v[104:107], a[48:51], v[16:19]
ds_read_b64_tr_b16 v[92:93], v13 offset:20480
s_add_u32 m0, s38, 24576
s_add_u32 s39, s37, 49152
buffer_load_dwordx4 v11, s[8:11], s39 offen offset:0 lds
buffer_load_dwordx4 v11, s[8:11], s39 offen offset:1024 lds
v_mfma_f32_16x16x32_bf16 v[16:19], v[108:111], a[64:67], v[16:19]
s_add_u32 m0, s38, 28672
s_add_u32 s39, s37, 53248
buffer_load_dwordx4 v11, s[8:11], s39 offen offset:0 lds
buffer_load_dwordx4 v11, s[8:11], s39 offen offset:1024 lds
ds_read_b128 a[96:99], v48 offset:49152
ds_read_b128 a[112:115], v48 offset:53248
s_waitcnt lgkmcnt(7)
v_mfma_f32_16x16x32_bf16 v[16:19], v[80:83], a[80:83], v[16:19]
ds_read_b64_tr_b16 v[94:95], v13 offset:20992
s_add_u32 m0, s38, 32768
s_add_u32 s39, s37, 57344
buffer_load_dwordx4 v11, s[8:11], s39 offen offset:0 lds
buffer_load_dwordx4 v11, s[8:11], s39 offen offset:1024 lds
v_mfma_f32_16x16x32_bf16 v[24:27], v[104:107], a[52:55], v[24:27]
ds_read_b128 a[128:131], v48 offset:57344
ds_read_b128 a[100:103], v48 offset:50176
v_mfma_f32_16x16x32_bf16 v[24:27], v[108:111], a[68:71], v[24:27]
ds_read_b64_tr_b16 v[96:97], v5 offset:24576
v_mfma_f32_16x16x32_bf16 v[24:27], v[80:83], a[84:87], v[24:27]
ds_read_b128 a[116:119], v48 offset:54272
ds_read_b128 a[132:135], v48 offset:58368
v_mfma_f32_16x16x32_bf16 v[32:35], v[104:107], a[56:59], v[32:35]
ds_read_b64_tr_b16 v[98:99], v5 offset:25088
v_mfma_f32_16x16x32_bf16 v[32:35], v[108:111], a[72:75], v[32:35]
ds_read_b128 a[104:107], v48 offset:51200
ds_read_b128 a[120:123], v48 offset:55296
v_mfma_f32_16x16x32_bf16 v[32:35], v[80:83], a[88:91], v[32:35]
ds_read_b64_tr_b16 v[100:101], v5 offset:28672
v_mfma_f32_16x16x32_bf16 v[40:43], v[104:107], a[60:63], v[40:43]
ds_read_b128 a[136:139], v48 offset:59392
ds_read_b128 a[108:111], v48 offset:52224
v_mfma_f32_16x16x32_bf16 v[40:43], v[108:111], a[76:79], v[40:43]
ds_read_b64_tr_b16 v[102:103], v5 offset:29184
v_mfma_f32_16x16x32_bf16 v[40:43], v[80:83], a[92:95], v[40:43]
s_add_u32 m0, s29, 0
s_add_u32 s31, s30, 0
ds_read_b128 a[124:127], v48 offset:56320
ds_read_b128 a[140:143], v48 offset:60416
s_waitcnt lgkmcnt(15)
v_mfma_f32_16x16x32_bf16 v[20:23], v[84:87], a[48:51], v[20:23]
ds_read_b64_tr_b16 v[104:105], v5 offset:32768
s_waitcnt lgkmcnt(15)
v_mfma_f32_16x16x32_bf16 v[20:23], v[88:91], a[64:67], v[20:23]
buffer_load_dwordx4 v2, s[16:19], s31 offen offset:0 lds
s_waitcnt lgkmcnt(15)
v_mfma_f32_16x16x32_bf16 v[20:23], v[92:95], a[80:83], v[20:23]
ds_read_b64_tr_b16 v[106:107], v5 offset:33280
v_mfma_f32_16x16x32_bf16 v[28:31], v[84:87], a[52:55], v[28:31]
v_mfma_f32_16x16x32_bf16 v[28:31], v[88:91], a[68:71], v[28:31]
ds_read_b64_tr_b16 v[108:109], v13 offset:24576
v_mfma_f32_16x16x32_bf16 v[28:31], v[92:95], a[84:87], v[28:31]
buffer_load_dwordx4 v3, s[16:19], s31 offen offset:1024 lds
v_mfma_f32_16x16x32_bf16 v[36:39], v[84:87], a[56:59], v[36:39]
ds_read_b64_tr_b16 v[110:111], v13 offset:25088
v_mfma_f32_16x16x32_bf16 v[36:39], v[88:91], a[72:75], v[36:39]
v_mfma_f32_16x16x32_bf16 v[36:39], v[92:95], a[88:91], v[36:39]
ds_read_b64_tr_b16 v[80:81], v13 offset:28672
v_mfma_f32_16x16x32_bf16 v[44:47], v[84:87], a[60:63], v[44:47]
buffer_load_dwordx4 v4, s[16:19], s31 offen offset:2048 lds
v_mfma_f32_16x16x32_bf16 v[44:47], v[88:91], a[76:79], v[44:47]
ds_read_b64_tr_b16 v[82:83], v13 offset:29184
v_mfma_f32_16x16x32_bf16 v[44:47], v[92:95], a[92:95], v[44:47]
s_waitcnt lgkmcnt(6)
v_accvgpr_read_b32 v49, a140
s_waitcnt vmcnt(15)
s_waitcnt vmcnt(15)
s_barrier
v_mfma_f32_16x16x32_bf16 v[16:19], v[96:99], a[96:99], v[16:19]
ds_read_b64_tr_b16 v[84:85], v13 offset:32768
s_add_u32 m0, s38, 49152
s_add_u32 s39, s37, 61440
buffer_load_dwordx4 v11, s[8:11], s39 offen offset:0 lds
buffer_load_dwordx4 v11, s[8:11], s39 offen offset:1024 lds
v_mfma_f32_16x16x32_bf16 v[16:19], v[100:103], a[112:115], v[16:19]
s_add_u32 m0, s38, 53248
s_add_u32 s39, s37, 65536
buffer_load_dwordx4 v11, s[8:11], s39 offen offset:0 lds
buffer_load_dwordx4 v11, s[8:11], s39 offen offset:1024 lds
ds_read_b128 a[144:147], v48 offset:0
ds_read_b128 a[160:163], v48 offset:4096
s_waitcnt lgkmcnt(7)
v_mfma_f32_16x16x32_bf16 v[16:19], v[104:107], a[128:131], v[16:19]
ds_read_b64_tr_b16 v[86:87], v13 offset:33280
s_add_u32 m0, s38, 57344
s_add_u32 s39, s37, 69632
buffer_load_dwordx4 v11, s[8:11], s39 offen offset:0 lds
buffer_load_dwordx4 v11, s[8:11], s39 offen offset:1024 lds
v_mfma_f32_16x16x32_bf16 v[24:27], v[96:99], a[100:103], v[24:27]
ds_read_b128 a[176:179], v48 offset:8192
ds_read_b128 a[148:151], v48 offset:1024
v_mfma_f32_16x16x32_bf16 v[24:27], v[100:103], a[116:119], v[24:27]
ds_read_b64_tr_b16 v[88:89], v5 offset:36864
v_mfma_f32_16x16x32_bf16 v[24:27], v[104:107], a[132:135], v[24:27]
ds_read_b128 a[164:167], v48 offset:5120
ds_read_b128 a[180:183], v48 offset:9216
v_mfma_f32_16x16x32_bf16 v[32:35], v[96:99], a[104:107], v[32:35]
ds_read_b64_tr_b16 v[90:91], v5 offset:37376
v_mfma_f32_16x16x32_bf16 v[32:35], v[100:103], a[120:123], v[32:35]
ds_read_b128 a[152:155], v48 offset:2048
ds_read_b128 a[168:171], v48 offset:6144
v_mfma_f32_16x16x32_bf16 v[32:35], v[104:107], a[136:139], v[32:35]
ds_read_b64_tr_b16 v[92:93], v5 offset:40960
v_mfma_f32_16x16x32_bf16 v[40:43], v[96:99], a[108:111], v[40:43]
ds_read_b128 a[184:187], v48 offset:10240
ds_read_b128 a[156:159], v48 offset:3072
v_mfma_f32_16x16x32_bf16 v[40:43], v[100:103], a[124:127], v[40:43]
ds_read_b64_tr_b16 v[94:95], v5 offset:41472
v_mfma_f32_16x16x32_bf16 v[40:43], v[104:107], a[140:143], v[40:43]
s_add_u32 m0, s29, 12288
s_add_u32 s31, s30, 884736
ds_read_b128 a[172:175], v48 offset:7168
ds_read_b128 a[188:191], v48 offset:11264
s_waitcnt lgkmcnt(15)
v_mfma_f32_16x16x32_bf16 v[20:23], v[108:111], a[96:99], v[20:23]
ds_read_b64_tr_b16 v[96:97], v5 offset:45056
s_waitcnt lgkmcnt(15)
v_mfma_f32_16x16x32_bf16 v[20:23], v[80:83], a[112:115], v[20:23]
buffer_load_dwordx4 v2, s[16:19], s31 offen offset:0 lds
s_waitcnt lgkmcnt(15)
v_mfma_f32_16x16x32_bf16 v[20:23], v[84:87], a[128:131], v[20:23]
ds_read_b64_tr_b16 v[98:99], v5 offset:45568
v_mfma_f32_16x16x32_bf16 v[28:31], v[108:111], a[100:103], v[28:31]
v_mfma_f32_16x16x32_bf16 v[28:31], v[80:83], a[116:119], v[28:31]
ds_read_b64_tr_b16 v[100:101], v13 offset:36864
v_mfma_f32_16x16x32_bf16 v[28:31], v[84:87], a[132:135], v[28:31]
buffer_load_dwordx4 v3, s[16:19], s31 offen offset:1024 lds
v_mfma_f32_16x16x32_bf16 v[36:39], v[108:111], a[104:107], v[36:39]
ds_read_b64_tr_b16 v[102:103], v13 offset:37376
v_mfma_f32_16x16x32_bf16 v[36:39], v[80:83], a[120:123], v[36:39]
v_mfma_f32_16x16x32_bf16 v[36:39], v[84:87], a[136:139], v[36:39]
ds_read_b64_tr_b16 v[104:105], v13 offset:40960
v_mfma_f32_16x16x32_bf16 v[44:47], v[108:111], a[108:111], v[44:47]
buffer_load_dwordx4 v4, s[16:19], s31 offen offset:2048 lds
v_mfma_f32_16x16x32_bf16 v[44:47], v[80:83], a[124:127], v[44:47]
ds_read_b64_tr_b16 v[106:107], v13 offset:41472
v_mfma_f32_16x16x32_bf16 v[44:47], v[84:87], a[140:143], v[44:47]
s_waitcnt vmcnt(12)
s_waitcnt vmcnt(12)
s_barrier
s_waitcnt lgkmcnt(14)
v_mfma_f32_16x16x32_bf16 v[16:19], v[88:91], a[144:147], v[16:19]
ds_read_b64_tr_b16 v[108:109], v13 offset:45056
s_waitcnt lgkmcnt(9)
v_mfma_f32_16x16x32_bf16 v[16:19], v[92:95], a[160:163], v[16:19]
s_add_u32 m0, s29, 24576
ds_read_b128 a[192:195], v48 offset:24576
ds_read_b128 a[208:211], v48 offset:28672
s_waitcnt lgkmcnt(7)
v_mfma_f32_16x16x32_bf16 v[16:19], v[96:99], a[176:179], v[16:19]
ds_read_b64_tr_b16 v[110:111], v13 offset:45568
v_mfma_f32_16x16x32_bf16 v[24:27], v[88:91], a[148:151], v[24:27]
s_add_u32 s31, s30, 1769472
ds_read_b128 a[224:227], v48 offset:32768
ds_read_b128 a[196:199], v48 offset:25600
v_mfma_f32_16x16x32_bf16 v[24:27], v[92:95], a[164:167], v[24:27]
ds_read_b64_tr_b16 v[80:81], v5 offset:49152
v_mfma_f32_16x16x32_bf16 v[24:27], v[96:99], a[180:183], v[24:27]
buffer_load_dwordx4 v[196:199], v192, s[20:23], 0 offen offset:0
ds_read_b128 a[212:215], v48 offset:29696
ds_read_b128 a[228:231], v48 offset:33792
v_mfma_f32_16x16x32_bf16 v[32:35], v[88:91], a[152:155], v[32:35]
ds_read_b64_tr_b16 v[82:83], v5 offset:49664
v_mfma_f32_16x16x32_bf16 v[32:35], v[92:95], a[168:171], v[32:35]
buffer_load_dwordx4 v2, s[16:19], s31 offen offset:0 lds
ds_read_b128 a[200:203], v48 offset:26624
ds_read_b128 a[216:219], v48 offset:30720
v_mfma_f32_16x16x32_bf16 v[32:35], v[96:99], a[184:187], v[32:35]
ds_read_b64_tr_b16 v[84:85], v5 offset:53248
v_mfma_f32_16x16x32_bf16 v[40:43], v[88:91], a[156:159], v[40:43]
buffer_load_dwordx4 v[200:203], v192, s[20:23], 0 offen offset:1024
ds_read_b128 a[232:235], v48 offset:34816
ds_read_b128 a[204:207], v48 offset:27648
v_mfma_f32_16x16x32_bf16 v[40:43], v[92:95], a[172:175], v[40:43]
ds_read_b64_tr_b16 v[86:87], v5 offset:53760
v_mfma_f32_16x16x32_bf16 v[40:43], v[96:99], a[188:191], v[40:43]
ds_read_b128 a[220:223], v48 offset:31744
ds_read_b128 a[236:239], v48 offset:35840
s_waitcnt lgkmcnt(15)
v_mfma_f32_16x16x32_bf16 v[20:23], v[100:103], a[144:147], v[20:23]
ds_read_b64_tr_b16 v[88:89], v5 offset:57344
s_waitcnt lgkmcnt(15)
v_mfma_f32_16x16x32_bf16 v[20:23], v[104:107], a[160:163], v[20:23]
buffer_load_dwordx4 v3, s[16:19], s31 offen offset:1024 lds
s_waitcnt lgkmcnt(15)
v_mfma_f32_16x16x32_bf16 v[20:23], v[108:111], a[176:179], v[20:23]
ds_read_b64_tr_b16 v[90:91], v5 offset:57856
v_mfma_f32_16x16x32_bf16 v[28:31], v[100:103], a[148:151], v[28:31]
buffer_load_dwordx4 v[204:207], v192, s[20:23], 0 offen offset:2048
v_mfma_f32_16x16x32_bf16 v[28:31], v[104:107], a[164:167], v[28:31]
ds_read_b64_tr_b16 v[92:93], v13 offset:49152
v_mfma_f32_16x16x32_bf16 v[28:31], v[108:111], a[180:183], v[28:31]
v_mfma_f32_16x16x32_bf16 v[36:39], v[100:103], a[152:155], v[36:39]
ds_read_b64_tr_b16 v[94:95], v13 offset:49664
v_mfma_f32_16x16x32_bf16 v[36:39], v[104:107], a[168:171], v[36:39]
buffer_load_dwordx4 v4, s[16:19], s31 offen offset:2048 lds
v_mfma_f32_16x16x32_bf16 v[36:39], v[108:111], a[184:187], v[36:39]
ds_read_b64_tr_b16 v[96:97], v13 offset:53248
v_mfma_f32_16x16x32_bf16 v[44:47], v[100:103], a[156:159], v[44:47]
buffer_load_dwordx4 v[208:211], v192, s[20:23], 0 offen offset:3072
v_mfma_f32_16x16x32_bf16 v[44:47], v[104:107], a[172:175], v[44:47]
ds_read_b64_tr_b16 v[98:99], v13 offset:53760
v_mfma_f32_16x16x32_bf16 v[44:47], v[108:111], a[188:191], v[44:47]
s_waitcnt vmcnt(10)
s_waitcnt vmcnt(10)
s_barrier
s_waitcnt lgkmcnt(14)
v_mfma_f32_16x16x32_bf16 v[16:19], v[80:83], a[192:195], v[16:19]
ds_read_b64_tr_b16 v[100:101], v13 offset:57344
s_waitcnt lgkmcnt(9)
v_mfma_f32_16x16x32_bf16 v[16:19], v[84:87], a[208:211], v[16:19]
s_add_u32 m0, s29, 36864
ds_read_b128 a[240:243], v48 offset:49152
ds_read_b128 v[224:227], v48 offset:53248
s_waitcnt lgkmcnt(7)
v_mfma_f32_16x16x32_bf16 v[16:19], v[88:91], a[224:227], v[16:19]
ds_read_b64_tr_b16 v[102:103], v13 offset:57856
v_mfma_f32_16x16x32_bf16 v[24:27], v[80:83], a[196:199], v[24:27]
s_add_u32 s31, s30, 2654208
ds_read_b128 v[240:243], v48 offset:57344
ds_read_b128 a[244:247], v48 offset:50176
v_mfma_f32_16x16x32_bf16 v[24:27], v[84:87], a[212:215], v[24:27]
ds_read_b64_tr_b16 v[104:105], v5 offset:61440
v_mfma_f32_16x16x32_bf16 v[24:27], v[88:91], a[228:231], v[24:27]
buffer_load_dwordx4 v[196:199], v193, s[20:23], 0 offen offset:0
ds_read_b128 v[228:231], v48 offset:54272
ds_read_b128 v[244:247], v48 offset:58368
v_mfma_f32_16x16x32_bf16 v[32:35], v[80:83], a[200:203], v[32:35]
ds_read_b64_tr_b16 v[106:107], v5 offset:61952
v_mfma_f32_16x16x32_bf16 v[32:35], v[84:87], a[216:219], v[32:35]
buffer_load_dwordx4 v2, s[16:19], s31 offen offset:0 lds
ds_read_b128 a[248:251], v48 offset:51200
ds_read_b128 v[232:235], v48 offset:55296
v_mfma_f32_16x16x32_bf16 v[32:35], v[88:91], a[232:235], v[32:35]
ds_read_b64_tr_b16 v[108:109], v6 offset:0
v_mfma_f32_16x16x32_bf16 v[40:43], v[80:83], a[204:207], v[40:43]
buffer_load_dwordx4 v[200:203], v193, s[20:23], 0 offen offset:1024
ds_read_b128 v[248:251], v48 offset:59392
ds_read_b128 a[252:255], v48 offset:52224
v_mfma_f32_16x16x32_bf16 v[40:43], v[84:87], a[220:223], v[40:43]
ds_read_b64_tr_b16 v[110:111], v6 offset:512
v_mfma_f32_16x16x32_bf16 v[40:43], v[88:91], a[236:239], v[40:43]
ds_read_b128 v[236:239], v48 offset:56320
ds_read_b128 v[252:255], v48 offset:60416
s_waitcnt lgkmcnt(15)
v_mfma_f32_16x16x32_bf16 v[20:23], v[92:95], a[192:195], v[20:23]
ds_read_b64_tr_b16 v[80:81], v6 offset:4096
s_waitcnt lgkmcnt(15)
v_mfma_f32_16x16x32_bf16 v[20:23], v[96:99], a[208:211], v[20:23]
buffer_load_dwordx4 v3, s[16:19], s31 offen offset:1024 lds
s_waitcnt lgkmcnt(15)
v_mfma_f32_16x16x32_bf16 v[20:23], v[100:103], a[224:227], v[20:23]
ds_read_b64_tr_b16 v[82:83], v6 offset:4608
v_mfma_f32_16x16x32_bf16 v[28:31], v[92:95], a[196:199], v[28:31]
buffer_load_dwordx4 v[204:207], v193, s[20:23], 0 offen offset:2048
v_mfma_f32_16x16x32_bf16 v[28:31], v[96:99], a[212:215], v[28:31]
ds_read_b64_tr_b16 v[84:85], v13 offset:61440
v_mfma_f32_16x16x32_bf16 v[28:31], v[100:103], a[228:231], v[28:31]
v_mfma_f32_16x16x32_bf16 v[36:39], v[92:95], a[200:203], v[36:39]
ds_read_b64_tr_b16 v[86:87], v13 offset:61952
v_mfma_f32_16x16x32_bf16 v[36:39], v[96:99], a[216:219], v[36:39]
buffer_load_dwordx4 v4, s[16:19], s31 offen offset:2048 lds
v_mfma_f32_16x16x32_bf16 v[36:39], v[100:103], a[232:235], v[36:39]
ds_read_b64_tr_b16 v[88:89], v14 offset:0
v_mfma_f32_16x16x32_bf16 v[44:47], v[92:95], a[204:207], v[44:47]
buffer_load_dwordx4 v[208:211], v193, s[20:23], 0 offen offset:3072
v_mfma_f32_16x16x32_bf16 v[44:47], v[96:99], a[220:223], v[44:47]
ds_read_b64_tr_b16 v[90:91], v14 offset:512
v_mfma_f32_16x16x32_bf16 v[44:47], v[100:103], a[236:239], v[44:47]
s_waitcnt vmcnt(17)
s_barrier
s_waitcnt lgkmcnt(14)
v_mfma_f32_16x16x32_bf16 v[16:19], v[104:107], a[240:243], v[16:19]
ds_read_b64_tr_b16 v[92:93], v14 offset:4096
s_waitcnt lgkmcnt(9)
v_mfma_f32_16x16x32_bf16 v[16:19], v[108:111], v[224:227], v[16:19]
s_add_u32 m0, s29, 49152
s_waitcnt lgkmcnt(5)
v_mfma_f32_16x16x32_bf16 v[16:19], v[80:83], v[240:243], v[16:19]
ds_read_b64_tr_b16 v[94:95], v14 offset:4608
v_mfma_f32_16x16x32_bf16 v[24:27], v[104:107], a[244:247], v[24:27]
s_add_u32 s31, s30, 3538944
v_mfma_f32_16x16x32_bf16 v[24:27], v[108:111], v[228:231], v[24:27]
ds_read_b64_tr_b16 v[96:97], v5 offset:0
v_mfma_f32_16x16x32_bf16 v[24:27], v[80:83], v[244:247], v[24:27]
buffer_load_dwordx4 v[196:199], v194, s[20:23], 0 offen offset:0
v_mfma_f32_16x16x32_bf16 v[32:35], v[104:107], a[248:251], v[32:35]
ds_read_b64_tr_b16 v[98:99], v5 offset:512
v_mfma_f32_16x16x32_bf16 v[32:35], v[108:111], v[232:235], v[32:35]
buffer_load_dwordx4 v2, s[16:19], s31 offen offset:0 lds
v_mfma_f32_16x16x32_bf16 v[32:35], v[80:83], v[248:251], v[32:35]
ds_read_b64_tr_b16 v[100:101], v5 offset:4096
v_mfma_f32_16x16x32_bf16 v[40:43], v[104:107], a[252:255], v[40:43]
buffer_load_dwordx4 v[200:203], v194, s[20:23], 0 offen offset:1024
v_mfma_f32_16x16x32_bf16 v[40:43], v[108:111], v[236:239], v[40:43]
ds_read_b64_tr_b16 v[102:103], v5 offset:4608
v_mfma_f32_16x16x32_bf16 v[40:43], v[80:83], v[252:255], v[40:43]
s_waitcnt lgkmcnt(8)
v_mfma_f32_16x16x32_bf16 v[20:23], v[84:87], a[240:243], v[20:23]
ds_read_b64_tr_b16 v[104:105], v5 offset:8192
s_waitcnt lgkmcnt(7)
v_mfma_f32_16x16x32_bf16 v[20:23], v[88:91], v[224:227], v[20:23]
buffer_load_dwordx4 v3, s[16:19], s31 offen offset:1024 lds
s_waitcnt lgkmcnt(5)
v_mfma_f32_16x16x32_bf16 v[20:23], v[92:95], v[240:243], v[20:23]
ds_read_b64_tr_b16 v[106:107], v5 offset:8704
v_mfma_f32_16x16x32_bf16 v[28:31], v[84:87], a[244:247], v[28:31]
buffer_load_dwordx4 v[204:207], v194, s[20:23], 0 offen offset:2048
v_mfma_f32_16x16x32_bf16 v[28:31], v[88:91], v[228:231], v[28:31]
ds_read_b64_tr_b16 v[108:109], v13 offset:0
v_mfma_f32_16x16x32_bf16 v[28:31], v[92:95], v[244:247], v[28:31]
v_mfma_f32_16x16x32_bf16 v[36:39], v[84:87], a[248:251], v[36:39]
ds_read_b64_tr_b16 v[110:111], v13 offset:512
v_mfma_f32_16x16x32_bf16 v[36:39], v[88:91], v[232:235], v[36:39]
buffer_load_dwordx4 v4, s[16:19], s31 offen offset:2048 lds
v_mfma_f32_16x16x32_bf16 v[36:39], v[92:95], v[248:251], v[36:39]
ds_read_b64_tr_b16 v[80:81], v13 offset:4096
v_mfma_f32_16x16x32_bf16 v[44:47], v[84:87], a[252:255], v[44:47]
buffer_load_dwordx4 v[208:211], v194, s[20:23], 0 offen offset:3072
v_mfma_f32_16x16x32_bf16 v[44:47], v[88:91], v[236:239], v[44:47]
ds_read_b64_tr_b16 v[82:83], v13 offset:4608
v_mfma_f32_16x16x32_bf16 v[44:47], v[92:95], v[252:255], v[44:47]
s_waitcnt vmcnt(21)
s_barrier
K2_loop:
s_waitcnt lgkmcnt(8)
v_mfma_f32_16x16x32_bf16 v[48:51], v[96:99], a[0:3], 0
ds_read_b64_tr_b16 v[84:85], v13 offset:8192
s_waitcnt lgkmcnt(7)
v_mfma_f32_16x16x32_bf16 v[48:51], v[100:103], a[16:19], v[48:51]
s_add_u32 m0, s29, 61440
s_waitcnt lgkmcnt(5)
v_mfma_f32_16x16x32_bf16 v[48:51], v[104:107], a[32:35], v[48:51]
ds_read_b64_tr_b16 v[86:87], v13 offset:8704
v_mfma_f32_16x16x32_bf16 v[56:59], v[96:99], a[4:7], 0
s_add_u32 s31, s30, 4423680
v_mfma_f32_16x16x32_bf16 v[56:59], v[100:103], a[20:23], v[56:59]
ds_read_b64_tr_b16 v[88:89], v5 offset:12288
v_mfma_f32_16x16x32_bf16 v[56:59], v[104:107], a[36:39], v[56:59]
v_mul_f32 v112, s33, v16
v_mul_f32 v113, s33, v17
v_mfma_f32_16x16x32_bf16 v[64:67], v[96:99], a[8:11], 0
ds_read_b64_tr_b16 v[90:91], v5 offset:12800
v_mfma_f32_16x16x32_bf16 v[64:67], v[100:103], a[24:27], v[64:67]
buffer_load_dwordx4 v2, s[16:19], s31 offen offset:0 lds
v_mul_f32 v114, s33, v18
v_mfma_f32_16x16x32_bf16 v[64:67], v[104:107], a[40:43], v[64:67]
ds_read_b64_tr_b16 v[92:93], v5 offset:16384
v_mfma_f32_16x16x32_bf16 v[72:75], v[96:99], a[12:15], 0
v_mul_f32 v115, s33, v19
v_mfma_f32_16x16x32_bf16 v[72:75], v[100:103], a[28:31], v[72:75]
ds_read_b64_tr_b16 v[94:95], v5 offset:16896
v_exp_f32 v144, v112
v_mfma_f32_16x16x32_bf16 v[72:75], v[104:107], a[44:47], v[72:75]
s_waitcnt lgkmcnt(8)
v_mfma_f32_16x16x32_bf16 v[52:55], v[108:111], a[0:3], 0
ds_read_b64_tr_b16 v[96:97], v5 offset:20480
v_exp_f32 v145, v113
s_waitcnt lgkmcnt(7)
v_mfma_f32_16x16x32_bf16 v[52:55], v[80:83], a[16:19], v[52:55]
buffer_load_dwordx4 v3, s[16:19], s31 offen offset:1024 lds
s_waitcnt lgkmcnt(5)
v_mfma_f32_16x16x32_bf16 v[52:55], v[84:87], a[32:35], v[52:55]
ds_read_b64_tr_b16 v[98:99], v5 offset:20992
v_mfma_f32_16x16x32_bf16 v[60:63], v[108:111], a[4:7], 0
v_exp_f32 v146, v114
v_mfma_f32_16x16x32_bf16 v[60:63], v[80:83], a[20:23], v[60:63]
ds_read_b64_tr_b16 v[100:101], v13 offset:12288
v_mfma_f32_16x16x32_bf16 v[60:63], v[84:87], a[36:39], v[60:63]
v_exp_f32 v147, v115
v_mfma_f32_16x16x32_bf16 v[68:71], v[108:111], a[8:11], 0
ds_read_b64_tr_b16 v[102:103], v13 offset:12800
v_mfma_f32_16x16x32_bf16 v[68:71], v[80:83], a[24:27], v[68:71]
buffer_load_dwordx4 v4, s[16:19], s31 offen offset:2048 lds
v_mfma_f32_16x16x32_bf16 v[68:71], v[84:87], a[40:43], v[68:71]
ds_read_b64_tr_b16 v[104:105], v13 offset:16384
v_fma_f32 v144, v144, s33, s33
v_mfma_f32_16x16x32_bf16 v[76:79], v[108:111], a[12:15], 0
s_add_u32 s30, s30, 128
v_fma_f32 v145, v145, s33, s33
v_mfma_f32_16x16x32_bf16 v[76:79], v[80:83], a[28:31], v[76:79]
ds_read_b64_tr_b16 v[106:107], v13 offset:16896
v_fma_f32 v146, v146, s33, s33
v_mfma_f32_16x16x32_bf16 v[76:79], v[84:87], a[44:47], v[76:79]
v_fma_f32 v147, v147, s33, s33
s_waitcnt vmcnt(9)
s_barrier
s_waitcnt lgkmcnt(8)
v_mfma_f32_16x16x32_bf16 v[48:51], v[88:91], a[48:51], v[48:51]
ds_read_b64_tr_b16 v[108:109], v13 offset:20480
v_mul_f32 v116, s33, v20
s_waitcnt lgkmcnt(7)
v_mfma_f32_16x16x32_bf16 v[48:51], v[92:95], a[64:67], v[48:51]
s_add_u32 m0, s29, 0
v_mul_f32 v117, s33, v21
s_waitcnt lgkmcnt(5)
v_mfma_f32_16x16x32_bf16 v[48:51], v[96:99], a[80:83], v[48:51]
ds_read_b64_tr_b16 v[110:111], v13 offset:20992
v_mul_f32 v118, s33, v22
v_mfma_f32_16x16x32_bf16 v[56:59], v[88:91], a[52:55], v[56:59]
s_add_u32 s31, s30, 0
v_mul_f32 v119, s33, v23
v_mfma_f32_16x16x32_bf16 v[56:59], v[92:95], a[68:71], v[56:59]
ds_read_b64_tr_b16 v[80:81], v5 offset:24576
v_mfma_f32_16x16x32_bf16 v[56:59], v[96:99], a[84:87], v[56:59]
v_exp_f32 v148, v116
v_mfma_f32_16x16x32_bf16 v[64:67], v[88:91], a[56:59], v[64:67]
ds_read_b64_tr_b16 v[82:83], v5 offset:25088
v_mfma_f32_16x16x32_bf16 v[64:67], v[92:95], a[72:75], v[64:67]
buffer_load_dwordx4 v2, s[12:15], s31 offen offset:0 lds
v_exp_f32 v149, v117
v_mfma_f32_16x16x32_bf16 v[64:67], v[96:99], a[88:91], v[64:67]
ds_read_b64_tr_b16 v[84:85], v5 offset:28672
v_mfma_f32_16x16x32_bf16 v[72:75], v[88:91], a[60:63], v[72:75]
v_exp_f32 v150, v118
v_mfma_f32_16x16x32_bf16 v[72:75], v[92:95], a[76:79], v[72:75]
ds_read_b64_tr_b16 v[86:87], v5 offset:29184
v_mfma_f32_16x16x32_bf16 v[72:75], v[96:99], a[92:95], v[72:75]
global_load_dword v218, v[216:217], off
s_waitcnt lgkmcnt(8)
v_mfma_f32_16x16x32_bf16 v[52:55], v[100:103], a[48:51], v[52:55]
ds_read_b64_tr_b16 v[88:89], v5 offset:32768
v_exp_f32 v151, v119
s_waitcnt lgkmcnt(7)
v_mfma_f32_16x16x32_bf16 v[52:55], v[104:107], a[64:67], v[52:55]
buffer_load_dwordx4 v3, s[12:15], s31 offen offset:1024 lds
s_waitcnt lgkmcnt(5)
v_mfma_f32_16x16x32_bf16 v[52:55], v[108:111], a[80:83], v[52:55]
ds_read_b64_tr_b16 v[90:91], v5 offset:33280
v_fma_f32 v148, v148, s33, s33
v_mfma_f32_16x16x32_bf16 v[60:63], v[100:103], a[52:55], v[60:63]
v_fma_f32 v149, v149, s33, s33
v_mfma_f32_16x16x32_bf16 v[60:63], v[104:107], a[68:71], v[60:63]
ds_read_b64_tr_b16 v[92:93], v13 offset:24576
v_fma_f32 v150, v150, s33, s33
v_mfma_f32_16x16x32_bf16 v[60:63], v[108:111], a[84:87], v[60:63]
v_fma_f32 v151, v151, s33, s33
v_mfma_f32_16x16x32_bf16 v[68:71], v[100:103], a[56:59], v[68:71]
ds_read_b64_tr_b16 v[94:95], v13 offset:25088
v_mul_f32 v120, s33, v24
v_mfma_f32_16x16x32_bf16 v[68:71], v[104:107], a[72:75], v[68:71]
buffer_load_dwordx4 v4, s[12:15], s31 offen offset:2048 lds
v_mul_f32 v121, s33, v25
v_mfma_f32_16x16x32_bf16 v[68:71], v[108:111], a[88:91], v[68:71]
ds_read_b64_tr_b16 v[96:97], v13 offset:28672
v_mfma_f32_16x16x32_bf16 v[76:79], v[100:103], a[60:63], v[76:79]
v_mul_f32 v122, s33, v26
v_mul_f32 v123, s33, v27
v_mfma_f32_16x16x32_bf16 v[76:79], v[104:107], a[76:79], v[76:79]
ds_read_b64_tr_b16 v[98:99], v13 offset:29184
v_mfma_f32_16x16x32_bf16 v[76:79], v[108:111], a[92:95], v[76:79]
v_exp_f32 v152, v120
s_waitcnt vmcnt(10)
s_barrier
s_waitcnt lgkmcnt(8)
v_mfma_f32_16x16x32_bf16 v[48:51], v[80:83], a[96:99], v[48:51]
ds_read_b64_tr_b16 v[100:101], v13 offset:32768
s_waitcnt lgkmcnt(7)
v_mfma_f32_16x16x32_bf16 v[48:51], v[84:87], a[112:115], v[48:51]
s_add_u32 m0, s29, 12288
v_exp_f32 v153, v121
s_waitcnt lgkmcnt(5)
v_mfma_f32_16x16x32_bf16 v[48:51], v[88:91], a[128:131], v[48:51]
ds_read_b64_tr_b16 v[102:103], v13 offset:33280
v_mfma_f32_16x16x32_bf16 v[56:59], v[80:83], a[100:103], v[56:59]
s_add_u32 s31, s30, 884736
v_exp_f32 v154, v122
v_mfma_f32_16x16x32_bf16 v[56:59], v[84:87], a[116:119], v[56:59]
ds_read_b64_tr_b16 v[104:105], v5 offset:36864
v_mfma_f32_16x16x32_bf16 v[56:59], v[88:91], a[132:135], v[56:59]
v_exp_f32 v155, v123
v_mfma_f32_16x16x32_bf16 v[64:67], v[80:83], a[104:107], v[64:67]
ds_read_b64_tr_b16 v[106:107], v5 offset:37376
v_fma_f32 v152, v152, s33, s33
v_mfma_f32_16x16x32_bf16 v[64:67], v[84:87], a[120:123], v[64:67]
buffer_load_dwordx4 v2, s[12:15], s31 offen offset:0 lds
v_fma_f32 v153, v153, s33, s33
v_mfma_f32_16x16x32_bf16 v[64:67], v[88:91], a[136:139], v[64:67]
ds_read_b64_tr_b16 v[108:109], v5 offset:40960
v_mfma_f32_16x16x32_bf16 v[72:75], v[80:83], a[108:111], v[72:75]
v_fma_f32 v154, v154, s33, s33
v_fma_f32 v155, v155, s33, s33
v_mfma_f32_16x16x32_bf16 v[72:75], v[84:87], a[124:127], v[72:75]
ds_read_b64_tr_b16 v[110:111], v5 offset:41472
v_mul_f32 v124, s33, v28
v_mfma_f32_16x16x32_bf16 v[72:75], v[88:91], a[140:143], v[72:75]
v_mul_f32 v125, s33, v29
s_waitcnt lgkmcnt(8)
v_mfma_f32_16x16x32_bf16 v[52:55], v[92:95], a[96:99], v[52:55]
ds_read_b64_tr_b16 v[80:81], v5 offset:45056
v_mul_f32 v126, s33, v30
s_waitcnt lgkmcnt(7)
v_mfma_f32_16x16x32_bf16 v[52:55], v[96:99], a[112:115], v[52:55]
buffer_load_dwordx4 v3, s[12:15], s31 offen offset:1024 lds
s_waitcnt lgkmcnt(5)
v_mfma_f32_16x16x32_bf16 v[52:55], v[100:103], a[128:131], v[52:55]
ds_read_b64_tr_b16 v[82:83], v5 offset:45568
v_mul_f32 v127, s33, v31
v_mfma_f32_16x16x32_bf16 v[60:63], v[92:95], a[100:103], v[60:63]
v_exp_f32 v156, v124
v_mfma_f32_16x16x32_bf16 v[60:63], v[96:99], a[116:119], v[60:63]
ds_read_b64_tr_b16 v[84:85], v13 offset:36864
v_mfma_f32_16x16x32_bf16 v[60:63], v[100:103], a[132:135], v[60:63]
v_exp_f32 v157, v125
v_mfma_f32_16x16x32_bf16 v[68:71], v[92:95], a[104:107], v[68:71]
ds_read_b64_tr_b16 v[86:87], v13 offset:37376
v_mfma_f32_16x16x32_bf16 v[68:71], v[96:99], a[120:123], v[68:71]
buffer_load_dwordx4 v4, s[12:15], s31 offen offset:2048 lds
v_exp_f32 v158, v126
v_mfma_f32_16x16x32_bf16 v[68:71], v[100:103], a[136:139], v[68:71]
ds_read_b64_tr_b16 v[88:89], v13 offset:40960
v_mfma_f32_16x16x32_bf16 v[76:79], v[92:95], a[108:111], v[76:79]
v_exp_f32 v159, v127
v_mfma_f32_16x16x32_bf16 v[76:79], v[96:99], a[124:127], v[76:79]
ds_read_b64_tr_b16 v[90:91], v13 offset:41472
v_mfma_f32_16x16x32_bf16 v[76:79], v[100:103], a[140:143], v[76:79]
v_fma_f32 v156, v156, s33, s33
v_fma_f32 v157, v157, s33, s33
s_waitcnt vmcnt(10)
s_barrier
s_waitcnt lgkmcnt(8)
v_mfma_f32_16x16x32_bf16 v[48:51], v[104:107], a[144:147], v[48:51]
ds_read_b64_tr_b16 v[92:93], v13 offset:45056
v_fma_f32 v158, v158, s33, s33
s_waitcnt lgkmcnt(7)
v_mfma_f32_16x16x32_bf16 v[48:51], v[108:111], a[160:163], v[48:51]
s_add_u32 m0, s29, 24576
v_fma_f32 v159, v159, s33, s33
s_waitcnt lgkmcnt(5)
v_mfma_f32_16x16x32_bf16 v[48:51], v[80:83], a[176:179], v[48:51]
ds_read_b64_tr_b16 v[94:95], v13 offset:45568
v_mfma_f32_16x16x32_bf16 v[56:59], v[104:107], a[148:151], v[56:59]
s_add_u32 s31, s30, 1769472
v_mul_f32 v128, s33, v32
v_mul_f32 v129, s33, v33
v_mfma_f32_16x16x32_bf16 v[56:59], v[108:111], a[164:167], v[56:59]
ds_read_b64_tr_b16 v[96:97], v5 offset:49152
v_mfma_f32_16x16x32_bf16 v[56:59], v[80:83], a[180:183], v[56:59]
v_mul_f32 v130, s33, v34
v_mul_f32 v131, s33, v35
v_mfma_f32_16x16x32_bf16 v[64:67], v[104:107], a[152:155], v[64:67]
ds_read_b64_tr_b16 v[98:99], v5 offset:49664
v_mfma_f32_16x16x32_bf16 v[64:67], v[108:111], a[168:171], v[64:67]
buffer_load_dwordx4 v2, s[12:15], s31 offen offset:0 lds
v_mfma_f32_16x16x32_bf16 v[64:67], v[80:83], a[184:187], v[64:67]
ds_read_b64_tr_b16 v[100:101], v5 offset:53248
v_exp_f32 v160, v128
v_mfma_f32_16x16x32_bf16 v[72:75], v[104:107], a[156:159], v[72:75]
v_mfma_f32_16x16x32_bf16 v[72:75], v[108:111], a[172:175], v[72:75]
ds_read_b64_tr_b16 v[102:103], v5 offset:53760
v_exp_f32 v161, v129
v_mfma_f32_16x16x32_bf16 v[72:75], v[80:83], a[188:191], v[72:75]
s_waitcnt lgkmcnt(8)
v_mfma_f32_16x16x32_bf16 v[52:55], v[84:87], a[144:147], v[52:55]
ds_read_b64_tr_b16 v[104:105], v5 offset:57344
v_exp_f32 v162, v130
s_waitcnt lgkmcnt(7)
v_mfma_f32_16x16x32_bf16 v[52:55], v[88:91], a[160:163], v[52:55]
buffer_load_dwordx4 v3, s[12:15], s31 offen offset:1024 lds
s_waitcnt lgkmcnt(5)
v_mfma_f32_16x16x32_bf16 v[52:55], v[92:95], a[176:179], v[52:55]
ds_read_b64_tr_b16 v[106:107], v5 offset:57856
v_mfma_f32_16x16x32_bf16 v[60:63], v[84:87], a[148:151], v[60:63]
v_exp_f32 v163, v131
v_mfma_f32_16x16x32_bf16 v[60:63], v[88:91], a[164:167], v[60:63]
ds_read_b64_tr_b16 v[108:109], v13 offset:49152
v_mfma_f32_16x16x32_bf16 v[60:63], v[92:95], a[180:183], v[60:63]
v_fma_f32 v160, v160, s33, s33
v_fma_f32 v161, v161, s33, s33
v_mfma_f32_16x16x32_bf16 v[68:71], v[84:87], a[152:155], v[68:71]
ds_read_b64_tr_b16 v[110:111], v13 offset:49664
v_mfma_f32_16x16x32_bf16 v[68:71], v[88:91], a[168:171], v[68:71]
buffer_load_dwordx4 v4, s[12:15], s31 offen offset:2048 lds
v_fma_f32 v162, v162, s33, s33
v_mfma_f32_16x16x32_bf16 v[68:71], v[92:95], a[184:187], v[68:71]
ds_read_b64_tr_b16 v[80:81], v13 offset:53248
v_mfma_f32_16x16x32_bf16 v[76:79], v[84:87], a[156:159], v[76:79]
v_fma_f32 v163, v163, s33, s33
v_mul_f32 v132, s33, v36
v_mfma_f32_16x16x32_bf16 v[76:79], v[88:91], a[172:175], v[76:79]
ds_read_b64_tr_b16 v[82:83], v13 offset:53760
v_mfma_f32_16x16x32_bf16 v[76:79], v[92:95], a[188:191], v[76:79]
v_mul_f32 v133, s33, v37
v_mul_f32 v134, s33, v38
s_waitcnt vmcnt(10)
s_barrier
s_waitcnt lgkmcnt(8)
v_mfma_f32_16x16x32_bf16 v[48:51], v[96:99], a[192:195], v[48:51]
ds_read_b64_tr_b16 v[84:85], v13 offset:57344
v_mul_f32 v135, s33, v39
s_waitcnt lgkmcnt(7)
v_mfma_f32_16x16x32_bf16 v[48:51], v[100:103], a[208:211], v[48:51]
s_add_u32 m0, s29, 36864
v_exp_f32 v164, v132
s_waitcnt lgkmcnt(5)
v_mfma_f32_16x16x32_bf16 v[48:51], v[104:107], a[224:227], v[48:51]
ds_read_b64_tr_b16 v[86:87], v13 offset:57856
v_mfma_f32_16x16x32_bf16 v[56:59], v[96:99], a[196:199], v[56:59]
s_add_u32 s31, s30, 2654208
v_exp_f32 v165, v133
v_mfma_f32_16x16x32_bf16 v[56:59], v[100:103], a[212:215], v[56:59]
ds_read_b64_tr_b16 v[88:89], v5 offset:61440
v_mfma_f32_16x16x32_bf16 v[56:59], v[104:107], a[228:231], v[56:59]
v_exp_f32 v166, v134
v_mfma_f32_16x16x32_bf16 v[64:67], v[96:99], a[200:203], v[64:67]
ds_read_b64_tr_b16 v[90:91], v5 offset:61952
v_mfma_f32_16x16x32_bf16 v[64:67], v[100:103], a[216:219], v[64:67]
buffer_load_dwordx4 v2, s[12:15], s31 offen offset:0 lds
v_mfma_f32_16x16x32_bf16 v[64:67], v[104:107], a[232:235], v[64:67]
ds_read_b64_tr_b16 v[92:93], v6 offset:0
v_exp_f32 v167, v135
v_mfma_f32_16x16x32_bf16 v[72:75], v[96:99], a[204:207], v[72:75]
v_fma_f32 v164, v164, s33, s33
v_mfma_f32_16x16x32_bf16 v[72:75], v[100:103], a[220:223], v[72:75]
ds_read_b64_tr_b16 v[94:95], v6 offset:512
v_fma_f32 v165, v165, s33, s33
v_mfma_f32_16x16x32_bf16 v[72:75], v[104:107], a[236:239], v[72:75]
v_fma_f32 v166, v166, s33, s33
v_fma_f32 v167, v167, s33, s33
s_waitcnt lgkmcnt(8)
v_mfma_f32_16x16x32_bf16 v[52:55], v[108:111], a[192:195], v[52:55]
ds_read_b64_tr_b16 v[96:97], v6 offset:4096
s_waitcnt lgkmcnt(7)
v_mfma_f32_16x16x32_bf16 v[52:55], v[80:83], a[208:211], v[52:55]
buffer_load_dwordx4 v3, s[12:15], s31 offen offset:1024 lds
v_mul_f32 v136, s33, v40
s_waitcnt lgkmcnt(5)
v_mfma_f32_16x16x32_bf16 v[52:55], v[84:87], a[224:227], v[52:55]
ds_read_b64_tr_b16 v[98:99], v6 offset:4608
v_mul_f32 v137, s33, v41
v_mfma_f32_16x16x32_bf16 v[60:63], v[108:111], a[196:199], v[60:63]
v_mul_f32 v138, s33, v42
v_mfma_f32_16x16x32_bf16 v[60:63], v[80:83], a[212:215], v[60:63]
ds_read_b64_tr_b16 v[100:101], v13 offset:61440
v_mul_f32 v139, s33, v43
v_mfma_f32_16x16x32_bf16 v[60:63], v[84:87], a[228:231], v[60:63]
v_exp_f32 v168, v136
v_mfma_f32_16x16x32_bf16 v[68:71], v[108:111], a[200:203], v[68:71]
ds_read_b64_tr_b16 v[102:103], v13 offset:61952
v_mfma_f32_16x16x32_bf16 v[68:71], v[80:83], a[216:219], v[68:71]
buffer_load_dwordx4 v4, s[12:15], s31 offen offset:2048 lds
v_exp_f32 v169, v137
v_mfma_f32_16x16x32_bf16 v[68:71], v[84:87], a[232:235], v[68:71]
ds_read_b64_tr_b16 v[104:105], v14 offset:0
v_mfma_f32_16x16x32_bf16 v[76:79], v[108:111], a[204:207], v[76:79]
v_exp_f32 v170, v138
v_mfma_f32_16x16x32_bf16 v[76:79], v[80:83], a[220:223], v[76:79]
ds_read_b64_tr_b16 v[106:107], v14 offset:512
v_mfma_f32_16x16x32_bf16 v[76:79], v[84:87], a[236:239], v[76:79]
v_exp_f32 v171, v139
s_waitcnt vmcnt(9)
s_barrier
s_waitcnt lgkmcnt(8)
v_mfma_f32_16x16x32_bf16 v[48:51], v[88:91], a[240:243], v[48:51]
ds_read_b64_tr_b16 v[108:109], v14 offset:4096
s_waitcnt lgkmcnt(7)
v_mfma_f32_16x16x32_bf16 v[48:51], v[92:95], v[224:227], v[48:51]
s_add_u32 m0, s29, 49152
v_fma_f32 v168, v168, s33, s33
v_fma_f32 v169, v169, s33, s33
s_waitcnt lgkmcnt(5)
v_mfma_f32_16x16x32_bf16 v[48:51], v[96:99], v[240:243], v[48:51]
ds_read_b64_tr_b16 v[110:111], v14 offset:4608
v_mfma_f32_16x16x32_bf16 v[56:59], v[88:91], a[244:247], v[56:59]
s_add_u32 s31, s30, 3538944
v_fma_f32 v170, v170, s33, s33
v_mfma_f32_16x16x32_bf16 v[56:59], v[92:95], v[228:231], v[56:59]
ds_read_b64_tr_b16 v[80:81], v5 offset:0
v_fma_f32 v171, v171, s33, s33
v_mfma_f32_16x16x32_bf16 v[56:59], v[96:99], v[244:247], v[56:59]
v_mul_f32 v140, s33, v44
v_mfma_f32_16x16x32_bf16 v[64:67], v[88:91], a[248:251], v[64:67]
ds_read_b64_tr_b16 v[82:83], v5 offset:512
v_mul_f32 v141, s33, v45
v_mfma_f32_16x16x32_bf16 v[64:67], v[92:95], v[232:235], v[64:67]
buffer_load_dwordx4 v2, s[12:15], s31 offen offset:0 lds
v_mfma_f32_16x16x32_bf16 v[64:67], v[96:99], v[248:251], v[64:67]
ds_read_b64_tr_b16 v[84:85], v5 offset:4096
v_mul_f32 v142, s33, v46
v_mfma_f32_16x16x32_bf16 v[72:75], v[88:91], a[252:255], v[72:75]
v_mul_f32 v143, s33, v47
v_mfma_f32_16x16x32_bf16 v[72:75], v[92:95], v[236:239], v[72:75]
ds_read_b64_tr_b16 v[86:87], v5 offset:4608
v_mfma_f32_16x16x32_bf16 v[72:75], v[96:99], v[252:255], v[72:75]
v_exp_f32 v172, v140
s_waitcnt lgkmcnt(8)
v_mfma_f32_16x16x32_bf16 v[52:55], v[100:103], a[240:243], v[52:55]
ds_read_b64_tr_b16 v[88:89], v5 offset:8192
s_waitcnt lgkmcnt(7)
v_mfma_f32_16x16x32_bf16 v[52:55], v[104:107], v[224:227], v[52:55]
buffer_load_dwordx4 v3, s[12:15], s31 offen offset:1024 lds
v_exp_f32 v173, v141
s_waitcnt lgkmcnt(5)
v_mfma_f32_16x16x32_bf16 v[52:55], v[108:111], v[240:243], v[52:55]
ds_read_b64_tr_b16 v[90:91], v5 offset:8704
v_mfma_f32_16x16x32_bf16 v[60:63], v[100:103], a[244:247], v[60:63]
v_exp_f32 v174, v142
v_mfma_f32_16x16x32_bf16 v[60:63], v[104:107], v[228:231], v[60:63]
ds_read_b64_tr_b16 v[92:93], v13 offset:0
v_mfma_f32_16x16x32_bf16 v[60:63], v[108:111], v[244:247], v[60:63]
v_exp_f32 v175, v143
v_mfma_f32_16x16x32_bf16 v[68:71], v[100:103], a[248:251], v[68:71]
ds_read_b64_tr_b16 v[94:95], v13 offset:512
v_mfma_f32_16x16x32_bf16 v[68:71], v[104:107], v[232:235], v[68:71]
buffer_load_dwordx4 v4, s[12:15], s31 offen offset:2048 lds
v_mfma_f32_16x16x32_bf16 v[68:71], v[108:111], v[248:251], v[68:71]
ds_read_b64_tr_b16 v[96:97], v13 offset:4096
v_fma_f32 v172, v172, s33, s33
v_mfma_f32_16x16x32_bf16 v[76:79], v[100:103], a[252:255], v[76:79]
v_fma_f32 v173, v173, s33, s33
v_mfma_f32_16x16x32_bf16 v[76:79], v[104:107], v[236:239], v[76:79]
ds_read_b64_tr_b16 v[98:99], v13 offset:4608
v_fma_f32 v174, v174, s33, s33
v_mfma_f32_16x16x32_bf16 v[76:79], v[108:111], v[252:255], v[76:79]
v_fma_f32 v175, v175, s33, s33
s_waitcnt vmcnt(9)
s_barrier
s_waitcnt lgkmcnt(8)
v_mfma_f32_16x16x32_bf16 v[16:19], v[80:83], a[0:3], 0
ds_read_b64_tr_b16 v[100:101], v13 offset:8192
s_waitcnt lgkmcnt(7)
v_mfma_f32_16x16x32_bf16 v[16:19], v[84:87], a[16:19], v[16:19]
s_add_u32 m0, s29, 61440
s_waitcnt lgkmcnt(5)
v_mfma_f32_16x16x32_bf16 v[16:19], v[88:91], a[32:35], v[16:19]
ds_read_b64_tr_b16 v[102:103], v13 offset:8704
v_mfma_f32_16x16x32_bf16 v[24:27], v[80:83], a[4:7], 0
s_add_u32 s31, s30, 4423680
v_mfma_f32_16x16x32_bf16 v[24:27], v[84:87], a[20:23], v[24:27]
ds_read_b64_tr_b16 v[104:105], v5 offset:12288
v_mfma_f32_16x16x32_bf16 v[24:27], v[88:91], a[36:39], v[24:27]
v_rcp_f32 v144, v144
v_mfma_f32_16x16x32_bf16 v[32:35], v[80:83], a[8:11], 0
ds_read_b64_tr_b16 v[106:107], v5 offset:12800
v_rcp_f32 v145, v145
v_mfma_f32_16x16x32_bf16 v[32:35], v[84:87], a[24:27], v[32:35]
buffer_load_dwordx4 v2, s[12:15], s31 offen offset:0 lds
v_mfma_f32_16x16x32_bf16 v[32:35], v[88:91], a[40:43], v[32:35]
ds_read_b64_tr_b16 v[108:109], v5 offset:16384
v_mfma_f32_16x16x32_bf16 v[40:43], v[80:83], a[12:15], 0
v_rcp_f32 v146, v146
v_mfma_f32_16x16x32_bf16 v[40:43], v[84:87], a[28:31], v[40:43]
ds_read_b64_tr_b16 v[110:111], v5 offset:16896
v_rcp_f32 v147, v147
v_mfma_f32_16x16x32_bf16 v[40:43], v[88:91], a[44:47], v[40:43]
v_mul_f32 v112, v112, v48
s_waitcnt lgkmcnt(8)
v_mfma_f32_16x16x32_bf16 v[20:23], v[92:95], a[0:3], 0
ds_read_b64_tr_b16 v[80:81], v5 offset:20480
v_mul_f32 v113, v113, v49
s_waitcnt lgkmcnt(7)
v_mfma_f32_16x16x32_bf16 v[20:23], v[96:99], a[16:19], v[20:23]
buffer_load_dwordx4 v3, s[12:15], s31 offen offset:1024 lds
v_mul_f32 v114, v114, v50
s_waitcnt lgkmcnt(5)
v_mfma_f32_16x16x32_bf16 v[20:23], v[100:103], a[32:35], v[20:23]
ds_read_b64_tr_b16 v[82:83], v5 offset:20992
v_mfma_f32_16x16x32_bf16 v[28:31], v[92:95], a[4:7], 0
v_mul_f32 v115, v115, v51
v_mul_f32 v112, v112, v144
v_mfma_f32_16x16x32_bf16 v[28:31], v[96:99], a[20:23], v[28:31]
ds_read_b64_tr_b16 v[84:85], v13 offset:12288
v_mul_f32 v113, v113, v145
v_mfma_f32_16x16x32_bf16 v[28:31], v[100:103], a[36:39], v[28:31]
v_mul_f32 v114, v114, v146
v_mul_f32 v115, v115, v147
v_mfma_f32_16x16x32_bf16 v[36:39], v[92:95], a[8:11], 0
ds_read_b64_tr_b16 v[86:87], v13 offset:12800
v_mfma_f32_16x16x32_bf16 v[36:39], v[96:99], a[24:27], v[36:39]
buffer_load_dwordx4 v4, s[12:15], s31 offen offset:2048 lds
v_cvt_pk_bf16_f32 v176, v112, v113
v_mfma_f32_16x16x32_bf16 v[36:39], v[100:103], a[40:43], v[36:39]
ds_read_b64_tr_b16 v[88:89], v13 offset:16384
v_cvt_pk_bf16_f32 v177, v114, v115
v_mfma_f32_16x16x32_bf16 v[44:47], v[92:95], a[12:15], 0
v_rcp_f32 v148, v148
v_mfma_f32_16x16x32_bf16 v[44:47], v[96:99], a[28:31], v[44:47]
ds_read_b64_tr_b16 v[90:91], v13 offset:16896
v_mfma_f32_16x16x32_bf16 v[44:47], v[100:103], a[44:47], v[44:47]
v_rcp_f32 v149, v149
s_waitcnt vmcnt(9)
s_barrier
s_waitcnt lgkmcnt(8)
v_mfma_f32_16x16x32_bf16 v[16:19], v[104:107], a[48:51], v[16:19]
ds_read_b64_tr_b16 v[92:93], v13 offset:20480
s_waitcnt lgkmcnt(7)
v_mfma_f32_16x16x32_bf16 v[16:19], v[108:111], a[64:67], v[16:19]
s_add_u32 m0, s29, 0
v_rcp_f32 v150, v150
s_waitcnt lgkmcnt(5)
v_mfma_f32_16x16x32_bf16 v[16:19], v[80:83], a[80:83], v[16:19]
ds_read_b64_tr_b16 v[94:95], v13 offset:20992
v_rcp_f32 v151, v151
v_mfma_f32_16x16x32_bf16 v[24:27], v[104:107], a[52:55], v[24:27]
s_add_u32 s31, s30, 0
v_mul_f32 v116, v116, v52
v_mfma_f32_16x16x32_bf16 v[24:27], v[108:111], a[68:71], v[24:27]
ds_read_b64_tr_b16 v[96:97], v5 offset:24576
v_mfma_f32_16x16x32_bf16 v[24:27], v[80:83], a[84:87], v[24:27]
v_mul_f32 v117, v117, v53
v_mul_f32 v118, v118, v54
v_mfma_f32_16x16x32_bf16 v[32:35], v[104:107], a[56:59], v[32:35]
ds_read_b64_tr_b16 v[98:99], v5 offset:25088
v_mul_f32 v119, v119, v55
v_mfma_f32_16x16x32_bf16 v[32:35], v[108:111], a[72:75], v[32:35]
buffer_load_dwordx4 v2, s[16:19], s31 offen offset:0 lds
v_mul_f32 v116, v116, v148
v_mfma_f32_16x16x32_bf16 v[32:35], v[80:83], a[88:91], v[32:35]
ds_read_b64_tr_b16 v[100:101], v5 offset:28672
v_mfma_f32_16x16x32_bf16 v[40:43], v[104:107], a[60:63], v[40:43]
v_mul_f32 v117, v117, v149
v_mul_f32 v118, v118, v150
v_mfma_f32_16x16x32_bf16 v[40:43], v[108:111], a[76:79], v[40:43]
ds_read_b64_tr_b16 v[102:103], v5 offset:29184
v_mul_f32 v119, v119, v151
v_mfma_f32_16x16x32_bf16 v[40:43], v[80:83], a[92:95], v[40:43]
v_cvt_pk_bf16_f32 v178, v116, v117
v_cvt_pk_bf16_f32 v179, v118, v119
s_waitcnt lgkmcnt(8)
v_mfma_f32_16x16x32_bf16 v[20:23], v[84:87], a[48:51], v[20:23]
ds_read_b64_tr_b16 v[104:105], v5 offset:32768
s_waitcnt lgkmcnt(7)
v_mfma_f32_16x16x32_bf16 v[20:23], v[88:91], a[64:67], v[20:23]
buffer_load_dwordx4 v3, s[16:19], s31 offen offset:1024 lds
ds_write_b128 v7, v[176:179] offset:0
s_waitcnt lgkmcnt(6)
v_mfma_f32_16x16x32_bf16 v[20:23], v[92:95], a[80:83], v[20:23]
ds_read_b64_tr_b16 v[106:107], v5 offset:33280
v_rcp_f32 v152, v152
v_mfma_f32_16x16x32_bf16 v[28:31], v[84:87], a[52:55], v[28:31]
v_mfma_f32_16x16x32_bf16 v[28:31], v[88:91], a[68:71], v[28:31]
ds_read_b64_tr_b16 v[108:109], v13 offset:24576
v_rcp_f32 v153, v153
v_mfma_f32_16x16x32_bf16 v[28:31], v[92:95], a[84:87], v[28:31]
v_rcp_f32 v154, v154
v_mfma_f32_16x16x32_bf16 v[36:39], v[84:87], a[56:59], v[36:39]
ds_read_b64_tr_b16 v[110:111], v13 offset:25088
v_mfma_f32_16x16x32_bf16 v[36:39], v[88:91], a[72:75], v[36:39]
buffer_load_dwordx4 v4, s[16:19], s31 offen offset:2048 lds
v_mfma_f32_16x16x32_bf16 v[36:39], v[92:95], a[88:91], v[36:39]
ds_read_b64_tr_b16 v[80:81], v13 offset:28672
v_rcp_f32 v155, v155
v_mfma_f32_16x16x32_bf16 v[44:47], v[84:87], a[60:63], v[44:47]
v_mul_f32 v120, v120, v56
v_mfma_f32_16x16x32_bf16 v[44:47], v[88:91], a[76:79], v[44:47]
ds_read_b64_tr_b16 v[82:83], v13 offset:29184
v_mul_f32 v121, v121, v57
v_mfma_f32_16x16x32_bf16 v[44:47], v[92:95], a[92:95], v[44:47]
v_mul_f32 v122, v122, v58
v_mul_f32 v123, v123, v59
s_waitcnt vmcnt(9)
s_barrier
s_waitcnt lgkmcnt(9)
v_mfma_f32_16x16x32_bf16 v[16:19], v[96:99], a[96:99], v[16:19]
ds_read_b64_tr_b16 v[84:85], v13 offset:32768
v_mul_f32 v120, v120, v152
s_waitcnt lgkmcnt(8)
v_mfma_f32_16x16x32_bf16 v[16:19], v[100:103], a[112:115], v[16:19]
s_add_u32 m0, s29, 12288
v_mul_f32 v121, v121, v153
s_waitcnt lgkmcnt(5)
v_mfma_f32_16x16x32_bf16 v[16:19], v[104:107], a[128:131], v[16:19]
ds_read_b64_tr_b16 v[86:87], v13 offset:33280
v_mul_f32 v122, v122, v154
v_mfma_f32_16x16x32_bf16 v[24:27], v[96:99], a[100:103], v[24:27]
s_add_u32 s31, s30, 884736
v_mul_f32 v123, v123, v155
v_mfma_f32_16x16x32_bf16 v[24:27], v[100:103], a[116:119], v[24:27]
ds_read_b64_tr_b16 v[88:89], v5 offset:36864
v_cvt_pk_bf16_f32 v180, v120, v121
v_mfma_f32_16x16x32_bf16 v[24:27], v[104:107], a[132:135], v[24:27]
v_cvt_pk_bf16_f32 v181, v122, v123
v_mfma_f32_16x16x32_bf16 v[32:35], v[96:99], a[104:107], v[32:35]
ds_read_b64_tr_b16 v[90:91], v5 offset:37376
v_mfma_f32_16x16x32_bf16 v[32:35], v[100:103], a[120:123], v[32:35]
buffer_load_dwordx4 v2, s[16:19], s31 offen offset:0 lds
v_rcp_f32 v156, v156
v_mfma_f32_16x16x32_bf16 v[32:35], v[104:107], a[136:139], v[32:35]
ds_read_b64_tr_b16 v[92:93], v5 offset:40960
v_mfma_f32_16x16x32_bf16 v[40:43], v[96:99], a[108:111], v[40:43]
v_rcp_f32 v157, v157
v_mfma_f32_16x16x32_bf16 v[40:43], v[100:103], a[124:127], v[40:43]
ds_read_b64_tr_b16 v[94:95], v5 offset:41472
v_mfma_f32_16x16x32_bf16 v[40:43], v[104:107], a[140:143], v[40:43]
v_rcp_f32 v158, v158
s_waitcnt lgkmcnt(8)
v_mfma_f32_16x16x32_bf16 v[20:23], v[108:111], a[96:99], v[20:23]
ds_read_b64_tr_b16 v[96:97], v5 offset:45056
s_waitcnt lgkmcnt(7)
v_mfma_f32_16x16x32_bf16 v[20:23], v[80:83], a[112:115], v[20:23]
buffer_load_dwordx4 v3, s[16:19], s31 offen offset:1024 lds
v_rcp_f32 v159, v159
s_waitcnt lgkmcnt(5)
v_mfma_f32_16x16x32_bf16 v[20:23], v[84:87], a[128:131], v[20:23]
ds_read_b64_tr_b16 v[98:99], v5 offset:45568
v_mfma_f32_16x16x32_bf16 v[28:31], v[108:111], a[100:103], v[28:31]
v_mul_f32 v124, v124, v60
v_mul_f32 v125, v125, v61
v_mfma_f32_16x16x32_bf16 v[28:31], v[80:83], a[116:119], v[28:31]
ds_read_b64_tr_b16 v[100:101], v13 offset:36864
v_mfma_f32_16x16x32_bf16 v[28:31], v[84:87], a[132:135], v[28:31]
v_mul_f32 v126, v126, v62
v_mul_f32 v127, v127, v63
v_mfma_f32_16x16x32_bf16 v[36:39], v[108:111], a[104:107], v[36:39]
ds_read_b64_tr_b16 v[102:103], v13 offset:37376
v_mul_f32 v124, v124, v156
v_mfma_f32_16x16x32_bf16 v[36:39], v[80:83], a[120:123], v[36:39]
buffer_load_dwordx4 v4, s[16:19], s31 offen offset:2048 lds
v_mfma_f32_16x16x32_bf16 v[36:39], v[84:87], a[136:139], v[36:39]
ds_read_b64_tr_b16 v[104:105], v13 offset:40960
v_mul_f32 v125, v125, v157
v_mfma_f32_16x16x32_bf16 v[44:47], v[108:111], a[108:111], v[44:47]
v_mul_f32 v126, v126, v158
v_mul_f32 v127, v127, v159
v_mfma_f32_16x16x32_bf16 v[44:47], v[80:83], a[124:127], v[44:47]
ds_read_b64_tr_b16 v[106:107], v13 offset:41472
v_mfma_f32_16x16x32_bf16 v[44:47], v[84:87], a[140:143], v[44:47]
v_cvt_pk_bf16_f32 v182, v124, v125
v_cvt_pk_bf16_f32 v183, v126, v127
s_waitcnt vmcnt(9)
s_barrier
s_waitcnt lgkmcnt(8)
v_mfma_f32_16x16x32_bf16 v[16:19], v[88:91], a[144:147], v[16:19]
ds_read_b64_tr_b16 v[108:109], v13 offset:45056
ds_write_b128 v7, v[180:183] offset:10240
s_waitcnt lgkmcnt(8)
v_mfma_f32_16x16x32_bf16 v[16:19], v[92:95], a[160:163], v[16:19]
s_add_u32 m0, s29, 24576
v_rcp_f32 v160, v160
s_waitcnt lgkmcnt(6)
v_mfma_f32_16x16x32_bf16 v[16:19], v[96:99], a[176:179], v[16:19]
ds_read_b64_tr_b16 v[110:111], v13 offset:45568
v_mfma_f32_16x16x32_bf16 v[24:27], v[88:91], a[148:151], v[24:27]
s_add_u32 s31, s30, 1769472
v_rcp_f32 v161, v161
v_mfma_f32_16x16x32_bf16 v[24:27], v[92:95], a[164:167], v[24:27]
ds_read_b64_tr_b16 v[80:81], v5 offset:49152
v_mfma_f32_16x16x32_bf16 v[24:27], v[96:99], a[180:183], v[24:27]
v_rcp_f32 v162, v162
v_mfma_f32_16x16x32_bf16 v[32:35], v[88:91], a[152:155], v[32:35]
ds_read_b64_tr_b16 v[82:83], v5 offset:49664
v_rcp_f32 v163, v163
v_mfma_f32_16x16x32_bf16 v[32:35], v[92:95], a[168:171], v[32:35]
buffer_load_dwordx4 v2, s[16:19], s31 offen offset:0 lds
v_mfma_f32_16x16x32_bf16 v[32:35], v[96:99], a[184:187], v[32:35]
ds_read_b64_tr_b16 v[84:85], v5 offset:53248
v_mul_f32 v128, v128, v64
v_mfma_f32_16x16x32_bf16 v[40:43], v[88:91], a[156:159], v[40:43]
v_mul_f32 v129, v129, v65
v_mul_f32 v130, v130, v66
v_mfma_f32_16x16x32_bf16 v[40:43], v[92:95], a[172:175], v[40:43]
ds_read_b64_tr_b16 v[86:87], v5 offset:53760
v_mfma_f32_16x16x32_bf16 v[40:43], v[96:99], a[188:191], v[40:43]
v_mul_f32 v131, v131, v67
v_mul_f32 v128, v128, v160
s_waitcnt lgkmcnt(9)
v_mfma_f32_16x16x32_bf16 v[20:23], v[100:103], a[144:147], v[20:23]
ds_read_b64_tr_b16 v[88:89], v5 offset:57344
v_mul_f32 v129, v129, v161
s_waitcnt lgkmcnt(8)
v_mfma_f32_16x16x32_bf16 v[20:23], v[104:107], a[160:163], v[20:23]
buffer_load_dwordx4 v3, s[16:19], s31 offen offset:1024 lds
v_mul_f32 v130, v130, v162
s_waitcnt lgkmcnt(5)
v_mfma_f32_16x16x32_bf16 v[20:23], v[108:111], a[176:179], v[20:23]
ds_read_b64_tr_b16 v[90:91], v5 offset:57856
v_mul_f32 v131, v131, v163
v_mfma_f32_16x16x32_bf16 v[28:31], v[100:103], a[148:151], v[28:31]
v_cvt_pk_bf16_f32 v184, v128, v129
v_mfma_f32_16x16x32_bf16 v[28:31], v[104:107], a[164:167], v[28:31]
ds_read_b64_tr_b16 v[92:93], v13 offset:49152
v_cvt_pk_bf16_f32 v185, v130, v131
v_mfma_f32_16x16x32_bf16 v[28:31], v[108:111], a[180:183], v[28:31]
v_rcp_f32 v164, v164
v_mfma_f32_16x16x32_bf16 v[36:39], v[100:103], a[152:155], v[36:39]
ds_read_b64_tr_b16 v[94:95], v13 offset:49664
v_mfma_f32_16x16x32_bf16 v[36:39], v[104:107], a[168:171], v[36:39]
buffer_load_dwordx4 v4, s[16:19], s31 offen offset:2048 lds
v_rcp_f32 v165, v165
v_mfma_f32_16x16x32_bf16 v[36:39], v[108:111], a[184:187], v[36:39]
ds_read_b64_tr_b16 v[96:97], v13 offset:53248
v_mfma_f32_16x16x32_bf16 v[44:47], v[100:103], a[156:159], v[44:47]
v_rcp_f32 v166, v166
v_mfma_f32_16x16x32_bf16 v[44:47], v[104:107], a[172:175], v[44:47]
ds_read_b64_tr_b16 v[98:99], v13 offset:53760
v_rcp_f32 v167, v167
v_mfma_f32_16x16x32_bf16 v[44:47], v[108:111], a[188:191], v[44:47]
v_mul_f32 v132, v132, v68
s_waitcnt vmcnt(9)
s_barrier
s_waitcnt lgkmcnt(8)
v_mfma_f32_16x16x32_bf16 v[16:19], v[80:83], a[192:195], v[16:19]
ds_read_b64_tr_b16 v[100:101], v13 offset:57344
v_mul_f32 v133, v133, v69
s_waitcnt lgkmcnt(7)
v_mfma_f32_16x16x32_bf16 v[16:19], v[84:87], a[208:211], v[16:19]
s_add_u32 m0, s29, 36864
v_mul_f32 v134, v134, v70
s_waitcnt lgkmcnt(5)
v_mfma_f32_16x16x32_bf16 v[16:19], v[88:91], a[224:227], v[16:19]
ds_read_b64_tr_b16 v[102:103], v13 offset:57856
v_mul_f32 v135, v135, v71
v_mfma_f32_16x16x32_bf16 v[24:27], v[80:83], a[196:199], v[24:27]
s_add_u32 s31, s30, 2654208
v_mul_f32 v132, v132, v164
v_mfma_f32_16x16x32_bf16 v[24:27], v[84:87], a[212:215], v[24:27]
ds_read_b64_tr_b16 v[104:105], v5 offset:61440
v_mul_f32 v133, v133, v165
v_mfma_f32_16x16x32_bf16 v[24:27], v[88:91], a[228:231], v[24:27]
v_mul_f32 v134, v134, v166
v_mfma_f32_16x16x32_bf16 v[32:35], v[80:83], a[200:203], v[32:35]
ds_read_b64_tr_b16 v[106:107], v5 offset:61952
v_mul_f32 v135, v135, v167
v_mfma_f32_16x16x32_bf16 v[32:35], v[84:87], a[216:219], v[32:35]
buffer_load_dwordx4 v2, s[16:19], s31 offen offset:0 lds
v_cvt_pk_bf16_f32 v186, v132, v133
v_mfma_f32_16x16x32_bf16 v[32:35], v[88:91], a[232:235], v[32:35]
ds_read_b64_tr_b16 v[108:109], v6 offset:0
v_mfma_f32_16x16x32_bf16 v[40:43], v[80:83], a[204:207], v[40:43]
v_cvt_pk_bf16_f32 v187, v134, v135
ds_write_b128 v7, v[184:187] offset:20480
v_mfma_f32_16x16x32_bf16 v[40:43], v[84:87], a[220:223], v[40:43]
ds_read_b64_tr_b16 v[110:111], v6 offset:512
v_mfma_f32_16x16x32_bf16 v[40:43], v[88:91], a[236:239], v[40:43]
v_rcp_f32 v168, v168
s_waitcnt lgkmcnt(9)
v_mfma_f32_16x16x32_bf16 v[20:23], v[92:95], a[192:195], v[20:23]
ds_read_b64_tr_b16 v[80:81], v6 offset:4096
s_waitcnt lgkmcnt(8)
v_mfma_f32_16x16x32_bf16 v[20:23], v[96:99], a[208:211], v[20:23]
buffer_load_dwordx4 v3, s[16:19], s31 offen offset:1024 lds
v_rcp_f32 v169, v169
s_waitcnt lgkmcnt(6)
v_mfma_f32_16x16x32_bf16 v[20:23], v[100:103], a[224:227], v[20:23]
ds_read_b64_tr_b16 v[82:83], v6 offset:4608
v_mfma_f32_16x16x32_bf16 v[28:31], v[92:95], a[196:199], v[28:31]
v_rcp_f32 v170, v170
v_mfma_f32_16x16x32_bf16 v[28:31], v[96:99], a[212:215], v[28:31]
ds_read_b64_tr_b16 v[84:85], v13 offset:61440
v_mfma_f32_16x16x32_bf16 v[28:31], v[100:103], a[228:231], v[28:31]
v_rcp_f32 v171, v171
v_mfma_f32_16x16x32_bf16 v[36:39], v[92:95], a[200:203], v[36:39]
ds_read_b64_tr_b16 v[86:87], v13 offset:61952
v_mul_f32 v136, v136, v72
v_mfma_f32_16x16x32_bf16 v[36:39], v[96:99], a[216:219], v[36:39]
buffer_load_dwordx4 v4, s[16:19], s31 offen offset:2048 lds
v_mfma_f32_16x16x32_bf16 v[36:39], v[100:103], a[232:235], v[36:39]
ds_read_b64_tr_b16 v[88:89], v14 offset:0
v_mul_f32 v137, v137, v73
v_mfma_f32_16x16x32_bf16 v[44:47], v[92:95], a[204:207], v[44:47]
v_mul_f32 v138, v138, v74
v_mul_f32 v139, v139, v75
v_mfma_f32_16x16x32_bf16 v[44:47], v[96:99], a[220:223], v[44:47]
ds_read_b64_tr_b16 v[90:91], v14 offset:512
v_mfma_f32_16x16x32_bf16 v[44:47], v[100:103], a[236:239], v[44:47]
v_mul_f32 v136, v136, v168
v_mul_f32 v137, v137, v169
s_waitcnt vmcnt(9)
s_barrier
s_waitcnt lgkmcnt(9)
v_mfma_f32_16x16x32_bf16 v[16:19], v[104:107], a[240:243], v[16:19]
ds_read_b64_tr_b16 v[92:93], v14 offset:4096
v_mul_f32 v138, v138, v170
s_waitcnt lgkmcnt(7)
v_mfma_f32_16x16x32_bf16 v[16:19], v[108:111], v[224:227], v[16:19]
s_add_u32 m0, s29, 49152
v_mul_f32 v139, v139, v171
s_waitcnt lgkmcnt(5)
v_mfma_f32_16x16x32_bf16 v[16:19], v[80:83], v[240:243], v[16:19]
ds_read_b64_tr_b16 v[94:95], v14 offset:4608
v_cvt_pk_bf16_f32 v188, v136, v137
v_mfma_f32_16x16x32_bf16 v[24:27], v[104:107], a[244:247], v[24:27]
s_add_u32 s31, s30, 3538944
v_cvt_pk_bf16_f32 v189, v138, v139
v_mfma_f32_16x16x32_bf16 v[24:27], v[108:111], v[228:231], v[24:27]
ds_read_b64_tr_b16 v[96:97], v5 offset:0
v_mfma_f32_16x16x32_bf16 v[24:27], v[80:83], v[244:247], v[24:27]
v_rcp_f32 v172, v172
v_mfma_f32_16x16x32_bf16 v[32:35], v[104:107], a[248:251], v[32:35]
ds_read_b64_tr_b16 v[98:99], v5 offset:512
v_mfma_f32_16x16x32_bf16 v[32:35], v[108:111], v[232:235], v[32:35]
buffer_load_dwordx4 v2, s[16:19], s31 offen offset:0 lds
v_rcp_f32 v173, v173
v_mfma_f32_16x16x32_bf16 v[32:35], v[80:83], v[248:251], v[32:35]
ds_read_b64_tr_b16 v[100:101], v5 offset:4096
v_mfma_f32_16x16x32_bf16 v[40:43], v[104:107], a[252:255], v[40:43]
v_rcp_f32 v174, v174
v_mfma_f32_16x16x32_bf16 v[40:43], v[108:111], v[236:239], v[40:43]
ds_read_b64_tr_b16 v[102:103], v5 offset:4608
v_mfma_f32_16x16x32_bf16 v[40:43], v[80:83], v[252:255], v[40:43]
v_rcp_f32 v175, v175
s_waitcnt lgkmcnt(8)
v_mfma_f32_16x16x32_bf16 v[20:23], v[84:87], a[240:243], v[20:23]
ds_read_b64_tr_b16 v[104:105], v5 offset:8192
v_mul_f32 v140, v140, v76
s_waitcnt lgkmcnt(7)
v_mfma_f32_16x16x32_bf16 v[20:23], v[88:91], v[224:227], v[20:23]
buffer_load_dwordx4 v3, s[16:19], s31 offen offset:1024 lds
s_waitcnt lgkmcnt(5)
v_mfma_f32_16x16x32_bf16 v[20:23], v[92:95], v[240:243], v[20:23]
ds_read_b64_tr_b16 v[106:107], v5 offset:8704
v_mul_f32 v141, v141, v77
v_mfma_f32_16x16x32_bf16 v[28:31], v[84:87], a[244:247], v[28:31]
v_mul_f32 v142, v142, v78
v_mul_f32 v143, v143, v79
v_mfma_f32_16x16x32_bf16 v[28:31], v[88:91], v[228:231], v[28:31]
ds_read_b64_tr_b16 v[108:109], v13 offset:0
v_mfma_f32_16x16x32_bf16 v[28:31], v[92:95], v[244:247], v[28:31]
v_mul_f32 v140, v140, v172
v_mul_f32 v141, v141, v173
v_mfma_f32_16x16x32_bf16 v[36:39], v[84:87], a[248:251], v[36:39]
ds_read_b64_tr_b16 v[110:111], v13 offset:512
v_mul_f32 v142, v142, v174
v_mfma_f32_16x16x32_bf16 v[36:39], v[88:91], v[232:235], v[36:39]
buffer_load_dwordx4 v4, s[16:19], s31 offen offset:2048 lds
v_mfma_f32_16x16x32_bf16 v[36:39], v[92:95], v[248:251], v[36:39]
ds_read_b64_tr_b16 v[80:81], v13 offset:4096
v_mul_f32 v143, v143, v175
v_mfma_f32_16x16x32_bf16 v[44:47], v[84:87], a[252:255], v[44:47]
v_cvt_pk_bf16_f32 v190, v140, v141
v_cvt_pk_bf16_f32 v191, v142, v143
v_mfma_f32_16x16x32_bf16 v[44:47], v[88:91], v[236:239], v[44:47]
ds_read_b64_tr_b16 v[82:83], v13 offset:4608
v_mfma_f32_16x16x32_bf16 v[44:47], v[92:95], v[252:255], v[44:47]
ds_write_b128 v7, v[188:191] offset:30720
v_add_u32 v7, 2048, v7
s_waitcnt vmcnt(9)
s_barrier
s_sub_u32 s32, s32, 1
s_cmp_lg_u32 s32, 0
s_cbranch_scc1 K2_loop
s_cmp_ge_u32 s27, 12
s_cbranch_scc1 K2_ffn4
K2_tail320:
s_waitcnt lgkmcnt(9)
v_mfma_f32_16x16x32_bf16 v[48:51], v[96:99], a[0:3], 0
ds_read_b64_tr_b16 v[84:85], v13 offset:8192
s_waitcnt lgkmcnt(8)
v_mfma_f32_16x16x32_bf16 v[48:51], v[100:103], a[16:19], v[48:51]
s_add_u32 m0, s29, 61440
s_waitcnt lgkmcnt(6)
v_mfma_f32_16x16x32_bf16 v[48:51], v[104:107], a[32:35], v[48:51]
ds_read_b64_tr_b16 v[86:87], v13 offset:8704
v_mfma_f32_16x16x32_bf16 v[56:59], v[96:99], a[4:7], 0
s_add_u32 s31, s30, 4423680
v_mfma_f32_16x16x32_bf16 v[56:59], v[100:103], a[20:23], v[56:59]
ds_read_b64_tr_b16 v[88:89], v5 offset:12288
v_mfma_f32_16x16x32_bf16 v[56:59], v[104:107], a[36:39], v[56:59]
v_mul_f32 v112, s33, v16
v_mul_f32 v113, s33, v17
v_mfma_f32_16x16x32_bf16 v[64:67], v[96:99], a[8:11], 0
ds_read_b64_tr_b16 v[90:91], v5 offset:12800
v_mfma_f32_16x16x32_bf16 v[64:67], v[100:103], a[24:27], v[64:67]
buffer_load_dwordx4 v2, s[16:19], s31 offen offset:0 lds
v_mul_f32 v114, s33, v18
v_mfma_f32_16x16x32_bf16 v[64:67], v[104:107], a[40:43], v[64:67]
ds_read_b64_tr_b16 v[92:93], v5 offset:16384
v_mfma_f32_16x16x32_bf16 v[72:75], v[96:99], a[12:15], 0
v_mul_f32 v115, s33, v19
v_mfma_f32_16x16x32_bf16 v[72:75], v[100:103], a[28:31], v[72:75]
ds_read_b64_tr_b16 v[94:95], v5 offset:16896
v_exp_f32 v144, v112
v_mfma_f32_16x16x32_bf16 v[72:75], v[104:107], a[44:47], v[72:75]
s_waitcnt lgkmcnt(9)
v_mfma_f32_16x16x32_bf16 v[52:55], v[108:111], a[0:3], 0
ds_read_b64_tr_b16 v[96:97], v5 offset:20480
v_exp_f32 v145, v113
s_waitcnt lgkmcnt(8)
v_mfma_f32_16x16x32_bf16 v[52:55], v[80:83], a[16:19], v[52:55]
buffer_load_dwordx4 v3, s[16:19], s31 offen offset:1024 lds
s_waitcnt lgkmcnt(5)
v_mfma_f32_16x16x32_bf16 v[52:55], v[84:87], a[32:35], v[52:55]
ds_read_b64_tr_b16 v[98:99], v5 offset:20992
v_mfma_f32_16x16x32_bf16 v[60:63], v[108:111], a[4:7], 0
v_exp_f32 v146, v114
v_mfma_f32_16x16x32_bf16 v[60:63], v[80:83], a[20:23], v[60:63]
ds_read_b64_tr_b16 v[100:101], v13 offset:12288
v_mfma_f32_16x16x32_bf16 v[60:63], v[84:87], a[36:39], v[60:63]
v_exp_f32 v147, v115
v_mfma_f32_16x16x32_bf16 v[68:71], v[108:111], a[8:11], 0
ds_read_b64_tr_b16 v[102:103], v13 offset:12800
v_mfma_f32_16x16x32_bf16 v[68:71], v[80:83], a[24:27], v[68:71]
buffer_load_dwordx4 v4, s[16:19], s31 offen offset:2048 lds
v_mfma_f32_16x16x32_bf16 v[68:71], v[84:87], a[40:43], v[68:71]
ds_read_b64_tr_b16 v[104:105], v13 offset:16384
v_fma_f32 v144, v144, s33, s33
v_mfma_f32_16x16x32_bf16 v[76:79], v[108:111], a[12:15], 0
v_fma_f32 v145, v145, s33, s33
v_mfma_f32_16x16x32_bf16 v[76:79], v[80:83], a[28:31], v[76:79]
ds_read_b64_tr_b16 v[106:107], v13 offset:16896
v_fma_f32 v146, v146, s33, s33
v_mfma_f32_16x16x32_bf16 v[76:79], v[84:87], a[44:47], v[76:79]
v_fma_f32 v147, v147, s33, s33
s_waitcnt vmcnt(9)
s_barrier
s_waitcnt lgkmcnt(8)
v_mfma_f32_16x16x32_bf16 v[48:51], v[88:91], a[48:51], v[48:51]
ds_read_b64_tr_b16 v[108:109], v13 offset:20480
v_mul_f32 v116, s33, v20
s_waitcnt lgkmcnt(7)
v_mfma_f32_16x16x32_bf16 v[48:51], v[92:95], a[64:67], v[48:51]
s_add_u32 m0, s34, 0
s_add_u32 s31, s35, 0
v_mul_f32 v117, s33, v21
s_waitcnt lgkmcnt(5)
v_mfma_f32_16x16x32_bf16 v[48:51], v[96:99], a[80:83], v[48:51]
ds_read_b64_tr_b16 v[110:111], v13 offset:20992
v_mfma_f32_16x16x32_bf16 v[56:59], v[88:91], a[52:55], v[56:59]
buffer_load_dwordx4 v10, s[20:23], s31 offen lds
v_mul_f32 v118, s33, v22
v_mfma_f32_16x16x32_bf16 v[56:59], v[92:95], a[68:71], v[56:59]
ds_read_b64_tr_b16 v[80:81], v5 offset:24576
v_mfma_f32_16x16x32_bf16 v[56:59], v[96:99], a[84:87], v[56:59]
v_mul_f32 v119, s33, v23
v_exp_f32 v148, v116
v_mfma_f32_16x16x32_bf16 v[64:67], v[88:91], a[56:59], v[64:67]
ds_read_b64_tr_b16 v[82:83], v5 offset:25088
v_mfma_f32_16x16x32_bf16 v[64:67], v[92:95], a[72:75], v[64:67]
v_exp_f32 v149, v117
v_mfma_f32_16x16x32_bf16 v[64:67], v[96:99], a[88:91], v[64:67]
ds_read_b64_tr_b16 v[84:85], v5 offset:28672
v_mfma_f32_16x16x32_bf16 v[72:75], v[88:91], a[60:63], v[72:75]
s_add_u32 m0, s34, 4096
s_add_u32 s31, s35, 36864
v_mfma_f32_16x16x32_bf16 v[72:75], v[92:95], a[76:79], v[72:75]
ds_read_b64_tr_b16 v[86:87], v5 offset:29184
v_exp_f32 v150, v118
v_mfma_f32_16x16x32_bf16 v[72:75], v[96:99], a[92:95], v[72:75]
buffer_load_dwordx4 v10, s[20:23], s31 offen lds
s_waitcnt lgkmcnt(8)
v_mfma_f32_16x16x32_bf16 v[52:55], v[100:103], a[48:51], v[52:55]
ds_read_b64_tr_b16 v[88:89], v5 offset:32768
s_waitcnt lgkmcnt(7)
v_mfma_f32_16x16x32_bf16 v[52:55], v[104:107], a[64:67], v[52:55]
v_exp_f32 v151, v119
s_waitcnt lgkmcnt(5)
v_mfma_f32_16x16x32_bf16 v[52:55], v[108:111], a[80:83], v[52:55]
ds_read_b64_tr_b16 v[90:91], v5 offset:33280
v_fma_f32 v148, v148, s33, s33
v_mfma_f32_16x16x32_bf16 v[60:63], v[100:103], a[52:55], v[60:63]
v_fma_f32 v149, v149, s33, s33
v_fma_f32 v150, v150, s33, s33
v_mfma_f32_16x16x32_bf16 v[60:63], v[104:107], a[68:71], v[60:63]
ds_read_b64_tr_b16 v[92:93], v13 offset:24576
v_mfma_f32_16x16x32_bf16 v[60:63], v[108:111], a[84:87], v[60:63]
s_add_u32 m0, s34, 8192
s_add_u32 s31, s35, 73728
v_fma_f32 v151, v151, s33, s33
v_mfma_f32_16x16x32_bf16 v[68:71], v[100:103], a[56:59], v[68:71]
ds_read_b64_tr_b16 v[94:95], v13 offset:25088
v_mul_f32 v120, s33, v24
v_mfma_f32_16x16x32_bf16 v[68:71], v[104:107], a[72:75], v[68:71]
buffer_load_dwordx4 v10, s[20:23], s31 offen lds
v_mul_f32 v121, s33, v25
v_mfma_f32_16x16x32_bf16 v[68:71], v[108:111], a[88:91], v[68:71]
ds_read_b64_tr_b16 v[96:97], v13 offset:28672
v_mfma_f32_16x16x32_bf16 v[76:79], v[100:103], a[60:63], v[76:79]
v_mul_f32 v122, s33, v26
v_mul_f32 v123, s33, v27
v_mfma_f32_16x16x32_bf16 v[76:79], v[104:107], a[76:79], v[76:79]
ds_read_b64_tr_b16 v[98:99], v13 offset:29184
v_mfma_f32_16x16x32_bf16 v[76:79], v[108:111], a[92:95], v[76:79]
v_exp_f32 v152, v120
s_waitcnt vmcnt(9)
s_barrier
s_waitcnt lgkmcnt(8)
v_mfma_f32_16x16x32_bf16 v[48:51], v[80:83], a[96:99], v[48:51]
ds_read_b64_tr_b16 v[100:101], v13 offset:32768
s_waitcnt lgkmcnt(7)
v_mfma_f32_16x16x32_bf16 v[48:51], v[84:87], a[112:115], v[48:51]
s_add_u32 m0, s34, 12288
s_add_u32 s31, s35, 110592
v_exp_f32 v153, v121
s_waitcnt lgkmcnt(5)
v_mfma_f32_16x16x32_bf16 v[48:51], v[88:91], a[128:131], v[48:51]
ds_read_b64_tr_b16 v[102:103], v13 offset:33280
v_mfma_f32_16x16x32_bf16 v[56:59], v[80:83], a[100:103], v[56:59]
buffer_load_dwordx4 v10, s[20:23], s31 offen lds
v_exp_f32 v154, v122
v_mfma_f32_16x16x32_bf16 v[56:59], v[84:87], a[116:119], v[56:59]
ds_read_b64_tr_b16 v[104:105], v5 offset:36864
v_mfma_f32_16x16x32_bf16 v[56:59], v[88:91], a[132:135], v[56:59]
v_exp_f32 v155, v123
v_mfma_f32_16x16x32_bf16 v[64:67], v[80:83], a[104:107], v[64:67]
ds_read_b64_tr_b16 v[106:107], v5 offset:37376
v_mfma_f32_16x16x32_bf16 v[64:67], v[84:87], a[120:123], v[64:67]
v_fma_f32 v152, v152, s33, s33
v_fma_f32 v153, v153, s33, s33
v_mfma_f32_16x16x32_bf16 v[64:67], v[88:91], a[136:139], v[64:67]
ds_read_b64_tr_b16 v[108:109], v5 offset:40960
v_fma_f32 v154, v154, s33, s33
v_mfma_f32_16x16x32_bf16 v[72:75], v[80:83], a[108:111], v[72:75]
s_add_u32 m0, s34, 16384
s_add_u32 s31, s35, 147456
v_fma_f32 v155, v155, s33, s33
v_mfma_f32_16x16x32_bf16 v[72:75], v[84:87], a[124:127], v[72:75]
ds_read_b64_tr_b16 v[110:111], v5 offset:41472
v_mul_f32 v124, s33, v28
v_mfma_f32_16x16x32_bf16 v[72:75], v[88:91], a[140:143], v[72:75]
buffer_load_dwordx4 v10, s[20:23], s31 offen lds
s_waitcnt lgkmcnt(8)
v_mfma_f32_16x16x32_bf16 v[52:55], v[92:95], a[96:99], v[52:55]
ds_read_b64_tr_b16 v[80:81], v5 offset:45056
v_mul_f32 v125, s33, v29
s_waitcnt lgkmcnt(7)
v_mfma_f32_16x16x32_bf16 v[52:55], v[96:99], a[112:115], v[52:55]
v_mul_f32 v126, s33, v30
v_mul_f32 v127, s33, v31
s_waitcnt lgkmcnt(5)
v_mfma_f32_16x16x32_bf16 v[52:55], v[100:103], a[128:131], v[52:55]
ds_read_b64_tr_b16 v[82:83], v5 offset:45568
v_mfma_f32_16x16x32_bf16 v[60:63], v[92:95], a[100:103], v[60:63]
v_exp_f32 v156, v124
v_mfma_f32_16x16x32_bf16 v[60:63], v[96:99], a[116:119], v[60:63]
ds_read_b64_tr_b16 v[84:85], v13 offset:36864
v_mfma_f32_16x16x32_bf16 v[60:63], v[100:103], a[132:135], v[60:63]
s_add_u32 m0, s34, 20480
s_add_u32 s31, s35, 184320
v_exp_f32 v157, v125
v_mfma_f32_16x16x32_bf16 v[68:71], v[92:95], a[104:107], v[68:71]
ds_read_b64_tr_b16 v[86:87], v13 offset:37376
v_mfma_f32_16x16x32_bf16 v[68:71], v[96:99], a[120:123], v[68:71]
buffer_load_dwordx4 v10, s[20:23], s31 offen lds
v_exp_f32 v158, v126
v_mfma_f32_16x16x32_bf16 v[68:71], v[100:103], a[136:139], v[68:71]
ds_read_b64_tr_b16 v[88:89], v13 offset:40960
v_mfma_f32_16x16x32_bf16 v[76:79], v[92:95], a[108:111], v[76:79]
v_exp_f32 v159, v127
v_mfma_f32_16x16x32_bf16 v[76:79], v[96:99], a[124:127], v[76:79]
ds_read_b64_tr_b16 v[90:91], v13 offset:41472
v_mfma_f32_16x16x32_bf16 v[76:79], v[100:103], a[140:143], v[76:79]
v_fma_f32 v156, v156, s33, s33
v_fma_f32 v157, v157, s33, s33
s_waitcnt vmcnt(9)
s_barrier
s_waitcnt lgkmcnt(8)
v_mfma_f32_16x16x32_bf16 v[48:51], v[104:107], a[144:147], v[48:51]
ds_read_b64_tr_b16 v[92:93], v13 offset:45056
v_fma_f32 v158, v158, s33, s33
s_waitcnt lgkmcnt(7)
v_mfma_f32_16x16x32_bf16 v[48:51], v[108:111], a[160:163], v[48:51]
s_add_u32 m0, s34, 24576
s_add_u32 s31, s35, 221184
v_fma_f32 v159, v159, s33, s33
s_waitcnt lgkmcnt(5)
v_mfma_f32_16x16x32_bf16 v[48:51], v[80:83], a[176:179], v[48:51]
ds_read_b64_tr_b16 v[94:95], v13 offset:45568
v_mfma_f32_16x16x32_bf16 v[56:59], v[104:107], a[148:151], v[56:59]
buffer_load_dwordx4 v10, s[20:23], s31 offen lds
v_mul_f32 v128, s33, v32
v_mfma_f32_16x16x32_bf16 v[56:59], v[108:111], a[164:167], v[56:59]
ds_read_b64_tr_b16 v[96:97], v5 offset:49152
v_mfma_f32_16x16x32_bf16 v[56:59], v[80:83], a[180:183], v[56:59]
v_mul_f32 v129, s33, v33
v_mul_f32 v130, s33, v34
v_mfma_f32_16x16x32_bf16 v[64:67], v[104:107], a[152:155], v[64:67]
ds_read_b64_tr_b16 v[98:99], v5 offset:49664
v_mfma_f32_16x16x32_bf16 v[64:67], v[108:111], a[168:171], v[64:67]
v_mul_f32 v131, s33, v35
v_exp_f32 v160, v128
v_mfma_f32_16x16x32_bf16 v[64:67], v[80:83], a[184:187], v[64:67]
ds_read_b64_tr_b16 v[100:101], v5 offset:53248
v_mfma_f32_16x16x32_bf16 v[72:75], v[104:107], a[156:159], v[72:75]
s_add_u32 m0, s34, 28672
s_add_u32 s31, s35, 258048
v_mfma_f32_16x16x32_bf16 v[72:75], v[108:111], a[172:175], v[72:75]
ds_read_b64_tr_b16 v[102:103], v5 offset:53760
v_exp_f32 v161, v129
v_mfma_f32_16x16x32_bf16 v[72:75], v[80:83], a[188:191], v[72:75]
buffer_load_dwordx4 v10, s[20:23], s31 offen lds
s_waitcnt lgkmcnt(8)
v_mfma_f32_16x16x32_bf16 v[52:55], v[84:87], a[144:147], v[52:55]
ds_read_b64_tr_b16 v[104:105], v5 offset:57344
s_waitcnt lgkmcnt(7)
v_mfma_f32_16x16x32_bf16 v[52:55], v[88:91], a[160:163], v[52:55]
v_exp_f32 v162, v130
s_waitcnt lgkmcnt(5)
v_mfma_f32_16x16x32_bf16 v[52:55], v[92:95], a[176:179], v[52:55]
ds_read_b64_tr_b16 v[106:107], v5 offset:57856
v_mfma_f32_16x16x32_bf16 v[60:63], v[84:87], a[148:151], v[60:63]
v_exp_f32 v163, v131
v_mfma_f32_16x16x32_bf16 v[60:63], v[88:91], a[164:167], v[60:63]
ds_read_b64_tr_b16 v[108:109], v13 offset:49152
v_fma_f32 v160, v160, s33, s33
v_mfma_f32_16x16x32_bf16 v[60:63], v[92:95], a[180:183], v[60:63]
s_add_u32 m0, s34, 32768
s_add_u32 s31, s35, 294912
v_fma_f32 v161, v161, s33, s33
v_mfma_f32_16x16x32_bf16 v[68:71], v[84:87], a[152:155], v[68:71]
ds_read_b64_tr_b16 v[110:111], v13 offset:49664
v_mfma_f32_16x16x32_bf16 v[68:71], v[88:91], a[168:171], v[68:71]
buffer_load_dwordx4 v10, s[20:23], s31 offen lds
v_fma_f32 v162, v162, s33, s33
v_mfma_f32_16x16x32_bf16 v[68:71], v[92:95], a[184:187], v[68:71]
ds_read_b64_tr_b16 v[80:81], v13 offset:53248
v_mfma_f32_16x16x32_bf16 v[76:79], v[84:87], a[156:159], v[76:79]
v_fma_f32 v163, v163, s33, s33
v_mul_f32 v132, s33, v36
v_mfma_f32_16x16x32_bf16 v[76:79], v[88:91], a[172:175], v[76:79]
ds_read_b64_tr_b16 v[82:83], v13 offset:53760
v_mfma_f32_16x16x32_bf16 v[76:79], v[92:95], a[188:191], v[76:79]
v_mul_f32 v133, s33, v37
v_mul_f32 v134, s33, v38
s_waitcnt vmcnt(9)
s_barrier
s_waitcnt lgkmcnt(8)
v_mfma_f32_16x16x32_bf16 v[48:51], v[96:99], a[192:195], v[48:51]
ds_read_b64_tr_b16 v[84:85], v13 offset:57344
v_mul_f32 v135, s33, v39
s_waitcnt lgkmcnt(7)
v_mfma_f32_16x16x32_bf16 v[48:51], v[100:103], a[208:211], v[48:51]
s_add_u32 m0, s34, 36864
s_add_u32 s31, s35, 331776
s_waitcnt lgkmcnt(5)
v_mfma_f32_16x16x32_bf16 v[48:51], v[104:107], a[224:227], v[48:51]
ds_read_b64_tr_b16 v[86:87], v13 offset:57856
v_exp_f32 v164, v132
v_mfma_f32_16x16x32_bf16 v[56:59], v[96:99], a[196:199], v[56:59]
buffer_load_dwordx4 v10, s[20:23], s31 offen lds
v_mfma_f32_16x16x32_bf16 v[56:59], v[100:103], a[212:215], v[56:59]
ds_read_b64_tr_b16 v[88:89], v5 offset:61440
v_exp_f32 v165, v133
v_mfma_f32_16x16x32_bf16 v[56:59], v[104:107], a[228:231], v[56:59]
v_mfma_f32_16x16x32_bf16 v[64:67], v[96:99], a[200:203], v[64:67]
ds_read_b64_tr_b16 v[90:91], v5 offset:61952
v_exp_f32 v166, v134
v_mfma_f32_16x16x32_bf16 v[64:67], v[100:103], a[216:219], v[64:67]
v_exp_f32 v167, v135
v_mfma_f32_16x16x32_bf16 v[64:67], v[104:107], a[232:235], v[64:67]
ds_read_b64_tr_b16 v[92:93], v6 offset:0
v_mfma_f32_16x16x32_bf16 v[72:75], v[96:99], a[204:207], v[72:75]
s_add_u32 m0, s34, 40960
s_add_u32 s31, s35, 128
v_fma_f32 v164, v164, s33, s33
v_mfma_f32_16x16x32_bf16 v[72:75], v[100:103], a[220:223], v[72:75]
ds_read_b64_tr_b16 v[94:95], v6 offset:512
v_fma_f32 v165, v165, s33, s33
v_mfma_f32_16x16x32_bf16 v[72:75], v[104:107], a[236:239], v[72:75]
buffer_load_dwordx4 v10, s[20:23], s31 offen lds
v_fma_f32 v166, v166, s33, s33
s_waitcnt lgkmcnt(8)
v_mfma_f32_16x16x32_bf16 v[52:55], v[108:111], a[192:195], v[52:55]
ds_read_b64_tr_b16 v[96:97], v6 offset:4096
s_waitcnt lgkmcnt(7)
v_mfma_f32_16x16x32_bf16 v[52:55], v[80:83], a[208:211], v[52:55]
v_fma_f32 v167, v167, s33, s33
v_mul_f32 v136, s33, v40
s_waitcnt lgkmcnt(5)
v_mfma_f32_16x16x32_bf16 v[52:55], v[84:87], a[224:227], v[52:55]
ds_read_b64_tr_b16 v[98:99], v6 offset:4608
v_mul_f32 v137, s33, v41
v_mfma_f32_16x16x32_bf16 v[60:63], v[108:111], a[196:199], v[60:63]
v_mul_f32 v138, s33, v42
v_mul_f32 v139, s33, v43
v_mfma_f32_16x16x32_bf16 v[60:63], v[80:83], a[212:215], v[60:63]
ds_read_b64_tr_b16 v[100:101], v13 offset:61440
v_mfma_f32_16x16x32_bf16 v[60:63], v[84:87], a[228:231], v[60:63]
s_add_u32 m0, s34, 45056
s_add_u32 s31, s35, 36992
v_exp_f32 v168, v136
v_mfma_f32_16x16x32_bf16 v[68:71], v[108:111], a[200:203], v[68:71]
ds_read_b64_tr_b16 v[102:103], v13 offset:61952
v_mfma_f32_16x16x32_bf16 v[68:71], v[80:83], a[216:219], v[68:71]
buffer_load_dwordx4 v10, s[20:23], s31 offen lds
v_exp_f32 v169, v137
v_mfma_f32_16x16x32_bf16 v[68:71], v[84:87], a[232:235], v[68:71]
ds_read_b64_tr_b16 v[104:105], v14 offset:0
v_mfma_f32_16x16x32_bf16 v[76:79], v[108:111], a[204:207], v[76:79]
v_exp_f32 v170, v138
v_mfma_f32_16x16x32_bf16 v[76:79], v[80:83], a[220:223], v[76:79]
ds_read_b64_tr_b16 v[106:107], v14 offset:512
v_mfma_f32_16x16x32_bf16 v[76:79], v[84:87], a[236:239], v[76:79]
v_exp_f32 v171, v139
s_waitcnt vmcnt(9)
s_barrier
s_waitcnt lgkmcnt(8)
v_mfma_f32_16x16x32_bf16 v[48:51], v[88:91], a[240:243], v[48:51]
ds_read_b64_tr_b16 v[108:109], v14 offset:4096
v_fma_f32 v168, v168, s33, s33
s_waitcnt lgkmcnt(7)
v_mfma_f32_16x16x32_bf16 v[48:51], v[92:95], v[224:227], v[48:51]
s_add_u32 m0, s34, 49152
s_add_u32 s31, s35, 73856
s_waitcnt lgkmcnt(5)
v_mfma_f32_16x16x32_bf16 v[48:51], v[96:99], v[240:243], v[48:51]
ds_read_b64_tr_b16 v[110:111], v14 offset:4608
v_fma_f32 v169, v169, s33, s33
v_mfma_f32_16x16x32_bf16 v[56:59], v[88:91], a[244:247], v[56:59]
buffer_load_dwordx4 v10, s[20:23], s31 offen lds
v_fma_f32 v170, v170, s33, s33
v_mfma_f32_16x16x32_bf16 v[56:59], v[92:95], v[228:231], v[56:59]
ds_read_b64_tr_b16 v[80:81], v8 offset:0
v_mfma_f32_16x16x32_bf16 v[56:59], v[96:99], v[244:247], v[56:59]
v_fma_f32 v171, v171, s33, s33
v_mul_f32 v140, s33, v44
v_mfma_f32_16x16x32_bf16 v[64:67], v[88:91], a[248:251], v[64:67]
ds_read_b64_tr_b16 v[82:83], v8 offset:2048
v_mfma_f32_16x16x32_bf16 v[64:67], v[92:95], v[232:235], v[64:67]
v_mul_f32 v141, s33, v45
v_mul_f32 v142, s33, v46
v_mfma_f32_16x16x32_bf16 v[64:67], v[96:99], v[248:251], v[64:67]
ds_read_b64_tr_b16 v[84:85], v8 offset:4096
v_mfma_f32_16x16x32_bf16 v[72:75], v[88:91], a[252:255], v[72:75]
s_add_u32 m0, s34, 53248
s_add_u32 s31, s35, 110720
v_mul_f32 v143, s33, v47
v_mfma_f32_16x16x32_bf16 v[72:75], v[92:95], v[236:239], v[72:75]
ds_read_b64_tr_b16 v[86:87], v8 offset:6144
v_mfma_f32_16x16x32_bf16 v[72:75], v[96:99], v[252:255], v[72:75]
buffer_load_dwordx4 v10, s[20:23], s31 offen lds
v_exp_f32 v172, v140
s_waitcnt lgkmcnt(8)
v_mfma_f32_16x16x32_bf16 v[52:55], v[100:103], a[240:243], v[52:55]
ds_read_b64_tr_b16 v[88:89], v8 offset:8192
s_waitcnt lgkmcnt(7)
v_mfma_f32_16x16x32_bf16 v[52:55], v[104:107], v[224:227], v[52:55]
v_exp_f32 v173, v141
s_waitcnt lgkmcnt(5)
v_mfma_f32_16x16x32_bf16 v[52:55], v[108:111], v[240:243], v[52:55]
ds_read_b64_tr_b16 v[90:91], v8 offset:10240
v_mfma_f32_16x16x32_bf16 v[60:63], v[100:103], a[244:247], v[60:63]
v_exp_f32 v174, v142
v_mfma_f32_16x16x32_bf16 v[60:63], v[104:107], v[228:231], v[60:63]
ds_read_b64_tr_b16 v[92:93], v9 offset:0
v_mfma_f32_16x16x32_bf16 v[60:63], v[108:111], v[244:247], v[60:63]
s_add_u32 m0, s34, 57344
s_add_u32 s31, s35, 147584
v_mfma_f32_16x16x32_bf16 v[68:71], v[100:103], a[248:251], v[68:71]
ds_read_b64_tr_b16 v[94:95], v9 offset:2048
v_exp_f32 v175, v143
v_mfma_f32_16x16x32_bf16 v[68:71], v[104:107], v[232:235], v[68:71]
buffer_load_dwordx4 v10, s[20:23], s31 offen lds
v_mfma_f32_16x16x32_bf16 v[68:71], v[108:111], v[248:251], v[68:71]
ds_read_b64_tr_b16 v[96:97], v9 offset:4096
v_mfma_f32_16x16x32_bf16 v[76:79], v[100:103], a[252:255], v[76:79]
v_fma_f32 v172, v172, s33, s33
v_fma_f32 v173, v173, s33, s33
v_mfma_f32_16x16x32_bf16 v[76:79], v[104:107], v[236:239], v[76:79]
ds_read_b64_tr_b16 v[98:99], v9 offset:6144
v_mfma_f32_16x16x32_bf16 v[76:79], v[108:111], v[252:255], v[76:79]
v_fma_f32 v174, v174, s33, s33
v_fma_f32 v175, v175, s33, s33
s_nop 7
v_rcp_f32 v144, v144
v_rcp_f32 v145, v145
v_rcp_f32 v146, v146
v_rcp_f32 v147, v147
v_mul_f32 v112, v112, v48
v_mul_f32 v113, v113, v49
v_mul_f32 v114, v114, v50
v_mul_f32 v115, v115, v51
v_mul_f32 v112, v112, v144
v_mul_f32 v113, v113, v145
v_mul_f32 v114, v114, v146
v_mul_f32 v115, v115, v147
v_cvt_pk_bf16_f32 v176, v112, v113
v_cvt_pk_bf16_f32 v177, v114, v115
v_rcp_f32 v148, v148
v_rcp_f32 v149, v149
v_rcp_f32 v150, v150
v_rcp_f32 v151, v151
v_mul_f32 v116, v116, v52
v_mul_f32 v117, v117, v53
v_mul_f32 v118, v118, v54
v_mul_f32 v119, v119, v55
v_mul_f32 v116, v116, v148
v_mul_f32 v117, v117, v149
v_mul_f32 v118, v118, v150
v_mul_f32 v119, v119, v151
v_cvt_pk_bf16_f32 v178, v116, v117
v_cvt_pk_bf16_f32 v179, v118, v119
ds_write_b128 v7, v[176:179] offset:0
v_rcp_f32 v152, v152
v_rcp_f32 v153, v153
v_rcp_f32 v154, v154
v_rcp_f32 v155, v155
v_mul_f32 v120, v120, v56
v_mul_f32 v121, v121, v57
v_mul_f32 v122, v122, v58
v_mul_f32 v123, v123, v59
v_mul_f32 v120, v120, v152
v_mul_f32 v121, v121, v153
v_mul_f32 v122, v122, v154
v_mul_f32 v123, v123, v155
v_cvt_pk_bf16_f32 v180, v120, v121
v_cvt_pk_bf16_f32 v181, v122, v123
v_rcp_f32 v156, v156
v_rcp_f32 v157, v157
v_rcp_f32 v158, v158
v_rcp_f32 v159, v159
v_mul_f32 v124, v124, v60
v_mul_f32 v125, v125, v61
v_mul_f32 v126, v126, v62
v_mul_f32 v127, v127, v63
v_mul_f32 v124, v124, v156
v_mul_f32 v125, v125, v157
v_mul_f32 v126, v126, v158
v_mul_f32 v127, v127, v159
v_cvt_pk_bf16_f32 v182, v124, v125
v_cvt_pk_bf16_f32 v183, v126, v127
ds_write_b128 v7, v[180:183] offset:10240
v_rcp_f32 v160, v160
v_rcp_f32 v161, v161
v_rcp_f32 v162, v162
v_rcp_f32 v163, v163
v_mul_f32 v128, v128, v64
v_mul_f32 v129, v129, v65
v_mul_f32 v130, v130, v66
v_mul_f32 v131, v131, v67
v_mul_f32 v128, v128, v160
v_mul_f32 v129, v129, v161
v_mul_f32 v130, v130, v162
v_mul_f32 v131, v131, v163
v_cvt_pk_bf16_f32 v184, v128, v129
v_cvt_pk_bf16_f32 v185, v130, v131
v_rcp_f32 v164, v164
v_rcp_f32 v165, v165
v_rcp_f32 v166, v166
v_rcp_f32 v167, v167
v_mul_f32 v132, v132, v68
v_mul_f32 v133, v133, v69
v_mul_f32 v134, v134, v70
v_mul_f32 v135, v135, v71
v_mul_f32 v132, v132, v164
v_mul_f32 v133, v133, v165
v_mul_f32 v134, v134, v166
v_mul_f32 v135, v135, v167
v_cvt_pk_bf16_f32 v186, v132, v133
v_cvt_pk_bf16_f32 v187, v134, v135
ds_write_b128 v7, v[184:187] offset:20480
v_rcp_f32 v168, v168
v_rcp_f32 v169, v169
v_rcp_f32 v170, v170
v_rcp_f32 v171, v171
v_mul_f32 v136, v136, v72
v_mul_f32 v137, v137, v73
v_mul_f32 v138, v138, v74
v_mul_f32 v139, v139, v75
v_mul_f32 v136, v136, v168
v_mul_f32 v137, v137, v169
v_mul_f32 v138, v138, v170
v_mul_f32 v139, v139, v171
v_cvt_pk_bf16_f32 v188, v136, v137
v_cvt_pk_bf16_f32 v189, v138, v139
v_rcp_f32 v172, v172
v_rcp_f32 v173, v173
v_rcp_f32 v174, v174
v_rcp_f32 v175, v175
v_mul_f32 v140, v140, v76
v_mul_f32 v141, v141, v77
v_mul_f32 v142, v142, v78
v_mul_f32 v143, v143, v79
v_mul_f32 v140, v140, v172
v_mul_f32 v141, v141, v173
v_mul_f32 v142, v142, v174
v_mul_f32 v143, v143, v175
v_cvt_pk_bf16_f32 v190, v140, v141
v_cvt_pk_bf16_f32 v191, v142, v143
ds_write_b128 v7, v[188:191] offset:30720
s_waitcnt vmcnt(9)
s_waitcnt lgkmcnt(0)
s_barrier
s_mul_i32 s3, s25, 40960
s_add_u32 s3, s3, 73728
v_add_u32 v1, s3, v11
ds_read_b128 a[0:3], v1 offset:0
ds_read_b128 a[16:19], v1 offset:1024
ds_read_b128 a[32:35], v1 offset:2048
ds_read_b128 a[4:7], v1 offset:10240
ds_read_b128 a[20:23], v1 offset:11264
ds_read_b128 a[36:39], v1 offset:12288
ds_read_b128 a[8:11], v1 offset:20480
ds_read_b128 a[24:27], v1 offset:21504
ds_read_b128 a[40:43], v1 offset:22528
ds_read_b128 a[12:15], v1 offset:30720
ds_read_b128 a[28:31], v1 offset:31744
ds_read_b128 a[44:47], v1 offset:32768
ds_read_b128 a[48:51], v1 offset:3072
ds_read_b128 a[64:67], v1 offset:4096
ds_read_b128 a[80:83], v1 offset:5120
ds_read_b128 a[52:55], v1 offset:13312
ds_read_b128 a[68:71], v1 offset:14336
ds_read_b128 a[84:87], v1 offset:15360
ds_read_b128 a[56:59], v1 offset:23552
ds_read_b128 a[72:75], v1 offset:24576
ds_read_b128 a[88:91], v1 offset:25600
ds_read_b128 a[60:63], v1 offset:33792
ds_read_b128 a[76:79], v1 offset:34816
ds_read_b128 a[92:95], v1 offset:35840
ds_read_b128 a[96:99], v1 offset:6144
ds_read_b128 a[112:115], v1 offset:7168
ds_read_b128 a[128:131], v1 offset:8192
ds_read_b128 a[100:103], v1 offset:16384
ds_read_b128 a[116:119], v1 offset:17408
ds_read_b128 a[132:135], v1 offset:18432
ds_read_b128 a[104:107], v1 offset:26624
ds_read_b128 a[120:123], v1 offset:27648
ds_read_b128 a[136:139], v1 offset:28672
ds_read_b128 a[108:111], v1 offset:36864
ds_read_b128 a[124:127], v1 offset:37888
ds_read_b128 a[140:143], v1 offset:38912
ds_read_b128 a[144:147], v1 offset:9216
ds_read_b128 a[148:151], v1 offset:19456
ds_read_b128 a[152:155], v1 offset:29696
ds_read_b128 a[156:159], v1 offset:39936
v_add_u32 v5, 0x10000, v8
v_add_u32 v6, 0x10000, v9
v_add_u32 v2, 0x20000, v8
v_add_u32 v3, 0x20000, v9
s_waitcnt lgkmcnt(15)
v_mfma_f32_16x16x32_bf16 v[16:19], v[80:83], a[0:3], 0
ds_read_b64_tr_b16 v[100:101], v9 offset:8192
s_waitcnt lgkmcnt(15)
v_mfma_f32_16x16x32_bf16 v[16:19], v[84:87], a[16:19], v[16:19]
s_add_u32 m0, s34, 61440
s_add_u32 s31, s35, 184448
s_waitcnt lgkmcnt(15)
v_mfma_f32_16x16x32_bf16 v[16:19], v[88:91], a[32:35], v[16:19]
ds_read_b64_tr_b16 v[102:103], v9 offset:10240
s_waitcnt lgkmcnt(15)
v_mfma_f32_16x16x32_bf16 v[24:27], v[80:83], a[4:7], 0
buffer_load_dwordx4 v10, s[20:23], s31 offen lds
s_waitcnt lgkmcnt(15)
v_mfma_f32_16x16x32_bf16 v[24:27], v[84:87], a[20:23], v[24:27]
ds_read_b64_tr_b16 v[104:105], v8 offset:12288
s_waitcnt lgkmcnt(15)
v_mfma_f32_16x16x32_bf16 v[24:27], v[88:91], a[36:39], v[24:27]
s_waitcnt lgkmcnt(15)
v_mfma_f32_16x16x32_bf16 v[32:35], v[80:83], a[8:11], 0
ds_read_b64_tr_b16 v[106:107], v8 offset:14336
s_waitcnt lgkmcnt(15)
v_mfma_f32_16x16x32_bf16 v[32:35], v[84:87], a[24:27], v[32:35]
s_waitcnt lgkmcnt(15)
v_mfma_f32_16x16x32_bf16 v[32:35], v[88:91], a[40:43], v[32:35]
ds_read_b64_tr_b16 v[108:109], v8 offset:16384
s_waitcnt lgkmcnt(15)
v_mfma_f32_16x16x32_bf16 v[40:43], v[80:83], a[12:15], 0
s_add_u32 m0, s34, 65536
s_add_u32 s31, s35, 221312
s_waitcnt lgkmcnt(15)
v_mfma_f32_16x16x32_bf16 v[40:43], v[84:87], a[28:31], v[40:43]
ds_read_b64_tr_b16 v[110:111], v8 offset:18432
s_waitcnt lgkmcnt(15)
v_mfma_f32_16x16x32_bf16 v[40:43], v[88:91], a[44:47], v[40:43]
buffer_load_dwordx4 v10, s[20:23], s31 offen lds
v_mfma_f32_16x16x32_bf16 v[20:23], v[92:95], a[0:3], 0
ds_read_b64_tr_b16 v[80:81], v8 offset:20480
v_mfma_f32_16x16x32_bf16 v[20:23], v[96:99], a[16:19], v[20:23]
s_waitcnt lgkmcnt(5)
v_mfma_f32_16x16x32_bf16 v[20:23], v[100:103], a[32:35], v[20:23]
ds_read_b64_tr_b16 v[82:83], v8 offset:22528
v_mfma_f32_16x16x32_bf16 v[28:31], v[92:95], a[4:7], 0
v_mfma_f32_16x16x32_bf16 v[28:31], v[96:99], a[20:23], v[28:31]
ds_read_b64_tr_b16 v[84:85], v9 offset:12288
v_mfma_f32_16x16x32_bf16 v[28:31], v[100:103], a[36:39], v[28:31]
s_add_u32 m0, s34, 69632
s_add_u32 s31, s35, 258176
v_mfma_f32_16x16x32_bf16 v[36:39], v[92:95], a[8:11], 0
ds_read_b64_tr_b16 v[86:87], v9 offset:14336
v_mfma_f32_16x16x32_bf16 v[36:39], v[96:99], a[24:27], v[36:39]
buffer_load_dwordx4 v10, s[20:23], s31 offen lds
v_mfma_f32_16x16x32_bf16 v[36:39], v[100:103], a[40:43], v[36:39]
ds_read_b64_tr_b16 v[88:89], v9 offset:16384
v_mfma_f32_16x16x32_bf16 v[44:47], v[92:95], a[12:15], 0
v_mfma_f32_16x16x32_bf16 v[44:47], v[96:99], a[28:31], v[44:47]
ds_read_b64_tr_b16 v[90:91], v9 offset:18432
v_mfma_f32_16x16x32_bf16 v[44:47], v[100:103], a[44:47], v[44:47]
s_waitcnt vmcnt(9)
s_barrier
s_waitcnt lgkmcnt(8)
v_mfma_f32_16x16x32_bf16 v[16:19], v[104:107], a[48:51], v[16:19]
ds_read_b64_tr_b16 v[92:93], v9 offset:20480
s_waitcnt lgkmcnt(7)
v_mfma_f32_16x16x32_bf16 v[16:19], v[108:111], a[64:67], v[16:19]
s_add_u32 m0, s34, 73728
s_add_u32 s31, s35, 295040
s_waitcnt lgkmcnt(5)
v_mfma_f32_16x16x32_bf16 v[16:19], v[80:83], a[80:83], v[16:19]
ds_read_b64_tr_b16 v[94:95], v9 offset:22528
v_mfma_f32_16x16x32_bf16 v[24:27], v[104:107], a[52:55], v[24:27]
buffer_load_dwordx4 v10, s[20:23], s31 offen lds
v_mfma_f32_16x16x32_bf16 v[24:27], v[108:111], a[68:71], v[24:27]
ds_read_b64_tr_b16 v[96:97], v8 offset:24576
v_mfma_f32_16x16x32_bf16 v[24:27], v[80:83], a[84:87], v[24:27]
s_add_u32 m0, s34, 77824
s_add_u32 s31, s35, 331904
v_mfma_f32_16x16x32_bf16 v[32:35], v[104:107], a[56:59], v[32:35]
ds_read_b64_tr_b16 v[98:99], v8 offset:26624
v_mfma_f32_16x16x32_bf16 v[32:35], v[108:111], a[72:75], v[32:35]
buffer_load_dwordx4 v10, s[20:23], s31 offen lds
v_mfma_f32_16x16x32_bf16 v[32:35], v[80:83], a[88:91], v[32:35]
ds_read_b64_tr_b16 v[100:101], v8 offset:28672
v_mfma_f32_16x16x32_bf16 v[40:43], v[104:107], a[60:63], v[40:43]
s_add_u32 m0, s34, 81920
s_add_u32 s31, s35, 256
v_mfma_f32_16x16x32_bf16 v[40:43], v[108:111], a[76:79], v[40:43]
ds_read_b64_tr_b16 v[102:103], v8 offset:30720
v_mfma_f32_16x16x32_bf16 v[40:43], v[80:83], a[92:95], v[40:43]
buffer_load_dwordx4 v10, s[20:23], s31 offen lds
s_waitcnt lgkmcnt(8)
v_mfma_f32_16x16x32_bf16 v[20:23], v[84:87], a[48:51], v[20:23]
ds_read_b64_tr_b16 v[104:105], v8 offset:32768
s_waitcnt lgkmcnt(7)
v_mfma_f32_16x16x32_bf16 v[20:23], v[88:91], a[64:67], v[20:23]
s_add_u32 m0, s34, 86016
s_add_u32 s31, s35, 37120
s_waitcnt lgkmcnt(5)
v_mfma_f32_16x16x32_bf16 v[20:23], v[92:95], a[80:83], v[20:23]
ds_read_b64_tr_b16 v[106:107], v8 offset:34816
v_mfma_f32_16x16x32_bf16 v[28:31], v[84:87], a[52:55], v[28:31]
buffer_load_dwordx4 v10, s[20:23], s31 offen lds
v_mfma_f32_16x16x32_bf16 v[28:31], v[88:91], a[68:71], v[28:31]
ds_read_b64_tr_b16 v[108:109], v9 offset:24576
v_mfma_f32_16x16x32_bf16 v[28:31], v[92:95], a[84:87], v[28:31]
s_add_u32 m0, s34, 90112
s_add_u32 s31, s35, 73984
v_mfma_f32_16x16x32_bf16 v[36:39], v[84:87], a[56:59], v[36:39]
ds_read_b64_tr_b16 v[110:111], v9 offset:26624
v_mfma_f32_16x16x32_bf16 v[36:39], v[88:91], a[72:75], v[36:39]
buffer_load_dwordx4 v10, s[20:23], s31 offen lds
v_mfma_f32_16x16x32_bf16 v[36:39], v[92:95], a[88:91], v[36:39]
ds_read_b64_tr_b16 v[80:81], v9 offset:28672
v_mfma_f32_16x16x32_bf16 v[44:47], v[84:87], a[60:63], v[44:47]
s_add_u32 m0, s34, 94208
s_add_u32 s31, s35, 110848
v_mfma_f32_16x16x32_bf16 v[44:47], v[88:91], a[76:79], v[44:47]
ds_read_b64_tr_b16 v[82:83], v9 offset:30720
v_mfma_f32_16x16x32_bf16 v[44:47], v[92:95], a[92:95], v[44:47]
buffer_load_dwordx4 v10, s[20:23], s31 offen lds
s_waitcnt vmcnt(12)
s_barrier
s_waitcnt lgkmcnt(8)
v_mfma_f32_16x16x32_bf16 v[16:19], v[96:99], a[96:99], v[16:19]
ds_read_b64_tr_b16 v[84:85], v9 offset:32768
s_waitcnt lgkmcnt(7)
v_mfma_f32_16x16x32_bf16 v[16:19], v[100:103], a[112:115], v[16:19]
s_add_u32 m0, s34, 98304
s_add_u32 s31, s35, 147712
s_waitcnt lgkmcnt(5)
v_mfma_f32_16x16x32_bf16 v[16:19], v[104:107], a[128:131], v[16:19]
ds_read_b64_tr_b16 v[86:87], v9 offset:34816
v_mfma_f32_16x16x32_bf16 v[24:27], v[96:99], a[100:103], v[24:27]
buffer_load_dwordx4 v10, s[20:23], s31 offen lds
v_mfma_f32_16x16x32_bf16 v[24:27], v[100:103], a[116:119], v[24:27]
ds_read_b64_tr_b16 v[88:89], v8 offset:36864
v_mfma_f32_16x16x32_bf16 v[24:27], v[104:107], a[132:135], v[24:27]
s_add_u32 m0, s34, 102400
s_add_u32 s31, s35, 184576
v_mfma_f32_16x16x32_bf16 v[32:35], v[96:99], a[104:107], v[32:35]
ds_read_b64_tr_b16 v[90:91], v8 offset:38912
v_mfma_f32_16x16x32_bf16 v[32:35], v[100:103], a[120:123], v[32:35]
buffer_load_dwordx4 v10, s[20:23], s31 offen lds
v_mfma_f32_16x16x32_bf16 v[32:35], v[104:107], a[136:139], v[32:35]
ds_read_b64_tr_b16 v[92:93], v8 offset:40960
v_mfma_f32_16x16x32_bf16 v[40:43], v[96:99], a[108:111], v[40:43]
s_add_u32 m0, s34, 106496
s_add_u32 s31, s35, 221440
v_mfma_f32_16x16x32_bf16 v[40:43], v[100:103], a[124:127], v[40:43]
ds_read_b64_tr_b16 v[94:95], v8 offset:43008
v_mfma_f32_16x16x32_bf16 v[40:43], v[104:107], a[140:143], v[40:43]
buffer_load_dwordx4 v10, s[20:23], s31 offen lds
s_waitcnt lgkmcnt(8)
v_mfma_f32_16x16x32_bf16 v[20:23], v[108:111], a[96:99], v[20:23]
ds_read_b64_tr_b16 v[96:97], v8 offset:45056
s_waitcnt lgkmcnt(7)
v_mfma_f32_16x16x32_bf16 v[20:23], v[80:83], a[112:115], v[20:23]
s_add_u32 m0, s34, 110592
s_add_u32 s31, s35, 258304
s_waitcnt lgkmcnt(5)
v_mfma_f32_16x16x32_bf16 v[20:23], v[84:87], a[128:131], v[20:23]
ds_read_b64_tr_b16 v[98:99], v8 offset:47104
v_mfma_f32_16x16x32_bf16 v[28:31], v[108:111], a[100:103], v[28:31]
buffer_load_dwordx4 v10, s[20:23], s31 offen lds
v_mfma_f32_16x16x32_bf16 v[28:31], v[80:83], a[116:119], v[28:31]
ds_read_b64_tr_b16 v[100:101], v9 offset:36864
v_mfma_f32_16x16x32_bf16 v[28:31], v[84:87], a[132:135], v[28:31]
s_add_u32 m0, s34, 114688
s_add_u32 s31, s35, 295168
v_mfma_f32_16x16x32_bf16 v[36:39], v[108:111], a[104:107], v[36:39]
ds_read_b64_tr_b16 v[102:103], v9 offset:38912
v_mfma_f32_16x16x32_bf16 v[36:39], v[80:83], a[120:123], v[36:39]
buffer_load_dwordx4 v10, s[20:23], s31 offen lds
v_mfma_f32_16x16x32_bf16 v[36:39], v[84:87], a[136:139], v[36:39]
ds_read_b64_tr_b16 v[104:105], v9 offset:40960
v_mfma_f32_16x16x32_bf16 v[44:47], v[108:111], a[108:111], v[44:47]
s_add_u32 m0, s34, 118784
s_add_u32 s31, s35, 332032
v_mfma_f32_16x16x32_bf16 v[44:47], v[80:83], a[124:127], v[44:47]
ds_read_b64_tr_b16 v[106:107], v9 offset:43008
v_mfma_f32_16x16x32_bf16 v[44:47], v[84:87], a[140:143], v[44:47]
buffer_load_dwordx4 v10, s[20:23], s31 offen lds
s_waitcnt vmcnt(15)
s_barrier
s_waitcnt lgkmcnt(8)
v_mfma_f32_16x16x32_bf16 v[16:19], v[88:91], a[144:147], v[16:19]
ds_read_b64_tr_b16 v[108:109], v9 offset:45056
s_waitcnt lgkmcnt(7)
v_mfma_f32_16x16x32_bf16 v[48:51], v[92:95], a[0:3], 0
s_add_u32 m0, s34, 122880
s_add_u32 s31, s35, 384
s_waitcnt lgkmcnt(5)
v_mfma_f32_16x16x32_bf16 v[48:51], v[96:99], a[16:19], v[48:51]
ds_read_b64_tr_b16 v[110:111], v9 offset:47104
v_mfma_f32_16x16x32_bf16 v[24:27], v[88:91], a[148:151], v[24:27]
buffer_load_dwordx4 v10, s[20:23], s31 offen lds
v_mfma_f32_16x16x32_bf16 v[56:59], v[92:95], a[4:7], 0
ds_read_b64_tr_b16 v[80:81], v8 offset:49152
v_mfma_f32_16x16x32_bf16 v[56:59], v[96:99], a[20:23], v[56:59]
s_add_u32 m0, s34, 126976
s_add_u32 s31, s35, 37248
v_mfma_f32_16x16x32_bf16 v[32:35], v[88:91], a[152:155], v[32:35]
ds_read_b64_tr_b16 v[82:83], v8 offset:51200
v_mfma_f32_16x16x32_bf16 v[64:67], v[92:95], a[8:11], 0
buffer_load_dwordx4 v10, s[20:23], s31 offen lds
v_mfma_f32_16x16x32_bf16 v[64:67], v[96:99], a[24:27], v[64:67]
ds_read_b64_tr_b16 v[84:85], v8 offset:53248
v_mfma_f32_16x16x32_bf16 v[40:43], v[88:91], a[156:159], v[40:43]
s_add_u32 m0, s34, 131072
s_add_u32 s31, s35, 74112
v_mfma_f32_16x16x32_bf16 v[72:75], v[92:95], a[12:15], 0
ds_read_b64_tr_b16 v[86:87], v8 offset:55296
v_mfma_f32_16x16x32_bf16 v[72:75], v[96:99], a[28:31], v[72:75]
buffer_load_dwordx4 v10, s[20:23], s31 offen lds
s_waitcnt lgkmcnt(8)
v_mfma_f32_16x16x32_bf16 v[20:23], v[100:103], a[144:147], v[20:23]
ds_read_b64_tr_b16 v[88:89], v8 offset:57344
s_waitcnt lgkmcnt(7)
v_mfma_f32_16x16x32_bf16 v[52:55], v[104:107], a[0:3], 0
s_add_u32 m0, s34, 135168
s_add_u32 s31, s35, 110976
s_waitcnt lgkmcnt(5)
v_mfma_f32_16x16x32_bf16 v[52:55], v[108:111], a[16:19], v[52:55]
ds_read_b64_tr_b16 v[90:91], v8 offset:59392
v_mfma_f32_16x16x32_bf16 v[28:31], v[100:103], a[148:151], v[28:31]
buffer_load_dwordx4 v10, s[20:23], s31 offen lds
v_mfma_f32_16x16x32_bf16 v[60:63], v[104:107], a[4:7], 0
ds_read_b64_tr_b16 v[92:93], v9 offset:49152
v_mfma_f32_16x16x32_bf16 v[60:63], v[108:111], a[20:23], v[60:63]
s_add_u32 m0, s34, 139264
s_add_u32 s31, s35, 147840
v_mfma_f32_16x16x32_bf16 v[36:39], v[100:103], a[152:155], v[36:39]
ds_read_b64_tr_b16 v[94:95], v9 offset:51200
v_mfma_f32_16x16x32_bf16 v[68:71], v[104:107], a[8:11], 0
buffer_load_dwordx4 v10, s[20:23], s31 offen lds
v_mfma_f32_16x16x32_bf16 v[68:71], v[108:111], a[24:27], v[68:71]
ds_read_b64_tr_b16 v[96:97], v9 offset:53248
v_mfma_f32_16x16x32_bf16 v[44:47], v[100:103], a[156:159], v[44:47]
s_add_u32 m0, s34, 143360
s_add_u32 s31, s35, 184704
v_mfma_f32_16x16x32_bf16 v[76:79], v[104:107], a[12:15], 0
ds_read_b64_tr_b16 v[98:99], v9 offset:55296
v_mfma_f32_16x16x32_bf16 v[76:79], v[108:111], a[28:31], v[76:79]
buffer_load_dwordx4 v10, s[20:23], s31 offen lds
s_waitcnt vmcnt(18)
s_barrier
s_waitcnt lgkmcnt(8)
v_mfma_f32_16x16x32_bf16 v[48:51], v[80:83], a[32:35], v[48:51]
ds_read_b64_tr_b16 v[100:101], v9 offset:57344
s_waitcnt lgkmcnt(7)
v_mfma_f32_16x16x32_bf16 v[48:51], v[84:87], a[48:51], v[48:51]
s_add_u32 m0, s34, 0
s_add_u32 s31, s35, 221568
s_waitcnt lgkmcnt(5)
v_mfma_f32_16x16x32_bf16 v[48:51], v[88:91], a[64:67], v[48:51]
ds_read_b64_tr_b16 v[102:103], v9 offset:59392
s_add_u32 s37, s36, 0
v_cvt_pk_bf16_f32 v176, v16, v17
v_mfma_f32_16x16x32_bf16 v[56:59], v[80:83], a[36:39], v[56:59]
buffer_load_dwordx4 v10, s[20:23], s31 offen lds
v_mfma_f32_16x16x32_bf16 v[56:59], v[84:87], a[52:55], v[56:59]
ds_read_b64_tr_b16 v[104:105], v8 offset:61440
v_cvt_pk_bf16_f32 v177, v18, v19
v_mfma_f32_16x16x32_bf16 v[56:59], v[88:91], a[68:71], v[56:59]
s_add_u32 m0, s34, 4096
s_add_u32 s31, s35, 258432
v_cvt_pk_bf16_f32 v178, v20, v21
v_mfma_f32_16x16x32_bf16 v[64:67], v[80:83], a[40:43], v[64:67]
ds_read_b64_tr_b16 v[106:107], v8 offset:63488
v_cvt_pk_bf16_f32 v179, v22, v23
v_mfma_f32_16x16x32_bf16 v[64:67], v[84:87], a[56:59], v[64:67]
buffer_load_dwordx4 v10, s[20:23], s31 offen lds
buffer_store_dwordx4 v[176:179], v11, s[8:11], s37 offen offset:0 sc1
v_mfma_f32_16x16x32_bf16 v[64:67], v[88:91], a[72:75], v[64:67]
ds_read_b64_tr_b16 v[108:109], v5 offset:0
v_cvt_pk_bf16_f32 v180, v24, v25
v_mfma_f32_16x16x32_bf16 v[72:75], v[80:83], a[44:47], v[72:75]
s_add_u32 m0, s34, 8192
s_add_u32 s31, s35, 295296
v_cvt_pk_bf16_f32 v181, v26, v27
v_mfma_f32_16x16x32_bf16 v[72:75], v[84:87], a[60:63], v[72:75]
ds_read_b64_tr_b16 v[110:111], v5 offset:2048
v_cvt_pk_bf16_f32 v182, v28, v29
v_mfma_f32_16x16x32_bf16 v[72:75], v[88:91], a[76:79], v[72:75]
buffer_load_dwordx4 v10, s[20:23], s31 offen lds
v_cvt_pk_bf16_f32 v183, v30, v31
s_waitcnt lgkmcnt(8)
v_mfma_f32_16x16x32_bf16 v[52:55], v[92:95], a[32:35], v[52:55]
ds_read_b64_tr_b16 v[80:81], v5 offset:4096
buffer_store_dwordx4 v[180:183], v11, s[8:11], s37 offen offset:1024 sc1
s_waitcnt lgkmcnt(7)
v_mfma_f32_16x16x32_bf16 v[52:55], v[96:99], a[48:51], v[52:55]
s_add_u32 m0, s34, 12288
s_add_u32 s31, s35, 332160
v_cvt_pk_bf16_f32 v184, v32, v33
s_waitcnt lgkmcnt(5)
v_mfma_f32_16x16x32_bf16 v[52:55], v[100:103], a[64:67], v[52:55]
ds_read_b64_tr_b16 v[82:83], v5 offset:6144
v_cvt_pk_bf16_f32 v185, v34, v35
v_mfma_f32_16x16x32_bf16 v[60:63], v[92:95], a[36:39], v[60:63]
buffer_load_dwordx4 v10, s[20:23], s31 offen lds
v_cvt_pk_bf16_f32 v186, v36, v37
v_mfma_f32_16x16x32_bf16 v[60:63], v[96:99], a[52:55], v[60:63]
ds_read_b64_tr_b16 v[84:85], v9 offset:61440
v_mfma_f32_16x16x32_bf16 v[60:63], v[100:103], a[68:71], v[60:63]
s_add_u32 m0, s34, 16384
s_add_u32 s31, s35, 512
v_cvt_pk_bf16_f32 v187, v38, v39
buffer_store_dwordx4 v[184:187], v11, s[8:11], s37 offen offset:2048 sc1
v_mfma_f32_16x16x32_bf16 v[68:71], v[92:95], a[40:43], v[68:71]
ds_read_b64_tr_b16 v[86:87], v9 offset:63488
v_mfma_f32_16x16x32_bf16 v[68:71], v[96:99], a[56:59], v[68:71]
buffer_load_dwordx4 v10, s[20:23], s31 offen lds
v_cvt_pk_bf16_f32 v188, v40, v41
v_mfma_f32_16x16x32_bf16 v[68:71], v[100:103], a[72:75], v[68:71]
ds_read_b64_tr_b16 v[88:89], v6 offset:0
v_cvt_pk_bf16_f32 v189, v42, v43
v_mfma_f32_16x16x32_bf16 v[76:79], v[92:95], a[44:47], v[76:79]
s_add_u32 m0, s34, 20480
s_add_u32 s31, s35, 37376
v_cvt_pk_bf16_f32 v190, v44, v45
v_mfma_f32_16x16x32_bf16 v[76:79], v[96:99], a[60:63], v[76:79]
ds_read_b64_tr_b16 v[90:91], v6 offset:2048
v_cvt_pk_bf16_f32 v191, v46, v47
v_mfma_f32_16x16x32_bf16 v[76:79], v[100:103], a[76:79], v[76:79]
buffer_load_dwordx4 v10, s[20:23], s31 offen lds
buffer_store_dwordx4 v[188:191], v11, s[8:11], s37 offen offset:3072 sc1
s_waitcnt vmcnt(25)
s_barrier
s_waitcnt lgkmcnt(8)
v_mfma_f32_16x16x32_bf16 v[48:51], v[104:107], a[80:83], v[48:51]
ds_read_b64_tr_b16 v[92:93], v6 offset:4096
s_waitcnt lgkmcnt(7)
v_mfma_f32_16x16x32_bf16 v[48:51], v[108:111], a[96:99], v[48:51]
s_add_u32 m0, s34, 24576
s_add_u32 s31, s35, 74240
s_waitcnt lgkmcnt(5)
v_mfma_f32_16x16x32_bf16 v[48:51], v[80:83], a[112:115], v[48:51]
ds_read_b64_tr_b16 v[94:95], v6 offset:6144
v_mfma_f32_16x16x32_bf16 v[56:59], v[104:107], a[84:87], v[56:59]
buffer_load_dwordx4 v10, s[20:23], s31 offen lds
v_mfma_f32_16x16x32_bf16 v[56:59], v[108:111], a[100:103], v[56:59]
ds_read_b64_tr_b16 v[96:97], v5 offset:8192
v_mfma_f32_16x16x32_bf16 v[56:59], v[80:83], a[116:119], v[56:59]
s_add_u32 m0, s34, 28672
s_add_u32 s31, s35, 111104
v_mfma_f32_16x16x32_bf16 v[64:67], v[104:107], a[88:91], v[64:67]
ds_read_b64_tr_b16 v[98:99], v5 offset:10240
v_mfma_f32_16x16x32_bf16 v[64:67], v[108:111], a[104:107], v[64:67]
buffer_load_dwordx4 v10, s[20:23], s31 offen lds
v_mfma_f32_16x16x32_bf16 v[64:67], v[80:83], a[120:123], v[64:67]
ds_read_b64_tr_b16 v[100:101], v5 offset:12288
v_mfma_f32_16x16x32_bf16 v[72:75], v[104:107], a[92:95], v[72:75]
s_add_u32 m0, s34, 32768
s_add_u32 s31, s35, 147968
v_mfma_f32_16x16x32_bf16 v[72:75], v[108:111], a[108:111], v[72:75]
ds_read_b64_tr_b16 v[102:103], v5 offset:14336
v_mfma_f32_16x16x32_bf16 v[72:75], v[80:83], a[124:127], v[72:75]
buffer_load_dwordx4 v10, s[20:23], s31 offen lds
s_waitcnt lgkmcnt(8)
v_mfma_f32_16x16x32_bf16 v[52:55], v[84:87], a[80:83], v[52:55]
ds_read_b64_tr_b16 v[104:105], v5 offset:16384
s_waitcnt lgkmcnt(7)
v_mfma_f32_16x16x32_bf16 v[52:55], v[88:91], a[96:99], v[52:55]
s_add_u32 m0, s34, 36864
s_add_u32 s31, s35, 184832
s_waitcnt lgkmcnt(5)
v_mfma_f32_16x16x32_bf16 v[52:55], v[92:95], a[112:115], v[52:55]
ds_read_b64_tr_b16 v[106:107], v5 offset:18432
v_mfma_f32_16x16x32_bf16 v[60:63], v[84:87], a[84:87], v[60:63]
buffer_load_dwordx4 v10, s[20:23], s31 offen lds
v_mfma_f32_16x16x32_bf16 v[60:63], v[88:91], a[100:103], v[60:63]
ds_read_b64_tr_b16 v[108:109], v6 offset:8192
v_mfma_f32_16x16x32_bf16 v[60:63], v[92:95], a[116:119], v[60:63]
s_add_u32 m0, s34, 40960
s_add_u32 s31, s35, 221696
v_mfma_f32_16x16x32_bf16 v[68:71], v[84:87], a[88:91], v[68:71]
ds_read_b64_tr_b16 v[110:111], v6 offset:10240
v_mfma_f32_16x16x32_bf16 v[68:71], v[88:91], a[104:107], v[68:71]
buffer_load_dwordx4 v10, s[20:23], s31 offen lds
v_mfma_f32_16x16x32_bf16 v[68:71], v[92:95], a[120:123], v[68:71]
ds_read_b64_tr_b16 v[80:81], v6 offset:12288
v_mfma_f32_16x16x32_bf16 v[76:79], v[84:87], a[92:95], v[76:79]
s_add_u32 m0, s34, 45056
s_add_u32 s31, s35, 258560
v_mfma_f32_16x16x32_bf16 v[76:79], v[88:91], a[108:111], v[76:79]
ds_read_b64_tr_b16 v[82:83], v6 offset:14336
v_mfma_f32_16x16x32_bf16 v[76:79], v[92:95], a[124:127], v[76:79]
buffer_load_dwordx4 v10, s[20:23], s31 offen lds
s_waitcnt vmcnt(28)
s_barrier
s_waitcnt lgkmcnt(8)
v_mfma_f32_16x16x32_bf16 v[48:51], v[96:99], a[128:131], v[48:51]
ds_read_b64_tr_b16 v[84:85], v6 offset:16384
s_waitcnt lgkmcnt(7)
v_mfma_f32_16x16x32_bf16 v[48:51], v[100:103], a[144:147], v[48:51]
s_add_u32 m0, s34, 49152
s_add_u32 s31, s35, 295424
s_waitcnt lgkmcnt(5)
v_mfma_f32_16x16x32_bf16 v[16:19], v[104:107], a[0:3], 0
ds_read_b64_tr_b16 v[86:87], v6 offset:18432
v_mfma_f32_16x16x32_bf16 v[56:59], v[96:99], a[132:135], v[56:59]
buffer_load_dwordx4 v10, s[20:23], s31 offen lds
v_mfma_f32_16x16x32_bf16 v[56:59], v[100:103], a[148:151], v[56:59]
ds_read_b64_tr_b16 v[88:89], v5 offset:20480
v_mfma_f32_16x16x32_bf16 v[24:27], v[104:107], a[4:7], 0
s_add_u32 m0, s34, 53248
s_add_u32 s31, s35, 332288
v_mfma_f32_16x16x32_bf16 v[64:67], v[96:99], a[136:139], v[64:67]
ds_read_b64_tr_b16 v[90:91], v5 offset:22528
v_mfma_f32_16x16x32_bf16 v[64:67], v[100:103], a[152:155], v[64:67]
buffer_load_dwordx4 v10, s[20:23], s31 offen lds
v_mfma_f32_16x16x32_bf16 v[32:35], v[104:107], a[8:11], 0
ds_read_b64_tr_b16 v[92:93], v5 offset:24576
v_mfma_f32_16x16x32_bf16 v[72:75], v[96:99], a[140:143], v[72:75]
s_add_u32 m0, s34, 57344
s_add_u32 s31, s35, 640
v_mfma_f32_16x16x32_bf16 v[72:75], v[100:103], a[156:159], v[72:75]
ds_read_b64_tr_b16 v[94:95], v5 offset:26624
v_mfma_f32_16x16x32_bf16 v[40:43], v[104:107], a[12:15], 0
buffer_load_dwordx4 v10, s[20:23], s31 offen lds
s_waitcnt lgkmcnt(8)
v_mfma_f32_16x16x32_bf16 v[52:55], v[108:111], a[128:131], v[52:55]
ds_read_b64_tr_b16 v[96:97], v5 offset:28672
s_waitcnt lgkmcnt(7)
v_mfma_f32_16x16x32_bf16 v[52:55], v[80:83], a[144:147], v[52:55]
s_add_u32 m0, s34, 61440
s_add_u32 s31, s35, 37504
s_waitcnt lgkmcnt(5)
v_mfma_f32_16x16x32_bf16 v[20:23], v[84:87], a[0:3], 0
ds_read_b64_tr_b16 v[98:99], v5 offset:30720
v_mfma_f32_16x16x32_bf16 v[60:63], v[108:111], a[132:135], v[60:63]
buffer_load_dwordx4 v10, s[20:23], s31 offen lds
v_mfma_f32_16x16x32_bf16 v[60:63], v[80:83], a[148:151], v[60:63]
ds_read_b64_tr_b16 v[100:101], v6 offset:20480
v_mfma_f32_16x16x32_bf16 v[28:31], v[84:87], a[4:7], 0
s_add_u32 m0, s34, 65536
s_add_u32 s31, s35, 74368
v_mfma_f32_16x16x32_bf16 v[68:71], v[108:111], a[136:139], v[68:71]
ds_read_b64_tr_b16 v[102:103], v6 offset:22528
v_mfma_f32_16x16x32_bf16 v[68:71], v[80:83], a[152:155], v[68:71]
buffer_load_dwordx4 v10, s[20:23], s31 offen lds
v_mfma_f32_16x16x32_bf16 v[36:39], v[84:87], a[8:11], 0
ds_read_b64_tr_b16 v[104:105], v6 offset:24576
v_mfma_f32_16x16x32_bf16 v[76:79], v[108:111], a[140:143], v[76:79]
s_add_u32 m0, s34, 69632
s_add_u32 s31, s35, 111232
v_mfma_f32_16x16x32_bf16 v[76:79], v[80:83], a[156:159], v[76:79]
ds_read_b64_tr_b16 v[106:107], v6 offset:26624
v_mfma_f32_16x16x32_bf16 v[44:47], v[84:87], a[12:15], 0
buffer_load_dwordx4 v10, s[20:23], s31 offen lds
s_waitcnt vmcnt(31)
s_barrier
s_waitcnt lgkmcnt(8)
v_mfma_f32_16x16x32_bf16 v[16:19], v[88:91], a[16:19], v[16:19]
ds_read_b64_tr_b16 v[108:109], v6 offset:28672
s_waitcnt lgkmcnt(7)
v_mfma_f32_16x16x32_bf16 v[16:19], v[92:95], a[32:35], v[16:19]
s_add_u32 m0, s34, 73728
s_add_u32 s31, s35, 148096
s_waitcnt lgkmcnt(5)
v_mfma_f32_16x16x32_bf16 v[16:19], v[96:99], a[48:51], v[16:19]
ds_read_b64_tr_b16 v[110:111], v6 offset:30720
s_add_u32 s37, s36, 8192
v_mfma_f32_16x16x32_bf16 v[24:27], v[88:91], a[20:23], v[24:27]
buffer_load_dwordx4 v10, s[20:23], s31 offen lds
v_cvt_pk_bf16_f32 v176, v48, v49
v_mfma_f32_16x16x32_bf16 v[24:27], v[92:95], a[36:39], v[24:27]
ds_read_b64_tr_b16 v[80:81], v5 offset:32768
v_cvt_pk_bf16_f32 v177, v50, v51
v_mfma_f32_16x16x32_bf16 v[24:27], v[96:99], a[52:55], v[24:27]
v_cvt_pk_bf16_f32 v178, v52, v53
v_mfma_f32_16x16x32_bf16 v[32:35], v[88:91], a[24:27], v[32:35]
ds_read_b64_tr_b16 v[82:83], v5 offset:34816
v_cvt_pk_bf16_f32 v179, v54, v55
v_mfma_f32_16x16x32_bf16 v[32:35], v[92:95], a[40:43], v[32:35]
buffer_store_dwordx4 v[176:179], v11, s[8:11], s37 offen offset:0 sc1
v_mfma_f32_16x16x32_bf16 v[32:35], v[96:99], a[56:59], v[32:35]
ds_read_b64_tr_b16 v[84:85], v5 offset:36864
v_cvt_pk_bf16_f32 v180, v56, v57
v_mfma_f32_16x16x32_bf16 v[40:43], v[88:91], a[28:31], v[40:43]
s_add_u32 m0, s34, 77824
s_add_u32 s31, s35, 184960
v_cvt_pk_bf16_f32 v181, v58, v59
v_mfma_f32_16x16x32_bf16 v[40:43], v[92:95], a[44:47], v[40:43]
ds_read_b64_tr_b16 v[86:87], v5 offset:38912
v_cvt_pk_bf16_f32 v182, v60, v61
v_mfma_f32_16x16x32_bf16 v[40:43], v[96:99], a[60:63], v[40:43]
buffer_load_dwordx4 v10, s[20:23], s31 offen lds
s_waitcnt lgkmcnt(8)
v_mfma_f32_16x16x32_bf16 v[20:23], v[100:103], a[16:19], v[20:23]
ds_read_b64_tr_b16 v[88:89], v5 offset:40960
v_cvt_pk_bf16_f32 v183, v62, v63
s_waitcnt lgkmcnt(7)
v_mfma_f32_16x16x32_bf16 v[20:23], v[104:107], a[32:35], v[20:23]
buffer_store_dwordx4 v[180:183], v11, s[8:11], s37 offen offset:1024 sc1
s_waitcnt lgkmcnt(5)
v_mfma_f32_16x16x32_bf16 v[20:23], v[108:111], a[48:51], v[20:23]
ds_read_b64_tr_b16 v[90:91], v5 offset:43008
v_cvt_pk_bf16_f32 v184, v64, v65
v_mfma_f32_16x16x32_bf16 v[28:31], v[100:103], a[20:23], v[28:31]
v_cvt_pk_bf16_f32 v185, v66, v67
v_cvt_pk_bf16_f32 v186, v68, v69
v_mfma_f32_16x16x32_bf16 v[28:31], v[104:107], a[36:39], v[28:31]
ds_read_b64_tr_b16 v[92:93], v6 offset:32768
v_mfma_f32_16x16x32_bf16 v[28:31], v[108:111], a[52:55], v[28:31]
s_add_u32 m0, s34, 81920
s_add_u32 s31, s35, 221824
v_cvt_pk_bf16_f32 v187, v70, v71
v_mfma_f32_16x16x32_bf16 v[36:39], v[100:103], a[24:27], v[36:39]
ds_read_b64_tr_b16 v[94:95], v6 offset:34816
buffer_store_dwordx4 v[184:187], v11, s[8:11], s37 offen offset:2048 sc1
v_mfma_f32_16x16x32_bf16 v[36:39], v[104:107], a[40:43], v[36:39]
buffer_load_dwordx4 v10, s[20:23], s31 offen lds
v_cvt_pk_bf16_f32 v188, v72, v73
v_mfma_f32_16x16x32_bf16 v[36:39], v[108:111], a[56:59], v[36:39]
ds_read_b64_tr_b16 v[96:97], v6 offset:36864
v_mfma_f32_16x16x32_bf16 v[44:47], v[100:103], a[28:31], v[44:47]
v_cvt_pk_bf16_f32 v189, v74, v75
v_cvt_pk_bf16_f32 v190, v76, v77
v_mfma_f32_16x16x32_bf16 v[44:47], v[104:107], a[44:47], v[44:47]
ds_read_b64_tr_b16 v[98:99], v6 offset:38912
v_mfma_f32_16x16x32_bf16 v[44:47], v[108:111], a[60:63], v[44:47]
v_cvt_pk_bf16_f32 v191, v78, v79
buffer_store_dwordx4 v[188:191], v11, s[8:11], s37 offen offset:3072 sc1
s_waitcnt vmcnt(35)
s_barrier
s_waitcnt lgkmcnt(8)
v_mfma_f32_16x16x32_bf16 v[16:19], v[80:83], a[64:67], v[16:19]
ds_read_b64_tr_b16 v[100:101], v6 offset:40960
s_waitcnt lgkmcnt(7)
v_mfma_f32_16x16x32_bf16 v[16:19], v[84:87], a[80:83], v[16:19]
s_add_u32 m0, s34, 86016
s_add_u32 s31, s35, 258688
s_waitcnt lgkmcnt(5)
v_mfma_f32_16x16x32_bf16 v[16:19], v[88:91], a[96:99], v[16:19]
ds_read_b64_tr_b16 v[102:103], v6 offset:43008
v_mfma_f32_16x16x32_bf16 v[24:27], v[80:83], a[68:71], v[24:27]
buffer_load_dwordx4 v10, s[20:23], s31 offen lds
v_mfma_f32_16x16x32_bf16 v[24:27], v[84:87], a[84:87], v[24:27]
ds_read_b64_tr_b16 v[104:105], v5 offset:45056
v_mfma_f32_16x16x32_bf16 v[24:27], v[88:91], a[100:103], v[24:27]
v_mfma_f32_16x16x32_bf16 v[32:35], v[80:83], a[72:75], v[32:35]
ds_read_b64_tr_b16 v[106:107], v5 offset:47104
v_mfma_f32_16x16x32_bf16 v[32:35], v[84:87], a[88:91], v[32:35]
v_mfma_f32_16x16x32_bf16 v[32:35], v[88:91], a[104:107], v[32:35]
ds_read_b64_tr_b16 v[108:109], v5 offset:49152
v_mfma_f32_16x16x32_bf16 v[40:43], v[80:83], a[76:79], v[40:43]
s_add_u32 m0, s34, 90112
s_add_u32 s31, s35, 295552
v_mfma_f32_16x16x32_bf16 v[40:43], v[84:87], a[92:95], v[40:43]
ds_read_b64_tr_b16 v[110:111], v5 offset:51200
v_mfma_f32_16x16x32_bf16 v[40:43], v[88:91], a[108:111], v[40:43]
buffer_load_dwordx4 v10, s[20:23], s31 offen lds
s_waitcnt lgkmcnt(8)
v_mfma_f32_16x16x32_bf16 v[20:23], v[92:95], a[64:67], v[20:23]
ds_read_b64_tr_b16 v[80:81], v5 offset:53248
s_waitcnt lgkmcnt(7)
v_mfma_f32_16x16x32_bf16 v[20:23], v[96:99], a[80:83], v[20:23]
s_waitcnt lgkmcnt(5)
v_mfma_f32_16x16x32_bf16 v[20:23], v[100:103], a[96:99], v[20:23]
ds_read_b64_tr_b16 v[82:83], v5 offset:55296
v_mfma_f32_16x16x32_bf16 v[28:31], v[92:95], a[68:71], v[28:31]
v_mfma_f32_16x16x32_bf16 v[28:31], v[96:99], a[84:87], v[28:31]
ds_read_b64_tr_b16 v[84:85], v6 offset:45056
v_mfma_f32_16x16x32_bf16 v[28:31], v[100:103], a[100:103], v[28:31]
s_add_u32 m0, s34, 94208
s_add_u32 s31, s35, 332416
v_mfma_f32_16x16x32_bf16 v[36:39], v[92:95], a[72:75], v[36:39]
ds_read_b64_tr_b16 v[86:87], v6 offset:47104
v_mfma_f32_16x16x32_bf16 v[36:39], v[96:99], a[88:91], v[36:39]
buffer_load_dwordx4 v10, s[20:23], s31 offen lds
v_mfma_f32_16x16x32_bf16 v[36:39], v[100:103], a[104:107], v[36:39]
ds_read_b64_tr_b16 v[88:89], v6 offset:49152
v_mfma_f32_16x16x32_bf16 v[44:47], v[92:95], a[76:79], v[44:47]
v_mfma_f32_16x16x32_bf16 v[44:47], v[96:99], a[92:95], v[44:47]
ds_read_b64_tr_b16 v[90:91], v6 offset:51200
v_mfma_f32_16x16x32_bf16 v[44:47], v[100:103], a[108:111], v[44:47]
s_waitcnt vmcnt(35)
s_barrier
s_waitcnt lgkmcnt(8)
v_mfma_f32_16x16x32_bf16 v[16:19], v[104:107], a[112:115], v[16:19]
ds_read_b64_tr_b16 v[92:93], v6 offset:53248
s_waitcnt lgkmcnt(7)
v_mfma_f32_16x16x32_bf16 v[16:19], v[108:111], a[128:131], v[16:19]
s_add_u32 m0, s34, 98304
s_add_u32 s31, s35, 768
s_waitcnt lgkmcnt(5)
v_mfma_f32_16x16x32_bf16 v[16:19], v[80:83], a[144:147], v[16:19]
ds_read_b64_tr_b16 v[94:95], v6 offset:55296
v_mfma_f32_16x16x32_bf16 v[24:27], v[104:107], a[116:119], v[24:27]
buffer_load_dwordx4 v10, s[20:23], s31 offen lds
v_mfma_f32_16x16x32_bf16 v[24:27], v[108:111], a[132:135], v[24:27]
ds_read_b64_tr_b16 v[96:97], v5 offset:57344
v_mfma_f32_16x16x32_bf16 v[24:27], v[80:83], a[148:151], v[24:27]
v_mfma_f32_16x16x32_bf16 v[32:35], v[104:107], a[120:123], v[32:35]
ds_read_b64_tr_b16 v[98:99], v5 offset:59392
v_mfma_f32_16x16x32_bf16 v[32:35], v[108:111], a[136:139], v[32:35]
v_mfma_f32_16x16x32_bf16 v[32:35], v[80:83], a[152:155], v[32:35]
ds_read_b64_tr_b16 v[100:101], v5 offset:61440
v_mfma_f32_16x16x32_bf16 v[40:43], v[104:107], a[124:127], v[40:43]
s_add_u32 m0, s34, 102400
s_add_u32 s31, s35, 37632
v_mfma_f32_16x16x32_bf16 v[40:43], v[108:111], a[140:143], v[40:43]
ds_read_b64_tr_b16 v[102:103], v5 offset:63488
v_mfma_f32_16x16x32_bf16 v[40:43], v[80:83], a[156:159], v[40:43]
buffer_load_dwordx4 v10, s[20:23], s31 offen lds
s_waitcnt lgkmcnt(8)
v_mfma_f32_16x16x32_bf16 v[20:23], v[84:87], a[112:115], v[20:23]
ds_read_b64_tr_b16 v[104:105], v2 offset:0
s_waitcnt lgkmcnt(7)
v_mfma_f32_16x16x32_bf16 v[20:23], v[88:91], a[128:131], v[20:23]
s_waitcnt lgkmcnt(5)
v_mfma_f32_16x16x32_bf16 v[20:23], v[92:95], a[144:147], v[20:23]
ds_read_b64_tr_b16 v[106:107], v2 offset:2048
v_mfma_f32_16x16x32_bf16 v[28:31], v[84:87], a[116:119], v[28:31]
v_mfma_f32_16x16x32_bf16 v[28:31], v[88:91], a[132:135], v[28:31]
ds_read_b64_tr_b16 v[108:109], v6 offset:57344
v_mfma_f32_16x16x32_bf16 v[28:31], v[92:95], a[148:151], v[28:31]
s_add_u32 m0, s34, 106496
s_add_u32 s31, s35, 74496
v_mfma_f32_16x16x32_bf16 v[36:39], v[84:87], a[120:123], v[36:39]
ds_read_b64_tr_b16 v[110:111], v6 offset:59392
v_mfma_f32_16x16x32_bf16 v[36:39], v[88:91], a[136:139], v[36:39]
buffer_load_dwordx4 v10, s[20:23], s31 offen lds
v_mfma_f32_16x16x32_bf16 v[36:39], v[92:95], a[152:155], v[36:39]
ds_read_b64_tr_b16 v[80:81], v6 offset:61440
v_mfma_f32_16x16x32_bf16 v[44:47], v[84:87], a[124:127], v[44:47]
v_mfma_f32_16x16x32_bf16 v[44:47], v[88:91], a[140:143], v[44:47]
ds_read_b64_tr_b16 v[82:83], v6 offset:63488
v_mfma_f32_16x16x32_bf16 v[44:47], v[92:95], a[156:159], v[44:47]
s_waitcnt vmcnt(35)
s_barrier
s_waitcnt lgkmcnt(8)
v_mfma_f32_16x16x32_bf16 v[48:51], v[96:99], a[0:3], 0
ds_read_b64_tr_b16 v[84:85], v3 offset:0
s_waitcnt lgkmcnt(7)
v_mfma_f32_16x16x32_bf16 v[48:51], v[100:103], a[16:19], v[48:51]
s_add_u32 m0, s34, 110592
s_add_u32 s31, s35, 111360
s_waitcnt lgkmcnt(5)
v_mfma_f32_16x16x32_bf16 v[48:51], v[104:107], a[32:35], v[48:51]
ds_read_b64_tr_b16 v[86:87], v3 offset:2048
s_add_u32 s37, s36, 16384
v_mfma_f32_16x16x32_bf16 v[56:59], v[96:99], a[4:7], 0
buffer_load_dwordx4 v10, s[20:23], s31 offen lds
v_cvt_pk_bf16_f32 v176, v16, v17
v_mfma_f32_16x16x32_bf16 v[56:59], v[100:103], a[20:23], v[56:59]
ds_read_b64_tr_b16 v[88:89], v2 offset:4096
v_cvt_pk_bf16_f32 v177, v18, v19
v_mfma_f32_16x16x32_bf16 v[56:59], v[104:107], a[36:39], v[56:59]
v_cvt_pk_bf16_f32 v178, v20, v21
v_mfma_f32_16x16x32_bf16 v[64:67], v[96:99], a[8:11], 0
ds_read_b64_tr_b16 v[90:91], v2 offset:6144
v_cvt_pk_bf16_f32 v179, v22, v23
v_mfma_f32_16x16x32_bf16 v[64:67], v[100:103], a[24:27], v[64:67]
buffer_store_dwordx4 v[176:179], v11, s[8:11], s37 offen offset:0 sc1
v_mfma_f32_16x16x32_bf16 v[64:67], v[104:107], a[40:43], v[64:67]
ds_read_b64_tr_b16 v[92:93], v2 offset:8192
v_cvt_pk_bf16_f32 v180, v24, v25
v_mfma_f32_16x16x32_bf16 v[72:75], v[96:99], a[12:15], 0
s_add_u32 m0, s34, 114688
s_add_u32 s31, s35, 148224
v_cvt_pk_bf16_f32 v181, v26, v27
v_mfma_f32_16x16x32_bf16 v[72:75], v[100:103], a[28:31], v[72:75]
ds_read_b64_tr_b16 v[94:95], v2 offset:10240
v_cvt_pk_bf16_f32 v182, v28, v29
v_mfma_f32_16x16x32_bf16 v[72:75], v[104:107], a[44:47], v[72:75]
buffer_load_dwordx4 v10, s[20:23], s31 offen lds
s_waitcnt lgkmcnt(8)
v_mfma_f32_16x16x32_bf16 v[52:55], v[108:111], a[0:3], 0
ds_read_b64_tr_b16 v[96:97], v2 offset:12288
v_cvt_pk_bf16_f32 v183, v30, v31
s_waitcnt lgkmcnt(7)
v_mfma_f32_16x16x32_bf16 v[52:55], v[80:83], a[16:19], v[52:55]
buffer_store_dwordx4 v[180:183], v11, s[8:11], s37 offen offset:1024 sc1
s_waitcnt lgkmcnt(5)
v_mfma_f32_16x16x32_bf16 v[52:55], v[84:87], a[32:35], v[52:55]
ds_read_b64_tr_b16 v[98:99], v2 offset:14336
v_cvt_pk_bf16_f32 v184, v32, v33
v_mfma_f32_16x16x32_bf16 v[60:63], v[108:111], a[4:7], 0
v_cvt_pk_bf16_f32 v185, v34, v35
v_cvt_pk_bf16_f32 v186, v36, v37
v_mfma_f32_16x16x32_bf16 v[60:63], v[80:83], a[20:23], v[60:63]
ds_read_b64_tr_b16 v[100:101], v3 offset:4096
v_mfma_f32_16x16x32_bf16 v[60:63], v[84:87], a[36:39], v[60:63]
s_add_u32 m0, s34, 118784
s_add_u32 s31, s35, 185088
v_cvt_pk_bf16_f32 v187, v38, v39
v_mfma_f32_16x16x32_bf16 v[68:71], v[108:111], a[8:11], 0
ds_read_b64_tr_b16 v[102:103], v3 offset:6144
buffer_store_dwordx4 v[184:187], v11, s[8:11], s37 offen offset:2048 sc1
v_mfma_f32_16x16x32_bf16 v[68:71], v[80:83], a[24:27], v[68:71]
buffer_load_dwordx4 v10, s[20:23], s31 offen lds
v_cvt_pk_bf16_f32 v188, v40, v41
v_mfma_f32_16x16x32_bf16 v[68:71], v[84:87], a[40:43], v[68:71]
ds_read_b64_tr_b16 v[104:105], v3 offset:8192
v_mfma_f32_16x16x32_bf16 v[76:79], v[108:111], a[12:15], 0
v_cvt_pk_bf16_f32 v189, v42, v43
v_cvt_pk_bf16_f32 v190, v44, v45
v_mfma_f32_16x16x32_bf16 v[76:79], v[80:83], a[28:31], v[76:79]
ds_read_b64_tr_b16 v[106:107], v3 offset:10240
v_mfma_f32_16x16x32_bf16 v[76:79], v[84:87], a[44:47], v[76:79]
v_cvt_pk_bf16_f32 v191, v46, v47
buffer_store_dwordx4 v[188:191], v11, s[8:11], s37 offen offset:3072 sc1
s_waitcnt vmcnt(38)
s_barrier
s_waitcnt lgkmcnt(8)
v_mfma_f32_16x16x32_bf16 v[48:51], v[88:91], a[48:51], v[48:51]
ds_read_b64_tr_b16 v[108:109], v3 offset:12288
s_waitcnt lgkmcnt(7)
v_mfma_f32_16x16x32_bf16 v[48:51], v[92:95], a[64:67], v[48:51]
s_add_u32 m0, s34, 122880
s_add_u32 s31, s35, 221952
s_waitcnt lgkmcnt(5)
v_mfma_f32_16x16x32_bf16 v[48:51], v[96:99], a[80:83], v[48:51]
ds_read_b64_tr_b16 v[110:111], v3 offset:14336
v_mfma_f32_16x16x32_bf16 v[56:59], v[88:91], a[52:55], v[56:59]
buffer_load_dwordx4 v10, s[20:23], s31 offen lds
v_mfma_f32_16x16x32_bf16 v[56:59], v[92:95], a[68:71], v[56:59]
ds_read_b64_tr_b16 v[80:81], v8 offset:0
v_mfma_f32_16x16x32_bf16 v[56:59], v[96:99], a[84:87], v[56:59]
v_mfma_f32_16x16x32_bf16 v[64:67], v[88:91], a[56:59], v[64:67]
ds_read_b64_tr_b16 v[82:83], v8 offset:2048
v_mfma_f32_16x16x32_bf16 v[64:67], v[92:95], a[72:75], v[64:67]
v_mfma_f32_16x16x32_bf16 v[64:67], v[96:99], a[88:91], v[64:67]
ds_read_b64_tr_b16 v[84:85], v8 offset:4096
v_mfma_f32_16x16x32_bf16 v[72:75], v[88:91], a[60:63], v[72:75]
s_add_u32 m0, s34, 126976
s_add_u32 s31, s35, 258816
v_mfma_f32_16x16x32_bf16 v[72:75], v[92:95], a[76:79], v[72:75]
ds_read_b64_tr_b16 v[86:87], v8 offset:6144
v_mfma_f32_16x16x32_bf16 v[72:75], v[96:99], a[92:95], v[72:75]
buffer_load_dwordx4 v10, s[20:23], s31 offen lds
s_waitcnt lgkmcnt(8)
v_mfma_f32_16x16x32_bf16 v[52:55], v[100:103], a[48:51], v[52:55]
ds_read_b64_tr_b16 v[88:89], v8 offset:8192
s_waitcnt lgkmcnt(7)
v_mfma_f32_16x16x32_bf16 v[52:55], v[104:107], a[64:67], v[52:55]
s_waitcnt lgkmcnt(5)
v_mfma_f32_16x16x32_bf16 v[52:55], v[108:111], a[80:83], v[52:55]
ds_read_b64_tr_b16 v[90:91], v8 offset:10240
v_mfma_f32_16x16x32_bf16 v[60:63], v[100:103], a[52:55], v[60:63]
v_mfma_f32_16x16x32_bf16 v[60:63], v[104:107], a[68:71], v[60:63]
ds_read_b64_tr_b16 v[92:93], v9 offset:0
v_mfma_f32_16x16x32_bf16 v[60:63], v[108:111], a[84:87], v[60:63]
s_add_u32 m0, s34, 131072
s_add_u32 s31, s35, 295680
v_mfma_f32_16x16x32_bf16 v[68:71], v[100:103], a[56:59], v[68:71]
ds_read_b64_tr_b16 v[94:95], v9 offset:2048
v_mfma_f32_16x16x32_bf16 v[68:71], v[104:107], a[72:75], v[68:71]
buffer_load_dwordx4 v10, s[20:23], s31 offen lds
v_mfma_f32_16x16x32_bf16 v[68:71], v[108:111], a[88:91], v[68:71]
ds_read_b64_tr_b16 v[96:97], v9 offset:4096
v_mfma_f32_16x16x32_bf16 v[76:79], v[100:103], a[60:63], v[76:79]
v_mfma_f32_16x16x32_bf16 v[76:79], v[104:107], a[76:79], v[76:79]
ds_read_b64_tr_b16 v[98:99], v9 offset:6144
v_mfma_f32_16x16x32_bf16 v[76:79], v[108:111], a[92:95], v[76:79]
s_waitcnt vmcnt(36)
s_barrier
s_waitcnt lgkmcnt(8)
v_mfma_f32_16x16x32_bf16 v[48:51], v[80:83], a[96:99], v[48:51]
ds_read_b64_tr_b16 v[100:101], v9 offset:8192
s_waitcnt lgkmcnt(7)
v_mfma_f32_16x16x32_bf16 v[48:51], v[84:87], a[112:115], v[48:51]
s_add_u32 m0, s34, 135168
s_add_u32 s31, s35, 332544
s_waitcnt lgkmcnt(5)
v_mfma_f32_16x16x32_bf16 v[48:51], v[88:91], a[128:131], v[48:51]
ds_read_b64_tr_b16 v[102:103], v9 offset:10240
v_mfma_f32_16x16x32_bf16 v[56:59], v[80:83], a[100:103], v[56:59]
buffer_load_dwordx4 v10, s[20:23], s31 offen lds
v_mfma_f32_16x16x32_bf16 v[56:59], v[84:87], a[116:119], v[56:59]
ds_read_b64_tr_b16 v[104:105], v8 offset:12288
v_mfma_f32_16x16x32_bf16 v[56:59], v[88:91], a[132:135], v[56:59]
v_mfma_f32_16x16x32_bf16 v[64:67], v[80:83], a[104:107], v[64:67]
ds_read_b64_tr_b16 v[106:107], v8 offset:14336
v_mfma_f32_16x16x32_bf16 v[64:67], v[84:87], a[120:123], v[64:67]
v_mfma_f32_16x16x32_bf16 v[64:67], v[88:91], a[136:139], v[64:67]
ds_read_b64_tr_b16 v[108:109], v8 offset:16384
v_mfma_f32_16x16x32_bf16 v[72:75], v[80:83], a[108:111], v[72:75]
s_add_u32 m0, s34, 139264
s_add_u32 s31, s35, 896
v_mfma_f32_16x16x32_bf16 v[72:75], v[84:87], a[124:127], v[72:75]
ds_read_b64_tr_b16 v[110:111], v8 offset:18432
v_mfma_f32_16x16x32_bf16 v[72:75], v[88:91], a[140:143], v[72:75]
buffer_load_dwordx4 v10, s[20:23], s31 offen lds
s_waitcnt lgkmcnt(8)
v_mfma_f32_16x16x32_bf16 v[52:55], v[92:95], a[96:99], v[52:55]
ds_read_b64_tr_b16 v[80:81], v8 offset:20480
s_waitcnt lgkmcnt(7)
v_mfma_f32_16x16x32_bf16 v[52:55], v[96:99], a[112:115], v[52:55]
s_waitcnt lgkmcnt(5)
v_mfma_f32_16x16x32_bf16 v[52:55], v[100:103], a[128:131], v[52:55]
ds_read_b64_tr_b16 v[82:83], v8 offset:22528
v_mfma_f32_16x16x32_bf16 v[60:63], v[92:95], a[100:103], v[60:63]
v_mfma_f32_16x16x32_bf16 v[60:63], v[96:99], a[116:119], v[60:63]
ds_read_b64_tr_b16 v[84:85], v9 offset:12288
v_mfma_f32_16x16x32_bf16 v[60:63], v[100:103], a[132:135], v[60:63]
s_add_u32 m0, s34, 143360
s_add_u32 s31, s35, 37760
v_mfma_f32_16x16x32_bf16 v[68:71], v[92:95], a[104:107], v[68:71]
ds_read_b64_tr_b16 v[86:87], v9 offset:14336
v_mfma_f32_16x16x32_bf16 v[68:71], v[96:99], a[120:123], v[68:71]
buffer_load_dwordx4 v10, s[20:23], s31 offen lds
v_mfma_f32_16x16x32_bf16 v[68:71], v[100:103], a[136:139], v[68:71]
ds_read_b64_tr_b16 v[88:89], v9 offset:16384
v_mfma_f32_16x16x32_bf16 v[76:79], v[92:95], a[108:111], v[76:79]
v_mfma_f32_16x16x32_bf16 v[76:79], v[96:99], a[124:127], v[76:79]
ds_read_b64_tr_b16 v[90:91], v9 offset:18432
v_mfma_f32_16x16x32_bf16 v[76:79], v[100:103], a[140:143], v[76:79]
s_waitcnt vmcnt(35)
s_barrier
s_waitcnt lgkmcnt(8)
v_mfma_f32_16x16x32_bf16 v[48:51], v[104:107], a[144:147], v[48:51]
ds_read_b64_tr_b16 v[92:93], v9 offset:20480
s_waitcnt lgkmcnt(7)
v_mfma_f32_16x16x32_bf16 v[16:19], v[108:111], a[0:3], 0
s_add_u32 m0, s34, 0
s_add_u32 s31, s35, 74624
s_waitcnt lgkmcnt(5)
v_mfma_f32_16x16x32_bf16 v[16:19], v[80:83], a[16:19], v[16:19]
ds_read_b64_tr_b16 v[94:95], v9 offset:22528
v_mfma_f32_16x16x32_bf16 v[56:59], v[104:107], a[148:151], v[56:59]
buffer_load_dwordx4 v10, s[20:23], s31 offen lds
v_mfma_f32_16x16x32_bf16 v[24:27], v[108:111], a[4:7], 0
ds_read_b64_tr_b16 v[96:97], v8 offset:24576
v_mfma_f32_16x16x32_bf16 v[24:27], v[80:83], a[20:23], v[24:27]
v_mfma_f32_16x16x32_bf16 v[64:67], v[104:107], a[152:155], v[64:67]
ds_read_b64_tr_b16 v[98:99], v8 offset:26624
v_mfma_f32_16x16x32_bf16 v[32:35], v[108:111], a[8:11], 0
v_mfma_f32_16x16x32_bf16 v[32:35], v[80:83], a[24:27], v[32:35]
ds_read_b64_tr_b16 v[100:101], v8 offset:28672
v_mfma_f32_16x16x32_bf16 v[72:75], v[104:107], a[156:159], v[72:75]
s_add_u32 m0, s34, 4096
s_add_u32 s31, s35, 111488
v_mfma_f32_16x16x32_bf16 v[40:43], v[108:111], a[12:15], 0
ds_read_b64_tr_b16 v[102:103], v8 offset:30720
v_mfma_f32_16x16x32_bf16 v[40:43], v[80:83], a[28:31], v[40:43]
buffer_load_dwordx4 v10, s[20:23], s31 offen lds
s_waitcnt lgkmcnt(8)
v_mfma_f32_16x16x32_bf16 v[52:55], v[84:87], a[144:147], v[52:55]
ds_read_b64_tr_b16 v[104:105], v8 offset:32768
s_waitcnt lgkmcnt(7)
v_mfma_f32_16x16x32_bf16 v[20:23], v[88:91], a[0:3], 0
s_waitcnt lgkmcnt(5)
v_mfma_f32_16x16x32_bf16 v[20:23], v[92:95], a[16:19], v[20:23]
ds_read_b64_tr_b16 v[106:107], v8 offset:34816
v_mfma_f32_16x16x32_bf16 v[60:63], v[84:87], a[148:151], v[60:63]
v_mfma_f32_16x16x32_bf16 v[28:31], v[88:91], a[4:7], 0
ds_read_b64_tr_b16 v[108:109], v9 offset:24576
v_mfma_f32_16x16x32_bf16 v[28:31], v[92:95], a[20:23], v[28:31]
s_add_u32 m0, s34, 8192
s_add_u32 s31, s35, 148352
v_mfma_f32_16x16x32_bf16 v[68:71], v[84:87], a[152:155], v[68:71]
ds_read_b64_tr_b16 v[110:111], v9 offset:26624
v_mfma_f32_16x16x32_bf16 v[36:39], v[88:91], a[8:11], 0
buffer_load_dwordx4 v10, s[20:23], s31 offen lds
v_mfma_f32_16x16x32_bf16 v[36:39], v[92:95], a[24:27], v[36:39]
ds_read_b64_tr_b16 v[80:81], v9 offset:28672
v_mfma_f32_16x16x32_bf16 v[76:79], v[84:87], a[156:159], v[76:79]
v_mfma_f32_16x16x32_bf16 v[44:47], v[88:91], a[12:15], 0
ds_read_b64_tr_b16 v[82:83], v9 offset:30720
v_mfma_f32_16x16x32_bf16 v[44:47], v[92:95], a[28:31], v[44:47]
s_waitcnt vmcnt(35)
s_barrier
s_waitcnt lgkmcnt(8)
v_mfma_f32_16x16x32_bf16 v[16:19], v[96:99], a[32:35], v[16:19]
ds_read_b64_tr_b16 v[84:85], v9 offset:32768
s_waitcnt lgkmcnt(7)
v_mfma_f32_16x16x32_bf16 v[16:19], v[100:103], a[48:51], v[16:19]
s_add_u32 m0, s34, 12288
s_add_u32 s31, s35, 185216
s_waitcnt lgkmcnt(5)
v_mfma_f32_16x16x32_bf16 v[16:19], v[104:107], a[64:67], v[16:19]
ds_read_b64_tr_b16 v[86:87], v9 offset:34816
s_add_u32 s37, s36, 24576
v_mfma_f32_16x16x32_bf16 v[24:27], v[96:99], a[36:39], v[24:27]
buffer_load_dwordx4 v10, s[20:23], s31 offen lds
v_cvt_pk_bf16_f32 v176, v48, v49
v_mfma_f32_16x16x32_bf16 v[24:27], v[100:103], a[52:55], v[24:27]
ds_read_b64_tr_b16 v[88:89], v8 offset:36864
v_cvt_pk_bf16_f32 v177, v50, v51
v_mfma_f32_16x16x32_bf16 v[24:27], v[104:107], a[68:71], v[24:27]
v_cvt_pk_bf16_f32 v178, v52, v53
v_mfma_f32_16x16x32_bf16 v[32:35], v[96:99], a[40:43], v[32:35]
ds_read_b64_tr_b16 v[90:91], v8 offset:38912
v_cvt_pk_bf16_f32 v179, v54, v55
v_mfma_f32_16x16x32_bf16 v[32:35], v[100:103], a[56:59], v[32:35]
buffer_store_dwordx4 v[176:179], v11, s[8:11], s37 offen offset:0 sc1
v_mfma_f32_16x16x32_bf16 v[32:35], v[104:107], a[72:75], v[32:35]
ds_read_b64_tr_b16 v[92:93], v8 offset:40960
v_cvt_pk_bf16_f32 v180, v56, v57
v_mfma_f32_16x16x32_bf16 v[40:43], v[96:99], a[44:47], v[40:43]
s_add_u32 m0, s34, 16384
s_add_u32 s31, s35, 222080
v_cvt_pk_bf16_f32 v181, v58, v59
v_mfma_f32_16x16x32_bf16 v[40:43], v[100:103], a[60:63], v[40:43]
ds_read_b64_tr_b16 v[94:95], v8 offset:43008
v_cvt_pk_bf16_f32 v182, v60, v61
v_mfma_f32_16x16x32_bf16 v[40:43], v[104:107], a[76:79], v[40:43]
buffer_load_dwordx4 v10, s[20:23], s31 offen lds
s_waitcnt lgkmcnt(8)
v_mfma_f32_16x16x32_bf16 v[20:23], v[108:111], a[32:35], v[20:23]
ds_read_b64_tr_b16 v[96:97], v8 offset:45056
v_cvt_pk_bf16_f32 v183, v62, v63
s_waitcnt lgkmcnt(7)
v_mfma_f32_16x16x32_bf16 v[20:23], v[80:83], a[48:51], v[20:23]
buffer_store_dwordx4 v[180:183], v11, s[8:11], s37 offen offset:1024 sc1
s_waitcnt lgkmcnt(5)
v_mfma_f32_16x16x32_bf16 v[20:23], v[84:87], a[64:67], v[20:23]
ds_read_b64_tr_b16 v[98:99], v8 offset:47104
v_cvt_pk_bf16_f32 v184, v64, v65
v_mfma_f32_16x16x32_bf16 v[28:31], v[108:111], a[36:39], v[28:31]
v_cvt_pk_bf16_f32 v185, v66, v67
v_cvt_pk_bf16_f32 v186, v68, v69
v_mfma_f32_16x16x32_bf16 v[28:31], v[80:83], a[52:55], v[28:31]
ds_read_b64_tr_b16 v[100:101], v9 offset:36864
v_mfma_f32_16x16x32_bf16 v[28:31], v[84:87], a[68:71], v[28:31]
s_add_u32 m0, s34, 20480
s_add_u32 s31, s35, 258944
v_cvt_pk_bf16_f32 v187, v70, v71
v_mfma_f32_16x16x32_bf16 v[36:39], v[108:111], a[40:43], v[36:39]
ds_read_b64_tr_b16 v[102:103], v9 offset:38912
buffer_store_dwordx4 v[184:187], v11, s[8:11], s37 offen offset:2048 sc1
v_mfma_f32_16x16x32_bf16 v[36:39], v[80:83], a[56:59], v[36:39]
buffer_load_dwordx4 v10, s[20:23], s31 offen lds
v_cvt_pk_bf16_f32 v188, v72, v73
v_mfma_f32_16x16x32_bf16 v[36:39], v[84:87], a[72:75], v[36:39]
ds_read_b64_tr_b16 v[104:105], v9 offset:40960
v_mfma_f32_16x16x32_bf16 v[44:47], v[108:111], a[44:47], v[44:47]
v_cvt_pk_bf16_f32 v189, v74, v75
v_cvt_pk_bf16_f32 v190, v76, v77
v_mfma_f32_16x16x32_bf16 v[44:47], v[80:83], a[60:63], v[44:47]
ds_read_b64_tr_b16 v[106:107], v9 offset:43008
v_mfma_f32_16x16x32_bf16 v[44:47], v[84:87], a[76:79], v[44:47]
v_cvt_pk_bf16_f32 v191, v78, v79
buffer_store_dwordx4 v[188:191], v11, s[8:11], s37 offen offset:3072 sc1
s_waitcnt vmcnt(39)
s_barrier
s_waitcnt lgkmcnt(8)
v_mfma_f32_16x16x32_bf16 v[16:19], v[88:91], a[80:83], v[16:19]
ds_read_b64_tr_b16 v[108:109], v9 offset:45056
s_waitcnt lgkmcnt(7)
v_mfma_f32_16x16x32_bf16 v[16:19], v[92:95], a[96:99], v[16:19]
s_add_u32 m0, s34, 24576
s_add_u32 s31, s35, 295808
s_waitcnt lgkmcnt(5)
v_mfma_f32_16x16x32_bf16 v[16:19], v[96:99], a[112:115], v[16:19]
ds_read_b64_tr_b16 v[110:111], v9 offset:47104
v_mfma_f32_16x16x32_bf16 v[24:27], v[88:91], a[84:87], v[24:27]
buffer_load_dwordx4 v10, s[20:23], s31 offen lds
v_mfma_f32_16x16x32_bf16 v[24:27], v[92:95], a[100:103], v[24:27]
ds_read_b64_tr_b16 v[80:81], v8 offset:49152
v_mfma_f32_16x16x32_bf16 v[24:27], v[96:99], a[116:119], v[24:27]
v_mfma_f32_16x16x32_bf16 v[32:35], v[88:91], a[88:91], v[32:35]
ds_read_b64_tr_b16 v[82:83], v8 offset:51200
v_mfma_f32_16x16x32_bf16 v[32:35], v[92:95], a[104:107], v[32:35]
v_mfma_f32_16x16x32_bf16 v[32:35], v[96:99], a[120:123], v[32:35]
ds_read_b64_tr_b16 v[84:85], v8 offset:53248
v_mfma_f32_16x16x32_bf16 v[40:43], v[88:91], a[92:95], v[40:43]
s_add_u32 m0, s34, 28672
s_add_u32 s31, s35, 332672
v_mfma_f32_16x16x32_bf16 v[40:43], v[92:95], a[108:111], v[40:43]
ds_read_b64_tr_b16 v[86:87], v8 offset:55296
v_mfma_f32_16x16x32_bf16 v[40:43], v[96:99], a[124:127], v[40:43]
buffer_load_dwordx4 v10, s[20:23], s31 offen lds
s_waitcnt lgkmcnt(8)
v_mfma_f32_16x16x32_bf16 v[20:23], v[100:103], a[80:83], v[20:23]
ds_read_b64_tr_b16 v[88:89], v8 offset:57344
s_waitcnt lgkmcnt(7)
v_mfma_f32_16x16x32_bf16 v[20:23], v[104:107], a[96:99], v[20:23]
s_waitcnt lgkmcnt(5)
v_mfma_f32_16x16x32_bf16 v[20:23], v[108:111], a[112:115], v[20:23]
ds_read_b64_tr_b16 v[90:91], v8 offset:59392
v_mfma_f32_16x16x32_bf16 v[28:31], v[100:103], a[84:87], v[28:31]
v_mfma_f32_16x16x32_bf16 v[28:31], v[104:107], a[100:103], v[28:31]
ds_read_b64_tr_b16 v[92:93], v9 offset:49152
v_mfma_f32_16x16x32_bf16 v[28:31], v[108:111], a[116:119], v[28:31]
s_add_u32 m0, s34, 32768
s_add_u32 s31, s35, 1024
v_mfma_f32_16x16x32_bf16 v[36:39], v[100:103], a[88:91], v[36:39]
ds_read_b64_tr_b16 v[94:95], v9 offset:51200
v_mfma_f32_16x16x32_bf16 v[36:39], v[104:107], a[104:107], v[36:39]
buffer_load_dwordx4 v10, s[20:23], s31 offen lds
v_mfma_f32_16x16x32_bf16 v[36:39], v[108:111], a[120:123], v[36:39]
ds_read_b64_tr_b16 v[96:97], v9 offset:53248
v_mfma_f32_16x16x32_bf16 v[44:47], v[100:103], a[92:95], v[44:47]
v_mfma_f32_16x16x32_bf16 v[44:47], v[104:107], a[108:111], v[44:47]
ds_read_b64_tr_b16 v[98:99], v9 offset:55296
v_mfma_f32_16x16x32_bf16 v[44:47], v[108:111], a[124:127], v[44:47]
s_waitcnt vmcnt(39)
s_barrier
s_waitcnt lgkmcnt(8)
v_mfma_f32_16x16x32_bf16 v[16:19], v[80:83], a[128:131], v[16:19]
ds_read_b64_tr_b16 v[100:101], v9 offset:57344
s_waitcnt lgkmcnt(7)
v_mfma_f32_16x16x32_bf16 v[16:19], v[84:87], a[144:147], v[16:19]
s_add_u32 m0, s34, 36864
s_add_u32 s31, s35, 37888
s_waitcnt lgkmcnt(5)
v_mfma_f32_16x16x32_bf16 v[48:51], v[88:91], a[0:3], 0
ds_read_b64_tr_b16 v[102:103], v9 offset:59392
v_mfma_f32_16x16x32_bf16 v[24:27], v[80:83], a[132:135], v[24:27]
buffer_load_dwordx4 v10, s[20:23], s31 offen lds
v_mfma_f32_16x16x32_bf16 v[24:27], v[84:87], a[148:151], v[24:27]
ds_read_b64_tr_b16 v[104:105], v8 offset:61440
v_mfma_f32_16x16x32_bf16 v[56:59], v[88:91], a[4:7], 0
v_mfma_f32_16x16x32_bf16 v[32:35], v[80:83], a[136:139], v[32:35]
ds_read_b64_tr_b16 v[106:107], v8 offset:63488
v_mfma_f32_16x16x32_bf16 v[32:35], v[84:87], a[152:155], v[32:35]
v_mfma_f32_16x16x32_bf16 v[64:67], v[88:91], a[8:11], 0
ds_read_b64_tr_b16 v[108:109], v5 offset:0
v_mfma_f32_16x16x32_bf16 v[40:43], v[80:83], a[140:143], v[40:43]
s_add_u32 m0, s34, 40960
s_add_u32 s31, s35, 74752
v_mfma_f32_16x16x32_bf16 v[40:43], v[84:87], a[156:159], v[40:43]
ds_read_b64_tr_b16 v[110:111], v5 offset:2048
v_mfma_f32_16x16x32_bf16 v[72:75], v[88:91], a[12:15], 0
buffer_load_dwordx4 v10, s[20:23], s31 offen lds
s_waitcnt lgkmcnt(8)
v_mfma_f32_16x16x32_bf16 v[20:23], v[92:95], a[128:131], v[20:23]
ds_read_b64_tr_b16 v[80:81], v5 offset:4096
s_waitcnt lgkmcnt(7)
v_mfma_f32_16x16x32_bf16 v[20:23], v[96:99], a[144:147], v[20:23]
s_waitcnt lgkmcnt(5)
v_mfma_f32_16x16x32_bf16 v[52:55], v[100:103], a[0:3], 0
ds_read_b64_tr_b16 v[82:83], v5 offset:6144
v_mfma_f32_16x16x32_bf16 v[28:31], v[92:95], a[132:135], v[28:31]
v_mfma_f32_16x16x32_bf16 v[28:31], v[96:99], a[148:151], v[28:31]
ds_read_b64_tr_b16 v[84:85], v9 offset:61440
v_mfma_f32_16x16x32_bf16 v[60:63], v[100:103], a[4:7], 0
s_add_u32 m0, s34, 45056
s_add_u32 s31, s35, 111616
v_mfma_f32_16x16x32_bf16 v[36:39], v[92:95], a[136:139], v[36:39]
ds_read_b64_tr_b16 v[86:87], v9 offset:63488
v_mfma_f32_16x16x32_bf16 v[36:39], v[96:99], a[152:155], v[36:39]
buffer_load_dwordx4 v10, s[20:23], s31 offen lds
v_mfma_f32_16x16x32_bf16 v[68:71], v[100:103], a[8:11], 0
ds_read_b64_tr_b16 v[88:89], v6 offset:0
v_mfma_f32_16x16x32_bf16 v[44:47], v[92:95], a[140:143], v[44:47]
v_mfma_f32_16x16x32_bf16 v[44:47], v[96:99], a[156:159], v[44:47]
ds_read_b64_tr_b16 v[90:91], v6 offset:2048
v_mfma_f32_16x16x32_bf16 v[76:79], v[100:103], a[12:15], 0
s_waitcnt vmcnt(36)
s_barrier
s_waitcnt lgkmcnt(8)
v_mfma_f32_16x16x32_bf16 v[48:51], v[104:107], a[16:19], v[48:51]
ds_read_b64_tr_b16 v[92:93], v6 offset:4096
s_waitcnt lgkmcnt(7)
v_mfma_f32_16x16x32_bf16 v[48:51], v[108:111], a[32:35], v[48:51]
s_add_u32 m0, s34, 49152
s_add_u32 s31, s35, 148480
s_waitcnt lgkmcnt(5)
v_mfma_f32_16x16x32_bf16 v[48:51], v[80:83], a[48:51], v[48:51]
ds_read_b64_tr_b16 v[94:95], v6 offset:6144
s_add_u32 s37, s36, 32768
v_mfma_f32_16x16x32_bf16 v[56:59], v[104:107], a[20:23], v[56:59]
buffer_load_dwordx4 v10, s[20:23], s31 offen lds
v_cvt_pk_bf16_f32 v176, v16, v17
v_mfma_f32_16x16x32_bf16 v[56:59], v[108:111], a[36:39], v[56:59]
ds_read_b64_tr_b16 v[96:97], v5 offset:8192
v_cvt_pk_bf16_f32 v177, v18, v19
v_mfma_f32_16x16x32_bf16 v[56:59], v[80:83], a[52:55], v[56:59]
v_cvt_pk_bf16_f32 v178, v20, v21
v_mfma_f32_16x16x32_bf16 v[64:67], v[104:107], a[24:27], v[64:67]
ds_read_b64_tr_b16 v[98:99], v5 offset:10240
v_cvt_pk_bf16_f32 v179, v22, v23
v_mfma_f32_16x16x32_bf16 v[64:67], v[108:111], a[40:43], v[64:67]
buffer_store_dwordx4 v[176:179], v11, s[8:11], s37 offen offset:0 sc1
v_mfma_f32_16x16x32_bf16 v[64:67], v[80:83], a[56:59], v[64:67]
ds_read_b64_tr_b16 v[100:101], v5 offset:12288
v_cvt_pk_bf16_f32 v180, v24, v25
v_mfma_f32_16x16x32_bf16 v[72:75], v[104:107], a[28:31], v[72:75]
s_add_u32 m0, s34, 53248
s_add_u32 s31, s35, 185344
v_cvt_pk_bf16_f32 v181, v26, v27
v_mfma_f32_16x16x32_bf16 v[72:75], v[108:111], a[44:47], v[72:75]
ds_read_b64_tr_b16 v[102:103], v5 offset:14336
v_cvt_pk_bf16_f32 v182, v28, v29
v_mfma_f32_16x16x32_bf16 v[72:75], v[80:83], a[60:63], v[72:75]
buffer_load_dwordx4 v10, s[20:23], s31 offen lds
s_waitcnt lgkmcnt(8)
v_mfma_f32_16x16x32_bf16 v[52:55], v[84:87], a[16:19], v[52:55]
ds_read_b64_tr_b16 v[104:105], v5 offset:16384
v_cvt_pk_bf16_f32 v183, v30, v31
s_waitcnt lgkmcnt(7)
v_mfma_f32_16x16x32_bf16 v[52:55], v[88:91], a[32:35], v[52:55]
buffer_store_dwordx4 v[180:183], v11, s[8:11], s37 offen offset:1024 sc1
s_waitcnt lgkmcnt(5)
v_mfma_f32_16x16x32_bf16 v[52:55], v[92:95], a[48:51], v[52:55]
ds_read_b64_tr_b16 v[106:107], v5 offset:18432
v_cvt_pk_bf16_f32 v184, v32, v33
v_mfma_f32_16x16x32_bf16 v[60:63], v[84:87], a[20:23], v[60:63]
v_cvt_pk_bf16_f32 v185, v34, v35
v_cvt_pk_bf16_f32 v186, v36, v37
v_mfma_f32_16x16x32_bf16 v[60:63], v[88:91], a[36:39], v[60:63]
ds_read_b64_tr_b16 v[108:109], v6 offset:8192
v_mfma_f32_16x16x32_bf16 v[60:63], v[92:95], a[52:55], v[60:63]
s_add_u32 m0, s34, 57344
s_add_u32 s31, s35, 222208
v_cvt_pk_bf16_f32 v187, v38, v39
v_mfma_f32_16x16x32_bf16 v[68:71], v[84:87], a[24:27], v[68:71]
ds_read_b64_tr_b16 v[110:111], v6 offset:10240
buffer_store_dwordx4 v[184:187], v11, s[8:11], s37 offen offset:2048 sc1
v_mfma_f32_16x16x32_bf16 v[68:71], v[88:91], a[40:43], v[68:71]
buffer_load_dwordx4 v10, s[20:23], s31 offen lds
v_cvt_pk_bf16_f32 v188, v40, v41
v_mfma_f32_16x16x32_bf16 v[68:71], v[92:95], a[56:59], v[68:71]
ds_read_b64_tr_b16 v[80:81], v6 offset:12288
v_mfma_f32_16x16x32_bf16 v[76:79], v[84:87], a[28:31], v[76:79]
v_cvt_pk_bf16_f32 v189, v42, v43
v_cvt_pk_bf16_f32 v190, v44, v45
v_mfma_f32_16x16x32_bf16 v[76:79], v[88:91], a[44:47], v[76:79]
ds_read_b64_tr_b16 v[82:83], v6 offset:14336
v_mfma_f32_16x16x32_bf16 v[76:79], v[92:95], a[60:63], v[76:79]
v_cvt_pk_bf16_f32 v191, v46, v47
buffer_store_dwordx4 v[188:191], v11, s[8:11], s37 offen offset:3072 sc1
s_waitcnt vmcnt(39)
s_barrier
s_waitcnt lgkmcnt(8)
v_mfma_f32_16x16x32_bf16 v[48:51], v[96:99], a[64:67], v[48:51]
ds_read_b64_tr_b16 v[84:85], v6 offset:16384
s_waitcnt lgkmcnt(7)
v_mfma_f32_16x16x32_bf16 v[48:51], v[100:103], a[80:83], v[48:51]
s_add_u32 m0, s34, 61440
s_add_u32 s31, s35, 259072
s_waitcnt lgkmcnt(5)
v_mfma_f32_16x16x32_bf16 v[48:51], v[104:107], a[96:99], v[48:51]
ds_read_b64_tr_b16 v[86:87], v6 offset:18432
v_mfma_f32_16x16x32_bf16 v[56:59], v[96:99], a[68:71], v[56:59]
buffer_load_dwordx4 v10, s[20:23], s31 offen lds
v_mfma_f32_16x16x32_bf16 v[56:59], v[100:103], a[84:87], v[56:59]
ds_read_b64_tr_b16 v[88:89], v5 offset:20480
v_mfma_f32_16x16x32_bf16 v[56:59], v[104:107], a[100:103], v[56:59]
v_mfma_f32_16x16x32_bf16 v[64:67], v[96:99], a[72:75], v[64:67]
ds_read_b64_tr_b16 v[90:91], v5 offset:22528
v_mfma_f32_16x16x32_bf16 v[64:67], v[100:103], a[88:91], v[64:67]
v_mfma_f32_16x16x32_bf16 v[64:67], v[104:107], a[104:107], v[64:67]
ds_read_b64_tr_b16 v[92:93], v5 offset:24576
v_mfma_f32_16x16x32_bf16 v[72:75], v[96:99], a[76:79], v[72:75]
s_add_u32 m0, s34, 65536
s_add_u32 s31, s35, 295936
v_mfma_f32_16x16x32_bf16 v[72:75], v[100:103], a[92:95], v[72:75]
ds_read_b64_tr_b16 v[94:95], v5 offset:26624
v_mfma_f32_16x16x32_bf16 v[72:75], v[104:107], a[108:111], v[72:75]
buffer_load_dwordx4 v10, s[20:23], s31 offen lds
s_waitcnt lgkmcnt(8)
v_mfma_f32_16x16x32_bf16 v[52:55], v[108:111], a[64:67], v[52:55]
ds_read_b64_tr_b16 v[96:97], v5 offset:28672
s_waitcnt lgkmcnt(7)
v_mfma_f32_16x16x32_bf16 v[52:55], v[80:83], a[80:83], v[52:55]
s_waitcnt lgkmcnt(5)
v_mfma_f32_16x16x32_bf16 v[52:55], v[84:87], a[96:99], v[52:55]
ds_read_b64_tr_b16 v[98:99], v5 offset:30720
v_mfma_f32_16x16x32_bf16 v[60:63], v[108:111], a[68:71], v[60:63]
v_mfma_f32_16x16x32_bf16 v[60:63], v[80:83], a[84:87], v[60:63]
ds_read_b64_tr_b16 v[100:101], v6 offset:20480
v_mfma_f32_16x16x32_bf16 v[60:63], v[84:87], a[100:103], v[60:63]
s_add_u32 m0, s34, 69632
s_add_u32 s31, s35, 332800
v_mfma_f32_16x16x32_bf16 v[68:71], v[108:111], a[72:75], v[68:71]
ds_read_b64_tr_b16 v[102:103], v6 offset:22528
v_mfma_f32_16x16x32_bf16 v[68:71], v[80:83], a[88:91], v[68:71]
buffer_load_dwordx4 v10, s[20:23], s31 offen lds
v_mfma_f32_16x16x32_bf16 v[68:71], v[84:87], a[104:107], v[68:71]
ds_read_b64_tr_b16 v[104:105], v6 offset:24576
v_mfma_f32_16x16x32_bf16 v[76:79], v[108:111], a[76:79], v[76:79]
v_mfma_f32_16x16x32_bf16 v[76:79], v[80:83], a[92:95], v[76:79]
ds_read_b64_tr_b16 v[106:107], v6 offset:26624
v_mfma_f32_16x16x32_bf16 v[76:79], v[84:87], a[108:111], v[76:79]
s_waitcnt vmcnt(39)
s_barrier
s_waitcnt lgkmcnt(8)
v_mfma_f32_16x16x32_bf16 v[48:51], v[88:91], a[112:115], v[48:51]
ds_read_b64_tr_b16 v[108:109], v6 offset:28672
s_waitcnt lgkmcnt(7)
v_mfma_f32_16x16x32_bf16 v[48:51], v[92:95], a[128:131], v[48:51]
s_waitcnt lgkmcnt(5)
v_mfma_f32_16x16x32_bf16 v[48:51], v[96:99], a[144:147], v[48:51]
ds_read_b64_tr_b16 v[110:111], v6 offset:30720
v_mfma_f32_16x16x32_bf16 v[56:59], v[88:91], a[116:119], v[56:59]
v_mfma_f32_16x16x32_bf16 v[56:59], v[92:95], a[132:135], v[56:59]
ds_read_b64_tr_b16 v[80:81], v5 offset:32768
v_mfma_f32_16x16x32_bf16 v[56:59], v[96:99], a[148:151], v[56:59]
v_mfma_f32_16x16x32_bf16 v[64:67], v[88:91], a[120:123], v[64:67]
ds_read_b64_tr_b16 v[82:83], v5 offset:34816
v_mfma_f32_16x16x32_bf16 v[64:67], v[92:95], a[136:139], v[64:67]
v_mfma_f32_16x16x32_bf16 v[64:67], v[96:99], a[152:155], v[64:67]
ds_read_b64_tr_b16 v[84:85], v5 offset:36864
v_mfma_f32_16x16x32_bf16 v[72:75], v[88:91], a[124:127], v[72:75]
v_mfma_f32_16x16x32_bf16 v[72:75], v[92:95], a[140:143], v[72:75]
ds_read_b64_tr_b16 v[86:87], v5 offset:38912
v_mfma_f32_16x16x32_bf16 v[72:75], v[96:99], a[156:159], v[72:75]
s_waitcnt lgkmcnt(8)
v_mfma_f32_16x16x32_bf16 v[52:55], v[100:103], a[112:115], v[52:55]
ds_read_b64_tr_b16 v[88:89], v5 offset:40960
s_waitcnt lgkmcnt(7)
v_mfma_f32_16x16x32_bf16 v[52:55], v[104:107], a[128:131], v[52:55]
s_waitcnt lgkmcnt(5)
v_mfma_f32_16x16x32_bf16 v[52:55], v[108:111], a[144:147], v[52:55]
ds_read_b64_tr_b16 v[90:91], v5 offset:43008
v_mfma_f32_16x16x32_bf16 v[60:63], v[100:103], a[116:119], v[60:63]
v_mfma_f32_16x16x32_bf16 v[60:63], v[104:107], a[132:135], v[60:63]
ds_read_b64_tr_b16 v[92:93], v6 offset:32768
v_mfma_f32_16x16x32_bf16 v[60:63], v[108:111], a[148:151], v[60:63]
v_mfma_f32_16x16x32_bf16 v[68:71], v[100:103], a[120:123], v[68:71]
ds_read_b64_tr_b16 v[94:95], v6 offset:34816
v_mfma_f32_16x16x32_bf16 v[68:71], v[104:107], a[136:139], v[68:71]
v_mfma_f32_16x16x32_bf16 v[68:71], v[108:111], a[152:155], v[68:71]
ds_read_b64_tr_b16 v[96:97], v6 offset:36864
v_mfma_f32_16x16x32_bf16 v[76:79], v[100:103], a[124:127], v[76:79]
v_mfma_f32_16x16x32_bf16 v[76:79], v[104:107], a[140:143], v[76:79]
ds_read_b64_tr_b16 v[98:99], v6 offset:38912
v_mfma_f32_16x16x32_bf16 v[76:79], v[108:111], a[156:159], v[76:79]
s_waitcnt vmcnt(33)
s_barrier
s_waitcnt lgkmcnt(8)
v_mfma_f32_16x16x32_bf16 v[16:19], v[80:83], a[0:3], 0
ds_read_b64_tr_b16 v[100:101], v6 offset:40960
s_waitcnt lgkmcnt(7)
v_mfma_f32_16x16x32_bf16 v[16:19], v[84:87], a[16:19], v[16:19]
s_waitcnt lgkmcnt(5)
v_mfma_f32_16x16x32_bf16 v[16:19], v[88:91], a[32:35], v[16:19]
ds_read_b64_tr_b16 v[102:103], v6 offset:43008
s_add_u32 s37, s36, 40960
v_mfma_f32_16x16x32_bf16 v[24:27], v[80:83], a[4:7], 0
v_cvt_pk_bf16_f32 v176, v48, v49
v_cvt_pk_bf16_f32 v177, v50, v51
v_mfma_f32_16x16x32_bf16 v[24:27], v[84:87], a[20:23], v[24:27]
ds_read_b64_tr_b16 v[104:105], v5 offset:45056
v_mfma_f32_16x16x32_bf16 v[24:27], v[88:91], a[36:39], v[24:27]
v_cvt_pk_bf16_f32 v178, v52, v53
v_mfma_f32_16x16x32_bf16 v[32:35], v[80:83], a[8:11], 0
ds_read_b64_tr_b16 v[106:107], v5 offset:47104
v_cvt_pk_bf16_f32 v179, v54, v55
v_mfma_f32_16x16x32_bf16 v[32:35], v[84:87], a[24:27], v[32:35]
buffer_store_dwordx4 v[176:179], v11, s[8:11], s37 offen offset:0 sc1
v_mfma_f32_16x16x32_bf16 v[32:35], v[88:91], a[40:43], v[32:35]
ds_read_b64_tr_b16 v[108:109], v5 offset:49152
v_cvt_pk_bf16_f32 v180, v56, v57
v_mfma_f32_16x16x32_bf16 v[40:43], v[80:83], a[12:15], 0
v_cvt_pk_bf16_f32 v181, v58, v59
v_mfma_f32_16x16x32_bf16 v[40:43], v[84:87], a[28:31], v[40:43]
ds_read_b64_tr_b16 v[110:111], v5 offset:51200
v_cvt_pk_bf16_f32 v182, v60, v61
v_mfma_f32_16x16x32_bf16 v[40:43], v[88:91], a[44:47], v[40:43]
v_cvt_pk_bf16_f32 v183, v62, v63
s_waitcnt lgkmcnt(8)
v_mfma_f32_16x16x32_bf16 v[20:23], v[92:95], a[0:3], 0
ds_read_b64_tr_b16 v[80:81], v5 offset:53248
s_waitcnt lgkmcnt(7)
v_mfma_f32_16x16x32_bf16 v[20:23], v[96:99], a[16:19], v[20:23]
buffer_store_dwordx4 v[180:183], v11, s[8:11], s37 offen offset:1024 sc1
v_cvt_pk_bf16_f32 v184, v64, v65
s_waitcnt lgkmcnt(5)
v_mfma_f32_16x16x32_bf16 v[20:23], v[100:103], a[32:35], v[20:23]
ds_read_b64_tr_b16 v[82:83], v5 offset:55296
v_mfma_f32_16x16x32_bf16 v[28:31], v[92:95], a[4:7], 0
v_cvt_pk_bf16_f32 v185, v66, v67
v_cvt_pk_bf16_f32 v186, v68, v69
v_mfma_f32_16x16x32_bf16 v[28:31], v[96:99], a[20:23], v[28:31]
ds_read_b64_tr_b16 v[84:85], v6 offset:45056
v_mfma_f32_16x16x32_bf16 v[28:31], v[100:103], a[36:39], v[28:31]
v_cvt_pk_bf16_f32 v187, v70, v71
v_mfma_f32_16x16x32_bf16 v[36:39], v[92:95], a[8:11], 0
ds_read_b64_tr_b16 v[86:87], v6 offset:47104
buffer_store_dwordx4 v[184:187], v11, s[8:11], s37 offen offset:2048 sc1
v_mfma_f32_16x16x32_bf16 v[36:39], v[96:99], a[24:27], v[36:39]
v_cvt_pk_bf16_f32 v188, v72, v73
v_mfma_f32_16x16x32_bf16 v[36:39], v[100:103], a[40:43], v[36:39]
ds_read_b64_tr_b16 v[88:89], v6 offset:49152
v_cvt_pk_bf16_f32 v189, v74, v75
v_mfma_f32_16x16x32_bf16 v[44:47], v[92:95], a[12:15], 0
v_cvt_pk_bf16_f32 v190, v76, v77
v_mfma_f32_16x16x32_bf16 v[44:47], v[96:99], a[28:31], v[44:47]
ds_read_b64_tr_b16 v[90:91], v6 offset:51200
v_cvt_pk_bf16_f32 v191, v78, v79
v_mfma_f32_16x16x32_bf16 v[44:47], v[100:103], a[44:47], v[44:47]
buffer_store_dwordx4 v[188:191], v11, s[8:11], s37 offen offset:3072 sc1
s_waitcnt vmcnt(33)
s_barrier
s_waitcnt lgkmcnt(8)
v_mfma_f32_16x16x32_bf16 v[16:19], v[104:107], a[48:51], v[16:19]
ds_read_b64_tr_b16 v[92:93], v6 offset:53248
s_waitcnt lgkmcnt(7)
v_mfma_f32_16x16x32_bf16 v[16:19], v[108:111], a[64:67], v[16:19]
s_waitcnt lgkmcnt(5)
v_mfma_f32_16x16x32_bf16 v[16:19], v[80:83], a[80:83], v[16:19]
ds_read_b64_tr_b16 v[94:95], v6 offset:55296
v_mfma_f32_16x16x32_bf16 v[24:27], v[104:107], a[52:55], v[24:27]
v_mfma_f32_16x16x32_bf16 v[24:27], v[108:111], a[68:71], v[24:27]
ds_read_b64_tr_b16 v[96:97], v5 offset:57344
v_mfma_f32_16x16x32_bf16 v[24:27], v[80:83], a[84:87], v[24:27]
v_mfma_f32_16x16x32_bf16 v[32:35], v[104:107], a[56:59], v[32:35]
ds_read_b64_tr_b16 v[98:99], v5 offset:59392
v_mfma_f32_16x16x32_bf16 v[32:35], v[108:111], a[72:75], v[32:35]
v_mfma_f32_16x16x32_bf16 v[32:35], v[80:83], a[88:91], v[32:35]
ds_read_b64_tr_b16 v[100:101], v5 offset:61440
v_mfma_f32_16x16x32_bf16 v[40:43], v[104:107], a[60:63], v[40:43]
v_mfma_f32_16x16x32_bf16 v[40:43], v[108:111], a[76:79], v[40:43]
ds_read_b64_tr_b16 v[102:103], v5 offset:63488
v_mfma_f32_16x16x32_bf16 v[40:43], v[80:83], a[92:95], v[40:43]
s_waitcnt lgkmcnt(8)
v_mfma_f32_16x16x32_bf16 v[20:23], v[84:87], a[48:51], v[20:23]
ds_read_b64_tr_b16 v[104:105], v2 offset:0
s_waitcnt lgkmcnt(7)
v_mfma_f32_16x16x32_bf16 v[20:23], v[88:91], a[64:67], v[20:23]
s_waitcnt lgkmcnt(5)
v_mfma_f32_16x16x32_bf16 v[20:23], v[92:95], a[80:83], v[20:23]
ds_read_b64_tr_b16 v[106:107], v2 offset:2048
v_mfma_f32_16x16x32_bf16 v[28:31], v[84:87], a[52:55], v[28:31]
v_mfma_f32_16x16x32_bf16 v[28:31], v[88:91], a[68:71], v[28:31]
ds_read_b64_tr_b16 v[108:109], v6 offset:57344
v_mfma_f32_16x16x32_bf16 v[28:31], v[92:95], a[84:87], v[28:31]
v_mfma_f32_16x16x32_bf16 v[36:39], v[84:87], a[56:59], v[36:39]
ds_read_b64_tr_b16 v[110:111], v6 offset:59392
v_mfma_f32_16x16x32_bf16 v[36:39], v[88:91], a[72:75], v[36:39]
v_mfma_f32_16x16x32_bf16 v[36:39], v[92:95], a[88:91], v[36:39]
ds_read_b64_tr_b16 v[80:81], v6 offset:61440
v_mfma_f32_16x16x32_bf16 v[44:47], v[84:87], a[60:63], v[44:47]
v_mfma_f32_16x16x32_bf16 v[44:47], v[88:91], a[76:79], v[44:47]
ds_read_b64_tr_b16 v[82:83], v6 offset:63488
v_mfma_f32_16x16x32_bf16 v[44:47], v[92:95], a[92:95], v[44:47]
s_waitcnt vmcnt(30)
s_barrier
s_waitcnt lgkmcnt(8)
v_mfma_f32_16x16x32_bf16 v[16:19], v[96:99], a[96:99], v[16:19]
ds_read_b64_tr_b16 v[84:85], v3 offset:0
s_waitcnt lgkmcnt(7)
v_mfma_f32_16x16x32_bf16 v[16:19], v[100:103], a[112:115], v[16:19]
s_waitcnt lgkmcnt(5)
v_mfma_f32_16x16x32_bf16 v[16:19], v[104:107], a[128:131], v[16:19]
ds_read_b64_tr_b16 v[86:87], v3 offset:2048
v_mfma_f32_16x16x32_bf16 v[24:27], v[96:99], a[100:103], v[24:27]
v_mfma_f32_16x16x32_bf16 v[24:27], v[100:103], a[116:119], v[24:27]
ds_read_b64_tr_b16 v[88:89], v2 offset:4096
v_mfma_f32_16x16x32_bf16 v[24:27], v[104:107], a[132:135], v[24:27]
v_mfma_f32_16x16x32_bf16 v[32:35], v[96:99], a[104:107], v[32:35]
ds_read_b64_tr_b16 v[90:91], v2 offset:6144
v_mfma_f32_16x16x32_bf16 v[32:35], v[100:103], a[120:123], v[32:35]
v_mfma_f32_16x16x32_bf16 v[32:35], v[104:107], a[136:139], v[32:35]
ds_read_b64_tr_b16 v[92:93], v2 offset:8192
v_mfma_f32_16x16x32_bf16 v[40:43], v[96:99], a[108:111], v[40:43]
v_mfma_f32_16x16x32_bf16 v[40:43], v[100:103], a[124:127], v[40:43]
ds_read_b64_tr_b16 v[94:95], v2 offset:10240
v_mfma_f32_16x16x32_bf16 v[40:43], v[104:107], a[140:143], v[40:43]
s_waitcnt lgkmcnt(8)
v_mfma_f32_16x16x32_bf16 v[20:23], v[108:111], a[96:99], v[20:23]
ds_read_b64_tr_b16 v[96:97], v2 offset:12288
s_waitcnt lgkmcnt(7)
v_mfma_f32_16x16x32_bf16 v[20:23], v[80:83], a[112:115], v[20:23]
s_waitcnt lgkmcnt(5)
v_mfma_f32_16x16x32_bf16 v[20:23], v[84:87], a[128:131], v[20:23]
ds_read_b64_tr_b16 v[98:99], v2 offset:14336
v_mfma_f32_16x16x32_bf16 v[28:31], v[108:111], a[100:103], v[28:31]
v_mfma_f32_16x16x32_bf16 v[28:31], v[80:83], a[116:119], v[28:31]
ds_read_b64_tr_b16 v[100:101], v3 offset:4096
v_mfma_f32_16x16x32_bf16 v[28:31], v[84:87], a[132:135], v[28:31]
v_mfma_f32_16x16x32_bf16 v[36:39], v[108:111], a[104:107], v[36:39]
ds_read_b64_tr_b16 v[102:103], v3 offset:6144
v_mfma_f32_16x16x32_bf16 v[36:39], v[80:83], a[120:123], v[36:39]
v_mfma_f32_16x16x32_bf16 v[36:39], v[84:87], a[136:139], v[36:39]
ds_read_b64_tr_b16 v[104:105], v3 offset:8192
v_mfma_f32_16x16x32_bf16 v[44:47], v[108:111], a[108:111], v[44:47]
v_mfma_f32_16x16x32_bf16 v[44:47], v[80:83], a[124:127], v[44:47]
ds_read_b64_tr_b16 v[106:107], v3 offset:10240
v_mfma_f32_16x16x32_bf16 v[44:47], v[84:87], a[140:143], v[44:47]
s_waitcnt vmcnt(27)
s_barrier
s_waitcnt lgkmcnt(8)
v_mfma_f32_16x16x32_bf16 v[16:19], v[88:91], a[144:147], v[16:19]
ds_read_b64_tr_b16 v[108:109], v3 offset:12288
s_waitcnt lgkmcnt(7)
v_mfma_f32_16x16x32_bf16 v[48:51], v[92:95], a[0:3], 0
s_waitcnt lgkmcnt(5)
v_mfma_f32_16x16x32_bf16 v[48:51], v[96:99], a[16:19], v[48:51]
ds_read_b64_tr_b16 v[110:111], v3 offset:14336
v_mfma_f32_16x16x32_bf16 v[24:27], v[88:91], a[148:151], v[24:27]
v_mfma_f32_16x16x32_bf16 v[56:59], v[92:95], a[4:7], 0
ds_read_b64_tr_b16 v[80:81], v8 offset:0
v_mfma_f32_16x16x32_bf16 v[56:59], v[96:99], a[20:23], v[56:59]
v_mfma_f32_16x16x32_bf16 v[32:35], v[88:91], a[152:155], v[32:35]
ds_read_b64_tr_b16 v[82:83], v8 offset:2048
v_mfma_f32_16x16x32_bf16 v[64:67], v[92:95], a[8:11], 0
v_mfma_f32_16x16x32_bf16 v[64:67], v[96:99], a[24:27], v[64:67]
ds_read_b64_tr_b16 v[84:85], v8 offset:4096
v_mfma_f32_16x16x32_bf16 v[40:43], v[88:91], a[156:159], v[40:43]
v_mfma_f32_16x16x32_bf16 v[72:75], v[92:95], a[12:15], 0
ds_read_b64_tr_b16 v[86:87], v8 offset:6144
v_mfma_f32_16x16x32_bf16 v[72:75], v[96:99], a[28:31], v[72:75]
s_waitcnt lgkmcnt(8)
v_mfma_f32_16x16x32_bf16 v[20:23], v[100:103], a[144:147], v[20:23]
ds_read_b64_tr_b16 v[88:89], v8 offset:8192
s_waitcnt lgkmcnt(7)
v_mfma_f32_16x16x32_bf16 v[52:55], v[104:107], a[0:3], 0
s_waitcnt lgkmcnt(5)
v_mfma_f32_16x16x32_bf16 v[52:55], v[108:111], a[16:19], v[52:55]
ds_read_b64_tr_b16 v[90:91], v8 offset:10240
v_mfma_f32_16x16x32_bf16 v[28:31], v[100:103], a[148:151], v[28:31]
v_mfma_f32_16x16x32_bf16 v[60:63], v[104:107], a[4:7], 0
ds_read_b64_tr_b16 v[92:93], v9 offset:0
v_mfma_f32_16x16x32_bf16 v[60:63], v[108:111], a[20:23], v[60:63]
v_mfma_f32_16x16x32_bf16 v[36:39], v[100:103], a[152:155], v[36:39]
ds_read_b64_tr_b16 v[94:95], v9 offset:2048
v_mfma_f32_16x16x32_bf16 v[68:71], v[104:107], a[8:11], 0
v_mfma_f32_16x16x32_bf16 v[68:71], v[108:111], a[24:27], v[68:71]
ds_read_b64_tr_b16 v[96:97], v9 offset:4096
v_mfma_f32_16x16x32_bf16 v[44:47], v[100:103], a[156:159], v[44:47]
v_mfma_f32_16x16x32_bf16 v[76:79], v[104:107], a[12:15], 0
ds_read_b64_tr_b16 v[98:99], v9 offset:6144
v_mfma_f32_16x16x32_bf16 v[76:79], v[108:111], a[28:31], v[76:79]
s_waitcnt vmcnt(21)
s_barrier
s_waitcnt lgkmcnt(8)
v_mfma_f32_16x16x32_bf16 v[48:51], v[80:83], a[32:35], v[48:51]
ds_read_b64_tr_b16 v[100:101], v9 offset:8192
s_waitcnt lgkmcnt(7)
v_mfma_f32_16x16x32_bf16 v[48:51], v[84:87], a[48:51], v[48:51]
s_waitcnt lgkmcnt(5)
v_mfma_f32_16x16x32_bf16 v[48:51], v[88:91], a[64:67], v[48:51]
ds_read_b64_tr_b16 v[102:103], v9 offset:10240
s_add_u32 s37, s36, 49152
v_mfma_f32_16x16x32_bf16 v[56:59], v[80:83], a[36:39], v[56:59]
v_cvt_pk_bf16_f32 v176, v16, v17
v_cvt_pk_bf16_f32 v177, v18, v19
v_mfma_f32_16x16x32_bf16 v[56:59], v[84:87], a[52:55], v[56:59]
ds_read_b64_tr_b16 v[104:105], v8 offset:12288
v_mfma_f32_16x16x32_bf16 v[56:59], v[88:91], a[68:71], v[56:59]
v_cvt_pk_bf16_f32 v178, v20, v21
v_mfma_f32_16x16x32_bf16 v[64:67], v[80:83], a[40:43], v[64:67]
ds_read_b64_tr_b16 v[106:107], v8 offset:14336
v_cvt_pk_bf16_f32 v179, v22, v23
v_mfma_f32_16x16x32_bf16 v[64:67], v[84:87], a[56:59], v[64:67]
buffer_store_dwordx4 v[176:179], v11, s[8:11], s37 offen offset:0 sc1
v_mfma_f32_16x16x32_bf16 v[64:67], v[88:91], a[72:75], v[64:67]
ds_read_b64_tr_b16 v[108:109], v8 offset:16384
v_cvt_pk_bf16_f32 v180, v24, v25
v_mfma_f32_16x16x32_bf16 v[72:75], v[80:83], a[44:47], v[72:75]
v_cvt_pk_bf16_f32 v181, v26, v27
v_mfma_f32_16x16x32_bf16 v[72:75], v[84:87], a[60:63], v[72:75]
ds_read_b64_tr_b16 v[110:111], v8 offset:18432
v_cvt_pk_bf16_f32 v182, v28, v29
v_mfma_f32_16x16x32_bf16 v[72:75], v[88:91], a[76:79], v[72:75]
v_cvt_pk_bf16_f32 v183, v30, v31
s_waitcnt lgkmcnt(8)
v_mfma_f32_16x16x32_bf16 v[52:55], v[92:95], a[32:35], v[52:55]
ds_read_b64_tr_b16 v[80:81], v8 offset:20480
s_waitcnt lgkmcnt(7)
v_mfma_f32_16x16x32_bf16 v[52:55], v[96:99], a[48:51], v[52:55]
buffer_store_dwordx4 v[180:183], v11, s[8:11], s37 offen offset:1024 sc1
v_cvt_pk_bf16_f32 v184, v32, v33
s_waitcnt lgkmcnt(5)
v_mfma_f32_16x16x32_bf16 v[52:55], v[100:103], a[64:67], v[52:55]
ds_read_b64_tr_b16 v[82:83], v8 offset:22528
v_mfma_f32_16x16x32_bf16 v[60:63], v[92:95], a[36:39], v[60:63]
v_cvt_pk_bf16_f32 v185, v34, v35
v_cvt_pk_bf16_f32 v186, v36, v37
v_mfma_f32_16x16x32_bf16 v[60:63], v[96:99], a[52:55], v[60:63]
ds_read_b64_tr_b16 v[84:85], v9 offset:12288
v_mfma_f32_16x16x32_bf16 v[60:63], v[100:103], a[68:71], v[60:63]
v_cvt_pk_bf16_f32 v187, v38, v39
v_mfma_f32_16x16x32_bf16 v[68:71], v[92:95], a[40:43], v[68:71]
ds_read_b64_tr_b16 v[86:87], v9 offset:14336
buffer_store_dwordx4 v[184:187], v11, s[8:11], s37 offen offset:2048 sc1
v_mfma_f32_16x16x32_bf16 v[68:71], v[96:99], a[56:59], v[68:71]
v_cvt_pk_bf16_f32 v188, v40, v41
v_mfma_f32_16x16x32_bf16 v[68:71], v[100:103], a[72:75], v[68:71]
ds_read_b64_tr_b16 v[88:89], v9 offset:16384
v_cvt_pk_bf16_f32 v189, v42, v43
v_mfma_f32_16x16x32_bf16 v[76:79], v[92:95], a[44:47], v[76:79]
v_cvt_pk_bf16_f32 v190, v44, v45
v_mfma_f32_16x16x32_bf16 v[76:79], v[96:99], a[60:63], v[76:79]
ds_read_b64_tr_b16 v[90:91], v9 offset:18432
v_cvt_pk_bf16_f32 v191, v46, v47
v_mfma_f32_16x16x32_bf16 v[76:79], v[100:103], a[76:79], v[76:79]
buffer_store_dwordx4 v[188:191], v11, s[8:11], s37 offen offset:3072 sc1
s_waitcnt vmcnt(21)
s_barrier
s_waitcnt lgkmcnt(8)
v_mfma_f32_16x16x32_bf16 v[48:51], v[104:107], a[80:83], v[48:51]
ds_read_b64_tr_b16 v[92:93], v9 offset:20480
s_waitcnt lgkmcnt(7)
v_mfma_f32_16x16x32_bf16 v[48:51], v[108:111], a[96:99], v[48:51]
s_waitcnt lgkmcnt(5)
v_mfma_f32_16x16x32_bf16 v[48:51], v[80:83], a[112:115], v[48:51]
ds_read_b64_tr_b16 v[94:95], v9 offset:22528
v_mfma_f32_16x16x32_bf16 v[56:59], v[104:107], a[84:87], v[56:59]
v_mfma_f32_16x16x32_bf16 v[56:59], v[108:111], a[100:103], v[56:59]
ds_read_b64_tr_b16 v[96:97], v8 offset:24576
v_mfma_f32_16x16x32_bf16 v[56:59], v[80:83], a[116:119], v[56:59]
v_mfma_f32_16x16x32_bf16 v[64:67], v[104:107], a[88:91], v[64:67]
ds_read_b64_tr_b16 v[98:99], v8 offset:26624
v_mfma_f32_16x16x32_bf16 v[64:67], v[108:111], a[104:107], v[64:67]
v_mfma_f32_16x16x32_bf16 v[64:67], v[80:83], a[120:123], v[64:67]
ds_read_b64_tr_b16 v[100:101], v8 offset:28672
v_mfma_f32_16x16x32_bf16 v[72:75], v[104:107], a[92:95], v[72:75]
v_mfma_f32_16x16x32_bf16 v[72:75], v[108:111], a[108:111], v[72:75]
ds_read_b64_tr_b16 v[102:103], v8 offset:30720
v_mfma_f32_16x16x32_bf16 v[72:75], v[80:83], a[124:127], v[72:75]
s_waitcnt lgkmcnt(8)
v_mfma_f32_16x16x32_bf16 v[52:55], v[84:87], a[80:83], v[52:55]
ds_read_b64_tr_b16 v[104:105], v8 offset:32768
s_waitcnt lgkmcnt(7)
v_mfma_f32_16x16x32_bf16 v[52:55], v[88:91], a[96:99], v[52:55]
s_waitcnt lgkmcnt(5)
v_mfma_f32_16x16x32_bf16 v[52:55], v[92:95], a[112:115], v[52:55]
ds_read_b64_tr_b16 v[106:107], v8 offset:34816
v_mfma_f32_16x16x32_bf16 v[60:63], v[84:87], a[84:87], v[60:63]
v_mfma_f32_16x16x32_bf16 v[60:63], v[88:91], a[100:103], v[60:63]
ds_read_b64_tr_b16 v[108:109], v9 offset:24576
v_mfma_f32_16x16x32_bf16 v[60:63], v[92:95], a[116:119], v[60:63]
v_mfma_f32_16x16x32_bf16 v[68:71], v[84:87], a[88:91], v[68:71]
ds_read_b64_tr_b16 v[110:111], v9 offset:26624
v_mfma_f32_16x16x32_bf16 v[68:71], v[88:91], a[104:107], v[68:71]
v_mfma_f32_16x16x32_bf16 v[68:71], v[92:95], a[120:123], v[68:71]
ds_read_b64_tr_b16 v[80:81], v9 offset:28672
v_mfma_f32_16x16x32_bf16 v[76:79], v[84:87], a[92:95], v[76:79]
v_mfma_f32_16x16x32_bf16 v[76:79], v[88:91], a[108:111], v[76:79]
ds_read_b64_tr_b16 v[82:83], v9 offset:30720
v_mfma_f32_16x16x32_bf16 v[76:79], v[92:95], a[124:127], v[76:79]
s_waitcnt vmcnt(18)
s_barrier
s_waitcnt lgkmcnt(8)
v_mfma_f32_16x16x32_bf16 v[48:51], v[96:99], a[128:131], v[48:51]
ds_read_b64_tr_b16 v[84:85], v9 offset:32768
s_waitcnt lgkmcnt(7)
v_mfma_f32_16x16x32_bf16 v[48:51], v[100:103], a[144:147], v[48:51]
s_waitcnt lgkmcnt(5)
v_mfma_f32_16x16x32_bf16 v[16:19], v[104:107], a[0:3], 0
ds_read_b64_tr_b16 v[86:87], v9 offset:34816
v_mfma_f32_16x16x32_bf16 v[56:59], v[96:99], a[132:135], v[56:59]
global_load_dword v222, v[220:221], off
v_mfma_f32_16x16x32_bf16 v[56:59], v[100:103], a[148:151], v[56:59]
ds_read_b64_tr_b16 v[88:89], v8 offset:36864
v_mfma_f32_16x16x32_bf16 v[24:27], v[104:107], a[4:7], 0
v_mfma_f32_16x16x32_bf16 v[64:67], v[96:99], a[136:139], v[64:67]
ds_read_b64_tr_b16 v[90:91], v8 offset:38912
v_mfma_f32_16x16x32_bf16 v[64:67], v[100:103], a[152:155], v[64:67]
v_mfma_f32_16x16x32_bf16 v[32:35], v[104:107], a[8:11], 0
ds_read_b64_tr_b16 v[92:93], v8 offset:40960
v_mfma_f32_16x16x32_bf16 v[72:75], v[96:99], a[140:143], v[72:75]
v_mfma_f32_16x16x32_bf16 v[72:75], v[100:103], a[156:159], v[72:75]
ds_read_b64_tr_b16 v[94:95], v8 offset:43008
v_mfma_f32_16x16x32_bf16 v[40:43], v[104:107], a[12:15], 0
s_waitcnt lgkmcnt(8)
v_mfma_f32_16x16x32_bf16 v[52:55], v[108:111], a[128:131], v[52:55]
ds_read_b64_tr_b16 v[96:97], v8 offset:45056
s_waitcnt lgkmcnt(7)
v_mfma_f32_16x16x32_bf16 v[52:55], v[80:83], a[144:147], v[52:55]
s_waitcnt lgkmcnt(5)
v_mfma_f32_16x16x32_bf16 v[20:23], v[84:87], a[0:3], 0
ds_read_b64_tr_b16 v[98:99], v8 offset:47104
v_mfma_f32_16x16x32_bf16 v[60:63], v[108:111], a[132:135], v[60:63]
v_mfma_f32_16x16x32_bf16 v[60:63], v[80:83], a[148:151], v[60:63]
ds_read_b64_tr_b16 v[100:101], v9 offset:36864
v_mfma_f32_16x16x32_bf16 v[28:31], v[84:87], a[4:7], 0
v_mfma_f32_16x16x32_bf16 v[68:71], v[108:111], a[136:139], v[68:71]
ds_read_b64_tr_b16 v[102:103], v9 offset:38912
v_mfma_f32_16x16x32_bf16 v[68:71], v[80:83], a[152:155], v[68:71]
v_mfma_f32_16x16x32_bf16 v[36:39], v[84:87], a[8:11], 0
ds_read_b64_tr_b16 v[104:105], v9 offset:40960
v_mfma_f32_16x16x32_bf16 v[76:79], v[108:111], a[140:143], v[76:79]
v_mfma_f32_16x16x32_bf16 v[76:79], v[80:83], a[156:159], v[76:79]
ds_read_b64_tr_b16 v[106:107], v9 offset:43008
v_mfma_f32_16x16x32_bf16 v[44:47], v[84:87], a[12:15], 0
s_waitcnt vmcnt(13)
s_barrier
s_waitcnt lgkmcnt(8)
v_mfma_f32_16x16x32_bf16 v[16:19], v[88:91], a[16:19], v[16:19]
ds_read_b64_tr_b16 v[108:109], v9 offset:45056
s_waitcnt lgkmcnt(7)
v_mfma_f32_16x16x32_bf16 v[16:19], v[92:95], a[32:35], v[16:19]
s_waitcnt lgkmcnt(5)
v_mfma_f32_16x16x32_bf16 v[16:19], v[96:99], a[48:51], v[16:19]
ds_read_b64_tr_b16 v[110:111], v9 offset:47104
s_add_u32 s37, s36, 57344
v_mfma_f32_16x16x32_bf16 v[24:27], v[88:91], a[20:23], v[24:27]
v_cvt_pk_bf16_f32 v176, v48, v49
v_cvt_pk_bf16_f32 v177, v50, v51
v_mfma_f32_16x16x32_bf16 v[24:27], v[92:95], a[36:39], v[24:27]
ds_read_b64_tr_b16 v[80:81], v8 offset:49152
v_mfma_f32_16x16x32_bf16 v[24:27], v[96:99], a[52:55], v[24:27]
v_cvt_pk_bf16_f32 v178, v52, v53
v_mfma_f32_16x16x32_bf16 v[32:35], v[88:91], a[24:27], v[32:35]
ds_read_b64_tr_b16 v[82:83], v8 offset:51200
v_cvt_pk_bf16_f32 v179, v54, v55
v_mfma_f32_16x16x32_bf16 v[32:35], v[92:95], a[40:43], v[32:35]
buffer_store_dwordx4 v[176:179], v11, s[8:11], s37 offen offset:0 sc1
v_mfma_f32_16x16x32_bf16 v[32:35], v[96:99], a[56:59], v[32:35]
ds_read_b64_tr_b16 v[84:85], v8 offset:53248
v_cvt_pk_bf16_f32 v180, v56, v57
v_mfma_f32_16x16x32_bf16 v[40:43], v[88:91], a[28:31], v[40:43]
v_cvt_pk_bf16_f32 v181, v58, v59
v_mfma_f32_16x16x32_bf16 v[40:43], v[92:95], a[44:47], v[40:43]
ds_read_b64_tr_b16 v[86:87], v8 offset:55296
v_cvt_pk_bf16_f32 v182, v60, v61
v_mfma_f32_16x16x32_bf16 v[40:43], v[96:99], a[60:63], v[40:43]
v_cvt_pk_bf16_f32 v183, v62, v63
s_waitcnt lgkmcnt(8)
v_mfma_f32_16x16x32_bf16 v[20:23], v[100:103], a[16:19], v[20:23]
ds_read_b64_tr_b16 v[88:89], v8 offset:57344
s_waitcnt lgkmcnt(7)
v_mfma_f32_16x16x32_bf16 v[20:23], v[104:107], a[32:35], v[20:23]
buffer_store_dwordx4 v[180:183], v11, s[8:11], s37 offen offset:1024 sc1
v_cvt_pk_bf16_f32 v184, v64, v65
s_waitcnt lgkmcnt(5)
v_mfma_f32_16x16x32_bf16 v[20:23], v[108:111], a[48:51], v[20:23]
ds_read_b64_tr_b16 v[90:91], v8 offset:59392
v_mfma_f32_16x16x32_bf16 v[28:31], v[100:103], a[20:23], v[28:31]
v_cvt_pk_bf16_f32 v185, v66, v67
v_cvt_pk_bf16_f32 v186, v68, v69
v_mfma_f32_16x16x32_bf16 v[28:31], v[104:107], a[36:39], v[28:31]
ds_read_b64_tr_b16 v[92:93], v9 offset:49152
v_mfma_f32_16x16x32_bf16 v[28:31], v[108:111], a[52:55], v[28:31]
v_cvt_pk_bf16_f32 v187, v70, v71
v_mfma_f32_16x16x32_bf16 v[36:39], v[100:103], a[24:27], v[36:39]
ds_read_b64_tr_b16 v[94:95], v9 offset:51200
buffer_store_dwordx4 v[184:187], v11, s[8:11], s37 offen offset:2048 sc1
v_mfma_f32_16x16x32_bf16 v[36:39], v[104:107], a[40:43], v[36:39]
v_cvt_pk_bf16_f32 v188, v72, v73
v_mfma_f32_16x16x32_bf16 v[36:39], v[108:111], a[56:59], v[36:39]
ds_read_b64_tr_b16 v[96:97], v9 offset:53248
v_cvt_pk_bf16_f32 v189, v74, v75
v_mfma_f32_16x16x32_bf16 v[44:47], v[100:103], a[28:31], v[44:47]
v_cvt_pk_bf16_f32 v190, v76, v77
v_mfma_f32_16x16x32_bf16 v[44:47], v[104:107], a[44:47], v[44:47]
ds_read_b64_tr_b16 v[98:99], v9 offset:55296
v_cvt_pk_bf16_f32 v191, v78, v79
v_mfma_f32_16x16x32_bf16 v[44:47], v[108:111], a[60:63], v[44:47]
buffer_store_dwordx4 v[188:191], v11, s[8:11], s37 offen offset:3072 sc1
s_waitcnt vmcnt(13)
s_barrier
s_waitcnt lgkmcnt(8)
v_mfma_f32_16x16x32_bf16 v[16:19], v[80:83], a[64:67], v[16:19]
ds_read_b64_tr_b16 v[100:101], v9 offset:57344
s_waitcnt lgkmcnt(7)
v_mfma_f32_16x16x32_bf16 v[16:19], v[84:87], a[80:83], v[16:19]
s_waitcnt lgkmcnt(5)
v_mfma_f32_16x16x32_bf16 v[16:19], v[88:91], a[96:99], v[16:19]
ds_read_b64_tr_b16 v[102:103], v9 offset:59392
v_mfma_f32_16x16x32_bf16 v[24:27], v[80:83], a[68:71], v[24:27]
v_mfma_f32_16x16x32_bf16 v[24:27], v[84:87], a[84:87], v[24:27]
ds_read_b64_tr_b16 v[104:105], v8 offset:61440
v_mfma_f32_16x16x32_bf16 v[24:27], v[88:91], a[100:103], v[24:27]
v_mfma_f32_16x16x32_bf16 v[32:35], v[80:83], a[72:75], v[32:35]
ds_read_b64_tr_b16 v[106:107], v8 offset:63488
v_mfma_f32_16x16x32_bf16 v[32:35], v[84:87], a[88:91], v[32:35]
v_mfma_f32_16x16x32_bf16 v[32:35], v[88:91], a[104:107], v[32:35]
ds_read_b64_tr_b16 v[108:109], v5 offset:0
v_mfma_f32_16x16x32_bf16 v[40:43], v[80:83], a[76:79], v[40:43]
v_mfma_f32_16x16x32_bf16 v[40:43], v[84:87], a[92:95], v[40:43]
ds_read_b64_tr_b16 v[110:111], v5 offset:2048
v_mfma_f32_16x16x32_bf16 v[40:43], v[88:91], a[108:111], v[40:43]
s_waitcnt lgkmcnt(8)
v_mfma_f32_16x16x32_bf16 v[20:23], v[92:95], a[64:67], v[20:23]
ds_read_b64_tr_b16 v[80:81], v5 offset:4096
s_waitcnt lgkmcnt(7)
v_mfma_f32_16x16x32_bf16 v[20:23], v[96:99], a[80:83], v[20:23]
s_waitcnt lgkmcnt(5)
v_mfma_f32_16x16x32_bf16 v[20:23], v[100:103], a[96:99], v[20:23]
ds_read_b64_tr_b16 v[82:83], v5 offset:6144
v_mfma_f32_16x16x32_bf16 v[28:31], v[92:95], a[68:71], v[28:31]
v_mfma_f32_16x16x32_bf16 v[28:31], v[96:99], a[84:87], v[28:31]
ds_read_b64_tr_b16 v[84:85], v9 offset:61440
v_mfma_f32_16x16x32_bf16 v[28:31], v[100:103], a[100:103], v[28:31]
v_mfma_f32_16x16x32_bf16 v[36:39], v[92:95], a[72:75], v[36:39]
ds_read_b64_tr_b16 v[86:87], v9 offset:63488
v_mfma_f32_16x16x32_bf16 v[36:39], v[96:99], a[88:91], v[36:39]
v_mfma_f32_16x16x32_bf16 v[36:39], v[100:103], a[104:107], v[36:39]
ds_read_b64_tr_b16 v[88:89], v6 offset:0
v_mfma_f32_16x16x32_bf16 v[44:47], v[92:95], a[76:79], v[44:47]
v_mfma_f32_16x16x32_bf16 v[44:47], v[96:99], a[92:95], v[44:47]
ds_read_b64_tr_b16 v[90:91], v6 offset:2048
v_mfma_f32_16x16x32_bf16 v[44:47], v[100:103], a[108:111], v[44:47]
s_waitcnt lgkmcnt(8)
v_mfma_f32_16x16x32_bf16 v[16:19], v[104:107], a[112:115], v[16:19]
ds_read_b64_tr_b16 v[92:93], v6 offset:4096
s_waitcnt lgkmcnt(7)
v_mfma_f32_16x16x32_bf16 v[16:19], v[108:111], a[128:131], v[16:19]
s_waitcnt lgkmcnt(5)
v_mfma_f32_16x16x32_bf16 v[16:19], v[80:83], a[144:147], v[16:19]
ds_read_b64_tr_b16 v[94:95], v6 offset:6144
v_mfma_f32_16x16x32_bf16 v[24:27], v[104:107], a[116:119], v[24:27]
v_mfma_f32_16x16x32_bf16 v[24:27], v[108:111], a[132:135], v[24:27]
v_mfma_f32_16x16x32_bf16 v[24:27], v[80:83], a[148:151], v[24:27]
v_mfma_f32_16x16x32_bf16 v[32:35], v[104:107], a[120:123], v[32:35]
v_mfma_f32_16x16x32_bf16 v[32:35], v[108:111], a[136:139], v[32:35]
v_mfma_f32_16x16x32_bf16 v[32:35], v[80:83], a[152:155], v[32:35]
v_mfma_f32_16x16x32_bf16 v[40:43], v[104:107], a[124:127], v[40:43]
v_mfma_f32_16x16x32_bf16 v[40:43], v[108:111], a[140:143], v[40:43]
v_mfma_f32_16x16x32_bf16 v[40:43], v[80:83], a[156:159], v[40:43]
s_waitcnt lgkmcnt(4)
v_mfma_f32_16x16x32_bf16 v[20:23], v[84:87], a[112:115], v[20:23]
s_waitcnt lgkmcnt(2)
v_mfma_f32_16x16x32_bf16 v[20:23], v[88:91], a[128:131], v[20:23]
s_waitcnt lgkmcnt(0)
v_mfma_f32_16x16x32_bf16 v[20:23], v[92:95], a[144:147], v[20:23]
v_mfma_f32_16x16x32_bf16 v[28:31], v[84:87], a[116:119], v[28:31]
v_mfma_f32_16x16x32_bf16 v[28:31], v[88:91], a[132:135], v[28:31]
v_mfma_f32_16x16x32_bf16 v[28:31], v[92:95], a[148:151], v[28:31]
v_mfma_f32_16x16x32_bf16 v[36:39], v[84:87], a[120:123], v[36:39]
v_mfma_f32_16x16x32_bf16 v[36:39], v[88:91], a[136:139], v[36:39]
v_mfma_f32_16x16x32_bf16 v[36:39], v[92:95], a[152:155], v[36:39]
v_mfma_f32_16x16x32_bf16 v[44:47], v[84:87], a[124:127], v[44:47]
v_mfma_f32_16x16x32_bf16 v[44:47], v[88:91], a[140:143], v[44:47]
v_mfma_f32_16x16x32_bf16 v[44:47], v[92:95], a[156:159], v[44:47]
s_add_u32 s37, s36, 65536
v_cvt_pk_bf16_f32 v176, v16, v17
v_cvt_pk_bf16_f32 v177, v18, v19
v_cvt_pk_bf16_f32 v178, v20, v21
v_cvt_pk_bf16_f32 v179, v22, v23
buffer_store_dwordx4 v[176:179], v11, s[8:11], s37 offen offset:0 sc1
v_cvt_pk_bf16_f32 v180, v24, v25
v_cvt_pk_bf16_f32 v181, v26, v27
v_cvt_pk_bf16_f32 v182, v28, v29
v_cvt_pk_bf16_f32 v183, v30, v31
buffer_store_dwordx4 v[180:183], v11, s[8:11], s37 offen offset:1024 sc1
v_cvt_pk_bf16_f32 v184, v32, v33
v_cvt_pk_bf16_f32 v185, v34, v35
v_cvt_pk_bf16_f32 v186, v36, v37
v_cvt_pk_bf16_f32 v187, v38, v39
buffer_store_dwordx4 v[184:187], v11, s[8:11], s37 offen offset:2048 sc1
v_cvt_pk_bf16_f32 v188, v40, v41
v_cvt_pk_bf16_f32 v189, v42, v43
v_cvt_pk_bf16_f32 v190, v44, v45
v_cvt_pk_bf16_f32 v191, v46, v47
buffer_store_dwordx4 v[188:191], v11, s[8:11], s37 offen offset:3072 sc1
s_endpgm
K2_ffn4:
s_waitcnt lgkmcnt(9)
v_mfma_f32_16x16x32_bf16 v[48:51], v[96:99], a[0:3], 0
ds_read_b64_tr_b16 v[84:85], v13 offset:8192
s_waitcnt lgkmcnt(8)
v_mfma_f32_16x16x32_bf16 v[48:51], v[100:103], a[16:19], v[48:51]
s_add_u32 m0, s29, 61440
s_waitcnt lgkmcnt(6)
v_mfma_f32_16x16x32_bf16 v[48:51], v[104:107], a[32:35], v[48:51]
ds_read_b64_tr_b16 v[86:87], v13 offset:8704
v_mfma_f32_16x16x32_bf16 v[56:59], v[96:99], a[4:7], 0
s_add_u32 s31, s30, 4423680
v_mfma_f32_16x16x32_bf16 v[56:59], v[100:103], a[20:23], v[56:59]
ds_read_b64_tr_b16 v[88:89], v5 offset:12288
v_mfma_f32_16x16x32_bf16 v[56:59], v[104:107], a[36:39], v[56:59]
v_mul_f32 v112, s33, v16
v_mul_f32 v113, s33, v17
v_mfma_f32_16x16x32_bf16 v[64:67], v[96:99], a[8:11], 0
ds_read_b64_tr_b16 v[90:91], v5 offset:12800
v_mfma_f32_16x16x32_bf16 v[64:67], v[100:103], a[24:27], v[64:67]
buffer_load_dwordx4 v2, s[16:19], s31 offen offset:0 lds
v_mul_f32 v114, s33, v18
v_mfma_f32_16x16x32_bf16 v[64:67], v[104:107], a[40:43], v[64:67]
ds_read_b64_tr_b16 v[92:93], v5 offset:16384
v_mfma_f32_16x16x32_bf16 v[72:75], v[96:99], a[12:15], 0
v_mul_f32 v115, s33, v19
v_mfma_f32_16x16x32_bf16 v[72:75], v[100:103], a[28:31], v[72:75]
ds_read_b64_tr_b16 v[94:95], v5 offset:16896
v_exp_f32 v144, v112
v_mfma_f32_16x16x32_bf16 v[72:75], v[104:107], a[44:47], v[72:75]
s_waitcnt lgkmcnt(9)
v_mfma_f32_16x16x32_bf16 v[52:55], v[108:111], a[0:3], 0
ds_read_b64_tr_b16 v[96:97], v5 offset:20480
v_exp_f32 v145, v113
s_waitcnt lgkmcnt(8)
v_mfma_f32_16x16x32_bf16 v[52:55], v[80:83], a[16:19], v[52:55]
buffer_load_dwordx4 v3, s[16:19], s31 offen offset:1024 lds
s_waitcnt lgkmcnt(5)
v_mfma_f32_16x16x32_bf16 v[52:55], v[84:87], a[32:35], v[52:55]
ds_read_b64_tr_b16 v[98:99], v5 offset:20992
v_mfma_f32_16x16x32_bf16 v[60:63], v[108:111], a[4:7], 0
v_exp_f32 v146, v114
v_mfma_f32_16x16x32_bf16 v[60:63], v[80:83], a[20:23], v[60:63]
ds_read_b64_tr_b16 v[100:101], v13 offset:12288
v_mfma_f32_16x16x32_bf16 v[60:63], v[84:87], a[36:39], v[60:63]
v_exp_f32 v147, v115
v_mfma_f32_16x16x32_bf16 v[68:71], v[108:111], a[8:11], 0
ds_read_b64_tr_b16 v[102:103], v13 offset:12800
v_mfma_f32_16x16x32_bf16 v[68:71], v[80:83], a[24:27], v[68:71]
buffer_load_dwordx4 v4, s[16:19], s31 offen offset:2048 lds
v_mfma_f32_16x16x32_bf16 v[68:71], v[84:87], a[40:43], v[68:71]
ds_read_b64_tr_b16 v[104:105], v13 offset:16384
v_fma_f32 v144, v144, s33, s33
v_mfma_f32_16x16x32_bf16 v[76:79], v[108:111], a[12:15], 0
v_fma_f32 v145, v145, s33, s33
v_mfma_f32_16x16x32_bf16 v[76:79], v[80:83], a[28:31], v[76:79]
ds_read_b64_tr_b16 v[106:107], v13 offset:16896
v_fma_f32 v146, v146, s33, s33
v_mfma_f32_16x16x32_bf16 v[76:79], v[84:87], a[44:47], v[76:79]
v_fma_f32 v147, v147, s33, s33
s_waitcnt vmcnt(9)
s_barrier
s_waitcnt lgkmcnt(8)
v_mfma_f32_16x16x32_bf16 v[48:51], v[88:91], a[48:51], v[48:51]
ds_read_b64_tr_b16 v[108:109], v13 offset:20480
v_mul_f32 v116, s33, v20
s_waitcnt lgkmcnt(7)
v_mfma_f32_16x16x32_bf16 v[48:51], v[92:95], a[64:67], v[48:51]
s_add_u32 m0, s34, 0
s_add_u32 s31, s35, 0
v_mul_f32 v117, s33, v21
s_waitcnt lgkmcnt(5)
v_mfma_f32_16x16x32_bf16 v[48:51], v[96:99], a[80:83], v[48:51]
ds_read_b64_tr_b16 v[110:111], v13 offset:20992
v_mfma_f32_16x16x32_bf16 v[56:59], v[88:91], a[52:55], v[56:59]
buffer_load_dwordx4 v10, s[20:23], s31 offen lds
v_mul_f32 v118, s33, v22
v_mfma_f32_16x16x32_bf16 v[56:59], v[92:95], a[68:71], v[56:59]
ds_read_b64_tr_b16 v[80:81], v5 offset:24576
v_mfma_f32_16x16x32_bf16 v[56:59], v[96:99], a[84:87], v[56:59]
v_mul_f32 v119, s33, v23
v_exp_f32 v148, v116
v_mfma_f32_16x16x32_bf16 v[64:67], v[88:91], a[56:59], v[64:67]
ds_read_b64_tr_b16 v[82:83], v5 offset:25088
v_mfma_f32_16x16x32_bf16 v[64:67], v[92:95], a[72:75], v[64:67]
v_exp_f32 v149, v117
v_mfma_f32_16x16x32_bf16 v[64:67], v[96:99], a[88:91], v[64:67]
ds_read_b64_tr_b16 v[84:85], v5 offset:28672
v_mfma_f32_16x16x32_bf16 v[72:75], v[88:91], a[60:63], v[72:75]
s_add_u32 m0, s34, 4096
s_add_u32 s31, s35, 36864
v_mfma_f32_16x16x32_bf16 v[72:75], v[92:95], a[76:79], v[72:75]
ds_read_b64_tr_b16 v[86:87], v5 offset:29184
v_exp_f32 v150, v118
v_mfma_f32_16x16x32_bf16 v[72:75], v[96:99], a[92:95], v[72:75]
buffer_load_dwordx4 v10, s[20:23], s31 offen lds
s_waitcnt lgkmcnt(8)
v_mfma_f32_16x16x32_bf16 v[52:55], v[100:103], a[48:51], v[52:55]
ds_read_b64_tr_b16 v[88:89], v5 offset:32768
s_waitcnt lgkmcnt(7)
v_mfma_f32_16x16x32_bf16 v[52:55], v[104:107], a[64:67], v[52:55]
v_exp_f32 v151, v119
s_waitcnt lgkmcnt(5)
v_mfma_f32_16x16x32_bf16 v[52:55], v[108:111], a[80:83], v[52:55]
ds_read_b64_tr_b16 v[90:91], v5 offset:33280
v_fma_f32 v148, v148, s33, s33
v_mfma_f32_16x16x32_bf16 v[60:63], v[100:103], a[52:55], v[60:63]
v_fma_f32 v149, v149, s33, s33
v_fma_f32 v150, v150, s33, s33
v_mfma_f32_16x16x32_bf16 v[60:63], v[104:107], a[68:71], v[60:63]
ds_read_b64_tr_b16 v[92:93], v13 offset:24576
v_mfma_f32_16x16x32_bf16 v[60:63], v[108:111], a[84:87], v[60:63]
s_add_u32 m0, s34, 8192
s_add_u32 s31, s35, 73728
v_fma_f32 v151, v151, s33, s33
v_mfma_f32_16x16x32_bf16 v[68:71], v[100:103], a[56:59], v[68:71]
ds_read_b64_tr_b16 v[94:95], v13 offset:25088
v_mul_f32 v120, s33, v24
v_mfma_f32_16x16x32_bf16 v[68:71], v[104:107], a[72:75], v[68:71]
buffer_load_dwordx4 v10, s[20:23], s31 offen lds
v_mul_f32 v121, s33, v25
v_mfma_f32_16x16x32_bf16 v[68:71], v[108:111], a[88:91], v[68:71]
ds_read_b64_tr_b16 v[96:97], v13 offset:28672
v_mfma_f32_16x16x32_bf16 v[76:79], v[100:103], a[60:63], v[76:79]
v_mul_f32 v122, s33, v26
v_mul_f32 v123, s33, v27
v_mfma_f32_16x16x32_bf16 v[76:79], v[104:107], a[76:79], v[76:79]
ds_read_b64_tr_b16 v[98:99], v13 offset:29184
v_mfma_f32_16x16x32_bf16 v[76:79], v[108:111], a[92:95], v[76:79]
v_exp_f32 v152, v120
s_waitcnt vmcnt(9)
s_barrier
s_waitcnt lgkmcnt(8)
v_mfma_f32_16x16x32_bf16 v[48:51], v[80:83], a[96:99], v[48:51]
ds_read_b64_tr_b16 v[100:101], v13 offset:32768
s_waitcnt lgkmcnt(7)
v_mfma_f32_16x16x32_bf16 v[48:51], v[84:87], a[112:115], v[48:51]
s_add_u32 m0, s34, 12288
s_add_u32 s31, s35, 110592
v_exp_f32 v153, v121
s_waitcnt lgkmcnt(5)
v_mfma_f32_16x16x32_bf16 v[48:51], v[88:91], a[128:131], v[48:51]
ds_read_b64_tr_b16 v[102:103], v13 offset:33280
v_mfma_f32_16x16x32_bf16 v[56:59], v[80:83], a[100:103], v[56:59]
buffer_load_dwordx4 v10, s[20:23], s31 offen lds
v_exp_f32 v154, v122
v_mfma_f32_16x16x32_bf16 v[56:59], v[84:87], a[116:119], v[56:59]
ds_read_b64_tr_b16 v[104:105], v5 offset:36864
v_mfma_f32_16x16x32_bf16 v[56:59], v[88:91], a[132:135], v[56:59]
v_exp_f32 v155, v123
v_mfma_f32_16x16x32_bf16 v[64:67], v[80:83], a[104:107], v[64:67]
ds_read_b64_tr_b16 v[106:107], v5 offset:37376
v_mfma_f32_16x16x32_bf16 v[64:67], v[84:87], a[120:123], v[64:67]
v_fma_f32 v152, v152, s33, s33
v_fma_f32 v153, v153, s33, s33
v_mfma_f32_16x16x32_bf16 v[64:67], v[88:91], a[136:139], v[64:67]
ds_read_b64_tr_b16 v[108:109], v5 offset:40960
v_fma_f32 v154, v154, s33, s33
v_mfma_f32_16x16x32_bf16 v[72:75], v[80:83], a[108:111], v[72:75]
s_add_u32 m0, s34, 16384
s_add_u32 s31, s35, 147456
v_fma_f32 v155, v155, s33, s33
v_mfma_f32_16x16x32_bf16 v[72:75], v[84:87], a[124:127], v[72:75]
ds_read_b64_tr_b16 v[110:111], v5 offset:41472
v_mul_f32 v124, s33, v28
v_mfma_f32_16x16x32_bf16 v[72:75], v[88:91], a[140:143], v[72:75]
buffer_load_dwordx4 v10, s[20:23], s31 offen lds
s_waitcnt lgkmcnt(8)
v_mfma_f32_16x16x32_bf16 v[52:55], v[92:95], a[96:99], v[52:55]
ds_read_b64_tr_b16 v[80:81], v5 offset:45056
v_mul_f32 v125, s33, v29
s_waitcnt lgkmcnt(7)
v_mfma_f32_16x16x32_bf16 v[52:55], v[96:99], a[112:115], v[52:55]
v_mul_f32 v126, s33, v30
v_mul_f32 v127, s33, v31
s_waitcnt lgkmcnt(5)
v_mfma_f32_16x16x32_bf16 v[52:55], v[100:103], a[128:131], v[52:55]
ds_read_b64_tr_b16 v[82:83], v5 offset:45568
v_mfma_f32_16x16x32_bf16 v[60:63], v[92:95], a[100:103], v[60:63]
v_exp_f32 v156, v124
v_mfma_f32_16x16x32_bf16 v[60:63], v[96:99], a[116:119], v[60:63]
ds_read_b64_tr_b16 v[84:85], v13 offset:36864
v_mfma_f32_16x16x32_bf16 v[60:63], v[100:103], a[132:135], v[60:63]
s_add_u32 m0, s34, 20480
s_add_u32 s31, s35, 184320
v_exp_f32 v157, v125
v_mfma_f32_16x16x32_bf16 v[68:71], v[92:95], a[104:107], v[68:71]
ds_read_b64_tr_b16 v[86:87], v13 offset:37376
v_mfma_f32_16x16x32_bf16 v[68:71], v[96:99], a[120:123], v[68:71]
buffer_load_dwordx4 v10, s[20:23], s31 offen lds
v_exp_f32 v158, v126
v_mfma_f32_16x16x32_bf16 v[68:71], v[100:103], a[136:139], v[68:71]
ds_read_b64_tr_b16 v[88:89], v13 offset:40960
v_mfma_f32_16x16x32_bf16 v[76:79], v[92:95], a[108:111], v[76:79]
v_exp_f32 v159, v127
v_mfma_f32_16x16x32_bf16 v[76:79], v[96:99], a[124:127], v[76:79]
ds_read_b64_tr_b16 v[90:91], v13 offset:41472
v_mfma_f32_16x16x32_bf16 v[76:79], v[100:103], a[140:143], v[76:79]
v_fma_f32 v156, v156, s33, s33
v_fma_f32 v157, v157, s33, s33
s_waitcnt vmcnt(9)
s_barrier
s_waitcnt lgkmcnt(8)
v_mfma_f32_16x16x32_bf16 v[48:51], v[104:107], a[144:147], v[48:51]
ds_read_b64_tr_b16 v[92:93], v13 offset:45056
v_fma_f32 v158, v158, s33, s33
s_waitcnt lgkmcnt(7)
v_mfma_f32_16x16x32_bf16 v[48:51], v[108:111], a[160:163], v[48:51]
s_add_u32 m0, s34, 24576
s_add_u32 s31, s35, 221184
v_fma_f32 v159, v159, s33, s33
s_waitcnt lgkmcnt(5)
v_mfma_f32_16x16x32_bf16 v[48:51], v[80:83], a[176:179], v[48:51]
ds_read_b64_tr_b16 v[94:95], v13 offset:45568
v_mfma_f32_16x16x32_bf16 v[56:59], v[104:107], a[148:151], v[56:59]
buffer_load_dwordx4 v10, s[20:23], s31 offen lds
v_mul_f32 v128, s33, v32
v_mfma_f32_16x16x32_bf16 v[56:59], v[108:111], a[164:167], v[56:59]
ds_read_b64_tr_b16 v[96:97], v5 offset:49152
v_mfma_f32_16x16x32_bf16 v[56:59], v[80:83], a[180:183], v[56:59]
v_mul_f32 v129, s33, v33
v_mul_f32 v130, s33, v34
v_mfma_f32_16x16x32_bf16 v[64:67], v[104:107], a[152:155], v[64:67]
ds_read_b64_tr_b16 v[98:99], v5 offset:49664
v_mfma_f32_16x16x32_bf16 v[64:67], v[108:111], a[168:171], v[64:67]
v_mul_f32 v131, s33, v35
v_exp_f32 v160, v128
v_mfma_f32_16x16x32_bf16 v[64:67], v[80:83], a[184:187], v[64:67]
ds_read_b64_tr_b16 v[100:101], v5 offset:53248
v_mfma_f32_16x16x32_bf16 v[72:75], v[104:107], a[156:159], v[72:75]
s_add_u32 m0, s34, 28672
s_add_u32 s31, s35, 258048
v_mfma_f32_16x16x32_bf16 v[72:75], v[108:111], a[172:175], v[72:75]
ds_read_b64_tr_b16 v[102:103], v5 offset:53760
v_exp_f32 v161, v129
v_mfma_f32_16x16x32_bf16 v[72:75], v[80:83], a[188:191], v[72:75]
buffer_load_dwordx4 v10, s[20:23], s31 offen lds
s_waitcnt lgkmcnt(8)
v_mfma_f32_16x16x32_bf16 v[52:55], v[84:87], a[144:147], v[52:55]
ds_read_b64_tr_b16 v[104:105], v5 offset:57344
s_waitcnt lgkmcnt(7)
v_mfma_f32_16x16x32_bf16 v[52:55], v[88:91], a[160:163], v[52:55]
v_exp_f32 v162, v130
s_waitcnt lgkmcnt(5)
v_mfma_f32_16x16x32_bf16 v[52:55], v[92:95], a[176:179], v[52:55]
ds_read_b64_tr_b16 v[106:107], v5 offset:57856
v_mfma_f32_16x16x32_bf16 v[60:63], v[84:87], a[148:151], v[60:63]
v_exp_f32 v163, v131
v_mfma_f32_16x16x32_bf16 v[60:63], v[88:91], a[164:167], v[60:63]
ds_read_b64_tr_b16 v[108:109], v13 offset:49152
v_fma_f32 v160, v160, s33, s33
v_mfma_f32_16x16x32_bf16 v[60:63], v[92:95], a[180:183], v[60:63]
s_add_u32 m0, s34, 32768
s_add_u32 s31, s35, 128
v_fma_f32 v161, v161, s33, s33
v_mfma_f32_16x16x32_bf16 v[68:71], v[84:87], a[152:155], v[68:71]
ds_read_b64_tr_b16 v[110:111], v13 offset:49664
v_mfma_f32_16x16x32_bf16 v[68:71], v[88:91], a[168:171], v[68:71]
buffer_load_dwordx4 v10, s[20:23], s31 offen lds
v_fma_f32 v162, v162, s33, s33
v_mfma_f32_16x16x32_bf16 v[68:71], v[92:95], a[184:187], v[68:71]
ds_read_b64_tr_b16 v[80:81], v13 offset:53248
v_mfma_f32_16x16x32_bf16 v[76:79], v[84:87], a[156:159], v[76:79]
v_fma_f32 v163, v163, s33, s33
v_mul_f32 v132, s33, v36
v_mfma_f32_16x16x32_bf16 v[76:79], v[88:91], a[172:175], v[76:79]
ds_read_b64_tr_b16 v[82:83], v13 offset:53760
v_mfma_f32_16x16x32_bf16 v[76:79], v[92:95], a[188:191], v[76:79]
v_mul_f32 v133, s33, v37
v_mul_f32 v134, s33, v38
s_waitcnt vmcnt(9)
s_barrier
s_waitcnt lgkmcnt(8)
v_mfma_f32_16x16x32_bf16 v[48:51], v[96:99], a[192:195], v[48:51]
ds_read_b64_tr_b16 v[84:85], v13 offset:57344
v_mul_f32 v135, s33, v39
s_waitcnt lgkmcnt(7)
v_mfma_f32_16x16x32_bf16 v[48:51], v[100:103], a[208:211], v[48:51]
s_add_u32 m0, s34, 36864
s_add_u32 s31, s35, 36992
s_waitcnt lgkmcnt(5)
v_mfma_f32_16x16x32_bf16 v[48:51], v[104:107], a[224:227], v[48:51]
ds_read_b64_tr_b16 v[86:87], v13 offset:57856
v_exp_f32 v164, v132
v_mfma_f32_16x16x32_bf16 v[56:59], v[96:99], a[196:199], v[56:59]
buffer_load_dwordx4 v10, s[20:23], s31 offen lds
v_mfma_f32_16x16x32_bf16 v[56:59], v[100:103], a[212:215], v[56:59]
ds_read_b64_tr_b16 v[88:89], v5 offset:61440
v_exp_f32 v165, v133
v_mfma_f32_16x16x32_bf16 v[56:59], v[104:107], a[228:231], v[56:59]
v_mfma_f32_16x16x32_bf16 v[64:67], v[96:99], a[200:203], v[64:67]
ds_read_b64_tr_b16 v[90:91], v5 offset:61952
v_exp_f32 v166, v134
v_mfma_f32_16x16x32_bf16 v[64:67], v[100:103], a[216:219], v[64:67]
v_exp_f32 v167, v135
v_mfma_f32_16x16x32_bf16 v[64:67], v[104:107], a[232:235], v[64:67]
ds_read_b64_tr_b16 v[92:93], v6 offset:0
v_mfma_f32_16x16x32_bf16 v[72:75], v[96:99], a[204:207], v[72:75]
s_add_u32 m0, s34, 40960
s_add_u32 s31, s35, 73856
v_fma_f32 v164, v164, s33, s33
v_mfma_f32_16x16x32_bf16 v[72:75], v[100:103], a[220:223], v[72:75]
ds_read_b64_tr_b16 v[94:95], v6 offset:512
v_fma_f32 v165, v165, s33, s33
v_mfma_f32_16x16x32_bf16 v[72:75], v[104:107], a[236:239], v[72:75]
buffer_load_dwordx4 v10, s[20:23], s31 offen lds
v_fma_f32 v166, v166, s33, s33
s_waitcnt lgkmcnt(8)
v_mfma_f32_16x16x32_bf16 v[52:55], v[108:111], a[192:195], v[52:55]
ds_read_b64_tr_b16 v[96:97], v6 offset:4096
s_waitcnt lgkmcnt(7)
v_mfma_f32_16x16x32_bf16 v[52:55], v[80:83], a[208:211], v[52:55]
v_fma_f32 v167, v167, s33, s33
v_mul_f32 v136, s33, v40
s_waitcnt lgkmcnt(5)
v_mfma_f32_16x16x32_bf16 v[52:55], v[84:87], a[224:227], v[52:55]
ds_read_b64_tr_b16 v[98:99], v6 offset:4608
v_mul_f32 v137, s33, v41
v_mfma_f32_16x16x32_bf16 v[60:63], v[108:111], a[196:199], v[60:63]
v_mul_f32 v138, s33, v42
v_mul_f32 v139, s33, v43
v_mfma_f32_16x16x32_bf16 v[60:63], v[80:83], a[212:215], v[60:63]
ds_read_b64_tr_b16 v[100:101], v13 offset:61440
v_mfma_f32_16x16x32_bf16 v[60:63], v[84:87], a[228:231], v[60:63]
s_add_u32 m0, s34, 45056
s_add_u32 s31, s35, 110720
v_exp_f32 v168, v136
v_mfma_f32_16x16x32_bf16 v[68:71], v[108:111], a[200:203], v[68:71]
ds_read_b64_tr_b16 v[102:103], v13 offset:61952
v_mfma_f32_16x16x32_bf16 v[68:71], v[80:83], a[216:219], v[68:71]
buffer_load_dwordx4 v10, s[20:23], s31 offen lds
v_exp_f32 v169, v137
v_mfma_f32_16x16x32_bf16 v[68:71], v[84:87], a[232:235], v[68:71]
ds_read_b64_tr_b16 v[104:105], v14 offset:0
v_mfma_f32_16x16x32_bf16 v[76:79], v[108:111], a[204:207], v[76:79]
v_exp_f32 v170, v138
v_mfma_f32_16x16x32_bf16 v[76:79], v[80:83], a[220:223], v[76:79]
ds_read_b64_tr_b16 v[106:107], v14 offset:512
v_mfma_f32_16x16x32_bf16 v[76:79], v[84:87], a[236:239], v[76:79]
v_exp_f32 v171, v139
s_waitcnt vmcnt(9)
s_barrier
s_waitcnt lgkmcnt(8)
v_mfma_f32_16x16x32_bf16 v[48:51], v[88:91], a[240:243], v[48:51]
ds_read_b64_tr_b16 v[108:109], v14 offset:4096
v_fma_f32 v168, v168, s33, s33
s_waitcnt lgkmcnt(7)
v_mfma_f32_16x16x32_bf16 v[48:51], v[92:95], v[224:227], v[48:51]
s_add_u32 m0, s34, 49152
s_add_u32 s31, s35, 147584
s_waitcnt lgkmcnt(5)
v_mfma_f32_16x16x32_bf16 v[48:51], v[96:99], v[240:243], v[48:51]
ds_read_b64_tr_b16 v[110:111], v14 offset:4608
v_fma_f32 v169, v169, s33, s33
v_mfma_f32_16x16x32_bf16 v[56:59], v[88:91], a[244:247], v[56:59]
buffer_load_dwordx4 v10, s[20:23], s31 offen lds
v_fma_f32 v170, v170, s33, s33
v_mfma_f32_16x16x32_bf16 v[56:59], v[92:95], v[228:231], v[56:59]
ds_read_b64_tr_b16 v[80:81], v8 offset:0
v_mfma_f32_16x16x32_bf16 v[56:59], v[96:99], v[244:247], v[56:59]
v_fma_f32 v171, v171, s33, s33
v_mul_f32 v140, s33, v44
v_mfma_f32_16x16x32_bf16 v[64:67], v[88:91], a[248:251], v[64:67]
ds_read_b64_tr_b16 v[82:83], v8 offset:2048
v_mfma_f32_16x16x32_bf16 v[64:67], v[92:95], v[232:235], v[64:67]
v_mul_f32 v141, s33, v45
v_mul_f32 v142, s33, v46
v_mfma_f32_16x16x32_bf16 v[64:67], v[96:99], v[248:251], v[64:67]
ds_read_b64_tr_b16 v[84:85], v8 offset:4096
v_mfma_f32_16x16x32_bf16 v[72:75], v[88:91], a[252:255], v[72:75]
s_add_u32 m0, s34, 53248
s_add_u32 s31, s35, 184448
v_mul_f32 v143, s33, v47
v_mfma_f32_16x16x32_bf16 v[72:75], v[92:95], v[236:239], v[72:75]
ds_read_b64_tr_b16 v[86:87], v8 offset:6144
v_mfma_f32_16x16x32_bf16 v[72:75], v[96:99], v[252:255], v[72:75]
buffer_load_dwordx4 v10, s[20:23], s31 offen lds
v_exp_f32 v172, v140
s_waitcnt lgkmcnt(8)
v_mfma_f32_16x16x32_bf16 v[52:55], v[100:103], a[240:243], v[52:55]
ds_read_b64_tr_b16 v[88:89], v8 offset:8192
s_waitcnt lgkmcnt(7)
v_mfma_f32_16x16x32_bf16 v[52:55], v[104:107], v[224:227], v[52:55]
v_exp_f32 v173, v141
s_waitcnt lgkmcnt(5)
v_mfma_f32_16x16x32_bf16 v[52:55], v[108:111], v[240:243], v[52:55]
ds_read_b64_tr_b16 v[90:91], v8 offset:10240
v_mfma_f32_16x16x32_bf16 v[60:63], v[100:103], a[244:247], v[60:63]
v_exp_f32 v174, v142
v_mfma_f32_16x16x32_bf16 v[60:63], v[104:107], v[228:231], v[60:63]
ds_read_b64_tr_b16 v[92:93], v9 offset:0
v_mfma_f32_16x16x32_bf16 v[60:63], v[108:111], v[244:247], v[60:63]
s_add_u32 m0, s34, 57344
s_add_u32 s31, s35, 221312
v_mfma_f32_16x16x32_bf16 v[68:71], v[100:103], a[248:251], v[68:71]
ds_read_b64_tr_b16 v[94:95], v9 offset:2048
v_exp_f32 v175, v143
v_mfma_f32_16x16x32_bf16 v[68:71], v[104:107], v[232:235], v[68:71]
buffer_load_dwordx4 v10, s[20:23], s31 offen lds
v_mfma_f32_16x16x32_bf16 v[68:71], v[108:111], v[248:251], v[68:71]
ds_read_b64_tr_b16 v[96:97], v9 offset:4096
v_mfma_f32_16x16x32_bf16 v[76:79], v[100:103], a[252:255], v[76:79]
v_fma_f32 v172, v172, s33, s33
v_fma_f32 v173, v173, s33, s33
v_mfma_f32_16x16x32_bf16 v[76:79], v[104:107], v[236:239], v[76:79]
ds_read_b64_tr_b16 v[98:99], v9 offset:6144
v_mfma_f32_16x16x32_bf16 v[76:79], v[108:111], v[252:255], v[76:79]
v_fma_f32 v174, v174, s33, s33
v_fma_f32 v175, v175, s33, s33
s_nop 7
v_rcp_f32 v144, v144
v_rcp_f32 v145, v145
v_rcp_f32 v146, v146
v_rcp_f32 v147, v147
v_mul_f32 v112, v112, v48
v_mul_f32 v113, v113, v49
v_mul_f32 v114, v114, v50
v_mul_f32 v115, v115, v51
v_mul_f32 v112, v112, v144
v_mul_f32 v113, v113, v145
v_mul_f32 v114, v114, v146
v_mul_f32 v115, v115, v147
v_cvt_pk_bf16_f32 v176, v112, v113
v_cvt_pk_bf16_f32 v177, v114, v115
v_rcp_f32 v148, v148
v_rcp_f32 v149, v149
v_rcp_f32 v150, v150
v_rcp_f32 v151, v151
v_mul_f32 v116, v116, v52
v_mul_f32 v117, v117, v53
v_mul_f32 v118, v118, v54
v_mul_f32 v119, v119, v55
v_mul_f32 v116, v116, v148
v_mul_f32 v117, v117, v149
v_mul_f32 v118, v118, v150
v_mul_f32 v119, v119, v151
v_cvt_pk_bf16_f32 v178, v116, v117
v_cvt_pk_bf16_f32 v179, v118, v119
ds_write_b128 v7, v[176:179] offset:0
v_rcp_f32 v152, v152
v_rcp_f32 v153, v153
v_rcp_f32 v154, v154
v_rcp_f32 v155, v155
v_mul_f32 v120, v120, v56
v_mul_f32 v121, v121, v57
v_mul_f32 v122, v122, v58
v_mul_f32 v123, v123, v59
v_mul_f32 v120, v120, v152
v_mul_f32 v121, v121, v153
v_mul_f32 v122, v122, v154
v_mul_f32 v123, v123, v155
v_cvt_pk_bf16_f32 v180, v120, v121
v_cvt_pk_bf16_f32 v181, v122, v123
v_rcp_f32 v156, v156
v_rcp_f32 v157, v157
v_rcp_f32 v158, v158
v_rcp_f32 v159, v159
v_mul_f32 v124, v124, v60
v_mul_f32 v125, v125, v61
v_mul_f32 v126, v126, v62
v_mul_f32 v127, v127, v63
v_mul_f32 v124, v124, v156
v_mul_f32 v125, v125, v157
v_mul_f32 v126, v126, v158
v_mul_f32 v127, v127, v159
v_cvt_pk_bf16_f32 v182, v124, v125
v_cvt_pk_bf16_f32 v183, v126, v127
ds_write_b128 v7, v[180:183] offset:10240
v_rcp_f32 v160, v160
v_rcp_f32 v161, v161
v_rcp_f32 v162, v162
v_rcp_f32 v163, v163
v_mul_f32 v128, v128, v64
v_mul_f32 v129, v129, v65
v_mul_f32 v130, v130, v66
v_mul_f32 v131, v131, v67
v_mul_f32 v128, v128, v160
v_mul_f32 v129, v129, v161
v_mul_f32 v130, v130, v162
v_mul_f32 v131, v131, v163
v_cvt_pk_bf16_f32 v184, v128, v129
v_cvt_pk_bf16_f32 v185, v130, v131
v_rcp_f32 v164, v164
v_rcp_f32 v165, v165
v_rcp_f32 v166, v166
v_rcp_f32 v167, v167
v_mul_f32 v132, v132, v68
v_mul_f32 v133, v133, v69
v_mul_f32 v134, v134, v70
v_mul_f32 v135, v135, v71
v_mul_f32 v132, v132, v164
v_mul_f32 v133, v133, v165
v_mul_f32 v134, v134, v166
v_mul_f32 v135, v135, v167
v_cvt_pk_bf16_f32 v186, v132, v133
v_cvt_pk_bf16_f32 v187, v134, v135
ds_write_b128 v7, v[184:187] offset:20480
v_rcp_f32 v168, v168
v_rcp_f32 v169, v169
v_rcp_f32 v170, v170
v_rcp_f32 v171, v171
v_mul_f32 v136, v136, v72
v_mul_f32 v137, v137, v73
v_mul_f32 v138, v138, v74
v_mul_f32 v139, v139, v75
v_mul_f32 v136, v136, v168
v_mul_f32 v137, v137, v169
v_mul_f32 v138, v138, v170
v_mul_f32 v139, v139, v171
v_cvt_pk_bf16_f32 v188, v136, v137
v_cvt_pk_bf16_f32 v189, v138, v139
v_rcp_f32 v172, v172
v_rcp_f32 v173, v173
v_rcp_f32 v174, v174
v_rcp_f32 v175, v175
v_mul_f32 v140, v140, v76
v_mul_f32 v141, v141, v77
v_mul_f32 v142, v142, v78
v_mul_f32 v143, v143, v79
v_mul_f32 v140, v140, v172
v_mul_f32 v141, v141, v173
v_mul_f32 v142, v142, v174
v_mul_f32 v143, v143, v175
v_cvt_pk_bf16_f32 v190, v140, v141
v_cvt_pk_bf16_f32 v191, v142, v143
ds_write_b128 v7, v[188:191] offset:30720
s_waitcnt vmcnt(9)
s_waitcnt lgkmcnt(0)
s_barrier
s_mul_i32 s3, s25, 40960
s_add_u32 s3, s3, 73728
v_add_u32 v1, s3, v11
ds_read_b128 a[0:3], v1 offset:0
ds_read_b128 a[16:19], v1 offset:1024
ds_read_b128 a[32:35], v1 offset:2048
ds_read_b128 a[4:7], v1 offset:10240
ds_read_b128 a[20:23], v1 offset:11264
ds_read_b128 a[36:39], v1 offset:12288
ds_read_b128 a[8:11], v1 offset:20480
ds_read_b128 a[24:27], v1 offset:21504
ds_read_b128 a[40:43], v1 offset:22528
ds_read_b128 a[12:15], v1 offset:30720
ds_read_b128 a[28:31], v1 offset:31744
ds_read_b128 a[44:47], v1 offset:32768
ds_read_b128 a[48:51], v1 offset:3072
ds_read_b128 a[64:67], v1 offset:4096
ds_read_b128 a[80:83], v1 offset:5120
ds_read_b128 a[52:55], v1 offset:13312
ds_read_b128 a[68:71], v1 offset:14336
ds_read_b128 a[84:87], v1 offset:15360
ds_read_b128 a[56:59], v1 offset:23552
ds_read_b128 a[72:75], v1 offset:24576
ds_read_b128 a[88:91], v1 offset:25600
ds_read_b128 a[60:63], v1 offset:33792
ds_read_b128 a[76:79], v1 offset:34816
ds_read_b128 a[92:95], v1 offset:35840
ds_read_b128 a[96:99], v1 offset:6144
ds_read_b128 a[112:115], v1 offset:7168
ds_read_b128 a[100:103], v1 offset:16384
ds_read_b128 a[116:119], v1 offset:17408
ds_read_b128 a[104:107], v1 offset:26624
ds_read_b128 a[120:123], v1 offset:27648
ds_read_b128 a[108:111], v1 offset:36864
ds_read_b128 a[124:127], v1 offset:37888
v_add_u32 v5, 0x10000, v8
v_add_u32 v6, 0x10000, v9
v_add_u32 v2, 0x20000, v8
v_add_u32 v3, 0x20000, v9
s_waitcnt lgkmcnt(15)
v_mfma_f32_16x16x32_bf16 v[16:19], v[80:83], a[0:3], 0
ds_read_b64_tr_b16 v[100:101], v9 offset:8192
s_waitcnt lgkmcnt(15)
v_mfma_f32_16x16x32_bf16 v[16:19], v[84:87], a[16:19], v[16:19]
s_add_u32 m0, s34, 61440
s_add_u32 s31, s35, 258176
s_waitcnt lgkmcnt(15)
v_mfma_f32_16x16x32_bf16 v[16:19], v[88:91], a[32:35], v[16:19]
ds_read_b64_tr_b16 v[102:103], v9 offset:10240
s_waitcnt lgkmcnt(15)
v_mfma_f32_16x16x32_bf16 v[24:27], v[80:83], a[4:7], 0
buffer_load_dwordx4 v10, s[20:23], s31 offen lds
s_waitcnt lgkmcnt(15)
v_mfma_f32_16x16x32_bf16 v[24:27], v[84:87], a[20:23], v[24:27]
ds_read_b64_tr_b16 v[104:105], v8 offset:12288
s_waitcnt lgkmcnt(15)
v_mfma_f32_16x16x32_bf16 v[24:27], v[88:91], a[36:39], v[24:27]
s_waitcnt lgkmcnt(15)
v_mfma_f32_16x16x32_bf16 v[32:35], v[80:83], a[8:11], 0
ds_read_b64_tr_b16 v[106:107], v8 offset:14336
s_waitcnt lgkmcnt(15)
v_mfma_f32_16x16x32_bf16 v[32:35], v[84:87], a[24:27], v[32:35]
s_waitcnt lgkmcnt(15)
v_mfma_f32_16x16x32_bf16 v[32:35], v[88:91], a[40:43], v[32:35]
ds_read_b64_tr_b16 v[108:109], v8 offset:16384
s_waitcnt lgkmcnt(15)
v_mfma_f32_16x16x32_bf16 v[40:43], v[80:83], a[12:15], 0
s_add_u32 m0, s34, 65536
s_add_u32 s31, s35, 256
s_waitcnt lgkmcnt(15)
v_mfma_f32_16x16x32_bf16 v[40:43], v[84:87], a[28:31], v[40:43]
ds_read_b64_tr_b16 v[110:111], v8 offset:18432
s_waitcnt lgkmcnt(15)
v_mfma_f32_16x16x32_bf16 v[40:43], v[88:91], a[44:47], v[40:43]
buffer_load_dwordx4 v10, s[20:23], s31 offen lds
v_mfma_f32_16x16x32_bf16 v[20:23], v[92:95], a[0:3], 0
ds_read_b64_tr_b16 v[80:81], v8 offset:20480
v_mfma_f32_16x16x32_bf16 v[20:23], v[96:99], a[16:19], v[20:23]
s_waitcnt lgkmcnt(5)
v_mfma_f32_16x16x32_bf16 v[20:23], v[100:103], a[32:35], v[20:23]
ds_read_b64_tr_b16 v[82:83], v8 offset:22528
v_mfma_f32_16x16x32_bf16 v[28:31], v[92:95], a[4:7], 0
v_mfma_f32_16x16x32_bf16 v[28:31], v[96:99], a[20:23], v[28:31]
ds_read_b64_tr_b16 v[84:85], v9 offset:12288
v_mfma_f32_16x16x32_bf16 v[28:31], v[100:103], a[36:39], v[28:31]
s_add_u32 m0, s34, 69632
s_add_u32 s31, s35, 37120
v_mfma_f32_16x16x32_bf16 v[36:39], v[92:95], a[8:11], 0
ds_read_b64_tr_b16 v[86:87], v9 offset:14336
v_mfma_f32_16x16x32_bf16 v[36:39], v[96:99], a[24:27], v[36:39]
buffer_load_dwordx4 v10, s[20:23], s31 offen lds
v_mfma_f32_16x16x32_bf16 v[36:39], v[100:103], a[40:43], v[36:39]
ds_read_b64_tr_b16 v[88:89], v9 offset:16384
v_mfma_f32_16x16x32_bf16 v[44:47], v[92:95], a[12:15], 0
v_mfma_f32_16x16x32_bf16 v[44:47], v[96:99], a[28:31], v[44:47]
ds_read_b64_tr_b16 v[90:91], v9 offset:18432
v_mfma_f32_16x16x32_bf16 v[44:47], v[100:103], a[44:47], v[44:47]
s_waitcnt vmcnt(9)
s_barrier
s_waitcnt lgkmcnt(8)
v_mfma_f32_16x16x32_bf16 v[16:19], v[104:107], a[48:51], v[16:19]
ds_read_b64_tr_b16 v[92:93], v9 offset:20480
s_waitcnt lgkmcnt(7)
v_mfma_f32_16x16x32_bf16 v[16:19], v[108:111], a[64:67], v[16:19]
s_add_u32 m0, s34, 73728
s_add_u32 s31, s35, 73984
s_waitcnt lgkmcnt(5)
v_mfma_f32_16x16x32_bf16 v[16:19], v[80:83], a[80:83], v[16:19]
ds_read_b64_tr_b16 v[94:95], v9 offset:22528
v_mfma_f32_16x16x32_bf16 v[24:27], v[104:107], a[52:55], v[24:27]
buffer_load_dwordx4 v10, s[20:23], s31 offen lds
v_mfma_f32_16x16x32_bf16 v[24:27], v[108:111], a[68:71], v[24:27]
ds_read_b64_tr_b16 v[96:97], v8 offset:24576
v_mfma_f32_16x16x32_bf16 v[24:27], v[80:83], a[84:87], v[24:27]
s_add_u32 m0, s34, 77824
s_add_u32 s31, s35, 110848
v_mfma_f32_16x16x32_bf16 v[32:35], v[104:107], a[56:59], v[32:35]
ds_read_b64_tr_b16 v[98:99], v8 offset:26624
v_mfma_f32_16x16x32_bf16 v[32:35], v[108:111], a[72:75], v[32:35]
buffer_load_dwordx4 v10, s[20:23], s31 offen lds
v_mfma_f32_16x16x32_bf16 v[32:35], v[80:83], a[88:91], v[32:35]
ds_read_b64_tr_b16 v[100:101], v8 offset:28672
v_mfma_f32_16x16x32_bf16 v[40:43], v[104:107], a[60:63], v[40:43]
s_add_u32 m0, s34, 81920
s_add_u32 s31, s35, 147712
v_mfma_f32_16x16x32_bf16 v[40:43], v[108:111], a[76:79], v[40:43]
ds_read_b64_tr_b16 v[102:103], v8 offset:30720
v_mfma_f32_16x16x32_bf16 v[40:43], v[80:83], a[92:95], v[40:43]
buffer_load_dwordx4 v10, s[20:23], s31 offen lds
s_waitcnt lgkmcnt(8)
v_mfma_f32_16x16x32_bf16 v[20:23], v[84:87], a[48:51], v[20:23]
ds_read_b64_tr_b16 v[104:105], v8 offset:32768
s_waitcnt lgkmcnt(7)
v_mfma_f32_16x16x32_bf16 v[20:23], v[88:91], a[64:67], v[20:23]
s_add_u32 m0, s34, 86016
s_add_u32 s31, s35, 184576
s_waitcnt lgkmcnt(5)
v_mfma_f32_16x16x32_bf16 v[20:23], v[92:95], a[80:83], v[20:23]
ds_read_b64_tr_b16 v[106:107], v8 offset:34816
v_mfma_f32_16x16x32_bf16 v[28:31], v[84:87], a[52:55], v[28:31]
buffer_load_dwordx4 v10, s[20:23], s31 offen lds
v_mfma_f32_16x16x32_bf16 v[28:31], v[88:91], a[68:71], v[28:31]
ds_read_b64_tr_b16 v[108:109], v9 offset:24576
v_mfma_f32_16x16x32_bf16 v[28:31], v[92:95], a[84:87], v[28:31]
s_add_u32 m0, s34, 90112
s_add_u32 s31, s35, 221440
v_mfma_f32_16x16x32_bf16 v[36:39], v[84:87], a[56:59], v[36:39]
ds_read_b64_tr_b16 v[110:111], v9 offset:26624
v_mfma_f32_16x16x32_bf16 v[36:39], v[88:91], a[72:75], v[36:39]
buffer_load_dwordx4 v10, s[20:23], s31 offen lds
v_mfma_f32_16x16x32_bf16 v[36:39], v[92:95], a[88:91], v[36:39]
ds_read_b64_tr_b16 v[80:81], v9 offset:28672
v_mfma_f32_16x16x32_bf16 v[44:47], v[84:87], a[60:63], v[44:47]
s_add_u32 m0, s34, 94208
s_add_u32 s31, s35, 258304
v_mfma_f32_16x16x32_bf16 v[44:47], v[88:91], a[76:79], v[44:47]
ds_read_b64_tr_b16 v[82:83], v9 offset:30720
v_mfma_f32_16x16x32_bf16 v[44:47], v[92:95], a[92:95], v[44:47]
buffer_load_dwordx4 v10, s[20:23], s31 offen lds
s_waitcnt vmcnt(12)
s_barrier
s_waitcnt lgkmcnt(8)
v_mfma_f32_16x16x32_bf16 v[16:19], v[96:99], a[96:99], v[16:19]
ds_read_b64_tr_b16 v[84:85], v9 offset:32768
s_waitcnt lgkmcnt(7)
v_mfma_f32_16x16x32_bf16 v[16:19], v[100:103], a[112:115], v[16:19]
s_add_u32 m0, s34, 98304
s_add_u32 s31, s35, 384
s_waitcnt lgkmcnt(5)
v_mfma_f32_16x16x32_bf16 v[48:51], v[104:107], a[0:3], 0
ds_read_b64_tr_b16 v[86:87], v9 offset:34816
v_mfma_f32_16x16x32_bf16 v[24:27], v[96:99], a[100:103], v[24:27]
buffer_load_dwordx4 v10, s[20:23], s31 offen lds
v_mfma_f32_16x16x32_bf16 v[24:27], v[100:103], a[116:119], v[24:27]
ds_read_b64_tr_b16 v[88:89], v8 offset:36864
v_mfma_f32_16x16x32_bf16 v[56:59], v[104:107], a[4:7], 0
s_add_u32 m0, s34, 102400
s_add_u32 s31, s35, 37248
v_mfma_f32_16x16x32_bf16 v[32:35], v[96:99], a[104:107], v[32:35]
ds_read_b64_tr_b16 v[90:91], v8 offset:38912
v_mfma_f32_16x16x32_bf16 v[32:35], v[100:103], a[120:123], v[32:35]
buffer_load_dwordx4 v10, s[20:23], s31 offen lds
v_mfma_f32_16x16x32_bf16 v[64:67], v[104:107], a[8:11], 0
ds_read_b64_tr_b16 v[92:93], v8 offset:40960
v_mfma_f32_16x16x32_bf16 v[40:43], v[96:99], a[108:111], v[40:43]
s_add_u32 m0, s34, 106496
s_add_u32 s31, s35, 74112
v_mfma_f32_16x16x32_bf16 v[40:43], v[100:103], a[124:127], v[40:43]
ds_read_b64_tr_b16 v[94:95], v8 offset:43008
v_mfma_f32_16x16x32_bf16 v[72:75], v[104:107], a[12:15], 0
buffer_load_dwordx4 v10, s[20:23], s31 offen lds
s_waitcnt lgkmcnt(8)
v_mfma_f32_16x16x32_bf16 v[20:23], v[108:111], a[96:99], v[20:23]
ds_read_b64_tr_b16 v[96:97], v8 offset:45056
s_waitcnt lgkmcnt(7)
v_mfma_f32_16x16x32_bf16 v[20:23], v[80:83], a[112:115], v[20:23]
s_add_u32 m0, s34, 110592
s_add_u32 s31, s35, 110976
s_waitcnt lgkmcnt(5)
v_mfma_f32_16x16x32_bf16 v[52:55], v[84:87], a[0:3], 0
ds_read_b64_tr_b16 v[98:99], v8 offset:47104
v_mfma_f32_16x16x32_bf16 v[28:31], v[108:111], a[100:103], v[28:31]
buffer_load_dwordx4 v10, s[20:23], s31 offen lds
v_mfma_f32_16x16x32_bf16 v[28:31], v[80:83], a[116:119], v[28:31]
ds_read_b64_tr_b16 v[100:101], v9 offset:36864
v_mfma_f32_16x16x32_bf16 v[60:63], v[84:87], a[4:7], 0
s_add_u32 m0, s34, 114688
s_add_u32 s31, s35, 147840
v_mfma_f32_16x16x32_bf16 v[36:39], v[108:111], a[104:107], v[36:39]
ds_read_b64_tr_b16 v[102:103], v9 offset:38912
v_mfma_f32_16x16x32_bf16 v[36:39], v[80:83], a[120:123], v[36:39]
buffer_load_dwordx4 v10, s[20:23], s31 offen lds
v_mfma_f32_16x16x32_bf16 v[68:71], v[84:87], a[8:11], 0
ds_read_b64_tr_b16 v[104:105], v9 offset:40960
v_mfma_f32_16x16x32_bf16 v[44:47], v[108:111], a[108:111], v[44:47]
s_add_u32 m0, s34, 118784
s_add_u32 s31, s35, 184704
v_mfma_f32_16x16x32_bf16 v[44:47], v[80:83], a[124:127], v[44:47]
ds_read_b64_tr_b16 v[106:107], v9 offset:43008
v_mfma_f32_16x16x32_bf16 v[76:79], v[84:87], a[12:15], 0
buffer_load_dwordx4 v10, s[20:23], s31 offen lds
s_waitcnt vmcnt(15)
s_barrier
s_waitcnt lgkmcnt(8)
v_mfma_f32_16x16x32_bf16 v[48:51], v[88:91], a[16:19], v[48:51]
ds_read_b64_tr_b16 v[108:109], v9 offset:45056
s_waitcnt lgkmcnt(7)
v_mfma_f32_16x16x32_bf16 v[48:51], v[92:95], a[32:35], v[48:51]
s_add_u32 m0, s34, 122880
s_add_u32 s31, s35, 221568
s_waitcnt lgkmcnt(5)
v_mfma_f32_16x16x32_bf16 v[48:51], v[96:99], a[48:51], v[48:51]
ds_read_b64_tr_b16 v[110:111], v9 offset:47104
s_add_u32 s37, s36, 0
v_cvt_pk_bf16_f32 v176, v16, v17
v_mfma_f32_16x16x32_bf16 v[56:59], v[88:91], a[20:23], v[56:59]
buffer_load_dwordx4 v10, s[20:23], s31 offen lds
v_mfma_f32_16x16x32_bf16 v[56:59], v[92:95], a[36:39], v[56:59]
ds_read_b64_tr_b16 v[80:81], v8 offset:49152
v_cvt_pk_bf16_f32 v177, v18, v19
v_mfma_f32_16x16x32_bf16 v[56:59], v[96:99], a[52:55], v[56:59]
s_add_u32 m0, s34, 126976
s_add_u32 s31, s35, 258432
v_cvt_pk_bf16_f32 v178, v20, v21
v_mfma_f32_16x16x32_bf16 v[64:67], v[88:91], a[24:27], v[64:67]
ds_read_b64_tr_b16 v[82:83], v8 offset:51200
v_cvt_pk_bf16_f32 v179, v22, v23
v_mfma_f32_16x16x32_bf16 v[64:67], v[92:95], a[40:43], v[64:67]
buffer_load_dwordx4 v10, s[20:23], s31 offen lds
buffer_store_dwordx4 v[176:179], v11, s[8:11], s37 offen offset:0 sc1
v_mfma_f32_16x16x32_bf16 v[64:67], v[96:99], a[56:59], v[64:67]
ds_read_b64_tr_b16 v[84:85], v8 offset:53248
v_cvt_pk_bf16_f32 v180, v24, v25
v_mfma_f32_16x16x32_bf16 v[72:75], v[88:91], a[28:31], v[72:75]
s_add_u32 m0, s34, 131072
s_add_u32 s31, s35, 512
v_cvt_pk_bf16_f32 v181, v26, v27
v_mfma_f32_16x16x32_bf16 v[72:75], v[92:95], a[44:47], v[72:75]
ds_read_b64_tr_b16 v[86:87], v8 offset:55296
v_cvt_pk_bf16_f32 v182, v28, v29
v_mfma_f32_16x16x32_bf16 v[72:75], v[96:99], a[60:63], v[72:75]
buffer_load_dwordx4 v10, s[20:23], s31 offen lds
v_cvt_pk_bf16_f32 v183, v30, v31
s_waitcnt lgkmcnt(8)
v_mfma_f32_16x16x32_bf16 v[52:55], v[100:103], a[16:19], v[52:55]
ds_read_b64_tr_b16 v[88:89], v8 offset:57344
buffer_store_dwordx4 v[180:183], v11, s[8:11], s37 offen offset:1024 sc1
s_waitcnt lgkmcnt(7)
v_mfma_f32_16x16x32_bf16 v[52:55], v[104:107], a[32:35], v[52:55]
s_add_u32 m0, s34, 135168
s_add_u32 s31, s35, 37376
v_cvt_pk_bf16_f32 v184, v32, v33
s_waitcnt lgkmcnt(5)
v_mfma_f32_16x16x32_bf16 v[52:55], v[108:111], a[48:51], v[52:55]
ds_read_b64_tr_b16 v[90:91], v8 offset:59392
v_cvt_pk_bf16_f32 v185, v34, v35
v_mfma_f32_16x16x32_bf16 v[60:63], v[100:103], a[20:23], v[60:63]
buffer_load_dwordx4 v10, s[20:23], s31 offen lds
v_cvt_pk_bf16_f32 v186, v36, v37
v_mfma_f32_16x16x32_bf16 v[60:63], v[104:107], a[36:39], v[60:63]
ds_read_b64_tr_b16 v[92:93], v9 offset:49152
v_mfma_f32_16x16x32_bf16 v[60:63], v[108:111], a[52:55], v[60:63]
s_add_u32 m0, s34, 139264
s_add_u32 s31, s35, 74240
v_cvt_pk_bf16_f32 v187, v38, v39
buffer_store_dwordx4 v[184:187], v11, s[8:11], s37 offen offset:2048 sc1
v_mfma_f32_16x16x32_bf16 v[68:71], v[100:103], a[24:27], v[68:71]
ds_read_b64_tr_b16 v[94:95], v9 offset:51200
v_mfma_f32_16x16x32_bf16 v[68:71], v[104:107], a[40:43], v[68:71]
buffer_load_dwordx4 v10, s[20:23], s31 offen lds
v_cvt_pk_bf16_f32 v188, v40, v41
v_mfma_f32_16x16x32_bf16 v[68:71], v[108:111], a[56:59], v[68:71]
ds_read_b64_tr_b16 v[96:97], v9 offset:53248
v_cvt_pk_bf16_f32 v189, v42, v43
v_mfma_f32_16x16x32_bf16 v[76:79], v[100:103], a[28:31], v[76:79]
s_add_u32 m0, s34, 143360
s_add_u32 s31, s35, 111104
v_cvt_pk_bf16_f32 v190, v44, v45
v_mfma_f32_16x16x32_bf16 v[76:79], v[104:107], a[44:47], v[76:79]
ds_read_b64_tr_b16 v[98:99], v9 offset:55296
v_cvt_pk_bf16_f32 v191, v46, v47
v_mfma_f32_16x16x32_bf16 v[76:79], v[108:111], a[60:63], v[76:79]
buffer_load_dwordx4 v10, s[20:23], s31 offen lds
buffer_store_dwordx4 v[188:191], v11, s[8:11], s37 offen offset:3072 sc1
s_waitcnt vmcnt(22)
s_barrier
s_waitcnt lgkmcnt(8)
v_mfma_f32_16x16x32_bf16 v[48:51], v[80:83], a[64:67], v[48:51]
ds_read_b64_tr_b16 v[100:101], v9 offset:57344
s_waitcnt lgkmcnt(7)
v_mfma_f32_16x16x32_bf16 v[48:51], v[84:87], a[80:83], v[48:51]
s_add_u32 m0, s34, 0
s_add_u32 s31, s35, 147968
s_waitcnt lgkmcnt(5)
v_mfma_f32_16x16x32_bf16 v[48:51], v[88:91], a[96:99], v[48:51]
ds_read_b64_tr_b16 v[102:103], v9 offset:59392
v_mfma_f32_16x16x32_bf16 v[56:59], v[80:83], a[68:71], v[56:59]
buffer_load_dwordx4 v10, s[20:23], s31 offen lds
v_mfma_f32_16x16x32_bf16 v[56:59], v[84:87], a[84:87], v[56:59]
ds_read_b64_tr_b16 v[104:105], v8 offset:61440
v_mfma_f32_16x16x32_bf16 v[56:59], v[88:91], a[100:103], v[56:59]
s_add_u32 m0, s34, 4096
s_add_u32 s31, s35, 184832
v_mfma_f32_16x16x32_bf16 v[64:67], v[80:83], a[72:75], v[64:67]
ds_read_b64_tr_b16 v[106:107], v8 offset:63488
v_mfma_f32_16x16x32_bf16 v[64:67], v[84:87], a[88:91], v[64:67]
buffer_load_dwordx4 v10, s[20:23], s31 offen lds
v_mfma_f32_16x16x32_bf16 v[64:67], v[88:91], a[104:107], v[64:67]
ds_read_b64_tr_b16 v[108:109], v5 offset:0
v_mfma_f32_16x16x32_bf16 v[72:75], v[80:83], a[76:79], v[72:75]
s_add_u32 m0, s34, 8192
s_add_u32 s31, s35, 221696
v_mfma_f32_16x16x32_bf16 v[72:75], v[84:87], a[92:95], v[72:75]
ds_read_b64_tr_b16 v[110:111], v5 offset:2048
v_mfma_f32_16x16x32_bf16 v[72:75], v[88:91], a[108:111], v[72:75]
buffer_load_dwordx4 v10, s[20:23], s31 offen lds
s_waitcnt lgkmcnt(8)
v_mfma_f32_16x16x32_bf16 v[52:55], v[92:95], a[64:67], v[52:55]
ds_read_b64_tr_b16 v[80:81], v5 offset:4096
s_waitcnt lgkmcnt(7)
v_mfma_f32_16x16x32_bf16 v[52:55], v[96:99], a[80:83], v[52:55]
s_add_u32 m0, s34, 12288
s_add_u32 s31, s35, 258560
s_waitcnt lgkmcnt(5)
v_mfma_f32_16x16x32_bf16 v[52:55], v[100:103], a[96:99], v[52:55]
ds_read_b64_tr_b16 v[82:83], v5 offset:6144
v_mfma_f32_16x16x32_bf16 v[60:63], v[92:95], a[68:71], v[60:63]
buffer_load_dwordx4 v10, s[20:23], s31 offen lds
v_mfma_f32_16x16x32_bf16 v[60:63], v[96:99], a[84:87], v[60:63]
ds_read_b64_tr_b16 v[84:85], v9 offset:61440
v_mfma_f32_16x16x32_bf16 v[60:63], v[100:103], a[100:103], v[60:63]
s_add_u32 m0, s34, 16384
s_add_u32 s31, s35, 640
v_mfma_f32_16x16x32_bf16 v[68:71], v[92:95], a[72:75], v[68:71]
ds_read_b64_tr_b16 v[86:87], v9 offset:63488
v_mfma_f32_16x16x32_bf16 v[68:71], v[96:99], a[88:91], v[68:71]
buffer_load_dwordx4 v10, s[20:23], s31 offen lds
v_mfma_f32_16x16x32_bf16 v[68:71], v[100:103], a[104:107], v[68:71]
ds_read_b64_tr_b16 v[88:89], v6 offset:0
v_mfma_f32_16x16x32_bf16 v[76:79], v[92:95], a[76:79], v[76:79]
s_add_u32 m0, s34, 20480
s_add_u32 s31, s35, 37504
v_mfma_f32_16x16x32_bf16 v[76:79], v[96:99], a[92:95], v[76:79]
ds_read_b64_tr_b16 v[90:91], v6 offset:2048
v_mfma_f32_16x16x32_bf16 v[76:79], v[100:103], a[108:111], v[76:79]
buffer_load_dwordx4 v10, s[20:23], s31 offen lds
s_waitcnt vmcnt(25)
s_barrier
s_waitcnt lgkmcnt(8)
v_mfma_f32_16x16x32_bf16 v[48:51], v[104:107], a[112:115], v[48:51]
ds_read_b64_tr_b16 v[92:93], v6 offset:4096
s_waitcnt lgkmcnt(7)
v_mfma_f32_16x16x32_bf16 v[16:19], v[108:111], a[0:3], 0
s_add_u32 m0, s34, 24576
s_add_u32 s31, s35, 74368
s_waitcnt lgkmcnt(5)
v_mfma_f32_16x16x32_bf16 v[16:19], v[80:83], a[16:19], v[16:19]
ds_read_b64_tr_b16 v[94:95], v6 offset:6144
v_mfma_f32_16x16x32_bf16 v[56:59], v[104:107], a[116:119], v[56:59]
buffer_load_dwordx4 v10, s[20:23], s31 offen lds
v_mfma_f32_16x16x32_bf16 v[24:27], v[108:111], a[4:7], 0
ds_read_b64_tr_b16 v[96:97], v5 offset:8192
v_mfma_f32_16x16x32_bf16 v[24:27], v[80:83], a[20:23], v[24:27]
s_add_u32 m0, s34, 28672
s_add_u32 s31, s35, 111232
v_mfma_f32_16x16x32_bf16 v[64:67], v[104:107], a[120:123], v[64:67]
ds_read_b64_tr_b16 v[98:99], v5 offset:10240
v_mfma_f32_16x16x32_bf16 v[32:35], v[108:111], a[8:11], 0
buffer_load_dwordx4 v10, s[20:23], s31 offen lds
v_mfma_f32_16x16x32_bf16 v[32:35], v[80:83], a[24:27], v[32:35]
ds_read_b64_tr_b16 v[100:101], v5 offset:12288
v_mfma_f32_16x16x32_bf16 v[72:75], v[104:107], a[124:127], v[72:75]
s_add_u32 m0, s34, 32768
s_add_u32 s31, s35, 148096
v_mfma_f32_16x16x32_bf16 v[40:43], v[108:111], a[12:15], 0
ds_read_b64_tr_b16 v[102:103], v5 offset:14336
v_mfma_f32_16x16x32_bf16 v[40:43], v[80:83], a[28:31], v[40:43]
buffer_load_dwordx4 v10, s[20:23], s31 offen lds
s_waitcnt lgkmcnt(8)
v_mfma_f32_16x16x32_bf16 v[52:55], v[84:87], a[112:115], v[52:55]
ds_read_b64_tr_b16 v[104:105], v5 offset:16384
s_waitcnt lgkmcnt(7)
v_mfma_f32_16x16x32_bf16 v[20:23], v[88:91], a[0:3], 0
s_add_u32 m0, s34, 36864
s_add_u32 s31, s35, 184960
s_waitcnt lgkmcnt(5)
v_mfma_f32_16x16x32_bf16 v[20:23], v[92:95], a[16:19], v[20:23]
ds_read_b64_tr_b16 v[106:107], v5 offset:18432
v_mfma_f32_16x16x32_bf16 v[60:63], v[84:87], a[116:119], v[60:63]
buffer_load_dwordx4 v10, s[20:23], s31 offen lds
v_mfma_f32_16x16x32_bf16 v[28:31], v[88:91], a[4:7], 0
ds_read_b64_tr_b16 v[108:109], v6 offset:8192
v_mfma_f32_16x16x32_bf16 v[28:31], v[92:95], a[20:23], v[28:31]
s_add_u32 m0, s34, 40960
s_add_u32 s31, s35, 221824
v_mfma_f32_16x16x32_bf16 v[68:71], v[84:87], a[120:123], v[68:71]
ds_read_b64_tr_b16 v[110:111], v6 offset:10240
v_mfma_f32_16x16x32_bf16 v[36:39], v[88:91], a[8:11], 0
buffer_load_dwordx4 v10, s[20:23], s31 offen lds
v_mfma_f32_16x16x32_bf16 v[36:39], v[92:95], a[24:27], v[36:39]
ds_read_b64_tr_b16 v[80:81], v6 offset:12288
v_mfma_f32_16x16x32_bf16 v[76:79], v[84:87], a[124:127], v[76:79]
s_add_u32 m0, s34, 45056
s_add_u32 s31, s35, 258688
v_mfma_f32_16x16x32_bf16 v[44:47], v[88:91], a[12:15], 0
ds_read_b64_tr_b16 v[82:83], v6 offset:14336
v_mfma_f32_16x16x32_bf16 v[44:47], v[92:95], a[28:31], v[44:47]
buffer_load_dwordx4 v10, s[20:23], s31 offen lds
s_waitcnt vmcnt(28)
s_barrier
s_waitcnt lgkmcnt(8)
v_mfma_f32_16x16x32_bf16 v[16:19], v[96:99], a[32:35], v[16:19]
ds_read_b64_tr_b16 v[84:85], v6 offset:16384
s_waitcnt lgkmcnt(7)
v_mfma_f32_16x16x32_bf16 v[16:19], v[100:103], a[48:51], v[16:19]
s_add_u32 m0, s34, 49152
s_add_u32 s31, s35, 768
s_waitcnt lgkmcnt(5)
v_mfma_f32_16x16x32_bf16 v[16:19], v[104:107], a[64:67], v[16:19]
ds_read_b64_tr_b16 v[86:87], v6 offset:18432
s_add_u32 s37, s36, 8192
v_cvt_pk_bf16_f32 v176, v48, v49
v_mfma_f32_16x16x32_bf16 v[24:27], v[96:99], a[36:39], v[24:27]
buffer_load_dwordx4 v10, s[20:23], s31 offen lds
v_mfma_f32_16x16x32_bf16 v[24:27], v[100:103], a[52:55], v[24:27]
ds_read_b64_tr_b16 v[88:89], v5 offset:20480
v_cvt_pk_bf16_f32 v177, v50, v51
v_mfma_f32_16x16x32_bf16 v[24:27], v[104:107], a[68:71], v[24:27]
s_add_u32 m0, s34, 53248
s_add_u32 s31, s35, 37632
v_cvt_pk_bf16_f32 v178, v52, v53
v_mfma_f32_16x16x32_bf16 v[32:35], v[96:99], a[40:43], v[32:35]
ds_read_b64_tr_b16 v[90:91], v5 offset:22528
v_cvt_pk_bf16_f32 v179, v54, v55
v_mfma_f32_16x16x32_bf16 v[32:35], v[100:103], a[56:59], v[32:35]
buffer_load_dwordx4 v10, s[20:23], s31 offen lds
buffer_store_dwordx4 v[176:179], v11, s[8:11], s37 offen offset:0 sc1
v_mfma_f32_16x16x32_bf16 v[32:35], v[104:107], a[72:75], v[32:35]
ds_read_b64_tr_b16 v[92:93], v5 offset:24576
v_cvt_pk_bf16_f32 v180, v56, v57
v_mfma_f32_16x16x32_bf16 v[40:43], v[96:99], a[44:47], v[40:43]
s_add_u32 m0, s34, 57344
s_add_u32 s31, s35, 74496
v_cvt_pk_bf16_f32 v181, v58, v59
v_mfma_f32_16x16x32_bf16 v[40:43], v[100:103], a[60:63], v[40:43]
ds_read_b64_tr_b16 v[94:95], v5 offset:26624
v_cvt_pk_bf16_f32 v182, v60, v61
v_mfma_f32_16x16x32_bf16 v[40:43], v[104:107], a[76:79], v[40:43]
buffer_load_dwordx4 v10, s[20:23], s31 offen lds
v_cvt_pk_bf16_f32 v183, v62, v63
s_waitcnt lgkmcnt(8)
v_mfma_f32_16x16x32_bf16 v[20:23], v[108:111], a[32:35], v[20:23]
ds_read_b64_tr_b16 v[96:97], v5 offset:28672
buffer_store_dwordx4 v[180:183], v11, s[8:11], s37 offen offset:1024 sc1
s_waitcnt lgkmcnt(7)
v_mfma_f32_16x16x32_bf16 v[20:23], v[80:83], a[48:51], v[20:23]
s_add_u32 m0, s34, 61440
s_add_u32 s31, s35, 111360
v_cvt_pk_bf16_f32 v184, v64, v65
s_waitcnt lgkmcnt(5)
v_mfma_f32_16x16x32_bf16 v[20:23], v[84:87], a[64:67], v[20:23]
ds_read_b64_tr_b16 v[98:99], v5 offset:30720
v_cvt_pk_bf16_f32 v185, v66, v67
v_mfma_f32_16x16x32_bf16 v[28:31], v[108:111], a[36:39], v[28:31]
buffer_load_dwordx4 v10, s[20:23], s31 offen lds
v_cvt_pk_bf16_f32 v186, v68, v69
v_mfma_f32_16x16x32_bf16 v[28:31], v[80:83], a[52:55], v[28:31]
ds_read_b64_tr_b16 v[100:101], v6 offset:20480
v_mfma_f32_16x16x32_bf16 v[28:31], v[84:87], a[68:71], v[28:31]
s_add_u32 m0, s34, 65536
s_add_u32 s31, s35, 148224
v_cvt_pk_bf16_f32 v187, v70, v71
buffer_store_dwordx4 v[184:187], v11, s[8:11], s37 offen offset:2048 sc1
v_mfma_f32_16x16x32_bf16 v[36:39], v[108:111], a[40:43], v[36:39]
ds_read_b64_tr_b16 v[102:103], v6 offset:22528
v_mfma_f32_16x16x32_bf16 v[36:39], v[80:83], a[56:59], v[36:39]
buffer_load_dwordx4 v10, s[20:23], s31 offen lds
v_cvt_pk_bf16_f32 v188, v72, v73
v_mfma_f32_16x16x32_bf16 v[36:39], v[84:87], a[72:75], v[36:39]
ds_read_b64_tr_b16 v[104:105], v6 offset:24576
v_cvt_pk_bf16_f32 v189, v74, v75
v_mfma_f32_16x16x32_bf16 v[44:47], v[108:111], a[44:47], v[44:47]
s_add_u32 m0, s34, 69632
s_add_u32 s31, s35, 185088
v_cvt_pk_bf16_f32 v190, v76, v77
v_mfma_f32_16x16x32_bf16 v[44:47], v[80:83], a[60:63], v[44:47]
ds_read_b64_tr_b16 v[106:107], v6 offset:26624
v_cvt_pk_bf16_f32 v191, v78, v79
v_mfma_f32_16x16x32_bf16 v[44:47], v[84:87], a[76:79], v[44:47]
buffer_load_dwordx4 v10, s[20:23], s31 offen lds
buffer_store_dwordx4 v[188:191], v11, s[8:11], s37 offen offset:3072 sc1
s_waitcnt vmcnt(35)
s_barrier
s_waitcnt lgkmcnt(8)
v_mfma_f32_16x16x32_bf16 v[16:19], v[88:91], a[80:83], v[16:19]
ds_read_b64_tr_b16 v[108:109], v6 offset:28672
s_waitcnt lgkmcnt(7)
v_mfma_f32_16x16x32_bf16 v[16:19], v[92:95], a[96:99], v[16:19]
s_add_u32 m0, s34, 73728
s_add_u32 s31, s35, 221952
s_waitcnt lgkmcnt(5)
v_mfma_f32_16x16x32_bf16 v[16:19], v[96:99], a[112:115], v[16:19]
ds_read_b64_tr_b16 v[110:111], v6 offset:30720
v_mfma_f32_16x16x32_bf16 v[24:27], v[88:91], a[84:87], v[24:27]
buffer_load_dwordx4 v10, s[20:23], s31 offen lds
v_mfma_f32_16x16x32_bf16 v[24:27], v[92:95], a[100:103], v[24:27]
ds_read_b64_tr_b16 v[80:81], v5 offset:32768
v_mfma_f32_16x16x32_bf16 v[24:27], v[96:99], a[116:119], v[24:27]
v_mfma_f32_16x16x32_bf16 v[32:35], v[88:91], a[88:91], v[32:35]
ds_read_b64_tr_b16 v[82:83], v5 offset:34816
v_mfma_f32_16x16x32_bf16 v[32:35], v[92:95], a[104:107], v[32:35]
v_mfma_f32_16x16x32_bf16 v[32:35], v[96:99], a[120:123], v[32:35]
ds_read_b64_tr_b16 v[84:85], v5 offset:36864
v_mfma_f32_16x16x32_bf16 v[40:43], v[88:91], a[92:95], v[40:43]
s_add_u32 m0, s34, 77824
s_add_u32 s31, s35, 258816
v_mfma_f32_16x16x32_bf16 v[40:43], v[92:95], a[108:111], v[40:43]
ds_read_b64_tr_b16 v[86:87], v5 offset:38912
v_mfma_f32_16x16x32_bf16 v[40:43], v[96:99], a[124:127], v[40:43]
buffer_load_dwordx4 v10, s[20:23], s31 offen lds
s_waitcnt lgkmcnt(8)
v_mfma_f32_16x16x32_bf16 v[20:23], v[100:103], a[80:83], v[20:23]
ds_read_b64_tr_b16 v[88:89], v5 offset:40960
s_waitcnt lgkmcnt(7)
v_mfma_f32_16x16x32_bf16 v[20:23], v[104:107], a[96:99], v[20:23]
s_waitcnt lgkmcnt(5)
v_mfma_f32_16x16x32_bf16 v[20:23], v[108:111], a[112:115], v[20:23]
ds_read_b64_tr_b16 v[90:91], v5 offset:43008
v_mfma_f32_16x16x32_bf16 v[28:31], v[100:103], a[84:87], v[28:31]
v_mfma_f32_16x16x32_bf16 v[28:31], v[104:107], a[100:103], v[28:31]
ds_read_b64_tr_b16 v[92:93], v6 offset:32768
v_mfma_f32_16x16x32_bf16 v[28:31], v[108:111], a[116:119], v[28:31]
s_add_u32 m0, s34, 81920
s_add_u32 s31, s35, 896
v_mfma_f32_16x16x32_bf16 v[36:39], v[100:103], a[88:91], v[36:39]
ds_read_b64_tr_b16 v[94:95], v6 offset:34816
v_mfma_f32_16x16x32_bf16 v[36:39], v[104:107], a[104:107], v[36:39]
buffer_load_dwordx4 v10, s[20:23], s31 offen lds
v_mfma_f32_16x16x32_bf16 v[36:39], v[108:111], a[120:123], v[36:39]
ds_read_b64_tr_b16 v[96:97], v6 offset:36864
v_mfma_f32_16x16x32_bf16 v[44:47], v[100:103], a[92:95], v[44:47]
v_mfma_f32_16x16x32_bf16 v[44:47], v[104:107], a[108:111], v[44:47]
ds_read_b64_tr_b16 v[98:99], v6 offset:38912
v_mfma_f32_16x16x32_bf16 v[44:47], v[108:111], a[124:127], v[44:47]
s_waitcnt vmcnt(35)
s_barrier
s_waitcnt lgkmcnt(8)
v_mfma_f32_16x16x32_bf16 v[48:51], v[80:83], a[0:3], 0
ds_read_b64_tr_b16 v[100:101], v6 offset:40960
s_waitcnt lgkmcnt(7)
v_mfma_f32_16x16x32_bf16 v[48:51], v[84:87], a[16:19], v[48:51]
s_add_u32 m0, s34, 86016
s_add_u32 s31, s35, 37760
s_waitcnt lgkmcnt(5)
v_mfma_f32_16x16x32_bf16 v[48:51], v[88:91], a[32:35], v[48:51]
ds_read_b64_tr_b16 v[102:103], v6 offset:43008
s_add_u32 s37, s36, 16384
v_mfma_f32_16x16x32_bf16 v[56:59], v[80:83], a[4:7], 0
buffer_load_dwordx4 v10, s[20:23], s31 offen lds
v_cvt_pk_bf16_f32 v176, v16, v17
v_mfma_f32_16x16x32_bf16 v[56:59], v[84:87], a[20:23], v[56:59]
ds_read_b64_tr_b16 v[104:105], v5 offset:45056
v_cvt_pk_bf16_f32 v177, v18, v19
v_mfma_f32_16x16x32_bf16 v[56:59], v[88:91], a[36:39], v[56:59]
v_cvt_pk_bf16_f32 v178, v20, v21
v_mfma_f32_16x16x32_bf16 v[64:67], v[80:83], a[8:11], 0
ds_read_b64_tr_b16 v[106:107], v5 offset:47104
v_cvt_pk_bf16_f32 v179, v22, v23
v_mfma_f32_16x16x32_bf16 v[64:67], v[84:87], a[24:27], v[64:67]
buffer_store_dwordx4 v[176:179], v11, s[8:11], s37 offen offset:0 sc1
v_mfma_f32_16x16x32_bf16 v[64:67], v[88:91], a[40:43], v[64:67]
ds_read_b64_tr_b16 v[108:109], v5 offset:49152
v_cvt_pk_bf16_f32 v180, v24, v25
v_mfma_f32_16x16x32_bf16 v[72:75], v[80:83], a[12:15], 0
s_add_u32 m0, s34, 90112
s_add_u32 s31, s35, 74624
v_cvt_pk_bf16_f32 v181, v26, v27
v_mfma_f32_16x16x32_bf16 v[72:75], v[84:87], a[28:31], v[72:75]
ds_read_b64_tr_b16 v[110:111], v5 offset:51200
v_cvt_pk_bf16_f32 v182, v28, v29
v_mfma_f32_16x16x32_bf16 v[72:75], v[88:91], a[44:47], v[72:75]
buffer_load_dwordx4 v10, s[20:23], s31 offen lds
s_waitcnt lgkmcnt(8)
v_mfma_f32_16x16x32_bf16 v[52:55], v[92:95], a[0:3], 0
ds_read_b64_tr_b16 v[80:81], v5 offset:53248
v_cvt_pk_bf16_f32 v183, v30, v31
s_waitcnt lgkmcnt(7)
v_mfma_f32_16x16x32_bf16 v[52:55], v[96:99], a[16:19], v[52:55]
buffer_store_dwordx4 v[180:183], v11, s[8:11], s37 offen offset:1024 sc1
s_waitcnt lgkmcnt(5)
v_mfma_f32_16x16x32_bf16 v[52:55], v[100:103], a[32:35], v[52:55]
ds_read_b64_tr_b16 v[82:83], v5 offset:55296
v_cvt_pk_bf16_f32 v184, v32, v33
v_mfma_f32_16x16x32_bf16 v[60:63], v[92:95], a[4:7], 0
v_cvt_pk_bf16_f32 v185, v34, v35
v_cvt_pk_bf16_f32 v186, v36, v37
v_mfma_f32_16x16x32_bf16 v[60:63], v[96:99], a[20:23], v[60:63]
ds_read_b64_tr_b16 v[84:85], v6 offset:45056
v_mfma_f32_16x16x32_bf16 v[60:63], v[100:103], a[36:39], v[60:63]
s_add_u32 m0, s34, 94208
s_add_u32 s31, s35, 111488
v_cvt_pk_bf16_f32 v187, v38, v39
v_mfma_f32_16x16x32_bf16 v[68:71], v[92:95], a[8:11], 0
ds_read_b64_tr_b16 v[86:87], v6 offset:47104
buffer_store_dwordx4 v[184:187], v11, s[8:11], s37 offen offset:2048 sc1
v_mfma_f32_16x16x32_bf16 v[68:71], v[96:99], a[24:27], v[68:71]
buffer_load_dwordx4 v10, s[20:23], s31 offen lds
v_cvt_pk_bf16_f32 v188, v40, v41
v_mfma_f32_16x16x32_bf16 v[68:71], v[100:103], a[40:43], v[68:71]
ds_read_b64_tr_b16 v[88:89], v6 offset:49152
v_mfma_f32_16x16x32_bf16 v[76:79], v[92:95], a[12:15], 0
v_cvt_pk_bf16_f32 v189, v42, v43
v_cvt_pk_bf16_f32 v190, v44, v45
v_mfma_f32_16x16x32_bf16 v[76:79], v[96:99], a[28:31], v[76:79]
ds_read_b64_tr_b16 v[90:91], v6 offset:51200
v_mfma_f32_16x16x32_bf16 v[76:79], v[100:103], a[44:47], v[76:79]
v_cvt_pk_bf16_f32 v191, v46, v47
buffer_store_dwordx4 v[188:191], v11, s[8:11], s37 offen offset:3072 sc1
s_waitcnt vmcnt(38)
s_barrier
s_waitcnt lgkmcnt(8)
v_mfma_f32_16x16x32_bf16 v[48:51], v[104:107], a[48:51], v[48:51]
ds_read_b64_tr_b16 v[92:93], v6 offset:53248
s_waitcnt lgkmcnt(7)
v_mfma_f32_16x16x32_bf16 v[48:51], v[108:111], a[64:67], v[48:51]
s_add_u32 m0, s34, 98304
s_add_u32 s31, s35, 148352
s_waitcnt lgkmcnt(5)
v_mfma_f32_16x16x32_bf16 v[48:51], v[80:83], a[80:83], v[48:51]
ds_read_b64_tr_b16 v[94:95], v6 offset:55296
v_mfma_f32_16x16x32_bf16 v[56:59], v[104:107], a[52:55], v[56:59]
buffer_load_dwordx4 v10, s[20:23], s31 offen lds
v_mfma_f32_16x16x32_bf16 v[56:59], v[108:111], a[68:71], v[56:59]
ds_read_b64_tr_b16 v[96:97], v5 offset:57344
v_mfma_f32_16x16x32_bf16 v[56:59], v[80:83], a[84:87], v[56:59]
v_mfma_f32_16x16x32_bf16 v[64:67], v[104:107], a[56:59], v[64:67]
ds_read_b64_tr_b16 v[98:99], v5 offset:59392
v_mfma_f32_16x16x32_bf16 v[64:67], v[108:111], a[72:75], v[64:67]
v_mfma_f32_16x16x32_bf16 v[64:67], v[80:83], a[88:91], v[64:67]
ds_read_b64_tr_b16 v[100:101], v5 offset:61440
v_mfma_f32_16x16x32_bf16 v[72:75], v[104:107], a[60:63], v[72:75]
s_add_u32 m0, s34, 102400
s_add_u32 s31, s35, 185216
v_mfma_f32_16x16x32_bf16 v[72:75], v[108:111], a[76:79], v[72:75]
ds_read_b64_tr_b16 v[102:103], v5 offset:63488
v_mfma_f32_16x16x32_bf16 v[72:75], v[80:83], a[92:95], v[72:75]
buffer_load_dwordx4 v10, s[20:23], s31 offen lds
s_waitcnt lgkmcnt(8)
v_mfma_f32_16x16x32_bf16 v[52:55], v[84:87], a[48:51], v[52:55]
ds_read_b64_tr_b16 v[104:105], v2 offset:0
s_waitcnt lgkmcnt(7)
v_mfma_f32_16x16x32_bf16 v[52:55], v[88:91], a[64:67], v[52:55]
s_waitcnt lgkmcnt(5)
v_mfma_f32_16x16x32_bf16 v[52:55], v[92:95], a[80:83], v[52:55]
ds_read_b64_tr_b16 v[106:107], v2 offset:2048
v_mfma_f32_16x16x32_bf16 v[60:63], v[84:87], a[52:55], v[60:63]
v_mfma_f32_16x16x32_bf16 v[60:63], v[88:91], a[68:71], v[60:63]
ds_read_b64_tr_b16 v[108:109], v6 offset:57344
v_mfma_f32_16x16x32_bf16 v[60:63], v[92:95], a[84:87], v[60:63]
s_add_u32 m0, s34, 106496
s_add_u32 s31, s35, 222080
v_mfma_f32_16x16x32_bf16 v[68:71], v[84:87], a[56:59], v[68:71]
ds_read_b64_tr_b16 v[110:111], v6 offset:59392
v_mfma_f32_16x16x32_bf16 v[68:71], v[88:91], a[72:75], v[68:71]
buffer_load_dwordx4 v10, s[20:23], s31 offen lds
v_mfma_f32_16x16x32_bf16 v[68:71], v[92:95], a[88:91], v[68:71]
ds_read_b64_tr_b16 v[80:81], v6 offset:61440
v_mfma_f32_16x16x32_bf16 v[76:79], v[84:87], a[60:63], v[76:79]
v_mfma_f32_16x16x32_bf16 v[76:79], v[88:91], a[76:79], v[76:79]
ds_read_b64_tr_b16 v[82:83], v6 offset:63488
v_mfma_f32_16x16x32_bf16 v[76:79], v[92:95], a[92:95], v[76:79]
s_waitcnt vmcnt(36)
s_barrier
s_waitcnt lgkmcnt(8)
v_mfma_f32_16x16x32_bf16 v[48:51], v[96:99], a[96:99], v[48:51]
ds_read_b64_tr_b16 v[84:85], v3 offset:0
s_waitcnt lgkmcnt(7)
v_mfma_f32_16x16x32_bf16 v[48:51], v[100:103], a[112:115], v[48:51]
s_add_u32 m0, s34, 110592
s_add_u32 s31, s35, 258944
s_waitcnt lgkmcnt(5)
v_mfma_f32_16x16x32_bf16 v[16:19], v[104:107], a[0:3], 0
ds_read_b64_tr_b16 v[86:87], v3 offset:2048
v_mfma_f32_16x16x32_bf16 v[56:59], v[96:99], a[100:103], v[56:59]
buffer_load_dwordx4 v10, s[20:23], s31 offen lds
v_mfma_f32_16x16x32_bf16 v[56:59], v[100:103], a[116:119], v[56:59]
ds_read_b64_tr_b16 v[88:89], v2 offset:4096
v_mfma_f32_16x16x32_bf16 v[24:27], v[104:107], a[4:7], 0
v_mfma_f32_16x16x32_bf16 v[64:67], v[96:99], a[104:107], v[64:67]
ds_read_b64_tr_b16 v[90:91], v2 offset:6144
v_mfma_f32_16x16x32_bf16 v[64:67], v[100:103], a[120:123], v[64:67]
v_mfma_f32_16x16x32_bf16 v[32:35], v[104:107], a[8:11], 0
ds_read_b64_tr_b16 v[92:93], v2 offset:8192
v_mfma_f32_16x16x32_bf16 v[72:75], v[96:99], a[108:111], v[72:75]
s_add_u32 m0, s34, 114688
s_add_u32 s31, s35, 1024
v_mfma_f32_16x16x32_bf16 v[72:75], v[100:103], a[124:127], v[72:75]
ds_read_b64_tr_b16 v[94:95], v2 offset:10240
v_mfma_f32_16x16x32_bf16 v[40:43], v[104:107], a[12:15], 0
buffer_load_dwordx4 v10, s[20:23], s31 offen lds
s_waitcnt lgkmcnt(8)
v_mfma_f32_16x16x32_bf16 v[52:55], v[108:111], a[96:99], v[52:55]
ds_read_b64_tr_b16 v[96:97], v2 offset:12288
s_waitcnt lgkmcnt(7)
v_mfma_f32_16x16x32_bf16 v[52:55], v[80:83], a[112:115], v[52:55]
s_waitcnt lgkmcnt(5)
v_mfma_f32_16x16x32_bf16 v[20:23], v[84:87], a[0:3], 0
ds_read_b64_tr_b16 v[98:99], v2 offset:14336
v_mfma_f32_16x16x32_bf16 v[60:63], v[108:111], a[100:103], v[60:63]
v_mfma_f32_16x16x32_bf16 v[60:63], v[80:83], a[116:119], v[60:63]
ds_read_b64_tr_b16 v[100:101], v3 offset:4096
v_mfma_f32_16x16x32_bf16 v[28:31], v[84:87], a[4:7], 0
s_add_u32 m0, s34, 118784
s_add_u32 s31, s35, 37888
v_mfma_f32_16x16x32_bf16 v[68:71], v[108:111], a[104:107], v[68:71]
ds_read_b64_tr_b16 v[102:103], v3 offset:6144
v_mfma_f32_16x16x32_bf16 v[68:71], v[80:83], a[120:123], v[68:71]
buffer_load_dwordx4 v10, s[20:23], s31 offen lds
v_mfma_f32_16x16x32_bf16 v[36:39], v[84:87], a[8:11], 0
ds_read_b64_tr_b16 v[104:105], v3 offset:8192
v_mfma_f32_16x16x32_bf16 v[76:79], v[108:111], a[108:111], v[76:79]
v_mfma_f32_16x16x32_bf16 v[76:79], v[80:83], a[124:127], v[76:79]
ds_read_b64_tr_b16 v[106:107], v3 offset:10240
v_mfma_f32_16x16x32_bf16 v[44:47], v[84:87], a[12:15], 0
s_waitcnt vmcnt(35)
s_barrier
s_waitcnt lgkmcnt(8)
v_mfma_f32_16x16x32_bf16 v[16:19], v[88:91], a[16:19], v[16:19]
ds_read_b64_tr_b16 v[108:109], v3 offset:12288
s_waitcnt lgkmcnt(7)
v_mfma_f32_16x16x32_bf16 v[16:19], v[92:95], a[32:35], v[16:19]
s_add_u32 m0, s34, 122880
s_add_u32 s31, s35, 74752
s_waitcnt lgkmcnt(5)
v_mfma_f32_16x16x32_bf16 v[16:19], v[96:99], a[48:51], v[16:19]
ds_read_b64_tr_b16 v[110:111], v3 offset:14336
s_add_u32 s37, s36, 24576
v_mfma_f32_16x16x32_bf16 v[24:27], v[88:91], a[20:23], v[24:27]
buffer_load_dwordx4 v10, s[20:23], s31 offen lds
v_cvt_pk_bf16_f32 v176, v48, v49
v_mfma_f32_16x16x32_bf16 v[24:27], v[92:95], a[36:39], v[24:27]
ds_read_b64_tr_b16 v[80:81], v8 offset:0
v_cvt_pk_bf16_f32 v177, v50, v51
v_mfma_f32_16x16x32_bf16 v[24:27], v[96:99], a[52:55], v[24:27]
v_cvt_pk_bf16_f32 v178, v52, v53
v_mfma_f32_16x16x32_bf16 v[32:35], v[88:91], a[24:27], v[32:35]
ds_read_b64_tr_b16 v[82:83], v8 offset:2048
v_cvt_pk_bf16_f32 v179, v54, v55
v_mfma_f32_16x16x32_bf16 v[32:35], v[92:95], a[40:43], v[32:35]
buffer_store_dwordx4 v[176:179], v11, s[8:11], s37 offen offset:0 sc1
v_mfma_f32_16x16x32_bf16 v[32:35], v[96:99], a[56:59], v[32:35]
ds_read_b64_tr_b16 v[84:85], v8 offset:4096
v_cvt_pk_bf16_f32 v180, v56, v57
v_mfma_f32_16x16x32_bf16 v[40:43], v[88:91], a[28:31], v[40:43]
s_add_u32 m0, s34, 126976
s_add_u32 s31, s35, 111616
v_cvt_pk_bf16_f32 v181, v58, v59
v_mfma_f32_16x16x32_bf16 v[40:43], v[92:95], a[44:47], v[40:43]
ds_read_b64_tr_b16 v[86:87], v8 offset:6144
v_cvt_pk_bf16_f32 v182, v60, v61
v_mfma_f32_16x16x32_bf16 v[40:43], v[96:99], a[60:63], v[40:43]
buffer_load_dwordx4 v10, s[20:23], s31 offen lds
s_waitcnt lgkmcnt(8)
v_mfma_f32_16x16x32_bf16 v[20:23], v[100:103], a[16:19], v[20:23]
ds_read_b64_tr_b16 v[88:89], v8 offset:8192
v_cvt_pk_bf16_f32 v183, v62, v63
s_waitcnt lgkmcnt(7)
v_mfma_f32_16x16x32_bf16 v[20:23], v[104:107], a[32:35], v[20:23]
buffer_store_dwordx4 v[180:183], v11, s[8:11], s37 offen offset:1024 sc1
s_waitcnt lgkmcnt(5)
v_mfma_f32_16x16x32_bf16 v[20:23], v[108:111], a[48:51], v[20:23]
ds_read_b64_tr_b16 v[90:91], v8 offset:10240
v_cvt_pk_bf16_f32 v184, v64, v65
v_mfma_f32_16x16x32_bf16 v[28:31], v[100:103], a[20:23], v[28:31]
v_cvt_pk_bf16_f32 v185, v66, v67
v_cvt_pk_bf16_f32 v186, v68, v69
v_mfma_f32_16x16x32_bf16 v[28:31], v[104:107], a[36:39], v[28:31]
ds_read_b64_tr_b16 v[92:93], v9 offset:0
v_mfma_f32_16x16x32_bf16 v[28:31], v[108:111], a[52:55], v[28:31]
s_add_u32 m0, s34, 131072
s_add_u32 s31, s35, 148480
v_cvt_pk_bf16_f32 v187, v70, v71
v_mfma_f32_16x16x32_bf16 v[36:39], v[100:103], a[24:27], v[36:39]
ds_read_b64_tr_b16 v[94:95], v9 offset:2048
buffer_store_dwordx4 v[184:187], v11, s[8:11], s37 offen offset:2048 sc1
v_mfma_f32_16x16x32_bf16 v[36:39], v[104:107], a[40:43], v[36:39]
buffer_load_dwordx4 v10, s[20:23], s31 offen lds
v_cvt_pk_bf16_f32 v188, v72, v73
v_mfma_f32_16x16x32_bf16 v[36:39], v[108:111], a[56:59], v[36:39]
ds_read_b64_tr_b16 v[96:97], v9 offset:4096
v_mfma_f32_16x16x32_bf16 v[44:47], v[100:103], a[28:31], v[44:47]
v_cvt_pk_bf16_f32 v189, v74, v75
v_cvt_pk_bf16_f32 v190, v76, v77
v_mfma_f32_16x16x32_bf16 v[44:47], v[104:107], a[44:47], v[44:47]
ds_read_b64_tr_b16 v[98:99], v9 offset:6144
v_mfma_f32_16x16x32_bf16 v[44:47], v[108:111], a[60:63], v[44:47]
v_cvt_pk_bf16_f32 v191, v78, v79
buffer_store_dwordx4 v[188:191], v11, s[8:11], s37 offen offset:3072 sc1
s_waitcnt vmcnt(39)
s_barrier
s_waitcnt lgkmcnt(8)
v_mfma_f32_16x16x32_bf16 v[16:19], v[80:83], a[64:67], v[16:19]
ds_read_b64_tr_b16 v[100:101], v9 offset:8192
s_waitcnt lgkmcnt(7)
v_mfma_f32_16x16x32_bf16 v[16:19], v[84:87], a[80:83], v[16:19]
s_add_u32 m0, s34, 135168
s_add_u32 s31, s35, 185344
s_waitcnt lgkmcnt(5)
v_mfma_f32_16x16x32_bf16 v[16:19], v[88:91], a[96:99], v[16:19]
ds_read_b64_tr_b16 v[102:103], v9 offset:10240
v_mfma_f32_16x16x32_bf16 v[24:27], v[80:83], a[68:71], v[24:27]
buffer_load_dwordx4 v10, s[20:23], s31 offen lds
v_mfma_f32_16x16x32_bf16 v[24:27], v[84:87], a[84:87], v[24:27]
ds_read_b64_tr_b16 v[104:105], v8 offset:12288
v_mfma_f32_16x16x32_bf16 v[24:27], v[88:91], a[100:103], v[24:27]
v_mfma_f32_16x16x32_bf16 v[32:35], v[80:83], a[72:75], v[32:35]
ds_read_b64_tr_b16 v[106:107], v8 offset:14336
v_mfma_f32_16x16x32_bf16 v[32:35], v[84:87], a[88:91], v[32:35]
v_mfma_f32_16x16x32_bf16 v[32:35], v[88:91], a[104:107], v[32:35]
ds_read_b64_tr_b16 v[108:109], v8 offset:16384
v_mfma_f32_16x16x32_bf16 v[40:43], v[80:83], a[76:79], v[40:43]
s_add_u32 m0, s34, 139264
s_add_u32 s31, s35, 222208
v_mfma_f32_16x16x32_bf16 v[40:43], v[84:87], a[92:95], v[40:43]
ds_read_b64_tr_b16 v[110:111], v8 offset:18432
v_mfma_f32_16x16x32_bf16 v[40:43], v[88:91], a[108:111], v[40:43]
buffer_load_dwordx4 v10, s[20:23], s31 offen lds
s_waitcnt lgkmcnt(8)
v_mfma_f32_16x16x32_bf16 v[20:23], v[92:95], a[64:67], v[20:23]
ds_read_b64_tr_b16 v[80:81], v8 offset:20480
s_waitcnt lgkmcnt(7)
v_mfma_f32_16x16x32_bf16 v[20:23], v[96:99], a[80:83], v[20:23]
s_waitcnt lgkmcnt(5)
v_mfma_f32_16x16x32_bf16 v[20:23], v[100:103], a[96:99], v[20:23]
ds_read_b64_tr_b16 v[82:83], v8 offset:22528
v_mfma_f32_16x16x32_bf16 v[28:31], v[92:95], a[68:71], v[28:31]
v_mfma_f32_16x16x32_bf16 v[28:31], v[96:99], a[84:87], v[28:31]
ds_read_b64_tr_b16 v[84:85], v9 offset:12288
v_mfma_f32_16x16x32_bf16 v[28:31], v[100:103], a[100:103], v[28:31]
s_add_u32 m0, s34, 143360
s_add_u32 s31, s35, 259072
v_mfma_f32_16x16x32_bf16 v[36:39], v[92:95], a[72:75], v[36:39]
ds_read_b64_tr_b16 v[86:87], v9 offset:14336
v_mfma_f32_16x16x32_bf16 v[36:39], v[96:99], a[88:91], v[36:39]
buffer_load_dwordx4 v10, s[20:23], s31 offen lds
v_mfma_f32_16x16x32_bf16 v[36:39], v[100:103], a[104:107], v[36:39]
ds_read_b64_tr_b16 v[88:89], v9 offset:16384
v_mfma_f32_16x16x32_bf16 v[44:47], v[92:95], a[76:79], v[44:47]
v_mfma_f32_16x16x32_bf16 v[44:47], v[96:99], a[92:95], v[44:47]
ds_read_b64_tr_b16 v[90:91], v9 offset:18432
v_mfma_f32_16x16x32_bf16 v[44:47], v[100:103], a[108:111], v[44:47]
s_waitcnt vmcnt(39)
s_barrier
s_waitcnt lgkmcnt(8)
v_mfma_f32_16x16x32_bf16 v[16:19], v[104:107], a[112:115], v[16:19]
ds_read_b64_tr_b16 v[92:93], v9 offset:20480
s_waitcnt lgkmcnt(7)
v_mfma_f32_16x16x32_bf16 v[48:51], v[108:111], a[0:3], 0
s_waitcnt lgkmcnt(5)
v_mfma_f32_16x16x32_bf16 v[48:51], v[80:83], a[16:19], v[48:51]
ds_read_b64_tr_b16 v[94:95], v9 offset:22528
v_mfma_f32_16x16x32_bf16 v[24:27], v[104:107], a[116:119], v[24:27]
v_mfma_f32_16x16x32_bf16 v[56:59], v[108:111], a[4:7], 0
ds_read_b64_tr_b16 v[96:97], v8 offset:24576
v_mfma_f32_16x16x32_bf16 v[56:59], v[80:83], a[20:23], v[56:59]
v_mfma_f32_16x16x32_bf16 v[32:35], v[104:107], a[120:123], v[32:35]
ds_read_b64_tr_b16 v[98:99], v8 offset:26624
v_mfma_f32_16x16x32_bf16 v[64:67], v[108:111], a[8:11], 0
v_mfma_f32_16x16x32_bf16 v[64:67], v[80:83], a[24:27], v[64:67]
ds_read_b64_tr_b16 v[100:101], v8 offset:28672
v_mfma_f32_16x16x32_bf16 v[40:43], v[104:107], a[124:127], v[40:43]
v_mfma_f32_16x16x32_bf16 v[72:75], v[108:111], a[12:15], 0
ds_read_b64_tr_b16 v[102:103], v8 offset:30720
v_mfma_f32_16x16x32_bf16 v[72:75], v[80:83], a[28:31], v[72:75]
s_waitcnt lgkmcnt(8)
v_mfma_f32_16x16x32_bf16 v[20:23], v[84:87], a[112:115], v[20:23]
ds_read_b64_tr_b16 v[104:105], v8 offset:32768
s_waitcnt lgkmcnt(7)
v_mfma_f32_16x16x32_bf16 v[52:55], v[88:91], a[0:3], 0
s_waitcnt lgkmcnt(5)
v_mfma_f32_16x16x32_bf16 v[52:55], v[92:95], a[16:19], v[52:55]
ds_read_b64_tr_b16 v[106:107], v8 offset:34816
v_mfma_f32_16x16x32_bf16 v[28:31], v[84:87], a[116:119], v[28:31]
v_mfma_f32_16x16x32_bf16 v[60:63], v[88:91], a[4:7], 0
ds_read_b64_tr_b16 v[108:109], v9 offset:24576
v_mfma_f32_16x16x32_bf16 v[60:63], v[92:95], a[20:23], v[60:63]
v_mfma_f32_16x16x32_bf16 v[36:39], v[84:87], a[120:123], v[36:39]
ds_read_b64_tr_b16 v[110:111], v9 offset:26624
v_mfma_f32_16x16x32_bf16 v[68:71], v[88:91], a[8:11], 0
v_mfma_f32_16x16x32_bf16 v[68:71], v[92:95], a[24:27], v[68:71]
ds_read_b64_tr_b16 v[80:81], v9 offset:28672
v_mfma_f32_16x16x32_bf16 v[44:47], v[84:87], a[124:127], v[44:47]
v_mfma_f32_16x16x32_bf16 v[76:79], v[88:91], a[12:15], 0
ds_read_b64_tr_b16 v[82:83], v9 offset:30720
v_mfma_f32_16x16x32_bf16 v[76:79], v[92:95], a[28:31], v[76:79]
s_waitcnt vmcnt(36)
s_barrier
s_waitcnt lgkmcnt(8)
v_mfma_f32_16x16x32_bf16 v[48:51], v[96:99], a[32:35], v[48:51]
ds_read_b64_tr_b16 v[84:85], v9 offset:32768
s_waitcnt lgkmcnt(7)
v_mfma_f32_16x16x32_bf16 v[48:51], v[100:103], a[48:51], v[48:51]
s_waitcnt lgkmcnt(5)
v_mfma_f32_16x16x32_bf16 v[48:51], v[104:107], a[64:67], v[48:51]
ds_read_b64_tr_b16 v[86:87], v9 offset:34816
s_add_u32 s37, s36, 32768
v_mfma_f32_16x16x32_bf16 v[56:59], v[96:99], a[36:39], v[56:59]
v_cvt_pk_bf16_f32 v176, v16, v17
v_cvt_pk_bf16_f32 v177, v18, v19
v_mfma_f32_16x16x32_bf16 v[56:59], v[100:103], a[52:55], v[56:59]
ds_read_b64_tr_b16 v[88:89], v8 offset:36864
v_mfma_f32_16x16x32_bf16 v[56:59], v[104:107], a[68:71], v[56:59]
v_cvt_pk_bf16_f32 v178, v20, v21
v_mfma_f32_16x16x32_bf16 v[64:67], v[96:99], a[40:43], v[64:67]
ds_read_b64_tr_b16 v[90:91], v8 offset:38912
v_cvt_pk_bf16_f32 v179, v22, v23
v_mfma_f32_16x16x32_bf16 v[64:67], v[100:103], a[56:59], v[64:67]
buffer_store_dwordx4 v[176:179], v11, s[8:11], s37 offen offset:0 sc1
v_mfma_f32_16x16x32_bf16 v[64:67], v[104:107], a[72:75], v[64:67]
ds_read_b64_tr_b16 v[92:93], v8 offset:40960
v_cvt_pk_bf16_f32 v180, v24, v25
v_mfma_f32_16x16x32_bf16 v[72:75], v[96:99], a[44:47], v[72:75]
v_cvt_pk_bf16_f32 v181, v26, v27
v_mfma_f32_16x16x32_bf16 v[72:75], v[100:103], a[60:63], v[72:75]
ds_read_b64_tr_b16 v[94:95], v8 offset:43008
v_cvt_pk_bf16_f32 v182, v28, v29
v_mfma_f32_16x16x32_bf16 v[72:75], v[104:107], a[76:79], v[72:75]
v_cvt_pk_bf16_f32 v183, v30, v31
s_waitcnt lgkmcnt(8)
v_mfma_f32_16x16x32_bf16 v[52:55], v[108:111], a[32:35], v[52:55]
ds_read_b64_tr_b16 v[96:97], v8 offset:45056
s_waitcnt lgkmcnt(7)
v_mfma_f32_16x16x32_bf16 v[52:55], v[80:83], a[48:51], v[52:55]
buffer_store_dwordx4 v[180:183], v11, s[8:11], s37 offen offset:1024 sc1
v_cvt_pk_bf16_f32 v184, v32, v33
s_waitcnt lgkmcnt(5)
v_mfma_f32_16x16x32_bf16 v[52:55], v[84:87], a[64:67], v[52:55]
ds_read_b64_tr_b16 v[98:99], v8 offset:47104
v_mfma_f32_16x16x32_bf16 v[60:63], v[108:111], a[36:39], v[60:63]
v_cvt_pk_bf16_f32 v185, v34, v35
v_cvt_pk_bf16_f32 v186, v36, v37
v_mfma_f32_16x16x32_bf16 v[60:63], v[80:83], a[52:55], v[60:63]
ds_read_b64_tr_b16 v[100:101], v9 offset:36864
v_mfma_f32_16x16x32_bf16 v[60:63], v[84:87], a[68:71], v[60:63]
v_cvt_pk_bf16_f32 v187, v38, v39
v_mfma_f32_16x16x32_bf16 v[68:71], v[108:111], a[40:43], v[68:71]
ds_read_b64_tr_b16 v[102:103], v9 offset:38912
buffer_store_dwordx4 v[184:187], v11, s[8:11], s37 offen offset:2048 sc1
v_mfma_f32_16x16x32_bf16 v[68:71], v[80:83], a[56:59], v[68:71]
v_cvt_pk_bf16_f32 v188, v40, v41
v_mfma_f32_16x16x32_bf16 v[68:71], v[84:87], a[72:75], v[68:71]
ds_read_b64_tr_b16 v[104:105], v9 offset:40960
v_cvt_pk_bf16_f32 v189, v42, v43
v_mfma_f32_16x16x32_bf16 v[76:79], v[108:111], a[44:47], v[76:79]
v_cvt_pk_bf16_f32 v190, v44, v45
v_mfma_f32_16x16x32_bf16 v[76:79], v[80:83], a[60:63], v[76:79]
ds_read_b64_tr_b16 v[106:107], v9 offset:43008
v_cvt_pk_bf16_f32 v191, v46, v47
v_mfma_f32_16x16x32_bf16 v[76:79], v[84:87], a[76:79], v[76:79]
buffer_store_dwordx4 v[188:191], v11, s[8:11], s37 offen offset:3072 sc1
s_waitcnt vmcnt(36)
s_barrier
s_waitcnt lgkmcnt(8)
v_mfma_f32_16x16x32_bf16 v[48:51], v[88:91], a[80:83], v[48:51]
ds_read_b64_tr_b16 v[108:109], v9 offset:45056
s_waitcnt lgkmcnt(7)
v_mfma_f32_16x16x32_bf16 v[48:51], v[92:95], a[96:99], v[48:51]
s_waitcnt lgkmcnt(5)
v_mfma_f32_16x16x32_bf16 v[48:51], v[96:99], a[112:115], v[48:51]
ds_read_b64_tr_b16 v[110:111], v9 offset:47104
v_mfma_f32_16x16x32_bf16 v[56:59], v[88:91], a[84:87], v[56:59]
v_mfma_f32_16x16x32_bf16 v[56:59], v[92:95], a[100:103], v[56:59]
ds_read_b64_tr_b16 v[80:81], v8 offset:49152
v_mfma_f32_16x16x32_bf16 v[56:59], v[96:99], a[116:119], v[56:59]
v_mfma_f32_16x16x32_bf16 v[64:67], v[88:91], a[88:91], v[64:67]
ds_read_b64_tr_b16 v[82:83], v8 offset:51200
v_mfma_f32_16x16x32_bf16 v[64:67], v[92:95], a[104:107], v[64:67]
v_mfma_f32_16x16x32_bf16 v[64:67], v[96:99], a[120:123], v[64:67]
ds_read_b64_tr_b16 v[84:85], v8 offset:53248
v_mfma_f32_16x16x32_bf16 v[72:75], v[88:91], a[92:95], v[72:75]
v_mfma_f32_16x16x32_bf16 v[72:75], v[92:95], a[108:111], v[72:75]
ds_read_b64_tr_b16 v[86:87], v8 offset:55296
v_mfma_f32_16x16x32_bf16 v[72:75], v[96:99], a[124:127], v[72:75]
s_waitcnt lgkmcnt(8)
v_mfma_f32_16x16x32_bf16 v[52:55], v[100:103], a[80:83], v[52:55]
ds_read_b64_tr_b16 v[88:89], v8 offset:57344
s_waitcnt lgkmcnt(7)
v_mfma_f32_16x16x32_bf16 v[52:55], v[104:107], a[96:99], v[52:55]
s_waitcnt lgkmcnt(5)
v_mfma_f32_16x16x32_bf16 v[52:55], v[108:111], a[112:115], v[52:55]
ds_read_b64_tr_b16 v[90:91], v8 offset:59392
v_mfma_f32_16x16x32_bf16 v[60:63], v[100:103], a[84:87], v[60:63]
v_mfma_f32_16x16x32_bf16 v[60:63], v[104:107], a[100:103], v[60:63]
ds_read_b64_tr_b16 v[92:93], v9 offset:49152
v_mfma_f32_16x16x32_bf16 v[60:63], v[108:111], a[116:119], v[60:63]
v_mfma_f32_16x16x32_bf16 v[68:71], v[100:103], a[88:91], v[68:71]
ds_read_b64_tr_b16 v[94:95], v9 offset:51200
v_mfma_f32_16x16x32_bf16 v[68:71], v[104:107], a[104:107], v[68:71]
v_mfma_f32_16x16x32_bf16 v[68:71], v[108:111], a[120:123], v[68:71]
ds_read_b64_tr_b16 v[96:97], v9 offset:53248
v_mfma_f32_16x16x32_bf16 v[76:79], v[100:103], a[92:95], v[76:79]
v_mfma_f32_16x16x32_bf16 v[76:79], v[104:107], a[108:111], v[76:79]
ds_read_b64_tr_b16 v[98:99], v9 offset:55296
v_mfma_f32_16x16x32_bf16 v[76:79], v[108:111], a[124:127], v[76:79]
s_waitcnt vmcnt(31)
s_barrier
s_waitcnt lgkmcnt(8)
v_mfma_f32_16x16x32_bf16 v[16:19], v[80:83], a[0:3], 0
ds_read_b64_tr_b16 v[100:101], v9 offset:57344
s_waitcnt lgkmcnt(7)
v_mfma_f32_16x16x32_bf16 v[16:19], v[84:87], a[16:19], v[16:19]
s_waitcnt lgkmcnt(5)
v_mfma_f32_16x16x32_bf16 v[16:19], v[88:91], a[32:35], v[16:19]
ds_read_b64_tr_b16 v[102:103], v9 offset:59392
s_add_u32 s37, s36, 40960
v_mfma_f32_16x16x32_bf16 v[24:27], v[80:83], a[4:7], 0
v_cvt_pk_bf16_f32 v176, v48, v49
v_cvt_pk_bf16_f32 v177, v50, v51
v_mfma_f32_16x16x32_bf16 v[24:27], v[84:87], a[20:23], v[24:27]
ds_read_b64_tr_b16 v[104:105], v8 offset:61440
v_mfma_f32_16x16x32_bf16 v[24:27], v[88:91], a[36:39], v[24:27]
v_cvt_pk_bf16_f32 v178, v52, v53
v_mfma_f32_16x16x32_bf16 v[32:35], v[80:83], a[8:11], 0
ds_read_b64_tr_b16 v[106:107], v8 offset:63488
v_cvt_pk_bf16_f32 v179, v54, v55
v_mfma_f32_16x16x32_bf16 v[32:35], v[84:87], a[24:27], v[32:35]
buffer_store_dwordx4 v[176:179], v11, s[8:11], s37 offen offset:0 sc1
v_mfma_f32_16x16x32_bf16 v[32:35], v[88:91], a[40:43], v[32:35]
ds_read_b64_tr_b16 v[108:109], v5 offset:0
v_cvt_pk_bf16_f32 v180, v56, v57
v_mfma_f32_16x16x32_bf16 v[40:43], v[80:83], a[12:15], 0
v_cvt_pk_bf16_f32 v181, v58, v59
v_mfma_f32_16x16x32_bf16 v[40:43], v[84:87], a[28:31], v[40:43]
ds_read_b64_tr_b16 v[110:111], v5 offset:2048
v_cvt_pk_bf16_f32 v182, v60, v61
v_mfma_f32_16x16x32_bf16 v[40:43], v[88:91], a[44:47], v[40:43]
v_cvt_pk_bf16_f32 v183, v62, v63
s_waitcnt lgkmcnt(8)
v_mfma_f32_16x16x32_bf16 v[20:23], v[92:95], a[0:3], 0
ds_read_b64_tr_b16 v[80:81], v5 offset:4096
s_waitcnt lgkmcnt(7)
v_mfma_f32_16x16x32_bf16 v[20:23], v[96:99], a[16:19], v[20:23]
buffer_store_dwordx4 v[180:183], v11, s[8:11], s37 offen offset:1024 sc1
v_cvt_pk_bf16_f32 v184, v64, v65
s_waitcnt lgkmcnt(5)
v_mfma_f32_16x16x32_bf16 v[20:23], v[100:103], a[32:35], v[20:23]
ds_read_b64_tr_b16 v[82:83], v5 offset:6144
v_mfma_f32_16x16x32_bf16 v[28:31], v[92:95], a[4:7], 0
v_cvt_pk_bf16_f32 v185, v66, v67
v_cvt_pk_bf16_f32 v186, v68, v69
v_mfma_f32_16x16x32_bf16 v[28:31], v[96:99], a[20:23], v[28:31]
ds_read_b64_tr_b16 v[84:85], v9 offset:61440
v_mfma_f32_16x16x32_bf16 v[28:31], v[100:103], a[36:39], v[28:31]
v_cvt_pk_bf16_f32 v187, v70, v71
v_mfma_f32_16x16x32_bf16 v[36:39], v[92:95], a[8:11], 0
ds_read_b64_tr_b16 v[86:87], v9 offset:63488
buffer_store_dwordx4 v[184:187], v11, s[8:11], s37 offen offset:2048 sc1
v_mfma_f32_16x16x32_bf16 v[36:39], v[96:99], a[24:27], v[36:39]
v_cvt_pk_bf16_f32 v188, v72, v73
v_mfma_f32_16x16x32_bf16 v[36:39], v[100:103], a[40:43], v[36:39]
ds_read_b64_tr_b16 v[88:89], v6 offset:0
v_cvt_pk_bf16_f32 v189, v74, v75
v_mfma_f32_16x16x32_bf16 v[44:47], v[92:95], a[12:15], 0
v_cvt_pk_bf16_f32 v190, v76, v77
v_mfma_f32_16x16x32_bf16 v[44:47], v[96:99], a[28:31], v[44:47]
ds_read_b64_tr_b16 v[90:91], v6 offset:2048
v_cvt_pk_bf16_f32 v191, v78, v79
v_mfma_f32_16x16x32_bf16 v[44:47], v[100:103], a[44:47], v[44:47]
buffer_store_dwordx4 v[188:191], v11, s[8:11], s37 offen offset:3072 sc1
s_waitcnt vmcnt(31)
s_barrier
s_waitcnt lgkmcnt(8)
v_mfma_f32_16x16x32_bf16 v[16:19], v[104:107], a[48:51], v[16:19]
ds_read_b64_tr_b16 v[92:93], v6 offset:4096
s_waitcnt lgkmcnt(7)
v_mfma_f32_16x16x32_bf16 v[16:19], v[108:111], a[64:67], v[16:19]
s_waitcnt lgkmcnt(5)
v_mfma_f32_16x16x32_bf16 v[16:19], v[80:83], a[80:83], v[16:19]
ds_read_b64_tr_b16 v[94:95], v6 offset:6144
v_mfma_f32_16x16x32_bf16 v[24:27], v[104:107], a[52:55], v[24:27]
v_mfma_f32_16x16x32_bf16 v[24:27], v[108:111], a[68:71], v[24:27]
ds_read_b64_tr_b16 v[96:97], v5 offset:8192
v_mfma_f32_16x16x32_bf16 v[24:27], v[80:83], a[84:87], v[24:27]
v_mfma_f32_16x16x32_bf16 v[32:35], v[104:107], a[56:59], v[32:35]
ds_read_b64_tr_b16 v[98:99], v5 offset:10240
v_mfma_f32_16x16x32_bf16 v[32:35], v[108:111], a[72:75], v[32:35]
v_mfma_f32_16x16x32_bf16 v[32:35], v[80:83], a[88:91], v[32:35]
ds_read_b64_tr_b16 v[100:101], v5 offset:12288
v_mfma_f32_16x16x32_bf16 v[40:43], v[104:107], a[60:63], v[40:43]
v_mfma_f32_16x16x32_bf16 v[40:43], v[108:111], a[76:79], v[40:43]
ds_read_b64_tr_b16 v[102:103], v5 offset:14336
v_mfma_f32_16x16x32_bf16 v[40:43], v[80:83], a[92:95], v[40:43]
s_waitcnt lgkmcnt(8)
v_mfma_f32_16x16x32_bf16 v[20:23], v[84:87], a[48:51], v[20:23]
ds_read_b64_tr_b16 v[104:105], v5 offset:16384
s_waitcnt lgkmcnt(7)
v_mfma_f32_16x16x32_bf16 v[20:23], v[88:91], a[64:67], v[20:23]
s_waitcnt lgkmcnt(5)
v_mfma_f32_16x16x32_bf16 v[20:23], v[92:95], a[80:83], v[20:23]
ds_read_b64_tr_b16 v[106:107], v5 offset:18432
v_mfma_f32_16x16x32_bf16 v[28:31], v[84:87], a[52:55], v[28:31]
v_mfma_f32_16x16x32_bf16 v[28:31], v[88:91], a[68:71], v[28:31]
ds_read_b64_tr_b16 v[108:109], v6 offset:8192
v_mfma_f32_16x16x32_bf16 v[28:31], v[92:95], a[84:87], v[28:31]
v_mfma_f32_16x16x32_bf16 v[36:39], v[84:87], a[56:59], v[36:39]
ds_read_b64_tr_b16 v[110:111], v6 offset:10240
v_mfma_f32_16x16x32_bf16 v[36:39], v[88:91], a[72:75], v[36:39]
v_mfma_f32_16x16x32_bf16 v[36:39], v[92:95], a[88:91], v[36:39]
ds_read_b64_tr_b16 v[80:81], v6 offset:12288
v_mfma_f32_16x16x32_bf16 v[44:47], v[84:87], a[60:63], v[44:47]
v_mfma_f32_16x16x32_bf16 v[44:47], v[88:91], a[76:79], v[44:47]
ds_read_b64_tr_b16 v[82:83], v6 offset:14336
v_mfma_f32_16x16x32_bf16 v[44:47], v[92:95], a[92:95], v[44:47]
s_waitcnt vmcnt(25)
s_barrier
s_waitcnt lgkmcnt(8)
v_mfma_f32_16x16x32_bf16 v[16:19], v[96:99], a[96:99], v[16:19]
ds_read_b64_tr_b16 v[84:85], v6 offset:16384
s_waitcnt lgkmcnt(7)
v_mfma_f32_16x16x32_bf16 v[16:19], v[100:103], a[112:115], v[16:19]
s_waitcnt lgkmcnt(5)
v_mfma_f32_16x16x32_bf16 v[48:51], v[104:107], a[0:3], 0
ds_read_b64_tr_b16 v[86:87], v6 offset:18432
v_mfma_f32_16x16x32_bf16 v[24:27], v[96:99], a[100:103], v[24:27]
v_mfma_f32_16x16x32_bf16 v[24:27], v[100:103], a[116:119], v[24:27]
ds_read_b64_tr_b16 v[88:89], v5 offset:20480
v_mfma_f32_16x16x32_bf16 v[56:59], v[104:107], a[4:7], 0
v_mfma_f32_16x16x32_bf16 v[32:35], v[96:99], a[104:107], v[32:35]
ds_read_b64_tr_b16 v[90:91], v5 offset:22528
v_mfma_f32_16x16x32_bf16 v[32:35], v[100:103], a[120:123], v[32:35]
v_mfma_f32_16x16x32_bf16 v[64:67], v[104:107], a[8:11], 0
ds_read_b64_tr_b16 v[92:93], v5 offset:24576
v_mfma_f32_16x16x32_bf16 v[40:43], v[96:99], a[108:111], v[40:43]
v_mfma_f32_16x16x32_bf16 v[40:43], v[100:103], a[124:127], v[40:43]
ds_read_b64_tr_b16 v[94:95], v5 offset:26624
v_mfma_f32_16x16x32_bf16 v[72:75], v[104:107], a[12:15], 0
s_waitcnt lgkmcnt(8)
v_mfma_f32_16x16x32_bf16 v[20:23], v[108:111], a[96:99], v[20:23]
ds_read_b64_tr_b16 v[96:97], v5 offset:28672
s_waitcnt lgkmcnt(7)
v_mfma_f32_16x16x32_bf16 v[20:23], v[80:83], a[112:115], v[20:23]
s_waitcnt lgkmcnt(5)
v_mfma_f32_16x16x32_bf16 v[52:55], v[84:87], a[0:3], 0
ds_read_b64_tr_b16 v[98:99], v5 offset:30720
v_mfma_f32_16x16x32_bf16 v[28:31], v[108:111], a[100:103], v[28:31]
v_mfma_f32_16x16x32_bf16 v[28:31], v[80:83], a[116:119], v[28:31]
ds_read_b64_tr_b16 v[100:101], v6 offset:20480
v_mfma_f32_16x16x32_bf16 v[60:63], v[84:87], a[4:7], 0
v_mfma_f32_16x16x32_bf16 v[36:39], v[108:111], a[104:107], v[36:39]
ds_read_b64_tr_b16 v[102:103], v6 offset:22528
v_mfma_f32_16x16x32_bf16 v[36:39], v[80:83], a[120:123], v[36:39]
v_mfma_f32_16x16x32_bf16 v[68:71], v[84:87], a[8:11], 0
ds_read_b64_tr_b16 v[104:105], v6 offset:24576
v_mfma_f32_16x16x32_bf16 v[44:47], v[108:111], a[108:111], v[44:47]
v_mfma_f32_16x16x32_bf16 v[44:47], v[80:83], a[124:127], v[44:47]
ds_read_b64_tr_b16 v[106:107], v6 offset:26624
v_mfma_f32_16x16x32_bf16 v[76:79], v[84:87], a[12:15], 0
s_waitcnt vmcnt(21)
s_barrier
s_waitcnt lgkmcnt(8)
v_mfma_f32_16x16x32_bf16 v[48:51], v[88:91], a[16:19], v[48:51]
ds_read_b64_tr_b16 v[108:109], v6 offset:28672
s_waitcnt lgkmcnt(7)
v_mfma_f32_16x16x32_bf16 v[48:51], v[92:95], a[32:35], v[48:51]
s_waitcnt lgkmcnt(5)
v_mfma_f32_16x16x32_bf16 v[48:51], v[96:99], a[48:51], v[48:51]
ds_read_b64_tr_b16 v[110:111], v6 offset:30720
s_add_u32 s37, s36, 49152
v_mfma_f32_16x16x32_bf16 v[56:59], v[88:91], a[20:23], v[56:59]
v_cvt_pk_bf16_f32 v176, v16, v17
v_cvt_pk_bf16_f32 v177, v18, v19
v_mfma_f32_16x16x32_bf16 v[56:59], v[92:95], a[36:39], v[56:59]
ds_read_b64_tr_b16 v[80:81], v5 offset:32768
v_mfma_f32_16x16x32_bf16 v[56:59], v[96:99], a[52:55], v[56:59]
v_cvt_pk_bf16_f32 v178, v20, v21
v_mfma_f32_16x16x32_bf16 v[64:67], v[88:91], a[24:27], v[64:67]
ds_read_b64_tr_b16 v[82:83], v5 offset:34816
v_cvt_pk_bf16_f32 v179, v22, v23
v_mfma_f32_16x16x32_bf16 v[64:67], v[92:95], a[40:43], v[64:67]
buffer_store_dwordx4 v[176:179], v11, s[8:11], s37 offen offset:0 sc1
v_mfma_f32_16x16x32_bf16 v[64:67], v[96:99], a[56:59], v[64:67]
ds_read_b64_tr_b16 v[84:85], v5 offset:36864
v_cvt_pk_bf16_f32 v180, v24, v25
v_mfma_f32_16x16x32_bf16 v[72:75], v[88:91], a[28:31], v[72:75]
v_cvt_pk_bf16_f32 v181, v26, v27
v_mfma_f32_16x16x32_bf16 v[72:75], v[92:95], a[44:47], v[72:75]
ds_read_b64_tr_b16 v[86:87], v5 offset:38912
v_cvt_pk_bf16_f32 v182, v28, v29
v_mfma_f32_16x16x32_bf16 v[72:75], v[96:99], a[60:63], v[72:75]
v_cvt_pk_bf16_f32 v183, v30, v31
s_waitcnt lgkmcnt(8)
v_mfma_f32_16x16x32_bf16 v[52:55], v[100:103], a[16:19], v[52:55]
ds_read_b64_tr_b16 v[88:89], v5 offset:40960
s_waitcnt lgkmcnt(7)
v_mfma_f32_16x16x32_bf16 v[52:55], v[104:107], a[32:35], v[52:55]
buffer_store_dwordx4 v[180:183], v11, s[8:11], s37 offen offset:1024 sc1
v_cvt_pk_bf16_f32 v184, v32, v33
s_waitcnt lgkmcnt(5)
v_mfma_f32_16x16x32_bf16 v[52:55], v[108:111], a[48:51], v[52:55]
ds_read_b64_tr_b16 v[90:91], v5 offset:43008
v_mfma_f32_16x16x32_bf16 v[60:63], v[100:103], a[20:23], v[60:63]
v_cvt_pk_bf16_f32 v185, v34, v35
v_cvt_pk_bf16_f32 v186, v36, v37
v_mfma_f32_16x16x32_bf16 v[60:63], v[104:107], a[36:39], v[60:63]
ds_read_b64_tr_b16 v[92:93], v6 offset:32768
v_mfma_f32_16x16x32_bf16 v[60:63], v[108:111], a[52:55], v[60:63]
v_cvt_pk_bf16_f32 v187, v38, v39
v_mfma_f32_16x16x32_bf16 v[68:71], v[100:103], a[24:27], v[68:71]
ds_read_b64_tr_b16 v[94:95], v6 offset:34816
buffer_store_dwordx4 v[184:187], v11, s[8:11], s37 offen offset:2048 sc1
v_mfma_f32_16x16x32_bf16 v[68:71], v[104:107], a[40:43], v[68:71]
v_cvt_pk_bf16_f32 v188, v40, v41
v_mfma_f32_16x16x32_bf16 v[68:71], v[108:111], a[56:59], v[68:71]
ds_read_b64_tr_b16 v[96:97], v6 offset:36864
v_cvt_pk_bf16_f32 v189, v42, v43
v_mfma_f32_16x16x32_bf16 v[76:79], v[100:103], a[28:31], v[76:79]
v_cvt_pk_bf16_f32 v190, v44, v45
v_mfma_f32_16x16x32_bf16 v[76:79], v[104:107], a[44:47], v[76:79]
ds_read_b64_tr_b16 v[98:99], v6 offset:38912
v_cvt_pk_bf16_f32 v191, v46, v47
v_mfma_f32_16x16x32_bf16 v[76:79], v[108:111], a[60:63], v[76:79]
buffer_store_dwordx4 v[188:191], v11, s[8:11], s37 offen offset:3072 sc1
s_waitcnt vmcnt(22)
s_barrier
s_waitcnt lgkmcnt(8)
v_mfma_f32_16x16x32_bf16 v[48:51], v[80:83], a[64:67], v[48:51]
ds_read_b64_tr_b16 v[100:101], v6 offset:40960
s_waitcnt lgkmcnt(7)
v_mfma_f32_16x16x32_bf16 v[48:51], v[84:87], a[80:83], v[48:51]
s_waitcnt lgkmcnt(5)
v_mfma_f32_16x16x32_bf16 v[48:51], v[88:91], a[96:99], v[48:51]
ds_read_b64_tr_b16 v[102:103], v6 offset:43008
v_mfma_f32_16x16x32_bf16 v[56:59], v[80:83], a[68:71], v[56:59]
global_load_dword v222, v[220:221], off
v_mfma_f32_16x16x32_bf16 v[56:59], v[84:87], a[84:87], v[56:59]
ds_read_b64_tr_b16 v[104:105], v5 offset:45056
v_mfma_f32_16x16x32_bf16 v[56:59], v[88:91], a[100:103], v[56:59]
v_mfma_f32_16x16x32_bf16 v[64:67], v[80:83], a[72:75], v[64:67]
ds_read_b64_tr_b16 v[106:107], v5 offset:47104
v_mfma_f32_16x16x32_bf16 v[64:67], v[84:87], a[88:91], v[64:67]
v_mfma_f32_16x16x32_bf16 v[64:67], v[88:91], a[104:107], v[64:67]
ds_read_b64_tr_b16 v[108:109], v5 offset:49152
v_mfma_f32_16x16x32_bf16 v[72:75], v[80:83], a[76:79], v[72:75]
v_mfma_f32_16x16x32_bf16 v[72:75], v[84:87], a[92:95], v[72:75]
ds_read_b64_tr_b16 v[110:111], v5 offset:51200
v_mfma_f32_16x16x32_bf16 v[72:75], v[88:91], a[108:111], v[72:75]
s_waitcnt lgkmcnt(8)
v_mfma_f32_16x16x32_bf16 v[52:55], v[92:95], a[64:67], v[52:55]
ds_read_b64_tr_b16 v[80:81], v5 offset:53248
s_waitcnt lgkmcnt(7)
v_mfma_f32_16x16x32_bf16 v[52:55], v[96:99], a[80:83], v[52:55]
s_waitcnt lgkmcnt(5)
v_mfma_f32_16x16x32_bf16 v[52:55], v[100:103], a[96:99], v[52:55]
ds_read_b64_tr_b16 v[82:83], v5 offset:55296
v_mfma_f32_16x16x32_bf16 v[60:63], v[92:95], a[68:71], v[60:63]
v_mfma_f32_16x16x32_bf16 v[60:63], v[96:99], a[84:87], v[60:63]
ds_read_b64_tr_b16 v[84:85], v6 offset:45056
v_mfma_f32_16x16x32_bf16 v[60:63], v[100:103], a[100:103], v[60:63]
v_mfma_f32_16x16x32_bf16 v[68:71], v[92:95], a[72:75], v[68:71]
ds_read_b64_tr_b16 v[86:87], v6 offset:47104
v_mfma_f32_16x16x32_bf16 v[68:71], v[96:99], a[88:91], v[68:71]
v_mfma_f32_16x16x32_bf16 v[68:71], v[100:103], a[104:107], v[68:71]
ds_read_b64_tr_b16 v[88:89], v6 offset:49152
v_mfma_f32_16x16x32_bf16 v[76:79], v[92:95], a[76:79], v[76:79]
v_mfma_f32_16x16x32_bf16 v[76:79], v[96:99], a[92:95], v[76:79]
ds_read_b64_tr_b16 v[90:91], v6 offset:51200
v_mfma_f32_16x16x32_bf16 v[76:79], v[100:103], a[108:111], v[76:79]
s_waitcnt vmcnt(17)
s_barrier
s_waitcnt lgkmcnt(8)
v_mfma_f32_16x16x32_bf16 v[48:51], v[104:107], a[112:115], v[48:51]
ds_read_b64_tr_b16 v[92:93], v6 offset:53248
s_waitcnt lgkmcnt(7)
v_mfma_f32_16x16x32_bf16 v[16:19], v[108:111], a[0:3], 0
s_waitcnt lgkmcnt(5)
v_mfma_f32_16x16x32_bf16 v[16:19], v[80:83], a[16:19], v[16:19]
ds_read_b64_tr_b16 v[94:95], v6 offset:55296
v_mfma_f32_16x16x32_bf16 v[56:59], v[104:107], a[116:119], v[56:59]
v_mfma_f32_16x16x32_bf16 v[24:27], v[108:111], a[4:7], 0
ds_read_b64_tr_b16 v[96:97], v5 offset:57344
v_mfma_f32_16x16x32_bf16 v[24:27], v[80:83], a[20:23], v[24:27]
v_mfma_f32_16x16x32_bf16 v[64:67], v[104:107], a[120:123], v[64:67]
ds_read_b64_tr_b16 v[98:99], v5 offset:59392
v_mfma_f32_16x16x32_bf16 v[32:35], v[108:111], a[8:11], 0
v_mfma_f32_16x16x32_bf16 v[32:35], v[80:83], a[24:27], v[32:35]
ds_read_b64_tr_b16 v[100:101], v5 offset:61440
v_mfma_f32_16x16x32_bf16 v[72:75], v[104:107], a[124:127], v[72:75]
v_mfma_f32_16x16x32_bf16 v[40:43], v[108:111], a[12:15], 0
ds_read_b64_tr_b16 v[102:103], v5 offset:63488
v_mfma_f32_16x16x32_bf16 v[40:43], v[80:83], a[28:31], v[40:43]
s_waitcnt lgkmcnt(8)
v_mfma_f32_16x16x32_bf16 v[52:55], v[84:87], a[112:115], v[52:55]
ds_read_b64_tr_b16 v[104:105], v2 offset:0
s_waitcnt lgkmcnt(7)
v_mfma_f32_16x16x32_bf16 v[20:23], v[88:91], a[0:3], 0
s_waitcnt lgkmcnt(5)
v_mfma_f32_16x16x32_bf16 v[20:23], v[92:95], a[16:19], v[20:23]
ds_read_b64_tr_b16 v[106:107], v2 offset:2048
v_mfma_f32_16x16x32_bf16 v[60:63], v[84:87], a[116:119], v[60:63]
v_mfma_f32_16x16x32_bf16 v[28:31], v[88:91], a[4:7], 0
ds_read_b64_tr_b16 v[108:109], v6 offset:57344
v_mfma_f32_16x16x32_bf16 v[28:31], v[92:95], a[20:23], v[28:31]
v_mfma_f32_16x16x32_bf16 v[68:71], v[84:87], a[120:123], v[68:71]
ds_read_b64_tr_b16 v[110:111], v6 offset:59392
v_mfma_f32_16x16x32_bf16 v[36:39], v[88:91], a[8:11], 0
v_mfma_f32_16x16x32_bf16 v[36:39], v[92:95], a[24:27], v[36:39]
ds_read_b64_tr_b16 v[80:81], v6 offset:61440
v_mfma_f32_16x16x32_bf16 v[76:79], v[84:87], a[124:127], v[76:79]
v_mfma_f32_16x16x32_bf16 v[44:47], v[88:91], a[12:15], 0
ds_read_b64_tr_b16 v[82:83], v6 offset:63488
v_mfma_f32_16x16x32_bf16 v[44:47], v[92:95], a[28:31], v[44:47]
s_waitcnt vmcnt(13)
s_barrier
s_waitcnt lgkmcnt(8)
v_mfma_f32_16x16x32_bf16 v[16:19], v[96:99], a[32:35], v[16:19]
ds_read_b64_tr_b16 v[84:85], v3 offset:0
s_waitcnt lgkmcnt(7)
v_mfma_f32_16x16x32_bf16 v[16:19], v[100:103], a[48:51], v[16:19]
s_waitcnt lgkmcnt(5)
v_mfma_f32_16x16x32_bf16 v[16:19], v[104:107], a[64:67], v[16:19]
ds_read_b64_tr_b16 v[86:87], v3 offset:2048
s_add_u32 s37, s36, 57344
v_mfma_f32_16x16x32_bf16 v[24:27], v[96:99], a[36:39], v[24:27]
v_cvt_pk_bf16_f32 v176, v48, v49
v_cvt_pk_bf16_f32 v177, v50, v51
v_mfma_f32_16x16x32_bf16 v[24:27], v[100:103], a[52:55], v[24:27]
ds_read_b64_tr_b16 v[88:89], v2 offset:4096
v_mfma_f32_16x16x32_bf16 v[24:27], v[104:107], a[68:71], v[24:27]
v_cvt_pk_bf16_f32 v178, v52, v53
v_mfma_f32_16x16x32_bf16 v[32:35], v[96:99], a[40:43], v[32:35]
ds_read_b64_tr_b16 v[90:91], v2 offset:6144
v_cvt_pk_bf16_f32 v179, v54, v55
v_mfma_f32_16x16x32_bf16 v[32:35], v[100:103], a[56:59], v[32:35]
buffer_store_dwordx4 v[176:179], v11, s[8:11], s37 offen offset:0 sc1
v_mfma_f32_16x16x32_bf16 v[32:35], v[104:107], a[72:75], v[32:35]
ds_read_b64_tr_b16 v[92:93], v2 offset:8192
v_cvt_pk_bf16_f32 v180, v56, v57
v_mfma_f32_16x16x32_bf16 v[40:43], v[96:99], a[44:47], v[40:43]
v_cvt_pk_bf16_f32 v181, v58, v59
v_mfma_f32_16x16x32_bf16 v[40:43], v[100:103], a[60:63], v[40:43]
ds_read_b64_tr_b16 v[94:95], v2 offset:10240
v_cvt_pk_bf16_f32 v182, v60, v61
v_mfma_f32_16x16x32_bf16 v[40:43], v[104:107], a[76:79], v[40:43]
v_cvt_pk_bf16_f32 v183, v62, v63
s_waitcnt lgkmcnt(8)
v_mfma_f32_16x16x32_bf16 v[20:23], v[108:111], a[32:35], v[20:23]
ds_read_b64_tr_b16 v[96:97], v2 offset:12288
s_waitcnt lgkmcnt(7)
v_mfma_f32_16x16x32_bf16 v[20:23], v[80:83], a[48:51], v[20:23]
buffer_store_dwordx4 v[180:183], v11, s[8:11], s37 offen offset:1024 sc1
v_cvt_pk_bf16_f32 v184, v64, v65
s_waitcnt lgkmcnt(5)
v_mfma_f32_16x16x32_bf16 v[20:23], v[84:87], a[64:67], v[20:23]
ds_read_b64_tr_b16 v[98:99], v2 offset:14336
v_mfma_f32_16x16x32_bf16 v[28:31], v[108:111], a[36:39], v[28:31]
v_cvt_pk_bf16_f32 v185, v66, v67
v_cvt_pk_bf16_f32 v186, v68, v69
v_mfma_f32_16x16x32_bf16 v[28:31], v[80:83], a[52:55], v[28:31]
ds_read_b64_tr_b16 v[100:101], v3 offset:4096
v_mfma_f32_16x16x32_bf16 v[28:31], v[84:87], a[68:71], v[28:31]
v_cvt_pk_bf16_f32 v187, v70, v71
v_mfma_f32_16x16x32_bf16 v[36:39], v[108:111], a[40:43], v[36:39]
ds_read_b64_tr_b16 v[102:103], v3 offset:6144
buffer_store_dwordx4 v[184:187], v11, s[8:11], s37 offen offset:2048 sc1
v_mfma_f32_16x16x32_bf16 v[36:39], v[80:83], a[56:59], v[36:39]
v_cvt_pk_bf16_f32 v188, v72, v73
v_mfma_f32_16x16x32_bf16 v[36:39], v[84:87], a[72:75], v[36:39]
ds_read_b64_tr_b16 v[104:105], v3 offset:8192
v_cvt_pk_bf16_f32 v189, v74, v75
v_mfma_f32_16x16x32_bf16 v[44:47], v[108:111], a[44:47], v[44:47]
v_cvt_pk_bf16_f32 v190, v76, v77
v_mfma_f32_16x16x32_bf16 v[44:47], v[80:83], a[60:63], v[44:47]
ds_read_b64_tr_b16 v[106:107], v3 offset:10240
v_cvt_pk_bf16_f32 v191, v78, v79
v_mfma_f32_16x16x32_bf16 v[44:47], v[84:87], a[76:79], v[44:47]
buffer_store_dwordx4 v[188:191], v11, s[8:11], s37 offen offset:3072 sc1
s_waitcnt lgkmcnt(8)
v_mfma_f32_16x16x32_bf16 v[16:19], v[88:91], a[80:83], v[16:19]
ds_read_b64_tr_b16 v[108:109], v3 offset:12288
s_waitcnt lgkmcnt(7)
v_mfma_f32_16x16x32_bf16 v[16:19], v[92:95], a[96:99], v[16:19]
s_waitcnt lgkmcnt(5)
v_mfma_f32_16x16x32_bf16 v[16:19], v[96:99], a[112:115], v[16:19]
ds_read_b64_tr_b16 v[110:111], v3 offset:14336
v_mfma_f32_16x16x32_bf16 v[24:27], v[88:91], a[84:87], v[24:27]
v_mfma_f32_16x16x32_bf16 v[24:27], v[92:95], a[100:103], v[24:27]
v_mfma_f32_16x16x32_bf16 v[24:27], v[96:99], a[116:119], v[24:27]
v_mfma_f32_16x16x32_bf16 v[32:35], v[88:91], a[88:91], v[32:35]
v_mfma_f32_16x16x32_bf16 v[32:35], v[92:95], a[104:107], v[32:35]
v_mfma_f32_16x16x32_bf16 v[32:35], v[96:99], a[120:123], v[32:35]
v_mfma_f32_16x16x32_bf16 v[40:43], v[88:91], a[92:95], v[40:43]
v_mfma_f32_16x16x32_bf16 v[40:43], v[92:95], a[108:111], v[40:43]
v_mfma_f32_16x16x32_bf16 v[40:43], v[96:99], a[124:127], v[40:43]
s_waitcnt lgkmcnt(4)
v_mfma_f32_16x16x32_bf16 v[20:23], v[100:103], a[80:83], v[20:23]
s_waitcnt lgkmcnt(2)
v_mfma_f32_16x16x32_bf16 v[20:23], v[104:107], a[96:99], v[20:23]
s_waitcnt lgkmcnt(0)
v_mfma_f32_16x16x32_bf16 v[20:23], v[108:111], a[112:115], v[20:23]
v_mfma_f32_16x16x32_bf16 v[28:31], v[100:103], a[84:87], v[28:31]
v_mfma_f32_16x16x32_bf16 v[28:31], v[104:107], a[100:103], v[28:31]
v_mfma_f32_16x16x32_bf16 v[28:31], v[108:111], a[116:119], v[28:31]
v_mfma_f32_16x16x32_bf16 v[36:39], v[100:103], a[88:91], v[36:39]
v_mfma_f32_16x16x32_bf16 v[36:39], v[104:107], a[104:107], v[36:39]
v_mfma_f32_16x16x32_bf16 v[36:39], v[108:111], a[120:123], v[36:39]
v_mfma_f32_16x16x32_bf16 v[44:47], v[100:103], a[92:95], v[44:47]
v_mfma_f32_16x16x32_bf16 v[44:47], v[104:107], a[108:111], v[44:47]
v_mfma_f32_16x16x32_bf16 v[44:47], v[108:111], a[124:127], v[44:47]
s_add_u32 s37, s36, 65536
v_cvt_pk_bf16_f32 v176, v16, v17
v_cvt_pk_bf16_f32 v177, v18, v19
v_cvt_pk_bf16_f32 v178, v20, v21
v_cvt_pk_bf16_f32 v179, v22, v23
buffer_store_dwordx4 v[176:179], v11, s[8:11], s37 offen offset:0 sc1
v_cvt_pk_bf16_f32 v180, v24, v25
v_cvt_pk_bf16_f32 v181, v26, v27
v_cvt_pk_bf16_f32 v182, v28, v29
v_cvt_pk_bf16_f32 v183, v30, v31
buffer_store_dwordx4 v[180:183], v11, s[8:11], s37 offen offset:1024 sc1
v_cvt_pk_bf16_f32 v184, v32, v33
v_cvt_pk_bf16_f32 v185, v34, v35
v_cvt_pk_bf16_f32 v186, v36, v37
v_cvt_pk_bf16_f32 v187, v38, v39
buffer_store_dwordx4 v[184:187], v11, s[8:11], s37 offen offset:2048 sc1
v_cvt_pk_bf16_f32 v188, v40, v41
v_cvt_pk_bf16_f32 v189, v42, v43
v_cvt_pk_bf16_f32 v190, v44, v45
v_cvt_pk_bf16_f32 v191, v46, v47
buffer_store_dwordx4 v[188:191], v11, s[8:11], s37 offen offset:3072 sc1
s_endpgm
K2_dft:
s_cmp_ge_u32 s28, 8
s_cselect_b32 s46, s50, s48
s_cselect_b32 s47, s51, s49
s_cselect_b32 s56, s54, s52
s_cselect_b32 s57, s55, s53
s_mov_b32 s58, 2359296
s_cselect_b32 s58, 3145728, s58
s_cselect_b32 s59, 1536, 0
s_cselect_b32 s60, 0, 0xbf803f80
s_mov_b32 s12, s46
s_mov_b32 s13, s47
s_mov_b32 s14, 0x800000
s_mov_b32 s15, 0x00020000
s_mov_b32 s20, s56
s_mov_b32 s21, s57
s_mov_b32 s22, 0xa2000
s_mov_b32 s23, 0x00020000
s_and_b32 s3, s28, 7
s_lshl_b32 s3, s3, 6
s_add_u32 s59, s59, s3
s_lshl_b32 s59, s59, 1
s_mul_i32 s61, s24, 10240
s_add_u32 s61, s61, s58
s_lshl_b32 s62, s24, 16
s_add_u32 s62, s62, s59
v_lshrrev_b32 v13, 3, v0
v_and_b32 v14, 7, v0
v_bfe_u32 v15, v13, 1, 2
v_lshlrev_b32 v15, 1, v15
v_xor_b32 v14, v14, v15
v_lshlrev_b32 v14, 4, v14
s_movk_i32 s3, 1280
v_mul_lo_u32 v2, v13, s3
v_add_u32 v2, v2, v14
v_lshlrev_b32 v3, 13, v13
v_add_u32 v3, v3, v14
s_add_u32 s31, s61, 0
s_add_u32 m0, s34, 0
s_nop 0
buffer_load_dwordx4 v2, s[8:11], s31 offen offset:0 lds
s_add_u32 m0, s34, 3968
s_nop 0
buffer_load_dwordx4 v2, s[8:11], s31 offen offset:128 lds
s_add_u32 m0, s34, 7936
s_nop 0
buffer_load_dwordx4 v2, s[8:11], s31 offen offset:256 lds
s_add_u32 m0, s34, 11904
s_nop 0
buffer_load_dwordx4 v2, s[8:11], s31 offen offset:384 lds
s_add_u32 m0, s34, 15872
s_nop 0
buffer_load_dwordx4 v2, s[8:11], s31 offen offset:512 lds
s_add_u32 s63, s62, 0
s_add_u32 m0, s34, 20480
s_nop 0
buffer_load_dwordx4 v3, s[12:15], s63 offen lds
s_add_u32 s31, s61, 640
s_add_u32 m0, s34, 24576
s_nop 0
buffer_load_dwordx4 v2, s[8:11], s31 offen offset:0 lds
s_add_u32 m0, s34, 28544
s_nop 0
buffer_load_dwordx4 v2, s[8:11], s31 offen offset:128 lds
s_add_u32 m0, s34, 32512
s_nop 0
buffer_load_dwordx4 v2, s[8:11], s31 offen offset:256 lds
s_add_u32 m0, s34, 36480
s_nop 0
buffer_load_dwordx4 v2, s[8:11], s31 offen offset:384 lds
s_add_u32 m0, s34, 40448
s_nop 0
buffer_load_dwordx4 v2, s[8:11], s31 offen offset:512 lds
s_add_u32 s63, s62, 4096
s_add_u32 m0, s34, 45056
s_nop 0
buffer_load_dwordx4 v3, s[12:15], s63 offen lds
s_add_u32 s31, s61, 40960
s_add_u32 m0, s34, 49152
s_nop 0
buffer_load_dwordx4 v2, s[8:11], s31 offen offset:0 lds
s_add_u32 m0, s34, 53120
s_nop 0
buffer_load_dwordx4 v2, s[8:11], s31 offen offset:128 lds
s_add_u32 m0, s34, 57088
s_nop 0
buffer_load_dwordx4 v2, s[8:11], s31 offen offset:256 lds
s_add_u32 m0, s34, 61056
s_nop 0
buffer_load_dwordx4 v2, s[8:11], s31 offen offset:384 lds
s_add_u32 m0, s34, 65024
s_nop 0
buffer_load_dwordx4 v2, s[8:11], s31 offen offset:512 lds
s_add_u32 s63, s62, 262144
s_add_u32 m0, s34, 69632
s_nop 0
buffer_load_dwordx4 v3, s[12:15], s63 offen lds
s_add_u32 s31, s61, 41600
s_add_u32 m0, s34, 73728
s_nop 0
buffer_load_dwordx4 v2, s[8:11], s31 offen offset:0 lds
s_add_u32 m0, s34, 77696
s_nop 0
buffer_load_dwordx4 v2, s[8:11], s31 offen offset:128 lds
s_add_u32 m0, s34, 81664
s_nop 0
buffer_load_dwordx4 v2, s[8:11], s31 offen offset:256 lds
s_add_u32 m0, s34, 85632
s_nop 0
buffer_load_dwordx4 v2, s[8:11], s31 offen offset:384 lds
s_add_u32 m0, s34, 89600
s_nop 0
buffer_load_dwordx4 v2, s[8:11], s31 offen offset:512 lds
s_add_u32 s63, s62, 266240
s_add_u32 m0, s34, 94208
s_nop 0
buffer_load_dwordx4 v3, s[12:15], s63 offen lds
s_add_u32 s31, s61, 81920
s_add_u32 m0, s34, 98304
s_nop 0
buffer_load_dwordx4 v2, s[8:11], s31 offen offset:0 lds
s_add_u32 m0, s34, 102272
s_nop 0
buffer_load_dwordx4 v2, s[8:11], s31 offen offset:128 lds
s_add_u32 m0, s34, 106240
s_nop 0
buffer_load_dwordx4 v2, s[8:11], s31 offen offset:256 lds
s_add_u32 m0, s34, 110208
s_nop 0
buffer_load_dwordx4 v2, s[8:11], s31 offen offset:384 lds
s_add_u32 m0, s34, 114176
s_nop 0
buffer_load_dwordx4 v2, s[8:11], s31 offen offset:512 lds
s_add_u32 s63, s62, 524288
s_add_u32 m0, s34, 118784
s_nop 0
buffer_load_dwordx4 v3, s[12:15], s63 offen lds
v_lshlrev_b32 v255, 7, v0
s_lshl_b32 s3, s24, 13
v_add_u32 v255, s3, v255
v_add_u32 v252, K2_dft1-K2_pc, v255
v_min_u32 v252, K2_dft2-K2_pc-4, v252
v_add_co_u32 v252, s[98:99], s96, v252
v_mov_b32 v253, s97
s_nop 0
v_addc_co_u32 v253, s[98:99], 0, v253, s[98:99]
global_load_dword v254, v[252:253], off
v_add_u32 v250, K2_dft2-K2_pc, v255
v_min_u32 v250, K2_dft3-K2_pc-4, v250
v_add_co_u32 v250, s[98:99], s96, v250
v_mov_b32 v251, s97
s_nop 0
v_addc_co_u32 v251, s[98:99], 0, v251, s[98:99]
s_and_b32 s3, s28, 7
s_lshl_b32 s3, s3, 2
s_add_u32 s3, s3, s24
s_mul_i32 s3, s3, 11520
v_add_u32 v192, s3, v11
v_add_u32 v193, 4096, v192
v_add_u32 v194, 8192, v192
buffer_load_dwordx4 v[224:227], v192, s[20:23], 0 offen offset:0
buffer_load_dwordx4 v[228:231], v192, s[20:23], 0 offen offset:1024
buffer_load_dwordx4 v[232:235], v192, s[20:23], 0 offen offset:2048
buffer_load_dwordx4 v[236:239], v192, s[20:23], 0 offen offset:3072
buffer_load_dwordx4 v[224:227], v193, s[20:23], 0 offen offset:0
buffer_load_dwordx4 v[228:231], v193, s[20:23], 0 offen offset:1024
buffer_load_dwordx4 v[232:235], v193, s[20:23], 0 offen offset:2048
buffer_load_dwordx4 v[236:239], v193, s[20:23], 0 offen offset:3072
buffer_load_dwordx4 v[224:227], v194, s[20:23], 0 offen offset:0
buffer_load_dwordx4 v[228:231], v194, s[20:23], 0 offen offset:1024
buffer_load_dwordx4 v[232:235], v194, s[20:23], 0 offen offset:2048
buffer_load_dwordx4 v[236:239], v194, s[20:23], 0 offen offset:3072
v_lshrrev_b32 v13, 2, v0
v_and_b32 v15, 3, v0
v_bfe_u32 v14, v13, 1, 2
v_lshlrev_b32 v14, 1, v14
v_lshlrev_b32 v13, 7, v13
v_and_b32 v1, 1, v15
v_lshlrev_b32 v1, 3, v1
v_add_u32 v13, v13, v1
v_lshrrev_b32 v15, 1, v15
v_add_u32 v1, 0, v15
v_xor_b32 v1, v1, v14
v_lshlrev_b32 v1, 4, v1
v_add_u32 v1, v1, v13
v_add_u32 v196, 20480, v1
v_add_u32 v1, 2, v15
v_xor_b32 v1, v1, v14
v_lshlrev_b32 v1, 4, v1
v_add_u32 v1, v1, v13
v_add_u32 v197, 20480, v1
v_add_u32 v1, 4, v15
v_xor_b32 v1, v1, v14
v_lshlrev_b32 v1, 4, v1
v_add_u32 v1, v1, v13
v_add_u32 v198, 20480, v1
v_add_u32 v1, 6, v15
v_xor_b32 v1, v1, v14
v_lshlrev_b32 v1, 4, v1
v_add_u32 v1, v1, v13
v_add_u32 v199, 20480, v1
s_mul_i32 s3, s24, 5
s_add_u32 s3, s3, 0
s_and_b32 s46, s3, 3
s_lshl_b32 s46, s46, 1
s_lshr_b32 s47, s3, 2
s_lshl_b32 s47, s47, 12
v_add_u32 v1, s46, v15
v_xor_b32 v1, v1, v14
v_lshlrev_b32 v1, 4, v1
v_add_u32 v1, v1, v13
v_add_u32 v200, s47, v1
s_mul_i32 s3, s24, 5
s_add_u32 s3, s3, 1
s_and_b32 s46, s3, 3
s_lshl_b32 s46, s46, 1
s_lshr_b32 s47, s3, 2
s_lshl_b32 s47, s47, 12
v_add_u32 v1, s46, v15
v_xor_b32 v1, v1, v14
v_lshlrev_b32 v1, 4, v1
v_add_u32 v1, v1, v13
v_add_u32 v201, s47, v1
s_mul_i32 s3, s24, 5
s_add_u32 s3, s3, 2
s_and_b32 s46, s3, 3
s_lshl_b32 s46, s46, 1
s_lshr_b32 s47, s3, 2
s_lshl_b32 s47, s47, 12
v_add_u32 v1, s46, v15
v_xor_b32 v1, v1, v14
v_lshlrev_b32 v1, 4, v1
v_add_u32 v1, v1, v13
v_add_u32 v202, s47, v1
s_mul_i32 s3, s24, 5
s_add_u32 s3, s3, 3
s_and_b32 s46, s3, 3
s_lshl_b32 s46, s46, 1
s_lshr_b32 s47, s3, 2
s_lshl_b32 s47, s47, 12
v_add_u32 v1, s46, v15
v_xor_b32 v1, v1, v14
v_lshlrev_b32 v1, 4, v1
v_add_u32 v1, v1, v13
v_add_u32 v203, s47, v1
s_mul_i32 s3, s24, 5
s_add_u32 s3, s3, 4
s_and_b32 s46, s3, 3
s_lshl_b32 s46, s46, 1
s_lshr_b32 s47, s3, 2
s_lshl_b32 s47, s47, 12
v_add_u32 v1, s46, v15
v_xor_b32 v1, v1, v14
v_lshlrev_b32 v1, 4, v1
v_add_u32 v1, v1, v13
v_add_u32 v204, s47, v1
v_add_u32 v205, 73728, v196
v_add_u32 v206, 73728, v197
v_add_u32 v207, 73728, v198
v_add_u32 v208, 73728, v199
v_add_u32 v209, 73728, v200
v_add_u32 v210, 73728, v201
v_add_u32 v211, 73728, v202
v_add_u32 v212, 73728, v203
v_add_u32 v213, 73728, v204
v_mov_b32 v216, s60
v_mov_b32 v217, s60
v_mov_b32 v218, s60
v_mov_b32 v219, s60
s_waitcnt vmcnt(31)
s_barrier
K2_dft1:
ds_read_b64_tr_b16 a[16:17], v200 offset:0
ds_read_b64_tr_b16 a[18:19], v200 offset:2048
ds_read_b64_tr_b16 a[0:1], v196 offset:0
ds_read_b64_tr_b16 a[2:3], v196 offset:2048
ds_read_b64_tr_b16 a[4:5], v197 offset:0
ds_read_b64_tr_b16 a[6:7], v197 offset:2048
ds_read_b64_tr_b16 a[8:9], v198 offset:0
ds_read_b64_tr_b16 a[10:11], v198 offset:2048
ds_read_b64_tr_b16 a[12:13], v199 offset:0
ds_read_b64_tr_b16 a[14:15], v199 offset:2048
ds_read_b64_tr_b16 a[20:21], v201 offset:0
ds_read_b64_tr_b16 a[22:23], v201 offset:2048
ds_read_b64_tr_b16 a[24:25], v202 offset:0
ds_read_b64_tr_b16 a[26:27], v202 offset:2048
ds_read_b64_tr_b16 a[28:29], v203 offset:0
ds_read_b64_tr_b16 a[30:31], v203 offset:2048
ds_read_b64_tr_b16 a[32:33], v204 offset:0
ds_read_b64_tr_b16 a[34:35], v204 offset:2048
s_waitcnt lgkmcnt(14)
v_mfma_f32_16x16x32_bf16 v[16:19], a[16:19], a[0:3], 0
ds_read_b64_tr_b16 a[52:53], v200 offset:24576
s_waitcnt lgkmcnt(13)
v_mfma_f32_16x16x32_bf16 v[20:23], a[16:19], a[4:7], 0
ds_read_b64_tr_b16 a[54:55], v200 offset:26624
s_add_u32 s31, s61, 82560
s_add_u32 m0, s34, 122880
s_waitcnt lgkmcnt(12)
v_mfma_f32_16x16x32_bf16 v[24:27], a[16:19], a[8:11], 0
ds_read_b64_tr_b16 a[36:37], v196 offset:24576
buffer_load_dwordx4 v2, s[8:11], s31 offen offset:0 lds
s_waitcnt lgkmcnt(11)
v_mfma_f32_16x16x32_bf16 v[28:31], a[16:19], a[12:15], 0
ds_read_b64_tr_b16 a[38:39], v196 offset:26624
v_mfma_f32_16x16x32_bf16 v[176:179], a[16:19], v[216:219], 0
ds_read_b64_tr_b16 a[40:41], v197 offset:24576
s_add_u32 m0, s34, 126848
s_waitcnt lgkmcnt(11)
v_mfma_f32_16x16x32_bf16 v[32:35], a[20:23], a[0:3], 0
ds_read_b64_tr_b16 a[42:43], v197 offset:26624
buffer_load_dwordx4 v2, s[8:11], s31 offen offset:128 lds
v_mfma_f32_16x16x32_bf16 v[36:39], a[20:23], a[4:7], 0
ds_read_b64_tr_b16 a[44:45], v198 offset:24576
v_mfma_f32_16x16x32_bf16 v[40:43], a[20:23], a[8:11], 0
ds_read_b64_tr_b16 a[46:47], v198 offset:26624
s_add_u32 m0, s34, 130816
v_mfma_f32_16x16x32_bf16 v[44:47], a[20:23], a[12:15], 0
ds_read_b64_tr_b16 a[48:49], v199 offset:24576
buffer_load_dwordx4 v2, s[8:11], s31 offen offset:256 lds
v_mfma_f32_16x16x32_bf16 v[180:183], a[20:23], v[216:219], 0
ds_read_b64_tr_b16 a[50:51], v199 offset:26624
s_waitcnt lgkmcnt(14)
v_mfma_f32_16x16x32_bf16 v[48:51], a[24:27], a[0:3], 0
ds_read_b64_tr_b16 a[56:57], v201 offset:24576
s_add_u32 m0, s34, 134784
v_mfma_f32_16x16x32_bf16 v[52:55], a[24:27], a[4:7], 0
ds_read_b64_tr_b16 a[58:59], v201 offset:26624
buffer_load_dwordx4 v2, s[8:11], s31 offen offset:384 lds
v_mfma_f32_16x16x32_bf16 v[56:59], a[24:27], a[8:11], 0
ds_read_b64_tr_b16 a[60:61], v202 offset:24576
v_mfma_f32_16x16x32_bf16 v[60:63], a[24:27], a[12:15], 0
ds_read_b64_tr_b16 a[62:63], v202 offset:26624
s_add_u32 m0, s34, 138752
v_mfma_f32_16x16x32_bf16 v[184:187], a[24:27], v[216:219], 0
ds_read_b64_tr_b16 a[64:65], v203 offset:24576
buffer_load_dwordx4 v2, s[8:11], s31 offen offset:512 lds
s_waitcnt lgkmcnt(15)
v_mfma_f32_16x16x32_bf16 v[64:67], a[28:31], a[0:3], 0
ds_read_b64_tr_b16 a[66:67], v203 offset:26624
v_mfma_f32_16x16x32_bf16 v[68:71], a[28:31], a[4:7], 0
ds_read_b64_tr_b16 a[68:69], v204 offset:24576
s_add_u32 s63, s62, 528384
s_add_u32 m0, s34, 143360
v_mfma_f32_16x16x32_bf16 v[72:75], a[28:31], a[8:11], 0
ds_read_b64_tr_b16 a[70:71], v204 offset:26624
buffer_load_dwordx4 v3, s[12:15], s63 offen lds
v_mfma_f32_16x16x32_bf16 v[76:79], a[28:31], a[12:15], 0
v_mfma_f32_16x16x32_bf16 v[188:191], a[28:31], v[216:219], 0
s_waitcnt lgkmcnt(15)
v_mfma_f32_16x16x32_bf16 v[80:83], a[32:35], a[0:3], 0
v_mfma_f32_16x16x32_bf16 v[84:87], a[32:35], a[4:7], 0
v_mfma_f32_16x16x32_bf16 v[88:91], a[32:35], a[8:11], 0
v_mfma_f32_16x16x32_bf16 v[92:95], a[32:35], a[12:15], 0
v_mfma_f32_16x16x32_bf16 v[192:195], a[32:35], v[216:219], 0
s_waitcnt vmcnt(31)
s_barrier
s_waitcnt lgkmcnt(14)
v_mfma_f32_16x16x32_bf16 v[96:99], a[52:55], a[36:39], 0
ds_read_b64_tr_b16 a[16:17], v200 offset:49152
s_waitcnt lgkmcnt(13)
v_mfma_f32_16x16x32_bf16 v[100:103], a[52:55], a[40:43], 0
ds_read_b64_tr_b16 a[18:19], v200 offset:51200
s_add_u32 s31, s61, 122880
s_add_u32 m0, s34, 0
s_waitcnt lgkmcnt(12)
v_mfma_f32_16x16x32_bf16 v[104:107], a[52:55], a[44:47], 0
ds_read_b64_tr_b16 a[0:1], v196 offset:49152
buffer_load_dwordx4 v2, s[8:11], s31 offen offset:0 lds
s_waitcnt lgkmcnt(11)
v_mfma_f32_16x16x32_bf16 v[108:111], a[52:55], a[48:51], 0
ds_read_b64_tr_b16 a[2:3], v196 offset:51200
s_waitcnt lgkmcnt(10)
v_mfma_f32_16x16x32_bf16 v[112:115], a[56:59], a[36:39], 0
ds_read_b64_tr_b16 a[4:5], v197 offset:49152
s_add_u32 m0, s34, 3968
v_mfma_f32_16x16x32_bf16 v[116:119], a[56:59], a[40:43], 0
ds_read_b64_tr_b16 a[6:7], v197 offset:51200
buffer_load_dwordx4 v2, s[8:11], s31 offen offset:128 lds
v_mfma_f32_16x16x32_bf16 v[120:123], a[56:59], a[44:47], 0
ds_read_b64_tr_b16 a[8:9], v198 offset:49152
v_mfma_f32_16x16x32_bf16 v[124:127], a[56:59], a[48:51], 0
ds_read_b64_tr_b16 a[10:11], v198 offset:51200
s_add_u32 m0, s34, 7936
s_waitcnt lgkmcnt(12)
v_mfma_f32_16x16x32_bf16 v[128:131], a[60:63], a[36:39], 0
ds_read_b64_tr_b16 a[12:13], v199 offset:49152
buffer_load_dwordx4 v2, s[8:11], s31 offen offset:256 lds
v_mfma_f32_16x16x32_bf16 v[132:135], a[60:63], a[40:43], 0
ds_read_b64_tr_b16 a[14:15], v199 offset:51200
v_mfma_f32_16x16x32_bf16 v[136:139], a[60:63], a[44:47], 0
ds_read_b64_tr_b16 a[20:21], v201 offset:49152
s_add_u32 m0, s34, 11904
v_mfma_f32_16x16x32_bf16 v[140:143], a[60:63], a[48:51], 0
ds_read_b64_tr_b16 a[22:23], v201 offset:51200
buffer_load_dwordx4 v2, s[8:11], s31 offen offset:384 lds
s_waitcnt lgkmcnt(14)
v_mfma_f32_16x16x32_bf16 v[144:147], a[64:67], a[36:39], 0
ds_read_b64_tr_b16 a[24:25], v202 offset:49152
v_mfma_f32_16x16x32_bf16 v[148:151], a[64:67], a[40:43], 0
ds_read_b64_tr_b16 a[26:27], v202 offset:51200
s_add_u32 m0, s34, 15872
v_mfma_f32_16x16x32_bf16 v[152:155], a[64:67], a[44:47], 0
ds_read_b64_tr_b16 a[28:29], v203 offset:49152
buffer_load_dwordx4 v2, s[8:11], s31 offen offset:512 lds
v_mfma_f32_16x16x32_bf16 v[156:159], a[64:67], a[48:51], 0
ds_read_b64_tr_b16 a[30:31], v203 offset:51200
s_waitcnt lgkmcnt(15)
v_mfma_f32_16x16x32_bf16 v[160:163], a[68:71], a[36:39], 0
ds_read_b64_tr_b16 a[32:33], v204 offset:49152
s_add_u32 s63, s62, 786432
s_add_u32 m0, s34, 20480
v_mfma_f32_16x16x32_bf16 v[164:167], a[68:71], a[40:43], 0
ds_read_b64_tr_b16 a[34:35], v204 offset:51200
buffer_load_dwordx4 v3, s[12:15], s63 offen lds
v_mfma_f32_16x16x32_bf16 v[168:171], a[68:71], a[44:47], 0
v_mfma_f32_16x16x32_bf16 v[172:175], a[68:71], a[48:51], 0
s_waitcnt vmcnt(31)
s_barrier
s_waitcnt lgkmcnt(14)
v_mfma_f32_16x16x32_bf16 v[16:19], a[16:19], a[0:3], v[16:19]
ds_read_b64_tr_b16 a[52:53], v209 offset:0
s_waitcnt lgkmcnt(13)
v_mfma_f32_16x16x32_bf16 v[20:23], a[16:19], a[4:7], v[20:23]
ds_read_b64_tr_b16 a[54:55], v209 offset:2048
s_add_u32 s31, s61, 123520
s_add_u32 m0, s34, 24576
s_waitcnt lgkmcnt(12)
v_mfma_f32_16x16x32_bf16 v[24:27], a[16:19], a[8:11], v[24:27]
ds_read_b64_tr_b16 a[36:37], v205 offset:0
buffer_load_dwordx4 v2, s[8:11], s31 offen offset:0 lds
s_waitcnt lgkmcnt(11)
v_mfma_f32_16x16x32_bf16 v[28:31], a[16:19], a[12:15], v[28:31]
ds_read_b64_tr_b16 a[38:39], v205 offset:2048
v_mfma_f32_16x16x32_bf16 v[176:179], a[16:19], v[216:219], v[176:179]
ds_read_b64_tr_b16 a[40:41], v206 offset:0
s_add_u32 m0, s34, 28544
s_waitcnt lgkmcnt(11)
v_mfma_f32_16x16x32_bf16 v[32:35], a[20:23], a[0:3], v[32:35]
ds_read_b64_tr_b16 a[42:43], v206 offset:2048
buffer_load_dwordx4 v2, s[8:11], s31 offen offset:128 lds
v_mfma_f32_16x16x32_bf16 v[36:39], a[20:23], a[4:7], v[36:39]
ds_read_b64_tr_b16 a[44:45], v207 offset:0
v_mfma_f32_16x16x32_bf16 v[40:43], a[20:23], a[8:11], v[40:43]
ds_read_b64_tr_b16 a[46:47], v207 offset:2048
s_add_u32 m0, s34, 32512
v_mfma_f32_16x16x32_bf16 v[44:47], a[20:23], a[12:15], v[44:47]
ds_read_b64_tr_b16 a[48:49], v208 offset:0
buffer_load_dwordx4 v2, s[8:11], s31 offen offset:256 lds
v_mfma_f32_16x16x32_bf16 v[180:183], a[20:23], v[216:219], v[180:183]
ds_read_b64_tr_b16 a[50:51], v208 offset:2048
s_waitcnt lgkmcnt(14)
v_mfma_f32_16x16x32_bf16 v[48:51], a[24:27], a[0:3], v[48:51]
ds_read_b64_tr_b16 a[56:57], v210 offset:0
s_add_u32 m0, s34, 36480
v_mfma_f32_16x16x32_bf16 v[52:55], a[24:27], a[4:7], v[52:55]
ds_read_b64_tr_b16 a[58:59], v210 offset:2048
buffer_load_dwordx4 v2, s[8:11], s31 offen offset:384 lds
v_mfma_f32_16x16x32_bf16 v[56:59], a[24:27], a[8:11], v[56:59]
ds_read_b64_tr_b16 a[60:61], v211 offset:0
v_mfma_f32_16x16x32_bf16 v[60:63], a[24:27], a[12:15], v[60:63]
ds_read_b64_tr_b16 a[62:63], v211 offset:2048
s_add_u32 m0, s34, 40448
v_mfma_f32_16x16x32_bf16 v[184:187], a[24:27], v[216:219], v[184:187]
ds_read_b64_tr_b16 a[64:65], v212 offset:0
buffer_load_dwordx4 v2, s[8:11], s31 offen offset:512 lds
s_waitcnt lgkmcnt(15)
v_mfma_f32_16x16x32_bf16 v[64:67], a[28:31], a[0:3], v[64:67]
ds_read_b64_tr_b16 a[66:67], v212 offset:2048
v_mfma_f32_16x16x32_bf16 v[68:71], a[28:31], a[4:7], v[68:71]
ds_read_b64_tr_b16 a[68:69], v213 offset:0
s_add_u32 s63, s62, 790528
s_add_u32 m0, s34, 45056
v_mfma_f32_16x16x32_bf16 v[72:75], a[28:31], a[8:11], v[72:75]
ds_read_b64_tr_b16 a[70:71], v213 offset:2048
buffer_load_dwordx4 v3, s[12:15], s63 offen lds
v_mfma_f32_16x16x32_bf16 v[76:79], a[28:31], a[12:15], v[76:79]
v_mfma_f32_16x16x32_bf16 v[188:191], a[28:31], v[216:219], v[188:191]
s_waitcnt lgkmcnt(15)
v_mfma_f32_16x16x32_bf16 v[80:83], a[32:35], a[0:3], v[80:83]
v_mfma_f32_16x16x32_bf16 v[84:87], a[32:35], a[4:7], v[84:87]
v_mfma_f32_16x16x32_bf16 v[88:91], a[32:35], a[8:11], v[88:91]
v_mfma_f32_16x16x32_bf16 v[92:95], a[32:35], a[12:15], v[92:95]
v_mfma_f32_16x16x32_bf16 v[192:195], a[32:35], v[216:219], v[192:195]
s_waitcnt vmcnt(31)
s_barrier
s_waitcnt lgkmcnt(14)
v_mfma_f32_16x16x32_bf16 v[96:99], a[52:55], a[36:39], v[96:99]
ds_read_b64_tr_b16 a[16:17], v209 offset:24576
s_waitcnt lgkmcnt(13)
v_mfma_f32_16x16x32_bf16 v[100:103], a[52:55], a[40:43], v[100:103]
ds_read_b64_tr_b16 a[18:19], v209 offset:26624
s_add_u32 s31, s61, 163840
s_add_u32 m0, s34, 49152
s_waitcnt lgkmcnt(12)
v_mfma_f32_16x16x32_bf16 v[104:107], a[52:55], a[44:47], v[104:107]
ds_read_b64_tr_b16 a[0:1], v205 offset:24576
buffer_load_dwordx4 v2, s[8:11], s31 offen offset:0 lds
s_waitcnt lgkmcnt(11)
v_mfma_f32_16x16x32_bf16 v[108:111], a[52:55], a[48:51], v[108:111]
ds_read_b64_tr_b16 a[2:3], v205 offset:26624
s_waitcnt lgkmcnt(10)
v_mfma_f32_16x16x32_bf16 v[112:115], a[56:59], a[36:39], v[112:115]
ds_read_b64_tr_b16 a[4:5], v206 offset:24576
s_add_u32 m0, s34, 53120
v_mfma_f32_16x16x32_bf16 v[116:119], a[56:59], a[40:43], v[116:119]
ds_read_b64_tr_b16 a[6:7], v206 offset:26624
buffer_load_dwordx4 v2, s[8:11], s31 offen offset:128 lds
v_mfma_f32_16x16x32_bf16 v[120:123], a[56:59], a[44:47], v[120:123]
ds_read_b64_tr_b16 a[8:9], v207 offset:24576
v_mfma_f32_16x16x32_bf16 v[124:127], a[56:59], a[48:51], v[124:127]
ds_read_b64_tr_b16 a[10:11], v207 offset:26624
s_add_u32 m0, s34, 57088
s_waitcnt lgkmcnt(12)
v_mfma_f32_16x16x32_bf16 v[128:131], a[60:63], a[36:39], v[128:131]
ds_read_b64_tr_b16 a[12:13], v208 offset:24576
buffer_load_dwordx4 v2, s[8:11], s31 offen offset:256 lds
v_mfma_f32_16x16x32_bf16 v[132:135], a[60:63], a[40:43], v[132:135]
ds_read_b64_tr_b16 a[14:15], v208 offset:26624
v_mfma_f32_16x16x32_bf16 v[136:139], a[60:63], a[44:47], v[136:139]
ds_read_b64_tr_b16 a[20:21], v210 offset:24576
s_add_u32 m0, s34, 61056
v_mfma_f32_16x16x32_bf16 v[140:143], a[60:63], a[48:51], v[140:143]
ds_read_b64_tr_b16 a[22:23], v210 offset:26624
buffer_load_dwordx4 v2, s[8:11], s31 offen offset:384 lds
s_waitcnt lgkmcnt(14)
v_mfma_f32_16x16x32_bf16 v[144:147], a[64:67], a[36:39], v[144:147]
ds_read_b64_tr_b16 a[24:25], v211 offset:24576
v_mfma_f32_16x16x32_bf16 v[148:151], a[64:67], a[40:43], v[148:151]
ds_read_b64_tr_b16 a[26:27], v211 offset:26624
s_add_u32 m0, s34, 65024
v_mfma_f32_16x16x32_bf16 v[152:155], a[64:67], a[44:47], v[152:155]
ds_read_b64_tr_b16 a[28:29], v212 offset:24576
buffer_load_dwordx4 v2, s[8:11], s31 offen offset:512 lds
v_mfma_f32_16x16x32_bf16 v[156:159], a[64:67], a[48:51], v[156:159]
ds_read_b64_tr_b16 a[30:31], v212 offset:26624
s_waitcnt lgkmcnt(15)
v_mfma_f32_16x16x32_bf16 v[160:163], a[68:71], a[36:39], v[160:163]
ds_read_b64_tr_b16 a[32:33], v213 offset:24576
s_add_u32 s63, s62, 1048576
s_add_u32 m0, s34, 69632
v_mfma_f32_16x16x32_bf16 v[164:167], a[68:71], a[40:43], v[164:167]
ds_read_b64_tr_b16 a[34:35], v213 offset:26624
buffer_load_dwordx4 v3, s[12:15], s63 offen lds
v_mfma_f32_16x16x32_bf16 v[168:171], a[68:71], a[44:47], v[168:171]
v_mfma_f32_16x16x32_bf16 v[172:175], a[68:71], a[48:51], v[172:175]
s_waitcnt vmcnt(18)
s_barrier
s_waitcnt lgkmcnt(14)
v_mfma_f32_16x16x32_bf16 v[16:19], a[16:19], a[0:3], v[16:19]
ds_read_b64_tr_b16 a[52:53], v209 offset:49152
s_waitcnt lgkmcnt(13)
v_mfma_f32_16x16x32_bf16 v[20:23], a[16:19], a[4:7], v[20:23]
ds_read_b64_tr_b16 a[54:55], v209 offset:51200
s_add_u32 s31, s61, 164480
s_add_u32 m0, s34, 73728
s_waitcnt lgkmcnt(12)
v_mfma_f32_16x16x32_bf16 v[24:27], a[16:19], a[8:11], v[24:27]
ds_read_b64_tr_b16 a[36:37], v205 offset:49152
buffer_load_dwordx4 v2, s[8:11], s31 offen offset:0 lds
s_waitcnt lgkmcnt(11)
v_mfma_f32_16x16x32_bf16 v[28:31], a[16:19], a[12:15], v[28:31]
ds_read_b64_tr_b16 a[38:39], v205 offset:51200
v_mfma_f32_16x16x32_bf16 v[176:179], a[16:19], v[216:219], v[176:179]
ds_read_b64_tr_b16 a[40:41], v206 offset:49152
s_add_u32 m0, s34, 77696
s_waitcnt lgkmcnt(11)
v_mfma_f32_16x16x32_bf16 v[32:35], a[20:23], a[0:3], v[32:35]
ds_read_b64_tr_b16 a[42:43], v206 offset:51200
buffer_load_dwordx4 v2, s[8:11], s31 offen offset:128 lds
v_mfma_f32_16x16x32_bf16 v[36:39], a[20:23], a[4:7], v[36:39]
ds_read_b64_tr_b16 a[44:45], v207 offset:49152
v_mfma_f32_16x16x32_bf16 v[40:43], a[20:23], a[8:11], v[40:43]
ds_read_b64_tr_b16 a[46:47], v207 offset:51200
s_add_u32 m0, s34, 81664
v_mfma_f32_16x16x32_bf16 v[44:47], a[20:23], a[12:15], v[44:47]
ds_read_b64_tr_b16 a[48:49], v208 offset:49152
buffer_load_dwordx4 v2, s[8:11], s31 offen offset:256 lds
v_mfma_f32_16x16x32_bf16 v[180:183], a[20:23], v[216:219], v[180:183]
ds_read_b64_tr_b16 a[50:51], v208 offset:51200
s_waitcnt lgkmcnt(14)
v_mfma_f32_16x16x32_bf16 v[48:51], a[24:27], a[0:3], v[48:51]
ds_read_b64_tr_b16 a[56:57], v210 offset:49152
s_add_u32 m0, s34, 85632
v_mfma_f32_16x16x32_bf16 v[52:55], a[24:27], a[4:7], v[52:55]
ds_read_b64_tr_b16 a[58:59], v210 offset:51200
buffer_load_dwordx4 v2, s[8:11], s31 offen offset:384 lds
v_mfma_f32_16x16x32_bf16 v[56:59], a[24:27], a[8:11], v[56:59]
ds_read_b64_tr_b16 a[60:61], v211 offset:49152
v_mfma_f32_16x16x32_bf16 v[60:63], a[24:27], a[12:15], v[60:63]
ds_read_b64_tr_b16 a[62:63], v211 offset:51200
s_add_u32 m0, s34, 89600
v_mfma_f32_16x16x32_bf16 v[184:187], a[24:27], v[216:219], v[184:187]
ds_read_b64_tr_b16 a[64:65], v212 offset:49152
buffer_load_dwordx4 v2, s[8:11], s31 offen offset:512 lds
s_waitcnt lgkmcnt(15)
v_mfma_f32_16x16x32_bf16 v[64:67], a[28:31], a[0:3], v[64:67]
ds_read_b64_tr_b16 a[66:67], v212 offset:51200
v_mfma_f32_16x16x32_bf16 v[68:71], a[28:31], a[4:7], v[68:71]
ds_read_b64_tr_b16 a[68:69], v213 offset:49152
s_add_u32 s63, s62, 1052672
s_add_u32 m0, s34, 94208
v_mfma_f32_16x16x32_bf16 v[72:75], a[28:31], a[8:11], v[72:75]
ds_read_b64_tr_b16 a[70:71], v213 offset:51200
buffer_load_dwordx4 v3, s[12:15], s63 offen lds
v_mfma_f32_16x16x32_bf16 v[76:79], a[28:31], a[12:15], v[76:79]
v_mfma_f32_16x16x32_bf16 v[188:191], a[28:31], v[216:219], v[188:191]
s_waitcnt lgkmcnt(15)
v_mfma_f32_16x16x32_bf16 v[80:83], a[32:35], a[0:3], v[80:83]
v_mfma_f32_16x16x32_bf16 v[84:87], a[32:35], a[4:7], v[84:87]
v_mfma_f32_16x16x32_bf16 v[88:91], a[32:35], a[8:11], v[88:91]
v_mfma_f32_16x16x32_bf16 v[92:95], a[32:35], a[12:15], v[92:95]
v_mfma_f32_16x16x32_bf16 v[192:195], a[32:35], v[216:219], v[192:195]
s_waitcnt vmcnt(18)
s_barrier
s_waitcnt lgkmcnt(14)
v_mfma_f32_16x16x32_bf16 v[96:99], a[52:55], a[36:39], v[96:99]
ds_read_b64_tr_b16 a[16:17], v200 offset:0
s_waitcnt lgkmcnt(13)
v_mfma_f32_16x16x32_bf16 v[100:103], a[52:55], a[40:43], v[100:103]
ds_read_b64_tr_b16 a[18:19], v200 offset:2048
s_add_u32 s31, s61, 204800
s_add_u32 m0, s34, 98304
s_waitcnt lgkmcnt(12)
v_mfma_f32_16x16x32_bf16 v[104:107], a[52:55], a[44:47], v[104:107]
ds_read_b64_tr_b16 a[0:1], v196 offset:0
buffer_load_dwordx4 v2, s[8:11], s31 offen offset:0 lds
s_waitcnt lgkmcnt(11)
v_mfma_f32_16x16x32_bf16 v[108:111], a[52:55], a[48:51], v[108:111]
ds_read_b64_tr_b16 a[2:3], v196 offset:2048
s_waitcnt lgkmcnt(10)
v_mfma_f32_16x16x32_bf16 v[112:115], a[56:59], a[36:39], v[112:115]
ds_read_b64_tr_b16 a[4:5], v197 offset:0
s_add_u32 m0, s34, 102272
v_mfma_f32_16x16x32_bf16 v[116:119], a[56:59], a[40:43], v[116:119]
ds_read_b64_tr_b16 a[6:7], v197 offset:2048
buffer_load_dwordx4 v2, s[8:11], s31 offen offset:128 lds
v_mfma_f32_16x16x32_bf16 v[120:123], a[56:59], a[44:47], v[120:123]
ds_read_b64_tr_b16 a[8:9], v198 offset:0
v_mfma_f32_16x16x32_bf16 v[124:127], a[56:59], a[48:51], v[124:127]
ds_read_b64_tr_b16 a[10:11], v198 offset:2048
s_add_u32 m0, s34, 106240
s_waitcnt lgkmcnt(12)
v_mfma_f32_16x16x32_bf16 v[128:131], a[60:63], a[36:39], v[128:131]
ds_read_b64_tr_b16 a[12:13], v199 offset:0
buffer_load_dwordx4 v2, s[8:11], s31 offen offset:256 lds
v_mfma_f32_16x16x32_bf16 v[132:135], a[60:63], a[40:43], v[132:135]
ds_read_b64_tr_b16 a[14:15], v199 offset:2048
v_mfma_f32_16x16x32_bf16 v[136:139], a[60:63], a[44:47], v[136:139]
ds_read_b64_tr_b16 a[20:21], v201 offset:0
s_add_u32 m0, s34, 110208
v_mfma_f32_16x16x32_bf16 v[140:143], a[60:63], a[48:51], v[140:143]
ds_read_b64_tr_b16 a[22:23], v201 offset:2048
buffer_load_dwordx4 v2, s[8:11], s31 offen offset:384 lds
s_waitcnt lgkmcnt(14)
v_mfma_f32_16x16x32_bf16 v[144:147], a[64:67], a[36:39], v[144:147]
ds_read_b64_tr_b16 a[24:25], v202 offset:0
v_mfma_f32_16x16x32_bf16 v[148:151], a[64:67], a[40:43], v[148:151]
ds_read_b64_tr_b16 a[26:27], v202 offset:2048
s_add_u32 m0, s34, 114176
v_mfma_f32_16x16x32_bf16 v[152:155], a[64:67], a[44:47], v[152:155]
ds_read_b64_tr_b16 a[28:29], v203 offset:0
buffer_load_dwordx4 v2, s[8:11], s31 offen offset:512 lds
v_mfma_f32_16x16x32_bf16 v[156:159], a[64:67], a[48:51], v[156:159]
ds_read_b64_tr_b16 a[30:31], v203 offset:2048
s_waitcnt lgkmcnt(15)
v_mfma_f32_16x16x32_bf16 v[160:163], a[68:71], a[36:39], v[160:163]
ds_read_b64_tr_b16 a[32:33], v204 offset:0
s_add_u32 s63, s62, 1310720
s_add_u32 m0, s34, 118784
v_mfma_f32_16x16x32_bf16 v[164:167], a[68:71], a[40:43], v[164:167]
ds_read_b64_tr_b16 a[34:35], v204 offset:2048
buffer_load_dwordx4 v3, s[12:15], s63 offen lds
v_mfma_f32_16x16x32_bf16 v[168:171], a[68:71], a[44:47], v[168:171]
v_mfma_f32_16x16x32_bf16 v[172:175], a[68:71], a[48:51], v[172:175]
s_waitcnt vmcnt(18)
s_barrier
s_waitcnt lgkmcnt(14)
v_mfma_f32_16x16x32_bf16 v[16:19], a[16:19], a[0:3], v[16:19]
ds_read_b64_tr_b16 a[52:53], v200 offset:24576
s_waitcnt lgkmcnt(13)
v_mfma_f32_16x16x32_bf16 v[20:23], a[16:19], a[4:7], v[20:23]
ds_read_b64_tr_b16 a[54:55], v200 offset:26624
s_add_u32 s31, s61, 205440
s_add_u32 m0, s34, 122880
s_waitcnt lgkmcnt(12)
v_mfma_f32_16x16x32_bf16 v[24:27], a[16:19], a[8:11], v[24:27]
ds_read_b64_tr_b16 a[36:37], v196 offset:24576
buffer_load_dwordx4 v2, s[8:11], s31 offen offset:0 lds
s_waitcnt lgkmcnt(11)
v_mfma_f32_16x16x32_bf16 v[28:31], a[16:19], a[12:15], v[28:31]
ds_read_b64_tr_b16 a[38:39], v196 offset:26624
v_mfma_f32_16x16x32_bf16 v[176:179], a[16:19], v[216:219], v[176:179]
ds_read_b64_tr_b16 a[40:41], v197 offset:24576
s_add_u32 m0, s34, 126848
s_waitcnt lgkmcnt(11)
v_mfma_f32_16x16x32_bf16 v[32:35], a[20:23], a[0:3], v[32:35]
ds_read_b64_tr_b16 a[42:43], v197 offset:26624
buffer_load_dwordx4 v2, s[8:11], s31 offen offset:128 lds
v_mfma_f32_16x16x32_bf16 v[36:39], a[20:23], a[4:7], v[36:39]
ds_read_b64_tr_b16 a[44:45], v198 offset:24576
v_mfma_f32_16x16x32_bf16 v[40:43], a[20:23], a[8:11], v[40:43]
ds_read_b64_tr_b16 a[46:47], v198 offset:26624
s_add_u32 m0, s34, 130816
v_mfma_f32_16x16x32_bf16 v[44:47], a[20:23], a[12:15], v[44:47]
ds_read_b64_tr_b16 a[48:49], v199 offset:24576
buffer_load_dwordx4 v2, s[8:11], s31 offen offset:256 lds
v_mfma_f32_16x16x32_bf16 v[180:183], a[20:23], v[216:219], v[180:183]
ds_read_b64_tr_b16 a[50:51], v199 offset:26624
s_waitcnt lgkmcnt(14)
v_mfma_f32_16x16x32_bf16 v[48:51], a[24:27], a[0:3], v[48:51]
ds_read_b64_tr_b16 a[56:57], v201 offset:24576
s_add_u32 m0, s34, 134784
v_mfma_f32_16x16x32_bf16 v[52:55], a[24:27], a[4:7], v[52:55]
ds_read_b64_tr_b16 a[58:59], v201 offset:26624
buffer_load_dwordx4 v2, s[8:11], s31 offen offset:384 lds
v_mfma_f32_16x16x32_bf16 v[56:59], a[24:27], a[8:11], v[56:59]
ds_read_b64_tr_b16 a[60:61], v202 offset:24576
v_mfma_f32_16x16x32_bf16 v[60:63], a[24:27], a[12:15], v[60:63]
ds_read_b64_tr_b16 a[62:63], v202 offset:26624
s_add_u32 m0, s34, 138752
v_mfma_f32_16x16x32_bf16 v[184:187], a[24:27], v[216:219], v[184:187]
ds_read_b64_tr_b16 a[64:65], v203 offset:24576
buffer_load_dwordx4 v2, s[8:11], s31 offen offset:512 lds
s_waitcnt lgkmcnt(15)
v_mfma_f32_16x16x32_bf16 v[64:67], a[28:31], a[0:3], v[64:67]
ds_read_b64_tr_b16 a[66:67], v203 offset:26624
v_mfma_f32_16x16x32_bf16 v[68:71], a[28:31], a[4:7], v[68:71]
ds_read_b64_tr_b16 a[68:69], v204 offset:24576
s_add_u32 s63, s62, 1314816
s_add_u32 m0, s34, 143360
v_mfma_f32_16x16x32_bf16 v[72:75], a[28:31], a[8:11], v[72:75]
ds_read_b64_tr_b16 a[70:71], v204 offset:26624
buffer_load_dwordx4 v3, s[12:15], s63 offen lds
v_mfma_f32_16x16x32_bf16 v[76:79], a[28:31], a[12:15], v[76:79]
v_mfma_f32_16x16x32_bf16 v[188:191], a[28:31], v[216:219], v[188:191]
s_waitcnt lgkmcnt(15)
v_mfma_f32_16x16x32_bf16 v[80:83], a[32:35], a[0:3], v[80:83]
v_mfma_f32_16x16x32_bf16 v[84:87], a[32:35], a[4:7], v[84:87]
v_mfma_f32_16x16x32_bf16 v[88:91], a[32:35], a[8:11], v[88:91]
v_mfma_f32_16x16x32_bf16 v[92:95], a[32:35], a[12:15], v[92:95]
v_mfma_f32_16x16x32_bf16 v[192:195], a[32:35], v[216:219], v[192:195]
s_waitcnt vmcnt(18)
s_barrier
s_waitcnt lgkmcnt(14)
v_mfma_f32_16x16x32_bf16 v[96:99], a[52:55], a[36:39], v[96:99]
ds_read_b64_tr_b16 a[16:17], v200 offset:49152
s_waitcnt lgkmcnt(13)
v_mfma_f32_16x16x32_bf16 v[100:103], a[52:55], a[40:43], v[100:103]
ds_read_b64_tr_b16 a[18:19], v200 offset:51200
s_add_u32 s31, s61, 245760
s_add_u32 m0, s34, 0
s_waitcnt lgkmcnt(12)
v_mfma_f32_16x16x32_bf16 v[104:107], a[52:55], a[44:47], v[104:107]
ds_read_b64_tr_b16 a[0:1], v196 offset:49152
buffer_load_dwordx4 v2, s[8:11], s31 offen offset:0 lds
s_waitcnt lgkmcnt(11)
v_mfma_f32_16x16x32_bf16 v[108:111], a[52:55], a[48:51], v[108:111]
ds_read_b64_tr_b16 a[2:3], v196 offset:51200
s_waitcnt lgkmcnt(10)
v_mfma_f32_16x16x32_bf16 v[112:115], a[56:59], a[36:39], v[112:115]
ds_read_b64_tr_b16 a[4:5], v197 offset:49152
s_add_u32 m0, s34, 3968
v_mfma_f32_16x16x32_bf16 v[116:119], a[56:59], a[40:43], v[116:119]
ds_read_b64_tr_b16 a[6:7], v197 offset:51200
buffer_load_dwordx4 v2, s[8:11], s31 offen offset:128 lds
v_mfma_f32_16x16x32_bf16 v[120:123], a[56:59], a[44:47], v[120:123]
ds_read_b64_tr_b16 a[8:9], v198 offset:49152
v_mfma_f32_16x16x32_bf16 v[124:127], a[56:59], a[48:51], v[124:127]
ds_read_b64_tr_b16 a[10:11], v198 offset:51200
s_add_u32 m0, s34, 7936
s_waitcnt lgkmcnt(12)
v_mfma_f32_16x16x32_bf16 v[128:131], a[60:63], a[36:39], v[128:131]
ds_read_b64_tr_b16 a[12:13], v199 offset:49152
buffer_load_dwordx4 v2, s[8:11], s31 offen offset:256 lds
v_mfma_f32_16x16x32_bf16 v[132:135], a[60:63], a[40:43], v[132:135]
ds_read_b64_tr_b16 a[14:15], v199 offset:51200
v_mfma_f32_16x16x32_bf16 v[136:139], a[60:63], a[44:47], v[136:139]
ds_read_b64_tr_b16 a[20:21], v201 offset:49152
s_add_u32 m0, s34, 11904
v_mfma_f32_16x16x32_bf16 v[140:143], a[60:63], a[48:51], v[140:143]
ds_read_b64_tr_b16 a[22:23], v201 offset:51200
buffer_load_dwordx4 v2, s[8:11], s31 offen offset:384 lds
s_waitcnt lgkmcnt(14)
v_mfma_f32_16x16x32_bf16 v[144:147], a[64:67], a[36:39], v[144:147]
ds_read_b64_tr_b16 a[24:25], v202 offset:49152
v_mfma_f32_16x16x32_bf16 v[148:151], a[64:67], a[40:43], v[148:151]
ds_read_b64_tr_b16 a[26:27], v202 offset:51200
s_add_u32 m0, s34, 15872
v_mfma_f32_16x16x32_bf16 v[152:155], a[64:67], a[44:47], v[152:155]
ds_read_b64_tr_b16 a[28:29], v203 offset:49152
buffer_load_dwordx4 v2, s[8:11], s31 offen offset:512 lds
v_mfma_f32_16x16x32_bf16 v[156:159], a[64:67], a[48:51], v[156:159]
ds_read_b64_tr_b16 a[30:31], v203 offset:51200
s_waitcnt lgkmcnt(15)
v_mfma_f32_16x16x32_bf16 v[160:163], a[68:71], a[36:39], v[160:163]
ds_read_b64_tr_b16 a[32:33], v204 offset:49152
s_add_u32 s63, s62, 1572864
s_add_u32 m0, s34, 20480
v_mfma_f32_16x16x32_bf16 v[164:167], a[68:71], a[40:43], v[164:167]
ds_read_b64_tr_b16 a[34:35], v204 offset:51200
buffer_load_dwordx4 v3, s[12:15], s63 offen lds
v_mfma_f32_16x16x32_bf16 v[168:171], a[68:71], a[44:47], v[168:171]
v_mfma_f32_16x16x32_bf16 v[172:175], a[68:71], a[48:51], v[172:175]
s_waitcnt vmcnt(18)
s_barrier
s_waitcnt lgkmcnt(14)
v_mfma_f32_16x16x32_bf16 v[16:19], a[16:19], a[0:3], v[16:19]
ds_read_b64_tr_b16 a[52:53], v209 offset:0
s_waitcnt lgkmcnt(13)
v_mfma_f32_16x16x32_bf16 v[20:23], a[16:19], a[4:7], v[20:23]
ds_read_b64_tr_b16 a[54:55], v209 offset:2048
s_add_u32 s31, s61, 246400
s_add_u32 m0, s34, 24576
s_waitcnt lgkmcnt(12)
v_mfma_f32_16x16x32_bf16 v[24:27], a[16:19], a[8:11], v[24:27]
ds_read_b64_tr_b16 a[36:37], v205 offset:0
buffer_load_dwordx4 v2, s[8:11], s31 offen offset:0 lds
s_waitcnt lgkmcnt(11)
v_mfma_f32_16x16x32_bf16 v[28:31], a[16:19], a[12:15], v[28:31]
ds_read_b64_tr_b16 a[38:39], v205 offset:2048
v_mfma_f32_16x16x32_bf16 v[176:179], a[16:19], v[216:219], v[176:179]
ds_read_b64_tr_b16 a[40:41], v206 offset:0
s_add_u32 m0, s34, 28544
s_waitcnt lgkmcnt(11)
v_mfma_f32_16x16x32_bf16 v[32:35], a[20:23], a[0:3], v[32:35]
ds_read_b64_tr_b16 a[42:43], v206 offset:2048
buffer_load_dwordx4 v2, s[8:11], s31 offen offset:128 lds
v_mfma_f32_16x16x32_bf16 v[36:39], a[20:23], a[4:7], v[36:39]
ds_read_b64_tr_b16 a[44:45], v207 offset:0
v_mfma_f32_16x16x32_bf16 v[40:43], a[20:23], a[8:11], v[40:43]
ds_read_b64_tr_b16 a[46:47], v207 offset:2048
s_add_u32 m0, s34, 32512
v_mfma_f32_16x16x32_bf16 v[44:47], a[20:23], a[12:15], v[44:47]
ds_read_b64_tr_b16 a[48:49], v208 offset:0
buffer_load_dwordx4 v2, s[8:11], s31 offen offset:256 lds
v_mfma_f32_16x16x32_bf16 v[180:183], a[20:23], v[216:219], v[180:183]
ds_read_b64_tr_b16 a[50:51], v208 offset:2048
s_waitcnt lgkmcnt(14)
v_mfma_f32_16x16x32_bf16 v[48:51], a[24:27], a[0:3], v[48:51]
ds_read_b64_tr_b16 a[56:57], v210 offset:0
s_add_u32 m0, s34, 36480
v_mfma_f32_16x16x32_bf16 v[52:55], a[24:27], a[4:7], v[52:55]
ds_read_b64_tr_b16 a[58:59], v210 offset:2048
buffer_load_dwordx4 v2, s[8:11], s31 offen offset:384 lds
v_mfma_f32_16x16x32_bf16 v[56:59], a[24:27], a[8:11], v[56:59]
ds_read_b64_tr_b16 a[60:61], v211 offset:0
v_mfma_f32_16x16x32_bf16 v[60:63], a[24:27], a[12:15], v[60:63]
ds_read_b64_tr_b16 a[62:63], v211 offset:2048
s_add_u32 m0, s34, 40448
v_mfma_f32_16x16x32_bf16 v[184:187], a[24:27], v[216:219], v[184:187]
ds_read_b64_tr_b16 a[64:65], v212 offset:0
buffer_load_dwordx4 v2, s[8:11], s31 offen offset:512 lds
s_waitcnt lgkmcnt(15)
v_mfma_f32_16x16x32_bf16 v[64:67], a[28:31], a[0:3], v[64:67]
ds_read_b64_tr_b16 a[66:67], v212 offset:2048
v_mfma_f32_16x16x32_bf16 v[68:71], a[28:31], a[4:7], v[68:71]
ds_read_b64_tr_b16 a[68:69], v213 offset:0
s_add_u32 s63, s62, 1576960
s_add_u32 m0, s34, 45056
v_mfma_f32_16x16x32_bf16 v[72:75], a[28:31], a[8:11], v[72:75]
ds_read_b64_tr_b16 a[70:71], v213 offset:2048
buffer_load_dwordx4 v3, s[12:15], s63 offen lds
v_mfma_f32_16x16x32_bf16 v[76:79], a[28:31], a[12:15], v[76:79]
v_mfma_f32_16x16x32_bf16 v[188:191], a[28:31], v[216:219], v[188:191]
s_waitcnt lgkmcnt(15)
v_mfma_f32_16x16x32_bf16 v[80:83], a[32:35], a[0:3], v[80:83]
v_mfma_f32_16x16x32_bf16 v[84:87], a[32:35], a[4:7], v[84:87]
v_mfma_f32_16x16x32_bf16 v[88:91], a[32:35], a[8:11], v[88:91]
v_mfma_f32_16x16x32_bf16 v[92:95], a[32:35], a[12:15], v[92:95]
v_mfma_f32_16x16x32_bf16 v[192:195], a[32:35], v[216:219], v[192:195]
s_waitcnt vmcnt(18)
s_barrier
s_waitcnt lgkmcnt(14)
v_mfma_f32_16x16x32_bf16 v[96:99], a[52:55], a[36:39], v[96:99]
ds_read_b64_tr_b16 a[16:17], v209 offset:24576
s_waitcnt lgkmcnt(13)
v_mfma_f32_16x16x32_bf16 v[100:103], a[52:55], a[40:43], v[100:103]
ds_read_b64_tr_b16 a[18:19], v209 offset:26624
s_add_u32 s31, s61, 286720
s_add_u32 m0, s34, 49152
s_waitcnt lgkmcnt(12)
v_mfma_f32_16x16x32_bf16 v[104:107], a[52:55], a[44:47], v[104:107]
ds_read_b64_tr_b16 a[0:1], v205 offset:24576
buffer_load_dwordx4 v2, s[8:11], s31 offen offset:0 lds
s_waitcnt lgkmcnt(11)
v_mfma_f32_16x16x32_bf16 v[108:111], a[52:55], a[48:51], v[108:111]
ds_read_b64_tr_b16 a[2:3], v205 offset:26624
s_waitcnt lgkmcnt(10)
v_mfma_f32_16x16x32_bf16 v[112:115], a[56:59], a[36:39], v[112:115]
ds_read_b64_tr_b16 a[4:5], v206 offset:24576
s_add_u32 m0, s34, 53120
v_mfma_f32_16x16x32_bf16 v[116:119], a[56:59], a[40:43], v[116:119]
ds_read_b64_tr_b16 a[6:7], v206 offset:26624
buffer_load_dwordx4 v2, s[8:11], s31 offen offset:128 lds
v_mfma_f32_16x16x32_bf16 v[120:123], a[56:59], a[44:47], v[120:123]
ds_read_b64_tr_b16 a[8:9], v207 offset:24576
v_mfma_f32_16x16x32_bf16 v[124:127], a[56:59], a[48:51], v[124:127]
ds_read_b64_tr_b16 a[10:11], v207 offset:26624
s_add_u32 m0, s34, 57088
s_waitcnt lgkmcnt(12)
v_mfma_f32_16x16x32_bf16 v[128:131], a[60:63], a[36:39], v[128:131]
ds_read_b64_tr_b16 a[12:13], v208 offset:24576
buffer_load_dwordx4 v2, s[8:11], s31 offen offset:256 lds
v_mfma_f32_16x16x32_bf16 v[132:135], a[60:63], a[40:43], v[132:135]
ds_read_b64_tr_b16 a[14:15], v208 offset:26624
v_mfma_f32_16x16x32_bf16 v[136:139], a[60:63], a[44:47], v[136:139]
ds_read_b64_tr_b16 a[20:21], v210 offset:24576
s_add_u32 m0, s34, 61056
v_mfma_f32_16x16x32_bf16 v[140:143], a[60:63], a[48:51], v[140:143]
ds_read_b64_tr_b16 a[22:23], v210 offset:26624
buffer_load_dwordx4 v2, s[8:11], s31 offen offset:384 lds
s_waitcnt lgkmcnt(14)
v_mfma_f32_16x16x32_bf16 v[144:147], a[64:67], a[36:39], v[144:147]
ds_read_b64_tr_b16 a[24:25], v211 offset:24576
v_mfma_f32_16x16x32_bf16 v[148:151], a[64:67], a[40:43], v[148:151]
ds_read_b64_tr_b16 a[26:27], v211 offset:26624
s_add_u32 m0, s34, 65024
v_mfma_f32_16x16x32_bf16 v[152:155], a[64:67], a[44:47], v[152:155]
ds_read_b64_tr_b16 a[28:29], v212 offset:24576
buffer_load_dwordx4 v2, s[8:11], s31 offen offset:512 lds
v_mfma_f32_16x16x32_bf16 v[156:159], a[64:67], a[48:51], v[156:159]
ds_read_b64_tr_b16 a[30:31], v212 offset:26624
s_waitcnt lgkmcnt(15)
v_mfma_f32_16x16x32_bf16 v[160:163], a[68:71], a[36:39], v[160:163]
ds_read_b64_tr_b16 a[32:33], v213 offset:24576
s_add_u32 s63, s62, 1835008
s_add_u32 m0, s34, 69632
v_mfma_f32_16x16x32_bf16 v[164:167], a[68:71], a[40:43], v[164:167]
ds_read_b64_tr_b16 a[34:35], v213 offset:26624
buffer_load_dwordx4 v3, s[12:15], s63 offen lds
v_mfma_f32_16x16x32_bf16 v[168:171], a[68:71], a[44:47], v[168:171]
v_mfma_f32_16x16x32_bf16 v[172:175], a[68:71], a[48:51], v[172:175]
s_waitcnt vmcnt(18)
s_barrier
s_waitcnt lgkmcnt(14)
v_mfma_f32_16x16x32_bf16 v[16:19], a[16:19], a[0:3], v[16:19]
ds_read_b64_tr_b16 a[52:53], v209 offset:49152
s_waitcnt lgkmcnt(13)
v_mfma_f32_16x16x32_bf16 v[20:23], a[16:19], a[4:7], v[20:23]
ds_read_b64_tr_b16 a[54:55], v209 offset:51200
s_add_u32 s31, s61, 287360
s_add_u32 m0, s34, 73728
s_waitcnt lgkmcnt(12)
v_mfma_f32_16x16x32_bf16 v[24:27], a[16:19], a[8:11], v[24:27]
ds_read_b64_tr_b16 a[36:37], v205 offset:49152
buffer_load_dwordx4 v2, s[8:11], s31 offen offset:0 lds
s_waitcnt lgkmcnt(11)
v_mfma_f32_16x16x32_bf16 v[28:31], a[16:19], a[12:15], v[28:31]
ds_read_b64_tr_b16 a[38:39], v205 offset:51200
v_mfma_f32_16x16x32_bf16 v[176:179], a[16:19], v[216:219], v[176:179]
ds_read_b64_tr_b16 a[40:41], v206 offset:49152
s_add_u32 m0, s34, 77696
s_waitcnt lgkmcnt(11)
v_mfma_f32_16x16x32_bf16 v[32:35], a[20:23], a[0:3], v[32:35]
ds_read_b64_tr_b16 a[42:43], v206 offset:51200
buffer_load_dwordx4 v2, s[8:11], s31 offen offset:128 lds
v_mfma_f32_16x16x32_bf16 v[36:39], a[20:23], a[4:7], v[36:39]
ds_read_b64_tr_b16 a[44:45], v207 offset:49152
v_mfma_f32_16x16x32_bf16 v[40:43], a[20:23], a[8:11], v[40:43]
ds_read_b64_tr_b16 a[46:47], v207 offset:51200
s_add_u32 m0, s34, 81664
v_mfma_f32_16x16x32_bf16 v[44:47], a[20:23], a[12:15], v[44:47]
ds_read_b64_tr_b16 a[48:49], v208 offset:49152
buffer_load_dwordx4 v2, s[8:11], s31 offen offset:256 lds
v_mfma_f32_16x16x32_bf16 v[180:183], a[20:23], v[216:219], v[180:183]
ds_read_b64_tr_b16 a[50:51], v208 offset:51200
s_waitcnt lgkmcnt(14)
v_mfma_f32_16x16x32_bf16 v[48:51], a[24:27], a[0:3], v[48:51]
ds_read_b64_tr_b16 a[56:57], v210 offset:49152
s_add_u32 m0, s34, 85632
v_mfma_f32_16x16x32_bf16 v[52:55], a[24:27], a[4:7], v[52:55]
ds_read_b64_tr_b16 a[58:59], v210 offset:51200
buffer_load_dwordx4 v2, s[8:11], s31 offen offset:384 lds
v_mfma_f32_16x16x32_bf16 v[56:59], a[24:27], a[8:11], v[56:59]
ds_read_b64_tr_b16 a[60:61], v211 offset:49152
v_mfma_f32_16x16x32_bf16 v[60:63], a[24:27], a[12:15], v[60:63]
ds_read_b64_tr_b16 a[62:63], v211 offset:51200
s_add_u32 m0, s34, 89600
v_mfma_f32_16x16x32_bf16 v[184:187], a[24:27], v[216:219], v[184:187]
ds_read_b64_tr_b16 a[64:65], v212 offset:49152
buffer_load_dwordx4 v2, s[8:11], s31 offen offset:512 lds
s_waitcnt lgkmcnt(15)
v_mfma_f32_16x16x32_bf16 v[64:67], a[28:31], a[0:3], v[64:67]
ds_read_b64_tr_b16 a[66:67], v212 offset:51200
v_mfma_f32_16x16x32_bf16 v[68:71], a[28:31], a[4:7], v[68:71]
ds_read_b64_tr_b16 a[68:69], v213 offset:49152
s_add_u32 s63, s62, 1839104
s_add_u32 m0, s34, 94208
v_mfma_f32_16x16x32_bf16 v[72:75], a[28:31], a[8:11], v[72:75]
ds_read_b64_tr_b16 a[70:71], v213 offset:51200
buffer_load_dwordx4 v3, s[12:15], s63 offen lds
v_mfma_f32_16x16x32_bf16 v[76:79], a[28:31], a[12:15], v[76:79]
v_mfma_f32_16x16x32_bf16 v[188:191], a[28:31], v[216:219], v[188:191]
s_waitcnt lgkmcnt(15)
v_mfma_f32_16x16x32_bf16 v[80:83], a[32:35], a[0:3], v[80:83]
v_mfma_f32_16x16x32_bf16 v[84:87], a[32:35], a[4:7], v[84:87]
v_mfma_f32_16x16x32_bf16 v[88:91], a[32:35], a[8:11], v[88:91]
v_mfma_f32_16x16x32_bf16 v[92:95], a[32:35], a[12:15], v[92:95]
v_mfma_f32_16x16x32_bf16 v[192:195], a[32:35], v[216:219], v[192:195]
s_waitcnt vmcnt(18)
s_barrier
s_waitcnt lgkmcnt(14)
v_mfma_f32_16x16x32_bf16 v[96:99], a[52:55], a[36:39], v[96:99]
ds_read_b64_tr_b16 a[16:17], v200 offset:0
s_waitcnt lgkmcnt(13)
v_mfma_f32_16x16x32_bf16 v[100:103], a[52:55], a[40:43], v[100:103]
ds_read_b64_tr_b16 a[18:19], v200 offset:2048
s_add_u32 s31, s61, 327680
s_add_u32 m0, s34, 98304
s_waitcnt lgkmcnt(12)
v_mfma_f32_16x16x32_bf16 v[104:107], a[52:55], a[44:47], v[104:107]
ds_read_b64_tr_b16 a[0:1], v196 offset:0
buffer_load_dwordx4 v2, s[8:11], s31 offen offset:0 lds
s_waitcnt lgkmcnt(11)
v_mfma_f32_16x16x32_bf16 v[108:111], a[52:55], a[48:51], v[108:111]
ds_read_b64_tr_b16 a[2:3], v196 offset:2048
s_waitcnt lgkmcnt(10)
v_mfma_f32_16x16x32_bf16 v[112:115], a[56:59], a[36:39], v[112:115]
ds_read_b64_tr_b16 a[4:5], v197 offset:0
s_add_u32 m0, s34, 102272
v_mfma_f32_16x16x32_bf16 v[116:119], a[56:59], a[40:43], v[116:119]
ds_read_b64_tr_b16 a[6:7], v197 offset:2048
buffer_load_dwordx4 v2, s[8:11], s31 offen offset:128 lds
v_mfma_f32_16x16x32_bf16 v[120:123], a[56:59], a[44:47], v[120:123]
ds_read_b64_tr_b16 a[8:9], v198 offset:0
v_mfma_f32_16x16x32_bf16 v[124:127], a[56:59], a[48:51], v[124:127]
ds_read_b64_tr_b16 a[10:11], v198 offset:2048
s_add_u32 m0, s34, 106240
s_waitcnt lgkmcnt(12)
v_mfma_f32_16x16x32_bf16 v[128:131], a[60:63], a[36:39], v[128:131]
ds_read_b64_tr_b16 a[12:13], v199 offset:0
buffer_load_dwordx4 v2, s[8:11], s31 offen offset:256 lds
v_mfma_f32_16x16x32_bf16 v[132:135], a[60:63], a[40:43], v[132:135]
ds_read_b64_tr_b16 a[14:15], v199 offset:2048
v_mfma_f32_16x16x32_bf16 v[136:139], a[60:63], a[44:47], v[136:139]
ds_read_b64_tr_b16 a[20:21], v201 offset:0
s_add_u32 m0, s34, 110208
v_mfma_f32_16x16x32_bf16 v[140:143], a[60:63], a[48:51], v[140:143]
ds_read_b64_tr_b16 a[22:23], v201 offset:2048
buffer_load_dwordx4 v2, s[8:11], s31 offen offset:384 lds
s_waitcnt lgkmcnt(14)
v_mfma_f32_16x16x32_bf16 v[144:147], a[64:67], a[36:39], v[144:147]
ds_read_b64_tr_b16 a[24:25], v202 offset:0
v_mfma_f32_16x16x32_bf16 v[148:151], a[64:67], a[40:43], v[148:151]
ds_read_b64_tr_b16 a[26:27], v202 offset:2048
s_add_u32 m0, s34, 114176
v_mfma_f32_16x16x32_bf16 v[152:155], a[64:67], a[44:47], v[152:155]
ds_read_b64_tr_b16 a[28:29], v203 offset:0
buffer_load_dwordx4 v2, s[8:11], s31 offen offset:512 lds
v_mfma_f32_16x16x32_bf16 v[156:159], a[64:67], a[48:51], v[156:159]
ds_read_b64_tr_b16 a[30:31], v203 offset:2048
s_waitcnt lgkmcnt(15)
v_mfma_f32_16x16x32_bf16 v[160:163], a[68:71], a[36:39], v[160:163]
ds_read_b64_tr_b16 a[32:33], v204 offset:0
s_add_u32 s63, s62, 2097152
s_add_u32 m0, s34, 118784
v_mfma_f32_16x16x32_bf16 v[164:167], a[68:71], a[40:43], v[164:167]
ds_read_b64_tr_b16 a[34:35], v204 offset:2048
buffer_load_dwordx4 v3, s[12:15], s63 offen lds
v_mfma_f32_16x16x32_bf16 v[168:171], a[68:71], a[44:47], v[168:171]
v_mfma_f32_16x16x32_bf16 v[172:175], a[68:71], a[48:51], v[172:175]
s_waitcnt vmcnt(18)
s_barrier
s_waitcnt lgkmcnt(14)
v_mfma_f32_16x16x32_bf16 v[16:19], a[16:19], a[0:3], v[16:19]
ds_read_b64_tr_b16 a[52:53], v200 offset:24576
s_waitcnt lgkmcnt(13)
v_mfma_f32_16x16x32_bf16 v[20:23], a[16:19], a[4:7], v[20:23]
ds_read_b64_tr_b16 a[54:55], v200 offset:26624
s_add_u32 s31, s61, 328320
s_add_u32 m0, s34, 122880
s_waitcnt lgkmcnt(12)
v_mfma_f32_16x16x32_bf16 v[24:27], a[16:19], a[8:11], v[24:27]
ds_read_b64_tr_b16 a[36:37], v196 offset:24576
buffer_load_dwordx4 v2, s[8:11], s31 offen offset:0 lds
s_waitcnt lgkmcnt(11)
v_mfma_f32_16x16x32_bf16 v[28:31], a[16:19], a[12:15], v[28:31]
ds_read_b64_tr_b16 a[38:39], v196 offset:26624
v_mfma_f32_16x16x32_bf16 v[176:179], a[16:19], v[216:219], v[176:179]
ds_read_b64_tr_b16 a[40:41], v197 offset:24576
s_add_u32 m0, s34, 126848
s_waitcnt lgkmcnt(11)
v_mfma_f32_16x16x32_bf16 v[32:35], a[20:23], a[0:3], v[32:35]
ds_read_b64_tr_b16 a[42:43], v197 offset:26624
buffer_load_dwordx4 v2, s[8:11], s31 offen offset:128 lds
v_mfma_f32_16x16x32_bf16 v[36:39], a[20:23], a[4:7], v[36:39]
ds_read_b64_tr_b16 a[44:45], v198 offset:24576
v_mfma_f32_16x16x32_bf16 v[40:43], a[20:23], a[8:11], v[40:43]
ds_read_b64_tr_b16 a[46:47], v198 offset:26624
s_add_u32 m0, s34, 130816
v_mfma_f32_16x16x32_bf16 v[44:47], a[20:23], a[12:15], v[44:47]
ds_read_b64_tr_b16 a[48:49], v199 offset:24576
buffer_load_dwordx4 v2, s[8:11], s31 offen offset:256 lds
v_mfma_f32_16x16x32_bf16 v[180:183], a[20:23], v[216:219], v[180:183]
ds_read_b64_tr_b16 a[50:51], v199 offset:26624
s_waitcnt lgkmcnt(14)
v_mfma_f32_16x16x32_bf16 v[48:51], a[24:27], a[0:3], v[48:51]
ds_read_b64_tr_b16 a[56:57], v201 offset:24576
s_add_u32 m0, s34, 134784
v_mfma_f32_16x16x32_bf16 v[52:55], a[24:27], a[4:7], v[52:55]
ds_read_b64_tr_b16 a[58:59], v201 offset:26624
buffer_load_dwordx4 v2, s[8:11], s31 offen offset:384 lds
v_mfma_f32_16x16x32_bf16 v[56:59], a[24:27], a[8:11], v[56:59]
ds_read_b64_tr_b16 a[60:61], v202 offset:24576
v_mfma_f32_16x16x32_bf16 v[60:63], a[24:27], a[12:15], v[60:63]
ds_read_b64_tr_b16 a[62:63], v202 offset:26624
s_add_u32 m0, s34, 138752
v_mfma_f32_16x16x32_bf16 v[184:187], a[24:27], v[216:219], v[184:187]
ds_read_b64_tr_b16 a[64:65], v203 offset:24576
buffer_load_dwordx4 v2, s[8:11], s31 offen offset:512 lds
s_waitcnt lgkmcnt(15)
v_mfma_f32_16x16x32_bf16 v[64:67], a[28:31], a[0:3], v[64:67]
ds_read_b64_tr_b16 a[66:67], v203 offset:26624
v_mfma_f32_16x16x32_bf16 v[68:71], a[28:31], a[4:7], v[68:71]
ds_read_b64_tr_b16 a[68:69], v204 offset:24576
s_add_u32 s63, s62, 2101248
s_add_u32 m0, s34, 143360
v_mfma_f32_16x16x32_bf16 v[72:75], a[28:31], a[8:11], v[72:75]
ds_read_b64_tr_b16 a[70:71], v204 offset:26624
buffer_load_dwordx4 v3, s[12:15], s63 offen lds
v_mfma_f32_16x16x32_bf16 v[76:79], a[28:31], a[12:15], v[76:79]
v_mfma_f32_16x16x32_bf16 v[188:191], a[28:31], v[216:219], v[188:191]
s_waitcnt lgkmcnt(15)
v_mfma_f32_16x16x32_bf16 v[80:83], a[32:35], a[0:3], v[80:83]
v_mfma_f32_16x16x32_bf16 v[84:87], a[32:35], a[4:7], v[84:87]
v_mfma_f32_16x16x32_bf16 v[88:91], a[32:35], a[8:11], v[88:91]
v_mfma_f32_16x16x32_bf16 v[92:95], a[32:35], a[12:15], v[92:95]
v_mfma_f32_16x16x32_bf16 v[192:195], a[32:35], v[216:219], v[192:195]
s_waitcnt vmcnt(18)
s_barrier
s_waitcnt lgkmcnt(14)
v_mfma_f32_16x16x32_bf16 v[96:99], a[52:55], a[36:39], v[96:99]
ds_read_b64_tr_b16 a[16:17], v200 offset:49152
s_waitcnt lgkmcnt(13)
v_mfma_f32_16x16x32_bf16 v[100:103], a[52:55], a[40:43], v[100:103]
ds_read_b64_tr_b16 a[18:19], v200 offset:51200
s_add_u32 s31, s61, 368640
s_add_u32 m0, s34, 0
s_waitcnt lgkmcnt(12)
v_mfma_f32_16x16x32_bf16 v[104:107], a[52:55], a[44:47], v[104:107]
ds_read_b64_tr_b16 a[0:1], v196 offset:49152
buffer_load_dwordx4 v2, s[8:11], s31 offen offset:0 lds
s_waitcnt lgkmcnt(11)
v_mfma_f32_16x16x32_bf16 v[108:111], a[52:55], a[48:51], v[108:111]
ds_read_b64_tr_b16 a[2:3], v196 offset:51200
s_waitcnt lgkmcnt(10)
v_mfma_f32_16x16x32_bf16 v[112:115], a[56:59], a[36:39], v[112:115]
ds_read_b64_tr_b16 a[4:5], v197 offset:49152
s_add_u32 m0, s34, 3968
v_mfma_f32_16x16x32_bf16 v[116:119], a[56:59], a[40:43], v[116:119]
ds_read_b64_tr_b16 a[6:7], v197 offset:51200
buffer_load_dwordx4 v2, s[8:11], s31 offen offset:128 lds
v_mfma_f32_16x16x32_bf16 v[120:123], a[56:59], a[44:47], v[120:123]
ds_read_b64_tr_b16 a[8:9], v198 offset:49152
v_mfma_f32_16x16x32_bf16 v[124:127], a[56:59], a[48:51], v[124:127]
ds_read_b64_tr_b16 a[10:11], v198 offset:51200
s_add_u32 m0, s34, 7936
s_waitcnt lgkmcnt(12)
v_mfma_f32_16x16x32_bf16 v[128:131], a[60:63], a[36:39], v[128:131]
ds_read_b64_tr_b16 a[12:13], v199 offset:49152
buffer_load_dwordx4 v2, s[8:11], s31 offen offset:256 lds
v_mfma_f32_16x16x32_bf16 v[132:135], a[60:63], a[40:43], v[132:135]
ds_read_b64_tr_b16 a[14:15], v199 offset:51200
v_mfma_f32_16x16x32_bf16 v[136:139], a[60:63], a[44:47], v[136:139]
ds_read_b64_tr_b16 a[20:21], v201 offset:49152
s_add_u32 m0, s34, 11904
v_mfma_f32_16x16x32_bf16 v[140:143], a[60:63], a[48:51], v[140:143]
ds_read_b64_tr_b16 a[22:23], v201 offset:51200
buffer_load_dwordx4 v2, s[8:11], s31 offen offset:384 lds
s_waitcnt lgkmcnt(14)
v_mfma_f32_16x16x32_bf16 v[144:147], a[64:67], a[36:39], v[144:147]
ds_read_b64_tr_b16 a[24:25], v202 offset:49152
v_mfma_f32_16x16x32_bf16 v[148:151], a[64:67], a[40:43], v[148:151]
ds_read_b64_tr_b16 a[26:27], v202 offset:51200
s_add_u32 m0, s34, 15872
v_mfma_f32_16x16x32_bf16 v[152:155], a[64:67], a[44:47], v[152:155]
ds_read_b64_tr_b16 a[28:29], v203 offset:49152
buffer_load_dwordx4 v2, s[8:11], s31 offen offset:512 lds
v_mfma_f32_16x16x32_bf16 v[156:159], a[64:67], a[48:51], v[156:159]
ds_read_b64_tr_b16 a[30:31], v203 offset:51200
s_waitcnt lgkmcnt(15)
v_mfma_f32_16x16x32_bf16 v[160:163], a[68:71], a[36:39], v[160:163]
ds_read_b64_tr_b16 a[32:33], v204 offset:49152
s_add_u32 s63, s62, 2359296
s_add_u32 m0, s34, 20480
v_mfma_f32_16x16x32_bf16 v[164:167], a[68:71], a[40:43], v[164:167]
ds_read_b64_tr_b16 a[34:35], v204 offset:51200
buffer_load_dwordx4 v3, s[12:15], s63 offen lds
v_mfma_f32_16x16x32_bf16 v[168:171], a[68:71], a[44:47], v[168:171]
v_mfma_f32_16x16x32_bf16 v[172:175], a[68:71], a[48:51], v[172:175]
s_waitcnt vmcnt(18)
s_barrier
s_waitcnt lgkmcnt(14)
v_mfma_f32_16x16x32_bf16 v[16:19], a[16:19], a[0:3], v[16:19]
ds_read_b64_tr_b16 a[52:53], v209 offset:0
s_waitcnt lgkmcnt(13)
v_mfma_f32_16x16x32_bf16 v[20:23], a[16:19], a[4:7], v[20:23]
ds_read_b64_tr_b16 a[54:55], v209 offset:2048
s_add_u32 s31, s61, 369280
s_add_u32 m0, s34, 24576
s_waitcnt lgkmcnt(12)
v_mfma_f32_16x16x32_bf16 v[24:27], a[16:19], a[8:11], v[24:27]
ds_read_b64_tr_b16 a[36:37], v205 offset:0
buffer_load_dwordx4 v2, s[8:11], s31 offen offset:0 lds
s_waitcnt lgkmcnt(11)
v_mfma_f32_16x16x32_bf16 v[28:31], a[16:19], a[12:15], v[28:31]
ds_read_b64_tr_b16 a[38:39], v205 offset:2048
v_mfma_f32_16x16x32_bf16 v[176:179], a[16:19], v[216:219], v[176:179]
ds_read_b64_tr_b16 a[40:41], v206 offset:0
s_add_u32 m0, s34, 28544
s_waitcnt lgkmcnt(11)
v_mfma_f32_16x16x32_bf16 v[32:35], a[20:23], a[0:3], v[32:35]
ds_read_b64_tr_b16 a[42:43], v206 offset:2048
buffer_load_dwordx4 v2, s[8:11], s31 offen offset:128 lds
v_mfma_f32_16x16x32_bf16 v[36:39], a[20:23], a[4:7], v[36:39]
ds_read_b64_tr_b16 a[44:45], v207 offset:0
v_mfma_f32_16x16x32_bf16 v[40:43], a[20:23], a[8:11], v[40:43]
ds_read_b64_tr_b16 a[46:47], v207 offset:2048
s_add_u32 m0, s34, 32512
v_mfma_f32_16x16x32_bf16 v[44:47], a[20:23], a[12:15], v[44:47]
ds_read_b64_tr_b16 a[48:49], v208 offset:0
buffer_load_dwordx4 v2, s[8:11], s31 offen offset:256 lds
v_mfma_f32_16x16x32_bf16 v[180:183], a[20:23], v[216:219], v[180:183]
ds_read_b64_tr_b16 a[50:51], v208 offset:2048
s_waitcnt lgkmcnt(14)
v_mfma_f32_16x16x32_bf16 v[48:51], a[24:27], a[0:3], v[48:51]
ds_read_b64_tr_b16 a[56:57], v210 offset:0
s_add_u32 m0, s34, 36480
v_mfma_f32_16x16x32_bf16 v[52:55], a[24:27], a[4:7], v[52:55]
ds_read_b64_tr_b16 a[58:59], v210 offset:2048
buffer_load_dwordx4 v2, s[8:11], s31 offen offset:384 lds
v_mfma_f32_16x16x32_bf16 v[56:59], a[24:27], a[8:11], v[56:59]
ds_read_b64_tr_b16 a[60:61], v211 offset:0
v_mfma_f32_16x16x32_bf16 v[60:63], a[24:27], a[12:15], v[60:63]
ds_read_b64_tr_b16 a[62:63], v211 offset:2048
s_add_u32 m0, s34, 40448
v_mfma_f32_16x16x32_bf16 v[184:187], a[24:27], v[216:219], v[184:187]
ds_read_b64_tr_b16 a[64:65], v212 offset:0
buffer_load_dwordx4 v2, s[8:11], s31 offen offset:512 lds
s_waitcnt lgkmcnt(15)
v_mfma_f32_16x16x32_bf16 v[64:67], a[28:31], a[0:3], v[64:67]
ds_read_b64_tr_b16 a[66:67], v212 offset:2048
v_mfma_f32_16x16x32_bf16 v[68:71], a[28:31], a[4:7], v[68:71]
ds_read_b64_tr_b16 a[68:69], v213 offset:0
s_add_u32 s63, s62, 2363392
s_add_u32 m0, s34, 45056
v_mfma_f32_16x16x32_bf16 v[72:75], a[28:31], a[8:11], v[72:75]
ds_read_b64_tr_b16 a[70:71], v213 offset:2048
buffer_load_dwordx4 v3, s[12:15], s63 offen lds
v_mfma_f32_16x16x32_bf16 v[76:79], a[28:31], a[12:15], v[76:79]
v_mfma_f32_16x16x32_bf16 v[188:191], a[28:31], v[216:219], v[188:191]
s_waitcnt lgkmcnt(15)
v_mfma_f32_16x16x32_bf16 v[80:83], a[32:35], a[0:3], v[80:83]
v_mfma_f32_16x16x32_bf16 v[84:87], a[32:35], a[4:7], v[84:87]
v_mfma_f32_16x16x32_bf16 v[88:91], a[32:35], a[8:11], v[88:91]
v_mfma_f32_16x16x32_bf16 v[92:95], a[32:35], a[12:15], v[92:95]
v_mfma_f32_16x16x32_bf16 v[192:195], a[32:35], v[216:219], v[192:195]
s_waitcnt vmcnt(18)
s_barrier
s_waitcnt lgkmcnt(14)
v_mfma_f32_16x16x32_bf16 v[96:99], a[52:55], a[36:39], v[96:99]
ds_read_b64_tr_b16 a[16:17], v209 offset:24576
s_waitcnt lgkmcnt(13)
v_mfma_f32_16x16x32_bf16 v[100:103], a[52:55], a[40:43], v[100:103]
ds_read_b64_tr_b16 a[18:19], v209 offset:26624
s_add_u32 s31, s61, 409600
s_add_u32 m0, s34, 49152
s_waitcnt lgkmcnt(12)
v_mfma_f32_16x16x32_bf16 v[104:107], a[52:55], a[44:47], v[104:107]
ds_read_b64_tr_b16 a[0:1], v205 offset:24576
buffer_load_dwordx4 v2, s[8:11], s31 offen offset:0 lds
s_waitcnt lgkmcnt(11)
v_mfma_f32_16x16x32_bf16 v[108:111], a[52:55], a[48:51], v[108:111]
ds_read_b64_tr_b16 a[2:3], v205 offset:26624
s_waitcnt lgkmcnt(10)
v_mfma_f32_16x16x32_bf16 v[112:115], a[56:59], a[36:39], v[112:115]
ds_read_b64_tr_b16 a[4:5], v206 offset:24576
s_add_u32 m0, s34, 53120
v_mfma_f32_16x16x32_bf16 v[116:119], a[56:59], a[40:43], v[116:119]
ds_read_b64_tr_b16 a[6:7], v206 offset:26624
buffer_load_dwordx4 v2, s[8:11], s31 offen offset:128 lds
v_mfma_f32_16x16x32_bf16 v[120:123], a[56:59], a[44:47], v[120:123]
ds_read_b64_tr_b16 a[8:9], v207 offset:24576
v_mfma_f32_16x16x32_bf16 v[124:127], a[56:59], a[48:51], v[124:127]
ds_read_b64_tr_b16 a[10:11], v207 offset:26624
s_add_u32 m0, s34, 57088
s_waitcnt lgkmcnt(12)
v_mfma_f32_16x16x32_bf16 v[128:131], a[60:63], a[36:39], v[128:131]
ds_read_b64_tr_b16 a[12:13], v208 offset:24576
buffer_load_dwordx4 v2, s[8:11], s31 offen offset:256 lds
v_mfma_f32_16x16x32_bf16 v[132:135], a[60:63], a[40:43], v[132:135]
ds_read_b64_tr_b16 a[14:15], v208 offset:26624
v_mfma_f32_16x16x32_bf16 v[136:139], a[60:63], a[44:47], v[136:139]
ds_read_b64_tr_b16 a[20:21], v210 offset:24576
s_add_u32 m0, s34, 61056
v_mfma_f32_16x16x32_bf16 v[140:143], a[60:63], a[48:51], v[140:143]
ds_read_b64_tr_b16 a[22:23], v210 offset:26624
buffer_load_dwordx4 v2, s[8:11], s31 offen offset:384 lds
s_waitcnt lgkmcnt(14)
v_mfma_f32_16x16x32_bf16 v[144:147], a[64:67], a[36:39], v[144:147]
ds_read_b64_tr_b16 a[24:25], v211 offset:24576
v_mfma_f32_16x16x32_bf16 v[148:151], a[64:67], a[40:43], v[148:151]
ds_read_b64_tr_b16 a[26:27], v211 offset:26624
s_add_u32 m0, s34, 65024
v_mfma_f32_16x16x32_bf16 v[152:155], a[64:67], a[44:47], v[152:155]
ds_read_b64_tr_b16 a[28:29], v212 offset:24576
buffer_load_dwordx4 v2, s[8:11], s31 offen offset:512 lds
v_mfma_f32_16x16x32_bf16 v[156:159], a[64:67], a[48:51], v[156:159]
ds_read_b64_tr_b16 a[30:31], v212 offset:26624
s_waitcnt lgkmcnt(15)
v_mfma_f32_16x16x32_bf16 v[160:163], a[68:71], a[36:39], v[160:163]
ds_read_b64_tr_b16 a[32:33], v213 offset:24576
s_add_u32 s63, s62, 2621440
s_add_u32 m0, s34, 69632
v_mfma_f32_16x16x32_bf16 v[164:167], a[68:71], a[40:43], v[164:167]
ds_read_b64_tr_b16 a[34:35], v213 offset:26624
buffer_load_dwordx4 v3, s[12:15], s63 offen lds
v_mfma_f32_16x16x32_bf16 v[168:171], a[68:71], a[44:47], v[168:171]
v_mfma_f32_16x16x32_bf16 v[172:175], a[68:71], a[48:51], v[172:175]
s_waitcnt vmcnt(18)
s_barrier
s_waitcnt lgkmcnt(14)
v_mfma_f32_16x16x32_bf16 v[16:19], a[16:19], a[0:3], v[16:19]
ds_read_b64_tr_b16 a[52:53], v209 offset:49152
s_waitcnt lgkmcnt(13)
v_mfma_f32_16x16x32_bf16 v[20:23], a[16:19], a[4:7], v[20:23]
ds_read_b64_tr_b16 a[54:55], v209 offset:51200
s_add_u32 s31, s61, 410240
s_add_u32 m0, s34, 73728
s_waitcnt lgkmcnt(12)
v_mfma_f32_16x16x32_bf16 v[24:27], a[16:19], a[8:11], v[24:27]
ds_read_b64_tr_b16 a[36:37], v205 offset:49152
buffer_load_dwordx4 v2, s[8:11], s31 offen offset:0 lds
s_waitcnt lgkmcnt(11)
v_mfma_f32_16x16x32_bf16 v[28:31], a[16:19], a[12:15], v[28:31]
ds_read_b64_tr_b16 a[38:39], v205 offset:51200
v_mfma_f32_16x16x32_bf16 v[176:179], a[16:19], v[216:219], v[176:179]
ds_read_b64_tr_b16 a[40:41], v206 offset:49152
s_add_u32 m0, s34, 77696
s_waitcnt lgkmcnt(11)
v_mfma_f32_16x16x32_bf16 v[32:35], a[20:23], a[0:3], v[32:35]
ds_read_b64_tr_b16 a[42:43], v206 offset:51200
buffer_load_dwordx4 v2, s[8:11], s31 offen offset:128 lds
v_mfma_f32_16x16x32_bf16 v[36:39], a[20:23], a[4:7], v[36:39]
ds_read_b64_tr_b16 a[44:45], v207 offset:49152
v_mfma_f32_16x16x32_bf16 v[40:43], a[20:23], a[8:11], v[40:43]
ds_read_b64_tr_b16 a[46:47], v207 offset:51200
s_add_u32 m0, s34, 81664
v_mfma_f32_16x16x32_bf16 v[44:47], a[20:23], a[12:15], v[44:47]
ds_read_b64_tr_b16 a[48:49], v208 offset:49152
buffer_load_dwordx4 v2, s[8:11], s31 offen offset:256 lds
v_mfma_f32_16x16x32_bf16 v[180:183], a[20:23], v[216:219], v[180:183]
ds_read_b64_tr_b16 a[50:51], v208 offset:51200
s_waitcnt lgkmcnt(14)
v_mfma_f32_16x16x32_bf16 v[48:51], a[24:27], a[0:3], v[48:51]
ds_read_b64_tr_b16 a[56:57], v210 offset:49152
s_add_u32 m0, s34, 85632
v_mfma_f32_16x16x32_bf16 v[52:55], a[24:27], a[4:7], v[52:55]
ds_read_b64_tr_b16 a[58:59], v210 offset:51200
buffer_load_dwordx4 v2, s[8:11], s31 offen offset:384 lds
v_mfma_f32_16x16x32_bf16 v[56:59], a[24:27], a[8:11], v[56:59]
ds_read_b64_tr_b16 a[60:61], v211 offset:49152
v_mfma_f32_16x16x32_bf16 v[60:63], a[24:27], a[12:15], v[60:63]
ds_read_b64_tr_b16 a[62:63], v211 offset:51200
s_add_u32 m0, s34, 89600
v_mfma_f32_16x16x32_bf16 v[184:187], a[24:27], v[216:219], v[184:187]
ds_read_b64_tr_b16 a[64:65], v212 offset:49152
buffer_load_dwordx4 v2, s[8:11], s31 offen offset:512 lds
s_waitcnt lgkmcnt(15)
v_mfma_f32_16x16x32_bf16 v[64:67], a[28:31], a[0:3], v[64:67]
ds_read_b64_tr_b16 a[66:67], v212 offset:51200
v_mfma_f32_16x16x32_bf16 v[68:71], a[28:31], a[4:7], v[68:71]
ds_read_b64_tr_b16 a[68:69], v213 offset:49152
s_add_u32 s63, s62, 2625536
s_add_u32 m0, s34, 94208
v_mfma_f32_16x16x32_bf16 v[72:75], a[28:31], a[8:11], v[72:75]
ds_read_b64_tr_b16 a[70:71], v213 offset:51200
buffer_load_dwordx4 v3, s[12:15], s63 offen lds
v_mfma_f32_16x16x32_bf16 v[76:79], a[28:31], a[12:15], v[76:79]
v_mfma_f32_16x16x32_bf16 v[188:191], a[28:31], v[216:219], v[188:191]
s_waitcnt lgkmcnt(15)
v_mfma_f32_16x16x32_bf16 v[80:83], a[32:35], a[0:3], v[80:83]
v_mfma_f32_16x16x32_bf16 v[84:87], a[32:35], a[4:7], v[84:87]
v_mfma_f32_16x16x32_bf16 v[88:91], a[32:35], a[8:11], v[88:91]
v_mfma_f32_16x16x32_bf16 v[92:95], a[32:35], a[12:15], v[92:95]
v_mfma_f32_16x16x32_bf16 v[192:195], a[32:35], v[216:219], v[192:195]
s_waitcnt vmcnt(18)
s_barrier
s_waitcnt lgkmcnt(14)
v_mfma_f32_16x16x32_bf16 v[96:99], a[52:55], a[36:39], v[96:99]
ds_read_b64_tr_b16 a[16:17], v200 offset:0
s_waitcnt lgkmcnt(13)
v_mfma_f32_16x16x32_bf16 v[100:103], a[52:55], a[40:43], v[100:103]
ds_read_b64_tr_b16 a[18:19], v200 offset:2048
s_add_u32 s31, s61, 450560
s_add_u32 m0, s34, 98304
s_waitcnt lgkmcnt(12)
v_mfma_f32_16x16x32_bf16 v[104:107], a[52:55], a[44:47], v[104:107]
ds_read_b64_tr_b16 a[0:1], v196 offset:0
buffer_load_dwordx4 v2, s[8:11], s31 offen offset:0 lds
s_waitcnt lgkmcnt(11)
v_mfma_f32_16x16x32_bf16 v[108:111], a[52:55], a[48:51], v[108:111]
ds_read_b64_tr_b16 a[2:3], v196 offset:2048
s_waitcnt lgkmcnt(10)
v_mfma_f32_16x16x32_bf16 v[112:115], a[56:59], a[36:39], v[112:115]
ds_read_b64_tr_b16 a[4:5], v197 offset:0
s_add_u32 m0, s34, 102272
v_mfma_f32_16x16x32_bf16 v[116:119], a[56:59], a[40:43], v[116:119]
ds_read_b64_tr_b16 a[6:7], v197 offset:2048
buffer_load_dwordx4 v2, s[8:11], s31 offen offset:128 lds
v_mfma_f32_16x16x32_bf16 v[120:123], a[56:59], a[44:47], v[120:123]
ds_read_b64_tr_b16 a[8:9], v198 offset:0
v_mfma_f32_16x16x32_bf16 v[124:127], a[56:59], a[48:51], v[124:127]
ds_read_b64_tr_b16 a[10:11], v198 offset:2048
s_add_u32 m0, s34, 106240
s_waitcnt lgkmcnt(12)
v_mfma_f32_16x16x32_bf16 v[128:131], a[60:63], a[36:39], v[128:131]
ds_read_b64_tr_b16 a[12:13], v199 offset:0
buffer_load_dwordx4 v2, s[8:11], s31 offen offset:256 lds
v_mfma_f32_16x16x32_bf16 v[132:135], a[60:63], a[40:43], v[132:135]
ds_read_b64_tr_b16 a[14:15], v199 offset:2048
v_mfma_f32_16x16x32_bf16 v[136:139], a[60:63], a[44:47], v[136:139]
ds_read_b64_tr_b16 a[20:21], v201 offset:0
s_add_u32 m0, s34, 110208
v_mfma_f32_16x16x32_bf16 v[140:143], a[60:63], a[48:51], v[140:143]
ds_read_b64_tr_b16 a[22:23], v201 offset:2048
buffer_load_dwordx4 v2, s[8:11], s31 offen offset:384 lds
s_waitcnt lgkmcnt(14)
v_mfma_f32_16x16x32_bf16 v[144:147], a[64:67], a[36:39], v[144:147]
ds_read_b64_tr_b16 a[24:25], v202 offset:0
v_mfma_f32_16x16x32_bf16 v[148:151], a[64:67], a[40:43], v[148:151]
ds_read_b64_tr_b16 a[26:27], v202 offset:2048
s_add_u32 m0, s34, 114176
v_mfma_f32_16x16x32_bf16 v[152:155], a[64:67], a[44:47], v[152:155]
ds_read_b64_tr_b16 a[28:29], v203 offset:0
buffer_load_dwordx4 v2, s[8:11], s31 offen offset:512 lds
v_mfma_f32_16x16x32_bf16 v[156:159], a[64:67], a[48:51], v[156:159]
ds_read_b64_tr_b16 a[30:31], v203 offset:2048
s_waitcnt lgkmcnt(15)
v_mfma_f32_16x16x32_bf16 v[160:163], a[68:71], a[36:39], v[160:163]
ds_read_b64_tr_b16 a[32:33], v204 offset:0
s_add_u32 s63, s62, 2883584
s_add_u32 m0, s34, 118784
v_mfma_f32_16x16x32_bf16 v[164:167], a[68:71], a[40:43], v[164:167]
ds_read_b64_tr_b16 a[34:35], v204 offset:2048
buffer_load_dwordx4 v3, s[12:15], s63 offen lds
v_mfma_f32_16x16x32_bf16 v[168:171], a[68:71], a[44:47], v[168:171]
v_mfma_f32_16x16x32_bf16 v[172:175], a[68:71], a[48:51], v[172:175]
s_waitcnt vmcnt(18)
s_barrier
s_waitcnt lgkmcnt(14)
v_mfma_f32_16x16x32_bf16 v[16:19], a[16:19], a[0:3], v[16:19]
ds_read_b64_tr_b16 a[52:53], v200 offset:24576
s_waitcnt lgkmcnt(13)
v_mfma_f32_16x16x32_bf16 v[20:23], a[16:19], a[4:7], v[20:23]
ds_read_b64_tr_b16 a[54:55], v200 offset:26624
s_add_u32 s31, s61, 451200
s_add_u32 m0, s34, 122880
s_waitcnt lgkmcnt(12)
v_mfma_f32_16x16x32_bf16 v[24:27], a[16:19], a[8:11], v[24:27]
ds_read_b64_tr_b16 a[36:37], v196 offset:24576
buffer_load_dwordx4 v2, s[8:11], s31 offen offset:0 lds
s_waitcnt lgkmcnt(11)
v_mfma_f32_16x16x32_bf16 v[28:31], a[16:19], a[12:15], v[28:31]
ds_read_b64_tr_b16 a[38:39], v196 offset:26624
v_mfma_f32_16x16x32_bf16 v[176:179], a[16:19], v[216:219], v[176:179]
ds_read_b64_tr_b16 a[40:41], v197 offset:24576
s_add_u32 m0, s34, 126848
s_waitcnt lgkmcnt(11)
v_mfma_f32_16x16x32_bf16 v[32:35], a[20:23], a[0:3], v[32:35]
ds_read_b64_tr_b16 a[42:43], v197 offset:26624
buffer_load_dwordx4 v2, s[8:11], s31 offen offset:128 lds
v_mfma_f32_16x16x32_bf16 v[36:39], a[20:23], a[4:7], v[36:39]
ds_read_b64_tr_b16 a[44:45], v198 offset:24576
v_mfma_f32_16x16x32_bf16 v[40:43], a[20:23], a[8:11], v[40:43]
ds_read_b64_tr_b16 a[46:47], v198 offset:26624
s_add_u32 m0, s34, 130816
v_mfma_f32_16x16x32_bf16 v[44:47], a[20:23], a[12:15], v[44:47]
ds_read_b64_tr_b16 a[48:49], v199 offset:24576
buffer_load_dwordx4 v2, s[8:11], s31 offen offset:256 lds
v_mfma_f32_16x16x32_bf16 v[180:183], a[20:23], v[216:219], v[180:183]
ds_read_b64_tr_b16 a[50:51], v199 offset:26624
s_waitcnt lgkmcnt(14)
v_mfma_f32_16x16x32_bf16 v[48:51], a[24:27], a[0:3], v[48:51]
ds_read_b64_tr_b16 a[56:57], v201 offset:24576
s_add_u32 m0, s34, 134784
v_mfma_f32_16x16x32_bf16 v[52:55], a[24:27], a[4:7], v[52:55]
ds_read_b64_tr_b16 a[58:59], v201 offset:26624
buffer_load_dwordx4 v2, s[8:11], s31 offen offset:384 lds
v_mfma_f32_16x16x32_bf16 v[56:59], a[24:27], a[8:11], v[56:59]
ds_read_b64_tr_b16 a[60:61], v202 offset:24576
v_mfma_f32_16x16x32_bf16 v[60:63], a[24:27], a[12:15], v[60:63]
ds_read_b64_tr_b16 a[62:63], v202 offset:26624
s_add_u32 m0, s34, 138752
v_mfma_f32_16x16x32_bf16 v[184:187], a[24:27], v[216:219], v[184:187]
ds_read_b64_tr_b16 a[64:65], v203 offset:24576
buffer_load_dwordx4 v2, s[8:11], s31 offen offset:512 lds
s_waitcnt lgkmcnt(15)
v_mfma_f32_16x16x32_bf16 v[64:67], a[28:31], a[0:3], v[64:67]
ds_read_b64_tr_b16 a[66:67], v203 offset:26624
v_mfma_f32_16x16x32_bf16 v[68:71], a[28:31], a[4:7], v[68:71]
ds_read_b64_tr_b16 a[68:69], v204 offset:24576
s_add_u32 s63, s62, 2887680
s_add_u32 m0, s34, 143360
v_mfma_f32_16x16x32_bf16 v[72:75], a[28:31], a[8:11], v[72:75]
ds_read_b64_tr_b16 a[70:71], v204 offset:26624
buffer_load_dwordx4 v3, s[12:15], s63 offen lds
v_mfma_f32_16x16x32_bf16 v[76:79], a[28:31], a[12:15], v[76:79]
v_mfma_f32_16x16x32_bf16 v[188:191], a[28:31], v[216:219], v[188:191]
global_load_dword v254, v[250:251], off
s_waitcnt lgkmcnt(15)
v_mfma_f32_16x16x32_bf16 v[80:83], a[32:35], a[0:3], v[80:83]
v_mfma_f32_16x16x32_bf16 v[84:87], a[32:35], a[4:7], v[84:87]
v_mfma_f32_16x16x32_bf16 v[88:91], a[32:35], a[8:11], v[88:91]
v_mfma_f32_16x16x32_bf16 v[92:95], a[32:35], a[12:15], v[92:95]
v_mfma_f32_16x16x32_bf16 v[192:195], a[32:35], v[216:219], v[192:195]
s_waitcnt vmcnt(19)
s_barrier
s_waitcnt lgkmcnt(14)
v_mfma_f32_16x16x32_bf16 v[96:99], a[52:55], a[36:39], v[96:99]
ds_read_b64_tr_b16 a[16:17], v200 offset:49152
s_waitcnt lgkmcnt(13)
v_mfma_f32_16x16x32_bf16 v[100:103], a[52:55], a[40:43], v[100:103]
ds_read_b64_tr_b16 a[18:19], v200 offset:51200
s_add_u32 s31, s61, 491520
s_add_u32 m0, s34, 0
s_waitcnt lgkmcnt(12)
v_mfma_f32_16x16x32_bf16 v[104:107], a[52:55], a[44:47], v[104:107]
ds_read_b64_tr_b16 a[0:1], v196 offset:49152
buffer_load_dwordx4 v2, s[8:11], s31 offen offset:0 lds
s_waitcnt lgkmcnt(11)
v_mfma_f32_16x16x32_bf16 v[108:111], a[52:55], a[48:51], v[108:111]
ds_read_b64_tr_b16 a[2:3], v196 offset:51200
s_waitcnt lgkmcnt(10)
v_mfma_f32_16x16x32_bf16 v[112:115], a[56:59], a[36:39], v[112:115]
ds_read_b64_tr_b16 a[4:5], v197 offset:49152
s_add_u32 m0, s34, 3968
v_mfma_f32_16x16x32_bf16 v[116:119], a[56:59], a[40:43], v[116:119]
ds_read_b64_tr_b16 a[6:7], v197 offset:51200
buffer_load_dwordx4 v2, s[8:11], s31 offen offset:128 lds
v_mfma_f32_16x16x32_bf16 v[120:123], a[56:59], a[44:47], v[120:123]
ds_read_b64_tr_b16 a[8:9], v198 offset:49152
v_mfma_f32_16x16x32_bf16 v[124:127], a[56:59], a[48:51], v[124:127]
ds_read_b64_tr_b16 a[10:11], v198 offset:51200
s_add_u32 m0, s34, 7936
s_waitcnt lgkmcnt(12)
v_mfma_f32_16x16x32_bf16 v[128:131], a[60:63], a[36:39], v[128:131]
ds_read_b64_tr_b16 a[12:13], v199 offset:49152
buffer_load_dwordx4 v2, s[8:11], s31 offen offset:256 lds
v_mfma_f32_16x16x32_bf16 v[132:135], a[60:63], a[40:43], v[132:135]
ds_read_b64_tr_b16 a[14:15], v199 offset:51200
v_mfma_f32_16x16x32_bf16 v[136:139], a[60:63], a[44:47], v[136:139]
ds_read_b64_tr_b16 a[20:21], v201 offset:49152
s_add_u32 m0, s34, 11904
v_mfma_f32_16x16x32_bf16 v[140:143], a[60:63], a[48:51], v[140:143]
ds_read_b64_tr_b16 a[22:23], v201 offset:51200
buffer_load_dwordx4 v2, s[8:11], s31 offen offset:384 lds
s_waitcnt lgkmcnt(14)
v_mfma_f32_16x16x32_bf16 v[144:147], a[64:67], a[36:39], v[144:147]
ds_read_b64_tr_b16 a[24:25], v202 offset:49152
v_mfma_f32_16x16x32_bf16 v[148:151], a[64:67], a[40:43], v[148:151]
ds_read_b64_tr_b16 a[26:27], v202 offset:51200
s_add_u32 m0, s34, 15872
v_mfma_f32_16x16x32_bf16 v[152:155], a[64:67], a[44:47], v[152:155]
ds_read_b64_tr_b16 a[28:29], v203 offset:49152
buffer_load_dwordx4 v2, s[8:11], s31 offen offset:512 lds
v_mfma_f32_16x16x32_bf16 v[156:159], a[64:67], a[48:51], v[156:159]
ds_read_b64_tr_b16 a[30:31], v203 offset:51200
s_waitcnt lgkmcnt(15)
v_mfma_f32_16x16x32_bf16 v[160:163], a[68:71], a[36:39], v[160:163]
ds_read_b64_tr_b16 a[32:33], v204 offset:49152
s_add_u32 s63, s62, 3145728
s_add_u32 m0, s34, 20480
v_mfma_f32_16x16x32_bf16 v[164:167], a[68:71], a[40:43], v[164:167]
ds_read_b64_tr_b16 a[34:35], v204 offset:51200
buffer_load_dwordx4 v3, s[12:15], s63 offen lds
v_mfma_f32_16x16x32_bf16 v[168:171], a[68:71], a[44:47], v[168:171]
v_mfma_f32_16x16x32_bf16 v[172:175], a[68:71], a[48:51], v[172:175]
s_waitcnt vmcnt(19)
s_barrier
s_waitcnt lgkmcnt(14)
v_mfma_f32_16x16x32_bf16 v[16:19], a[16:19], a[0:3], v[16:19]
ds_read_b64_tr_b16 a[52:53], v209 offset:0
s_waitcnt lgkmcnt(13)
v_mfma_f32_16x16x32_bf16 v[20:23], a[16:19], a[4:7], v[20:23]
ds_read_b64_tr_b16 a[54:55], v209 offset:2048
s_add_u32 s31, s61, 492160
s_add_u32 m0, s34, 24576
s_waitcnt lgkmcnt(12)
v_mfma_f32_16x16x32_bf16 v[24:27], a[16:19], a[8:11], v[24:27]
ds_read_b64_tr_b16 a[36:37], v205 offset:0
buffer_load_dwordx4 v2, s[8:11], s31 offen offset:0 lds
s_waitcnt lgkmcnt(11)
v_mfma_f32_16x16x32_bf16 v[28:31], a[16:19], a[12:15], v[28:31]
ds_read_b64_tr_b16 a[38:39], v205 offset:2048
v_mfma_f32_16x16x32_bf16 v[176:179], a[16:19], v[216:219], v[176:179]
ds_read_b64_tr_b16 a[40:41], v206 offset:0
s_add_u32 m0, s34, 28544
s_waitcnt lgkmcnt(11)
v_mfma_f32_16x16x32_bf16 v[32:35], a[20:23], a[0:3], v[32:35]
ds_read_b64_tr_b16 a[42:43], v206 offset:2048
buffer_load_dwordx4 v2, s[8:11], s31 offen offset:128 lds
v_mfma_f32_16x16x32_bf16 v[36:39], a[20:23], a[4:7], v[36:39]
ds_read_b64_tr_b16 a[44:45], v207 offset:0
v_mfma_f32_16x16x32_bf16 v[40:43], a[20:23], a[8:11], v[40:43]
ds_read_b64_tr_b16 a[46:47], v207 offset:2048
s_add_u32 m0, s34, 32512
v_mfma_f32_16x16x32_bf16 v[44:47], a[20:23], a[12:15], v[44:47]
ds_read_b64_tr_b16 a[48:49], v208 offset:0
buffer_load_dwordx4 v2, s[8:11], s31 offen offset:256 lds
v_mfma_f32_16x16x32_bf16 v[180:183], a[20:23], v[216:219], v[180:183]
ds_read_b64_tr_b16 a[50:51], v208 offset:2048
s_waitcnt lgkmcnt(14)
v_mfma_f32_16x16x32_bf16 v[48:51], a[24:27], a[0:3], v[48:51]
ds_read_b64_tr_b16 a[56:57], v210 offset:0
s_add_u32 m0, s34, 36480
v_mfma_f32_16x16x32_bf16 v[52:55], a[24:27], a[4:7], v[52:55]
ds_read_b64_tr_b16 a[58:59], v210 offset:2048
buffer_load_dwordx4 v2, s[8:11], s31 offen offset:384 lds
v_mfma_f32_16x16x32_bf16 v[56:59], a[24:27], a[8:11], v[56:59]
ds_read_b64_tr_b16 a[60:61], v211 offset:0
v_mfma_f32_16x16x32_bf16 v[60:63], a[24:27], a[12:15], v[60:63]
ds_read_b64_tr_b16 a[62:63], v211 offset:2048
s_add_u32 m0, s34, 40448
v_mfma_f32_16x16x32_bf16 v[184:187], a[24:27], v[216:219], v[184:187]
ds_read_b64_tr_b16 a[64:65], v212 offset:0
buffer_load_dwordx4 v2, s[8:11], s31 offen offset:512 lds
s_waitcnt lgkmcnt(15)
v_mfma_f32_16x16x32_bf16 v[64:67], a[28:31], a[0:3], v[64:67]
ds_read_b64_tr_b16 a[66:67], v212 offset:2048
v_mfma_f32_16x16x32_bf16 v[68:71], a[28:31], a[4:7], v[68:71]
ds_read_b64_tr_b16 a[68:69], v213 offset:0
s_add_u32 s63, s62, 3149824
s_add_u32 m0, s34, 45056
v_mfma_f32_16x16x32_bf16 v[72:75], a[28:31], a[8:11], v[72:75]
ds_read_b64_tr_b16 a[70:71], v213 offset:2048
buffer_load_dwordx4 v3, s[12:15], s63 offen lds
v_mfma_f32_16x16x32_bf16 v[76:79], a[28:31], a[12:15], v[76:79]
v_mfma_f32_16x16x32_bf16 v[188:191], a[28:31], v[216:219], v[188:191]
s_waitcnt lgkmcnt(15)
v_mfma_f32_16x16x32_bf16 v[80:83], a[32:35], a[0:3], v[80:83]
v_mfma_f32_16x16x32_bf16 v[84:87], a[32:35], a[4:7], v[84:87]
v_mfma_f32_16x16x32_bf16 v[88:91], a[32:35], a[8:11], v[88:91]
v_mfma_f32_16x16x32_bf16 v[92:95], a[32:35], a[12:15], v[92:95]
v_mfma_f32_16x16x32_bf16 v[192:195], a[32:35], v[216:219], v[192:195]
s_waitcnt vmcnt(19)
s_barrier
s_waitcnt lgkmcnt(14)
v_mfma_f32_16x16x32_bf16 v[96:99], a[52:55], a[36:39], v[96:99]
ds_read_b64_tr_b16 a[16:17], v209 offset:24576
s_waitcnt lgkmcnt(13)
v_mfma_f32_16x16x32_bf16 v[100:103], a[52:55], a[40:43], v[100:103]
ds_read_b64_tr_b16 a[18:19], v209 offset:26624
s_add_u32 s31, s61, 532480
s_add_u32 m0, s34, 49152
s_waitcnt lgkmcnt(12)
v_mfma_f32_16x16x32_bf16 v[104:107], a[52:55], a[44:47], v[104:107]
ds_read_b64_tr_b16 a[0:1], v205 offset:24576
buffer_load_dwordx4 v2, s[8:11], s31 offen offset:0 lds
s_waitcnt lgkmcnt(11)
v_mfma_f32_16x16x32_bf16 v[108:111], a[52:55], a[48:51], v[108:111]
ds_read_b64_tr_b16 a[2:3], v205 offset:26624
s_waitcnt lgkmcnt(10)
v_mfma_f32_16x16x32_bf16 v[112:115], a[56:59], a[36:39], v[112:115]
ds_read_b64_tr_b16 a[4:5], v206 offset:24576
s_add_u32 m0, s34, 53120
v_mfma_f32_16x16x32_bf16 v[116:119], a[56:59], a[40:43], v[116:119]
ds_read_b64_tr_b16 a[6:7], v206 offset:26624
buffer_load_dwordx4 v2, s[8:11], s31 offen offset:128 lds
v_mfma_f32_16x16x32_bf16 v[120:123], a[56:59], a[44:47], v[120:123]
ds_read_b64_tr_b16 a[8:9], v207 offset:24576
v_mfma_f32_16x16x32_bf16 v[124:127], a[56:59], a[48:51], v[124:127]
ds_read_b64_tr_b16 a[10:11], v207 offset:26624
s_add_u32 m0, s34, 57088
s_waitcnt lgkmcnt(12)
v_mfma_f32_16x16x32_bf16 v[128:131], a[60:63], a[36:39], v[128:131]
ds_read_b64_tr_b16 a[12:13], v208 offset:24576
buffer_load_dwordx4 v2, s[8:11], s31 offen offset:256 lds
v_mfma_f32_16x16x32_bf16 v[132:135], a[60:63], a[40:43], v[132:135]
ds_read_b64_tr_b16 a[14:15], v208 offset:26624
v_mfma_f32_16x16x32_bf16 v[136:139], a[60:63], a[44:47], v[136:139]
ds_read_b64_tr_b16 a[20:21], v210 offset:24576
s_add_u32 m0, s34, 61056
v_mfma_f32_16x16x32_bf16 v[140:143], a[60:63], a[48:51], v[140:143]
ds_read_b64_tr_b16 a[22:23], v210 offset:26624
buffer_load_dwordx4 v2, s[8:11], s31 offen offset:384 lds
s_waitcnt lgkmcnt(14)
v_mfma_f32_16x16x32_bf16 v[144:147], a[64:67], a[36:39], v[144:147]
ds_read_b64_tr_b16 a[24:25], v211 offset:24576
v_mfma_f32_16x16x32_bf16 v[148:151], a[64:67], a[40:43], v[148:151]
ds_read_b64_tr_b16 a[26:27], v211 offset:26624
s_add_u32 m0, s34, 65024
v_mfma_f32_16x16x32_bf16 v[152:155], a[64:67], a[44:47], v[152:155]
ds_read_b64_tr_b16 a[28:29], v212 offset:24576
buffer_load_dwordx4 v2, s[8:11], s31 offen offset:512 lds
v_mfma_f32_16x16x32_bf16 v[156:159], a[64:67], a[48:51], v[156:159]
ds_read_b64_tr_b16 a[30:31], v212 offset:26624
s_waitcnt lgkmcnt(15)
v_mfma_f32_16x16x32_bf16 v[160:163], a[68:71], a[36:39], v[160:163]
ds_read_b64_tr_b16 a[32:33], v213 offset:24576
s_add_u32 s63, s62, 3407872
s_add_u32 m0, s34, 69632
v_mfma_f32_16x16x32_bf16 v[164:167], a[68:71], a[40:43], v[164:167]
ds_read_b64_tr_b16 a[34:35], v213 offset:26624
buffer_load_dwordx4 v3, s[12:15], s63 offen lds
v_mfma_f32_16x16x32_bf16 v[168:171], a[68:71], a[44:47], v[168:171]
v_mfma_f32_16x16x32_bf16 v[172:175], a[68:71], a[48:51], v[172:175]
s_waitcnt vmcnt(19)
s_barrier
s_waitcnt lgkmcnt(14)
v_mfma_f32_16x16x32_bf16 v[16:19], a[16:19], a[0:3], v[16:19]
ds_read_b64_tr_b16 a[52:53], v209 offset:49152
s_waitcnt lgkmcnt(13)
v_mfma_f32_16x16x32_bf16 v[20:23], a[16:19], a[4:7], v[20:23]
ds_read_b64_tr_b16 a[54:55], v209 offset:51200
s_add_u32 s31, s61, 533120
s_add_u32 m0, s34, 73728
s_waitcnt lgkmcnt(12)
v_mfma_f32_16x16x32_bf16 v[24:27], a[16:19], a[8:11], v[24:27]
ds_read_b64_tr_b16 a[36:37], v205 offset:49152
buffer_load_dwordx4 v2, s[8:11], s31 offen offset:0 lds
s_waitcnt lgkmcnt(11)
v_mfma_f32_16x16x32_bf16 v[28:31], a[16:19], a[12:15], v[28:31]
ds_read_b64_tr_b16 a[38:39], v205 offset:51200
v_mfma_f32_16x16x32_bf16 v[176:179], a[16:19], v[216:219], v[176:179]
ds_read_b64_tr_b16 a[40:41], v206 offset:49152
s_add_u32 m0, s34, 77696
s_waitcnt lgkmcnt(11)
v_mfma_f32_16x16x32_bf16 v[32:35], a[20:23], a[0:3], v[32:35]
ds_read_b64_tr_b16 a[42:43], v206 offset:51200
buffer_load_dwordx4 v2, s[8:11], s31 offen offset:128 lds
v_mfma_f32_16x16x32_bf16 v[36:39], a[20:23], a[4:7], v[36:39]
ds_read_b64_tr_b16 a[44:45], v207 offset:49152
v_mfma_f32_16x16x32_bf16 v[40:43], a[20:23], a[8:11], v[40:43]
ds_read_b64_tr_b16 a[46:47], v207 offset:51200
s_add_u32 m0, s34, 81664
v_mfma_f32_16x16x32_bf16 v[44:47], a[20:23], a[12:15], v[44:47]
ds_read_b64_tr_b16 a[48:49], v208 offset:49152
buffer_load_dwordx4 v2, s[8:11], s31 offen offset:256 lds
v_mfma_f32_16x16x32_bf16 v[180:183], a[20:23], v[216:219], v[180:183]
ds_read_b64_tr_b16 a[50:51], v208 offset:51200
s_waitcnt lgkmcnt(14)
v_mfma_f32_16x16x32_bf16 v[48:51], a[24:27], a[0:3], v[48:51]
ds_read_b64_tr_b16 a[56:57], v210 offset:49152
s_add_u32 m0, s34, 85632
v_mfma_f32_16x16x32_bf16 v[52:55], a[24:27], a[4:7], v[52:55]
ds_read_b64_tr_b16 a[58:59], v210 offset:51200
buffer_load_dwordx4 v2, s[8:11], s31 offen offset:384 lds
v_mfma_f32_16x16x32_bf16 v[56:59], a[24:27], a[8:11], v[56:59]
ds_read_b64_tr_b16 a[60:61], v211 offset:49152
v_mfma_f32_16x16x32_bf16 v[60:63], a[24:27], a[12:15], v[60:63]
ds_read_b64_tr_b16 a[62:63], v211 offset:51200
s_add_u32 m0, s34, 89600
v_mfma_f32_16x16x32_bf16 v[184:187], a[24:27], v[216:219], v[184:187]
ds_read_b64_tr_b16 a[64:65], v212 offset:49152
buffer_load_dwordx4 v2, s[8:11], s31 offen offset:512 lds
s_waitcnt lgkmcnt(15)
v_mfma_f32_16x16x32_bf16 v[64:67], a[28:31], a[0:3], v[64:67]
ds_read_b64_tr_b16 a[66:67], v212 offset:51200
v_mfma_f32_16x16x32_bf16 v[68:71], a[28:31], a[4:7], v[68:71]
ds_read_b64_tr_b16 a[68:69], v213 offset:49152
s_add_u32 s63, s62, 3411968
s_add_u32 m0, s34, 94208
v_mfma_f32_16x16x32_bf16 v[72:75], a[28:31], a[8:11], v[72:75]
ds_read_b64_tr_b16 a[70:71], v213 offset:51200
buffer_load_dwordx4 v3, s[12:15], s63 offen lds
v_mfma_f32_16x16x32_bf16 v[76:79], a[28:31], a[12:15], v[76:79]
v_mfma_f32_16x16x32_bf16 v[188:191], a[28:31], v[216:219], v[188:191]
s_waitcnt lgkmcnt(15)
v_mfma_f32_16x16x32_bf16 v[80:83], a[32:35], a[0:3], v[80:83]
v_mfma_f32_16x16x32_bf16 v[84:87], a[32:35], a[4:7], v[84:87]
v_mfma_f32_16x16x32_bf16 v[88:91], a[32:35], a[8:11], v[88:91]
v_mfma_f32_16x16x32_bf16 v[92:95], a[32:35], a[12:15], v[92:95]
v_mfma_f32_16x16x32_bf16 v[192:195], a[32:35], v[216:219], v[192:195]
s_waitcnt vmcnt(18)
s_barrier
s_waitcnt lgkmcnt(14)
v_mfma_f32_16x16x32_bf16 v[96:99], a[52:55], a[36:39], v[96:99]
ds_read_b64_tr_b16 a[16:17], v200 offset:0
s_waitcnt lgkmcnt(13)
v_mfma_f32_16x16x32_bf16 v[100:103], a[52:55], a[40:43], v[100:103]
ds_read_b64_tr_b16 a[18:19], v200 offset:2048
s_add_u32 s31, s61, 573440
s_add_u32 m0, s34, 98304
s_waitcnt lgkmcnt(12)
v_mfma_f32_16x16x32_bf16 v[104:107], a[52:55], a[44:47], v[104:107]
ds_read_b64_tr_b16 a[0:1], v196 offset:0
buffer_load_dwordx4 v2, s[8:11], s31 offen offset:0 lds
s_waitcnt lgkmcnt(11)
v_mfma_f32_16x16x32_bf16 v[108:111], a[52:55], a[48:51], v[108:111]
ds_read_b64_tr_b16 a[2:3], v196 offset:2048
s_waitcnt lgkmcnt(10)
v_mfma_f32_16x16x32_bf16 v[112:115], a[56:59], a[36:39], v[112:115]
ds_read_b64_tr_b16 a[4:5], v197 offset:0
s_add_u32 m0, s34, 102272
v_mfma_f32_16x16x32_bf16 v[116:119], a[56:59], a[40:43], v[116:119]
ds_read_b64_tr_b16 a[6:7], v197 offset:2048
buffer_load_dwordx4 v2, s[8:11], s31 offen offset:128 lds
v_mfma_f32_16x16x32_bf16 v[120:123], a[56:59], a[44:47], v[120:123]
ds_read_b64_tr_b16 a[8:9], v198 offset:0
v_mfma_f32_16x16x32_bf16 v[124:127], a[56:59], a[48:51], v[124:127]
ds_read_b64_tr_b16 a[10:11], v198 offset:2048
s_add_u32 m0, s34, 106240
s_waitcnt lgkmcnt(12)
v_mfma_f32_16x16x32_bf16 v[128:131], a[60:63], a[36:39], v[128:131]
ds_read_b64_tr_b16 a[12:13], v199 offset:0
buffer_load_dwordx4 v2, s[8:11], s31 offen offset:256 lds
v_mfma_f32_16x16x32_bf16 v[132:135], a[60:63], a[40:43], v[132:135]
ds_read_b64_tr_b16 a[14:15], v199 offset:2048
v_mfma_f32_16x16x32_bf16 v[136:139], a[60:63], a[44:47], v[136:139]
ds_read_b64_tr_b16 a[20:21], v201 offset:0
s_add_u32 m0, s34, 110208
v_mfma_f32_16x16x32_bf16 v[140:143], a[60:63], a[48:51], v[140:143]
ds_read_b64_tr_b16 a[22:23], v201 offset:2048
buffer_load_dwordx4 v2, s[8:11], s31 offen offset:384 lds
s_waitcnt lgkmcnt(14)
v_mfma_f32_16x16x32_bf16 v[144:147], a[64:67], a[36:39], v[144:147]
ds_read_b64_tr_b16 a[24:25], v202 offset:0
v_mfma_f32_16x16x32_bf16 v[148:151], a[64:67], a[40:43], v[148:151]
ds_read_b64_tr_b16 a[26:27], v202 offset:2048
s_add_u32 m0, s34, 114176
v_mfma_f32_16x16x32_bf16 v[152:155], a[64:67], a[44:47], v[152:155]
ds_read_b64_tr_b16 a[28:29], v203 offset:0
buffer_load_dwordx4 v2, s[8:11], s31 offen offset:512 lds
v_mfma_f32_16x16x32_bf16 v[156:159], a[64:67], a[48:51], v[156:159]
ds_read_b64_tr_b16 a[30:31], v203 offset:2048
s_waitcnt lgkmcnt(15)
v_mfma_f32_16x16x32_bf16 v[160:163], a[68:71], a[36:39], v[160:163]
ds_read_b64_tr_b16 a[32:33], v204 offset:0
s_add_u32 s63, s62, 3670016
s_add_u32 m0, s34, 118784
v_mfma_f32_16x16x32_bf16 v[164:167], a[68:71], a[40:43], v[164:167]
ds_read_b64_tr_b16 a[34:35], v204 offset:2048
buffer_load_dwordx4 v3, s[12:15], s63 offen lds
v_mfma_f32_16x16x32_bf16 v[168:171], a[68:71], a[44:47], v[168:171]
v_mfma_f32_16x16x32_bf16 v[172:175], a[68:71], a[48:51], v[172:175]
s_waitcnt vmcnt(18)
s_barrier
s_waitcnt lgkmcnt(14)
v_mfma_f32_16x16x32_bf16 v[16:19], a[16:19], a[0:3], v[16:19]
ds_read_b64_tr_b16 a[52:53], v200 offset:24576
s_waitcnt lgkmcnt(13)
v_mfma_f32_16x16x32_bf16 v[20:23], a[16:19], a[4:7], v[20:23]
ds_read_b64_tr_b16 a[54:55], v200 offset:26624
s_add_u32 s31, s61, 574080
s_add_u32 m0, s34, 122880
s_waitcnt lgkmcnt(12)
v_mfma_f32_16x16x32_bf16 v[24:27], a[16:19], a[8:11], v[24:27]
ds_read_b64_tr_b16 a[36:37], v196 offset:24576
buffer_load_dwordx4 v2, s[8:11], s31 offen offset:0 lds
s_waitcnt lgkmcnt(11)
v_mfma_f32_16x16x32_bf16 v[28:31], a[16:19], a[12:15], v[28:31]
ds_read_b64_tr_b16 a[38:39], v196 offset:26624
v_mfma_f32_16x16x32_bf16 v[176:179], a[16:19], v[216:219], v[176:179]
ds_read_b64_tr_b16 a[40:41], v197 offset:24576
s_add_u32 m0, s34, 126848
s_waitcnt lgkmcnt(11)
v_mfma_f32_16x16x32_bf16 v[32:35], a[20:23], a[0:3], v[32:35]
ds_read_b64_tr_b16 a[42:43], v197 offset:26624
buffer_load_dwordx4 v2, s[8:11], s31 offen offset:128 lds
v_mfma_f32_16x16x32_bf16 v[36:39], a[20:23], a[4:7], v[36:39]
ds_read_b64_tr_b16 a[44:45], v198 offset:24576
v_mfma_f32_16x16x32_bf16 v[40:43], a[20:23], a[8:11], v[40:43]
ds_read_b64_tr_b16 a[46:47], v198 offset:26624
s_add_u32 m0, s34, 130816
v_mfma_f32_16x16x32_bf16 v[44:47], a[20:23], a[12:15], v[44:47]
ds_read_b64_tr_b16 a[48:49], v199 offset:24576
buffer_load_dwordx4 v2, s[8:11], s31 offen offset:256 lds
v_mfma_f32_16x16x32_bf16 v[180:183], a[20:23], v[216:219], v[180:183]
ds_read_b64_tr_b16 a[50:51], v199 offset:26624
s_waitcnt lgkmcnt(14)
v_mfma_f32_16x16x32_bf16 v[48:51], a[24:27], a[0:3], v[48:51]
ds_read_b64_tr_b16 a[56:57], v201 offset:24576
s_add_u32 m0, s34, 134784
v_mfma_f32_16x16x32_bf16 v[52:55], a[24:27], a[4:7], v[52:55]
ds_read_b64_tr_b16 a[58:59], v201 offset:26624
buffer_load_dwordx4 v2, s[8:11], s31 offen offset:384 lds
v_mfma_f32_16x16x32_bf16 v[56:59], a[24:27], a[8:11], v[56:59]
ds_read_b64_tr_b16 a[60:61], v202 offset:24576
v_mfma_f32_16x16x32_bf16 v[60:63], a[24:27], a[12:15], v[60:63]
ds_read_b64_tr_b16 a[62:63], v202 offset:26624
s_add_u32 m0, s34, 138752
v_mfma_f32_16x16x32_bf16 v[184:187], a[24:27], v[216:219], v[184:187]
ds_read_b64_tr_b16 a[64:65], v203 offset:24576
buffer_load_dwordx4 v2, s[8:11], s31 offen offset:512 lds
s_waitcnt lgkmcnt(15)
v_mfma_f32_16x16x32_bf16 v[64:67], a[28:31], a[0:3], v[64:67]
ds_read_b64_tr_b16 a[66:67], v203 offset:26624
v_mfma_f32_16x16x32_bf16 v[68:71], a[28:31], a[4:7], v[68:71]
ds_read_b64_tr_b16 a[68:69], v204 offset:24576
s_add_u32 s63, s62, 3674112
s_add_u32 m0, s34, 143360
v_mfma_f32_16x16x32_bf16 v[72:75], a[28:31], a[8:11], v[72:75]
ds_read_b64_tr_b16 a[70:71], v204 offset:26624
buffer_load_dwordx4 v3, s[12:15], s63 offen lds
v_mfma_f32_16x16x32_bf16 v[76:79], a[28:31], a[12:15], v[76:79]
v_mfma_f32_16x16x32_bf16 v[188:191], a[28:31], v[216:219], v[188:191]
s_waitcnt lgkmcnt(15)
v_mfma_f32_16x16x32_bf16 v[80:83], a[32:35], a[0:3], v[80:83]
v_mfma_f32_16x16x32_bf16 v[84:87], a[32:35], a[4:7], v[84:87]
v_mfma_f32_16x16x32_bf16 v[88:91], a[32:35], a[8:11], v[88:91]
v_mfma_f32_16x16x32_bf16 v[92:95], a[32:35], a[12:15], v[92:95]
v_mfma_f32_16x16x32_bf16 v[192:195], a[32:35], v[216:219], v[192:195]
s_waitcnt vmcnt(18)
s_barrier
s_waitcnt lgkmcnt(14)
v_mfma_f32_16x16x32_bf16 v[96:99], a[52:55], a[36:39], v[96:99]
ds_read_b64_tr_b16 a[16:17], v200 offset:49152
s_waitcnt lgkmcnt(13)
v_mfma_f32_16x16x32_bf16 v[100:103], a[52:55], a[40:43], v[100:103]
ds_read_b64_tr_b16 a[18:19], v200 offset:51200
s_add_u32 s31, s61, 614400
s_add_u32 m0, s34, 0
s_waitcnt lgkmcnt(12)
v_mfma_f32_16x16x32_bf16 v[104:107], a[52:55], a[44:47], v[104:107]
ds_read_b64_tr_b16 a[0:1], v196 offset:49152
buffer_load_dwordx4 v2, s[8:11], s31 offen offset:0 lds
s_waitcnt lgkmcnt(11)
v_mfma_f32_16x16x32_bf16 v[108:111], a[52:55], a[48:51], v[108:111]
ds_read_b64_tr_b16 a[2:3], v196 offset:51200
s_waitcnt lgkmcnt(10)
v_mfma_f32_16x16x32_bf16 v[112:115], a[56:59], a[36:39], v[112:115]
ds_read_b64_tr_b16 a[4:5], v197 offset:49152
s_add_u32 m0, s34, 3968
v_mfma_f32_16x16x32_bf16 v[116:119], a[56:59], a[40:43], v[116:119]
ds_read_b64_tr_b16 a[6:7], v197 offset:51200
buffer_load_dwordx4 v2, s[8:11], s31 offen offset:128 lds
v_mfma_f32_16x16x32_bf16 v[120:123], a[56:59], a[44:47], v[120:123]
ds_read_b64_tr_b16 a[8:9], v198 offset:49152
v_mfma_f32_16x16x32_bf16 v[124:127], a[56:59], a[48:51], v[124:127]
ds_read_b64_tr_b16 a[10:11], v198 offset:51200
s_add_u32 m0, s34, 7936
s_waitcnt lgkmcnt(12)
v_mfma_f32_16x16x32_bf16 v[128:131], a[60:63], a[36:39], v[128:131]
ds_read_b64_tr_b16 a[12:13], v199 offset:49152
buffer_load_dwordx4 v2, s[8:11], s31 offen offset:256 lds
v_mfma_f32_16x16x32_bf16 v[132:135], a[60:63], a[40:43], v[132:135]
ds_read_b64_tr_b16 a[14:15], v199 offset:51200
v_mfma_f32_16x16x32_bf16 v[136:139], a[60:63], a[44:47], v[136:139]
ds_read_b64_tr_b16 a[20:21], v201 offset:49152
s_add_u32 m0, s34, 11904
v_mfma_f32_16x16x32_bf16 v[140:143], a[60:63], a[48:51], v[140:143]
ds_read_b64_tr_b16 a[22:23], v201 offset:51200
buffer_load_dwordx4 v2, s[8:11], s31 offen offset:384 lds
s_waitcnt lgkmcnt(14)
v_mfma_f32_16x16x32_bf16 v[144:147], a[64:67], a[36:39], v[144:147]
ds_read_b64_tr_b16 a[24:25], v202 offset:49152
v_mfma_f32_16x16x32_bf16 v[148:151], a[64:67], a[40:43], v[148:151]
ds_read_b64_tr_b16 a[26:27], v202 offset:51200
s_add_u32 m0, s34, 15872
v_mfma_f32_16x16x32_bf16 v[152:155], a[64:67], a[44:47], v[152:155]
ds_read_b64_tr_b16 a[28:29], v203 offset:49152
buffer_load_dwordx4 v2, s[8:11], s31 offen offset:512 lds
v_mfma_f32_16x16x32_bf16 v[156:159], a[64:67], a[48:51], v[156:159]
ds_read_b64_tr_b16 a[30:31], v203 offset:51200
s_waitcnt lgkmcnt(15)
v_mfma_f32_16x16x32_bf16 v[160:163], a[68:71], a[36:39], v[160:163]
ds_read_b64_tr_b16 a[32:33], v204 offset:49152
s_add_u32 s63, s62, 3932160
s_add_u32 m0, s34, 20480
v_mfma_f32_16x16x32_bf16 v[164:167], a[68:71], a[40:43], v[164:167]
ds_read_b64_tr_b16 a[34:35], v204 offset:51200
buffer_load_dwordx4 v3, s[12:15], s63 offen lds
v_mfma_f32_16x16x32_bf16 v[168:171], a[68:71], a[44:47], v[168:171]
v_mfma_f32_16x16x32_bf16 v[172:175], a[68:71], a[48:51], v[172:175]
s_waitcnt vmcnt(18)
s_barrier
s_waitcnt lgkmcnt(14)
v_mfma_f32_16x16x32_bf16 v[16:19], a[16:19], a[0:3], v[16:19]
ds_read_b64_tr_b16 a[52:53], v209 offset:0
s_waitcnt lgkmcnt(13)
v_mfma_f32_16x16x32_bf16 v[20:23], a[16:19], a[4:7], v[20:23]
ds_read_b64_tr_b16 a[54:55], v209 offset:2048
s_add_u32 s31, s61, 615040
s_add_u32 m0, s34, 24576
s_waitcnt lgkmcnt(12)
v_mfma_f32_16x16x32_bf16 v[24:27], a[16:19], a[8:11], v[24:27]
ds_read_b64_tr_b16 a[36:37], v205 offset:0
buffer_load_dwordx4 v2, s[8:11], s31 offen offset:0 lds
s_waitcnt lgkmcnt(11)
v_mfma_f32_16x16x32_bf16 v[28:31], a[16:19], a[12:15], v[28:31]
ds_read_b64_tr_b16 a[38:39], v205 offset:2048
v_mfma_f32_16x16x32_bf16 v[176:179], a[16:19], v[216:219], v[176:179]
ds_read_b64_tr_b16 a[40:41], v206 offset:0
s_add_u32 m0, s34, 28544
s_waitcnt lgkmcnt(11)
v_mfma_f32_16x16x32_bf16 v[32:35], a[20:23], a[0:3], v[32:35]
ds_read_b64_tr_b16 a[42:43], v206 offset:2048
buffer_load_dwordx4 v2, s[8:11], s31 offen offset:128 lds
v_mfma_f32_16x16x32_bf16 v[36:39], a[20:23], a[4:7], v[36:39]
ds_read_b64_tr_b16 a[44:45], v207 offset:0
v_mfma_f32_16x16x32_bf16 v[40:43], a[20:23], a[8:11], v[40:43]
ds_read_b64_tr_b16 a[46:47], v207 offset:2048
s_add_u32 m0, s34, 32512
v_mfma_f32_16x16x32_bf16 v[44:47], a[20:23], a[12:15], v[44:47]
ds_read_b64_tr_b16 a[48:49], v208 offset:0
buffer_load_dwordx4 v2, s[8:11], s31 offen offset:256 lds
v_mfma_f32_16x16x32_bf16 v[180:183], a[20:23], v[216:219], v[180:183]
ds_read_b64_tr_b16 a[50:51], v208 offset:2048
s_waitcnt lgkmcnt(14)
v_mfma_f32_16x16x32_bf16 v[48:51], a[24:27], a[0:3], v[48:51]
ds_read_b64_tr_b16 a[56:57], v210 offset:0
s_add_u32 m0, s34, 36480
v_mfma_f32_16x16x32_bf16 v[52:55], a[24:27], a[4:7], v[52:55]
ds_read_b64_tr_b16 a[58:59], v210 offset:2048
buffer_load_dwordx4 v2, s[8:11], s31 offen offset:384 lds
v_mfma_f32_16x16x32_bf16 v[56:59], a[24:27], a[8:11], v[56:59]
ds_read_b64_tr_b16 a[60:61], v211 offset:0
v_mfma_f32_16x16x32_bf16 v[60:63], a[24:27], a[12:15], v[60:63]
ds_read_b64_tr_b16 a[62:63], v211 offset:2048
s_add_u32 m0, s34, 40448
v_mfma_f32_16x16x32_bf16 v[184:187], a[24:27], v[216:219], v[184:187]
ds_read_b64_tr_b16 a[64:65], v212 offset:0
buffer_load_dwordx4 v2, s[8:11], s31 offen offset:512 lds
s_waitcnt lgkmcnt(15)
v_mfma_f32_16x16x32_bf16 v[64:67], a[28:31], a[0:3], v[64:67]
ds_read_b64_tr_b16 a[66:67], v212 offset:2048
v_mfma_f32_16x16x32_bf16 v[68:71], a[28:31], a[4:7], v[68:71]
ds_read_b64_tr_b16 a[68:69], v213 offset:0
s_add_u32 s63, s62, 3936256
s_add_u32 m0, s34, 45056
v_mfma_f32_16x16x32_bf16 v[72:75], a[28:31], a[8:11], v[72:75]
ds_read_b64_tr_b16 a[70:71], v213 offset:2048
buffer_load_dwordx4 v3, s[12:15], s63 offen lds
v_mfma_f32_16x16x32_bf16 v[76:79], a[28:31], a[12:15], v[76:79]
v_mfma_f32_16x16x32_bf16 v[188:191], a[28:31], v[216:219], v[188:191]
s_waitcnt lgkmcnt(15)
v_mfma_f32_16x16x32_bf16 v[80:83], a[32:35], a[0:3], v[80:83]
v_mfma_f32_16x16x32_bf16 v[84:87], a[32:35], a[4:7], v[84:87]
v_mfma_f32_16x16x32_bf16 v[88:91], a[32:35], a[8:11], v[88:91]
v_mfma_f32_16x16x32_bf16 v[92:95], a[32:35], a[12:15], v[92:95]
v_mfma_f32_16x16x32_bf16 v[192:195], a[32:35], v[216:219], v[192:195]
s_waitcnt vmcnt(18)
s_barrier
s_waitcnt lgkmcnt(14)
v_mfma_f32_16x16x32_bf16 v[96:99], a[52:55], a[36:39], v[96:99]
ds_read_b64_tr_b16 a[16:17], v209 offset:24576
s_waitcnt lgkmcnt(13)
v_mfma_f32_16x16x32_bf16 v[100:103], a[52:55], a[40:43], v[100:103]
ds_read_b64_tr_b16 a[18:19], v209 offset:26624
s_add_u32 s31, s61, 655360
s_add_u32 m0, s34, 49152
s_waitcnt lgkmcnt(12)
v_mfma_f32_16x16x32_bf16 v[104:107], a[52:55], a[44:47], v[104:107]
ds_read_b64_tr_b16 a[0:1], v205 offset:24576
buffer_load_dwordx4 v2, s[8:11], s31 offen offset:0 lds
s_waitcnt lgkmcnt(11)
v_mfma_f32_16x16x32_bf16 v[108:111], a[52:55], a[48:51], v[108:111]
ds_read_b64_tr_b16 a[2:3], v205 offset:26624
s_waitcnt lgkmcnt(10)
v_mfma_f32_16x16x32_bf16 v[112:115], a[56:59], a[36:39], v[112:115]
ds_read_b64_tr_b16 a[4:5], v206 offset:24576
s_add_u32 m0, s34, 53120
v_mfma_f32_16x16x32_bf16 v[116:119], a[56:59], a[40:43], v[116:119]
ds_read_b64_tr_b16 a[6:7], v206 offset:26624
buffer_load_dwordx4 v2, s[8:11], s31 offen offset:128 lds
v_mfma_f32_16x16x32_bf16 v[120:123], a[56:59], a[44:47], v[120:123]
ds_read_b64_tr_b16 a[8:9], v207 offset:24576
v_mfma_f32_16x16x32_bf16 v[124:127], a[56:59], a[48:51], v[124:127]
ds_read_b64_tr_b16 a[10:11], v207 offset:26624
s_add_u32 m0, s34, 57088
s_waitcnt lgkmcnt(12)
v_mfma_f32_16x16x32_bf16 v[128:131], a[60:63], a[36:39], v[128:131]
ds_read_b64_tr_b16 a[12:13], v208 offset:24576
buffer_load_dwordx4 v2, s[8:11], s31 offen offset:256 lds
v_mfma_f32_16x16x32_bf16 v[132:135], a[60:63], a[40:43], v[132:135]
ds_read_b64_tr_b16 a[14:15], v208 offset:26624
v_mfma_f32_16x16x32_bf16 v[136:139], a[60:63], a[44:47], v[136:139]
ds_read_b64_tr_b16 a[20:21], v210 offset:24576
s_add_u32 m0, s34, 61056
v_mfma_f32_16x16x32_bf16 v[140:143], a[60:63], a[48:51], v[140:143]
ds_read_b64_tr_b16 a[22:23], v210 offset:26624
buffer_load_dwordx4 v2, s[8:11], s31 offen offset:384 lds
s_waitcnt lgkmcnt(14)
v_mfma_f32_16x16x32_bf16 v[144:147], a[64:67], a[36:39], v[144:147]
ds_read_b64_tr_b16 a[24:25], v211 offset:24576
v_mfma_f32_16x16x32_bf16 v[148:151], a[64:67], a[40:43], v[148:151]
ds_read_b64_tr_b16 a[26:27], v211 offset:26624
s_add_u32 m0, s34, 65024
v_mfma_f32_16x16x32_bf16 v[152:155], a[64:67], a[44:47], v[152:155]
ds_read_b64_tr_b16 a[28:29], v212 offset:24576
buffer_load_dwordx4 v2, s[8:11], s31 offen offset:512 lds
v_mfma_f32_16x16x32_bf16 v[156:159], a[64:67], a[48:51], v[156:159]
ds_read_b64_tr_b16 a[30:31], v212 offset:26624
s_waitcnt lgkmcnt(15)
v_mfma_f32_16x16x32_bf16 v[160:163], a[68:71], a[36:39], v[160:163]
ds_read_b64_tr_b16 a[32:33], v213 offset:24576
s_add_u32 s63, s62, 4194304
s_add_u32 m0, s34, 69632
v_mfma_f32_16x16x32_bf16 v[164:167], a[68:71], a[40:43], v[164:167]
ds_read_b64_tr_b16 a[34:35], v213 offset:26624
buffer_load_dwordx4 v3, s[12:15], s63 offen lds
v_mfma_f32_16x16x32_bf16 v[168:171], a[68:71], a[44:47], v[168:171]
v_mfma_f32_16x16x32_bf16 v[172:175], a[68:71], a[48:51], v[172:175]
s_waitcnt vmcnt(18)
s_barrier
s_waitcnt lgkmcnt(14)
v_mfma_f32_16x16x32_bf16 v[16:19], a[16:19], a[0:3], v[16:19]
ds_read_b64_tr_b16 a[52:53], v209 offset:49152
s_waitcnt lgkmcnt(13)
v_mfma_f32_16x16x32_bf16 v[20:23], a[16:19], a[4:7], v[20:23]
ds_read_b64_tr_b16 a[54:55], v209 offset:51200
s_waitcnt lgkmcnt(12)
v_mfma_f32_16x16x32_bf16 v[24:27], a[16:19], a[8:11], v[24:27]
ds_read_b64_tr_b16 a[36:37], v205 offset:49152
s_waitcnt lgkmcnt(11)
v_mfma_f32_16x16x32_bf16 v[28:31], a[16:19], a[12:15], v[28:31]
ds_read_b64_tr_b16 a[38:39], v205 offset:51200
v_mfma_f32_16x16x32_bf16 v[176:179], a[16:19], v[216:219], v[176:179]
ds_read_b64_tr_b16 a[40:41], v206 offset:49152
s_waitcnt lgkmcnt(11)
v_mfma_f32_16x16x32_bf16 v[32:35], a[20:23], a[0:3], v[32:35]
ds_read_b64_tr_b16 a[42:43], v206 offset:51200
v_mfma_f32_16x16x32_bf16 v[36:39], a[20:23], a[4:7], v[36:39]
ds_read_b64_tr_b16 a[44:45], v207 offset:49152
v_mfma_f32_16x16x32_bf16 v[40:43], a[20:23], a[8:11], v[40:43]
ds_read_b64_tr_b16 a[46:47], v207 offset:51200
v_mfma_f32_16x16x32_bf16 v[44:47], a[20:23], a[12:15], v[44:47]
ds_read_b64_tr_b16 a[48:49], v208 offset:49152
v_mfma_f32_16x16x32_bf16 v[180:183], a[20:23], v[216:219], v[180:183]
ds_read_b64_tr_b16 a[50:51], v208 offset:51200
s_waitcnt lgkmcnt(14)
v_mfma_f32_16x16x32_bf16 v[48:51], a[24:27], a[0:3], v[48:51]
ds_read_b64_tr_b16 a[56:57], v210 offset:49152
v_mfma_f32_16x16x32_bf16 v[52:55], a[24:27], a[4:7], v[52:55]
ds_read_b64_tr_b16 a[58:59], v210 offset:51200
v_mfma_f32_16x16x32_bf16 v[56:59], a[24:27], a[8:11], v[56:59]
ds_read_b64_tr_b16 a[60:61], v211 offset:49152
v_mfma_f32_16x16x32_bf16 v[60:63], a[24:27], a[12:15], v[60:63]
ds_read_b64_tr_b16 a[62:63], v211 offset:51200
v_mfma_f32_16x16x32_bf16 v[184:187], a[24:27], v[216:219], v[184:187]
ds_read_b64_tr_b16 a[64:65], v212 offset:49152
s_waitcnt lgkmcnt(15)
v_mfma_f32_16x16x32_bf16 v[64:67], a[28:31], a[0:3], v[64:67]
ds_read_b64_tr_b16 a[66:67], v212 offset:51200
v_mfma_f32_16x16x32_bf16 v[68:71], a[28:31], a[4:7], v[68:71]
ds_read_b64_tr_b16 a[68:69], v213 offset:49152
v_mfma_f32_16x16x32_bf16 v[72:75], a[28:31], a[8:11], v[72:75]
ds_read_b64_tr_b16 a[70:71], v213 offset:51200
v_mfma_f32_16x16x32_bf16 v[76:79], a[28:31], a[12:15], v[76:79]
v_mfma_f32_16x16x32_bf16 v[188:191], a[28:31], v[216:219], v[188:191]
s_waitcnt lgkmcnt(15)
v_mfma_f32_16x16x32_bf16 v[80:83], a[32:35], a[0:3], v[80:83]
v_mfma_f32_16x16x32_bf16 v[84:87], a[32:35], a[4:7], v[84:87]
v_mfma_f32_16x16x32_bf16 v[88:91], a[32:35], a[8:11], v[88:91]
v_mfma_f32_16x16x32_bf16 v[92:95], a[32:35], a[12:15], v[92:95]
v_mfma_f32_16x16x32_bf16 v[192:195], a[32:35], v[216:219], v[192:195]
s_waitcnt vmcnt(12)
s_barrier
s_waitcnt lgkmcnt(14)
v_mfma_f32_16x16x32_bf16 v[96:99], a[52:55], a[36:39], v[96:99]
ds_read_b64_tr_b16 a[16:17], v200 offset:0
s_waitcnt lgkmcnt(13)
v_mfma_f32_16x16x32_bf16 v[100:103], a[52:55], a[40:43], v[100:103]
ds_read_b64_tr_b16 a[18:19], v200 offset:2048
s_waitcnt lgkmcnt(12)
v_mfma_f32_16x16x32_bf16 v[104:107], a[52:55], a[44:47], v[104:107]
ds_read_b64_tr_b16 a[0:1], v196 offset:0
s_waitcnt lgkmcnt(11)
v_mfma_f32_16x16x32_bf16 v[108:111], a[52:55], a[48:51], v[108:111]
ds_read_b64_tr_b16 a[2:3], v196 offset:2048
s_waitcnt lgkmcnt(10)
v_mfma_f32_16x16x32_bf16 v[112:115], a[56:59], a[36:39], v[112:115]
ds_read_b64_tr_b16 a[4:5], v197 offset:0
v_mfma_f32_16x16x32_bf16 v[116:119], a[56:59], a[40:43], v[116:119]
ds_read_b64_tr_b16 a[6:7], v197 offset:2048
v_mfma_f32_16x16x32_bf16 v[120:123], a[56:59], a[44:47], v[120:123]
ds_read_b64_tr_b16 a[8:9], v198 offset:0
v_mfma_f32_16x16x32_bf16 v[124:127], a[56:59], a[48:51], v[124:127]
ds_read_b64_tr_b16 a[10:11], v198 offset:2048
s_waitcnt lgkmcnt(12)
v_mfma_f32_16x16x32_bf16 v[128:131], a[60:63], a[36:39], v[128:131]
ds_read_b64_tr_b16 a[12:13], v199 offset:0
v_mfma_f32_16x16x32_bf16 v[132:135], a[60:63], a[40:43], v[132:135]
ds_read_b64_tr_b16 a[14:15], v199 offset:2048
v_mfma_f32_16x16x32_bf16 v[136:139], a[60:63], a[44:47], v[136:139]
ds_read_b64_tr_b16 a[20:21], v201 offset:0
v_mfma_f32_16x16x32_bf16 v[140:143], a[60:63], a[48:51], v[140:143]
ds_read_b64_tr_b16 a[22:23], v201 offset:2048
s_waitcnt lgkmcnt(14)
v_mfma_f32_16x16x32_bf16 v[144:147], a[64:67], a[36:39], v[144:147]
ds_read_b64_tr_b16 a[24:25], v202 offset:0
v_mfma_f32_16x16x32_bf16 v[148:151], a[64:67], a[40:43], v[148:151]
ds_read_b64_tr_b16 a[26:27], v202 offset:2048
v_mfma_f32_16x16x32_bf16 v[152:155], a[64:67], a[44:47], v[152:155]
ds_read_b64_tr_b16 a[28:29], v203 offset:0
v_mfma_f32_16x16x32_bf16 v[156:159], a[64:67], a[48:51], v[156:159]
ds_read_b64_tr_b16 a[30:31], v203 offset:2048
s_waitcnt lgkmcnt(15)
v_mfma_f32_16x16x32_bf16 v[160:163], a[68:71], a[36:39], v[160:163]
ds_read_b64_tr_b16 a[32:33], v204 offset:0
v_mfma_f32_16x16x32_bf16 v[164:167], a[68:71], a[40:43], v[164:167]
ds_read_b64_tr_b16 a[34:35], v204 offset:2048
v_mfma_f32_16x16x32_bf16 v[168:171], a[68:71], a[44:47], v[168:171]
v_mfma_f32_16x16x32_bf16 v[172:175], a[68:71], a[48:51], v[172:175]
s_waitcnt vmcnt(6)
s_barrier
s_waitcnt lgkmcnt(14)
v_mfma_f32_16x16x32_bf16 v[16:19], a[16:19], a[0:3], v[16:19]
ds_read_b64_tr_b16 a[52:53], v200 offset:24576
s_waitcnt lgkmcnt(13)
v_mfma_f32_16x16x32_bf16 v[20:23], a[16:19], a[4:7], v[20:23]
ds_read_b64_tr_b16 a[54:55], v200 offset:26624
s_waitcnt lgkmcnt(12)
v_mfma_f32_16x16x32_bf16 v[24:27], a[16:19], a[8:11], v[24:27]
ds_read_b64_tr_b16 a[36:37], v196 offset:24576
s_waitcnt lgkmcnt(11)
v_mfma_f32_16x16x32_bf16 v[28:31], a[16:19], a[12:15], v[28:31]
ds_read_b64_tr_b16 a[38:39], v196 offset:26624
v_mfma_f32_16x16x32_bf16 v[176:179], a[16:19], v[216:219], v[176:179]
ds_read_b64_tr_b16 a[40:41], v197 offset:24576
s_waitcnt lgkmcnt(11)
v_mfma_f32_16x16x32_bf16 v[32:35], a[20:23], a[0:3], v[32:35]
ds_read_b64_tr_b16 a[42:43], v197 offset:26624
v_mfma_f32_16x16x32_bf16 v[36:39], a[20:23], a[4:7], v[36:39]
ds_read_b64_tr_b16 a[44:45], v198 offset:24576
v_mfma_f32_16x16x32_bf16 v[40:43], a[20:23], a[8:11], v[40:43]
ds_read_b64_tr_b16 a[46:47], v198 offset:26624
v_mfma_f32_16x16x32_bf16 v[44:47], a[20:23], a[12:15], v[44:47]
ds_read_b64_tr_b16 a[48:49], v199 offset:24576
v_mfma_f32_16x16x32_bf16 v[180:183], a[20:23], v[216:219], v[180:183]
ds_read_b64_tr_b16 a[50:51], v199 offset:26624
s_waitcnt lgkmcnt(14)
v_mfma_f32_16x16x32_bf16 v[48:51], a[24:27], a[0:3], v[48:51]
ds_read_b64_tr_b16 a[56:57], v201 offset:24576
v_mfma_f32_16x16x32_bf16 v[52:55], a[24:27], a[4:7], v[52:55]
ds_read_b64_tr_b16 a[58:59], v201 offset:26624
v_mfma_f32_16x16x32_bf16 v[56:59], a[24:27], a[8:11], v[56:59]
ds_read_b64_tr_b16 a[60:61], v202 offset:24576
v_mfma_f32_16x16x32_bf16 v[60:63], a[24:27], a[12:15], v[60:63]
ds_read_b64_tr_b16 a[62:63], v202 offset:26624
v_mfma_f32_16x16x32_bf16 v[184:187], a[24:27], v[216:219], v[184:187]
ds_read_b64_tr_b16 a[64:65], v203 offset:24576
s_waitcnt lgkmcnt(15)
v_mfma_f32_16x16x32_bf16 v[64:67], a[28:31], a[0:3], v[64:67]
ds_read_b64_tr_b16 a[66:67], v203 offset:26624
v_mfma_f32_16x16x32_bf16 v[68:71], a[28:31], a[4:7], v[68:71]
ds_read_b64_tr_b16 a[68:69], v204 offset:24576
v_mfma_f32_16x16x32_bf16 v[72:75], a[28:31], a[8:11], v[72:75]
ds_read_b64_tr_b16 a[70:71], v204 offset:26624
v_mfma_f32_16x16x32_bf16 v[76:79], a[28:31], a[12:15], v[76:79]
v_mfma_f32_16x16x32_bf16 v[188:191], a[28:31], v[216:219], v[188:191]
s_waitcnt lgkmcnt(15)
v_mfma_f32_16x16x32_bf16 v[80:83], a[32:35], a[0:3], v[80:83]
v_mfma_f32_16x16x32_bf16 v[84:87], a[32:35], a[4:7], v[84:87]
v_mfma_f32_16x16x32_bf16 v[88:91], a[32:35], a[8:11], v[88:91]
v_mfma_f32_16x16x32_bf16 v[92:95], a[32:35], a[12:15], v[92:95]
v_mfma_f32_16x16x32_bf16 v[192:195], a[32:35], v[216:219], v[192:195]
s_waitcnt vmcnt(0)
s_barrier
s_waitcnt lgkmcnt(14)
v_mfma_f32_16x16x32_bf16 v[96:99], a[52:55], a[36:39], v[96:99]
ds_read_b64_tr_b16 a[16:17], v200 offset:49152
s_waitcnt lgkmcnt(13)
v_mfma_f32_16x16x32_bf16 v[100:103], a[52:55], a[40:43], v[100:103]
ds_read_b64_tr_b16 a[18:19], v200 offset:51200
s_waitcnt lgkmcnt(12)
v_mfma_f32_16x16x32_bf16 v[104:107], a[52:55], a[44:47], v[104:107]
ds_read_b64_tr_b16 a[0:1], v196 offset:49152
s_waitcnt lgkmcnt(11)
v_mfma_f32_16x16x32_bf16 v[108:111], a[52:55], a[48:51], v[108:111]
ds_read_b64_tr_b16 a[2:3], v196 offset:51200
s_waitcnt lgkmcnt(10)
v_mfma_f32_16x16x32_bf16 v[112:115], a[56:59], a[36:39], v[112:115]
ds_read_b64_tr_b16 a[4:5], v197 offset:49152
v_mfma_f32_16x16x32_bf16 v[116:119], a[56:59], a[40:43], v[116:119]
ds_read_b64_tr_b16 a[6:7], v197 offset:51200
v_mfma_f32_16x16x32_bf16 v[120:123], a[56:59], a[44:47], v[120:123]
ds_read_b64_tr_b16 a[8:9], v198 offset:49152
v_mfma_f32_16x16x32_bf16 v[124:127], a[56:59], a[48:51], v[124:127]
ds_read_b64_tr_b16 a[10:11], v198 offset:51200
s_waitcnt lgkmcnt(12)
v_mfma_f32_16x16x32_bf16 v[128:131], a[60:63], a[36:39], v[128:131]
ds_read_b64_tr_b16 a[12:13], v199 offset:49152
v_mfma_f32_16x16x32_bf16 v[132:135], a[60:63], a[40:43], v[132:135]
ds_read_b64_tr_b16 a[14:15], v199 offset:51200
v_mfma_f32_16x16x32_bf16 v[136:139], a[60:63], a[44:47], v[136:139]
ds_read_b64_tr_b16 a[20:21], v201 offset:49152
v_mfma_f32_16x16x32_bf16 v[140:143], a[60:63], a[48:51], v[140:143]
ds_read_b64_tr_b16 a[22:23], v201 offset:51200
s_waitcnt lgkmcnt(14)
v_mfma_f32_16x16x32_bf16 v[144:147], a[64:67], a[36:39], v[144:147]
ds_read_b64_tr_b16 a[24:25], v202 offset:49152
v_mfma_f32_16x16x32_bf16 v[148:151], a[64:67], a[40:43], v[148:151]
ds_read_b64_tr_b16 a[26:27], v202 offset:51200
v_mfma_f32_16x16x32_bf16 v[152:155], a[64:67], a[44:47], v[152:155]
ds_read_b64_tr_b16 a[28:29], v203 offset:49152
v_mfma_f32_16x16x32_bf16 v[156:159], a[64:67], a[48:51], v[156:159]
ds_read_b64_tr_b16 a[30:31], v203 offset:51200
s_waitcnt lgkmcnt(15)
v_mfma_f32_16x16x32_bf16 v[160:163], a[68:71], a[36:39], v[160:163]
ds_read_b64_tr_b16 a[32:33], v204 offset:49152
v_mfma_f32_16x16x32_bf16 v[164:167], a[68:71], a[40:43], v[164:167]
ds_read_b64_tr_b16 a[34:35], v204 offset:51200
v_mfma_f32_16x16x32_bf16 v[168:171], a[68:71], a[44:47], v[168:171]
v_mfma_f32_16x16x32_bf16 v[172:175], a[68:71], a[48:51], v[172:175]
s_waitcnt lgkmcnt(14)
v_mfma_f32_16x16x32_bf16 v[16:19], a[16:19], a[0:3], v[16:19]
s_waitcnt lgkmcnt(12)
v_mfma_f32_16x16x32_bf16 v[20:23], a[16:19], a[4:7], v[20:23]
s_waitcnt lgkmcnt(10)
v_mfma_f32_16x16x32_bf16 v[24:27], a[16:19], a[8:11], v[24:27]
s_waitcnt lgkmcnt(8)
v_mfma_f32_16x16x32_bf16 v[28:31], a[16:19], a[12:15], v[28:31]
v_mfma_f32_16x16x32_bf16 v[176:179], a[16:19], v[216:219], v[176:179]
s_waitcnt lgkmcnt(6)
v_mfma_f32_16x16x32_bf16 v[32:35], a[20:23], a[0:3], v[32:35]
v_mfma_f32_16x16x32_bf16 v[36:39], a[20:23], a[4:7], v[36:39]
v_mfma_f32_16x16x32_bf16 v[40:43], a[20:23], a[8:11], v[40:43]
v_mfma_f32_16x16x32_bf16 v[44:47], a[20:23], a[12:15], v[44:47]
v_mfma_f32_16x16x32_bf16 v[180:183], a[20:23], v[216:219], v[180:183]
s_waitcnt lgkmcnt(4)
v_mfma_f32_16x16x32_bf16 v[48:51], a[24:27], a[0:3], v[48:51]
v_mfma_f32_16x16x32_bf16 v[52:55], a[24:27], a[4:7], v[52:55]
v_mfma_f32_16x16x32_bf16 v[56:59], a[24:27], a[8:11], v[56:59]
v_mfma_f32_16x16x32_bf16 v[60:63], a[24:27], a[12:15], v[60:63]
v_mfma_f32_16x16x32_bf16 v[184:187], a[24:27], v[216:219], v[184:187]
s_waitcnt lgkmcnt(2)
v_mfma_f32_16x16x32_bf16 v[64:67], a[28:31], a[0:3], v[64:67]
v_mfma_f32_16x16x32_bf16 v[68:71], a[28:31], a[4:7], v[68:71]
v_mfma_f32_16x16x32_bf16 v[72:75], a[28:31], a[8:11], v[72:75]
v_mfma_f32_16x16x32_bf16 v[76:79], a[28:31], a[12:15], v[76:79]
v_mfma_f32_16x16x32_bf16 v[188:191], a[28:31], v[216:219], v[188:191]
s_waitcnt lgkmcnt(0)
v_mfma_f32_16x16x32_bf16 v[80:83], a[32:35], a[0:3], v[80:83]
v_mfma_f32_16x16x32_bf16 v[84:87], a[32:35], a[4:7], v[84:87]
v_mfma_f32_16x16x32_bf16 v[88:91], a[32:35], a[8:11], v[88:91]
v_mfma_f32_16x16x32_bf16 v[92:95], a[32:35], a[12:15], v[92:95]
v_mfma_f32_16x16x32_bf16 v[192:195], a[32:35], v[216:219], v[192:195]
s_barrier
K2_dft2:
v_add_u32 v252, final_kernel-K2_pc, v255
v_min_u32 v252, K3_end-K2_pc-4, v252
v_add_co_u32 v252, s[98:99], s96, v252
v_mov_b32 v253, s97
s_nop 0
v_addc_co_u32 v253, s[98:99], 0, v253, s[98:99]
s_mul_i32 s35, s24, 9216
s_add_u32 m0, s34, 0
s_add_u32 s31, s35, 0
buffer_load_dwordx4 v10, s[20:23], s31 offen lds
s_add_u32 m0, s34, 4096
s_add_u32 s31, s35, 36864
buffer_load_dwordx4 v10, s[20:23], s31 offen lds
s_add_u32 m0, s34, 8192
s_add_u32 s31, s35, 73728
buffer_load_dwordx4 v10, s[20:23], s31 offen lds
s_add_u32 m0, s34, 12288
s_add_u32 s31, s35, 110592
buffer_load_dwordx4 v10, s[20:23], s31 offen lds
s_add_u32 m0, s34, 16384
s_add_u32 s31, s35, 147456
buffer_load_dwordx4 v10, s[20:23], s31 offen lds
s_add_u32 m0, s34, 20480
s_add_u32 s31, s35, 184320
buffer_load_dwordx4 v10, s[20:23], s31 offen lds
s_add_u32 m0, s34, 24576
s_add_u32 s31, s35, 221184
buffer_load_dwordx4 v10, s[20:23], s31 offen lds
s_add_u32 m0, s34, 28672
s_add_u32 s31, s35, 258048
buffer_load_dwordx4 v10, s[20:23], s31 offen lds
s_add_u32 m0, s34, 32768
s_add_u32 s31, s35, 294912
buffer_load_dwordx4 v10, s[20:23], s31 offen lds
s_add_u32 m0, s34, 36864
s_add_u32 s31, s35, 331776
buffer_load_dwordx4 v10, s[20:23], s31 offen lds
s_add_u32 m0, s34, 40960
s_add_u32 s31, s35, 128
buffer_load_dwordx4 v10, s[20:23], s31 offen lds
s_add_u32 m0, s34, 45056
s_add_u32 s31, s35, 36992
buffer_load_dwordx4 v10, s[20:23], s31 offen lds
s_add_u32 m0, s34, 49152
s_add_u32 s31, s35, 73856
buffer_load_dwordx4 v10, s[20:23], s31 offen lds
s_add_u32 m0, s34, 53248
s_add_u32 s31, s35, 110720
buffer_load_dwordx4 v10, s[20:23], s31 offen lds
s_add_u32 m0, s34, 57344
s_add_u32 s31, s35, 147584
buffer_load_dwordx4 v10, s[20:23], s31 offen lds
s_and_b32 s46, s24, 1
s_mul_i32 s3, s24, 5
s_sub_u32 s3, s3, s46
s_lshr_b32 s3, s3, 1
s_lshl_b32 s47, s46, 3
s_cmp_eq_u32 s46, 1
s_cselect_b32 s56, 1024, 8
s_cselect_b32 s57, 64, 8
s_lshl_b32 s58, s3, 10
s_add_u32 s58, s58, 73728
s_add_u32 s59, s58, s47
v_add_u32 v7, s59, v11
v_add_u32 v6, 40960, v7
s_add_u32 s59, s58, s56
v_add_u32 v4, s59, v11
v_add_u32 v3, 40960, v4
v_lshrrev_b32 v15, 4, v0
v_lshlrev_b32 v15, 4, v15
s_lshl_b32 s58, s3, 6
s_add_u32 s58, s58, 155648
s_add_u32 s59, s58, s47
v_add_u32 v5, s59, v15
s_add_u32 s59, s58, s57
v_add_u32 v2, s59, v15
v_add_f32 v220, v16, v96
v_sub_f32 v224, v16, v96
v_add_f32 v221, v17, v97
v_sub_f32 v225, v17, v97
v_add_f32 v222, v18, v98
v_sub_f32 v226, v18, v98
v_add_f32 v223, v19, v99
v_sub_f32 v227, v19, v99
v_cvt_pk_bf16_f32 v220, v220, v221
v_cvt_pk_bf16_f32 v221, v222, v223
v_cvt_pk_bf16_f32 v224, v224, v225
v_cvt_pk_bf16_f32 v225, v226, v227
ds_write_b64 v7, v[220:221] offset:0
ds_write_b64 v6, v[224:225] offset:0
v_add_f32 v228, v20, v100
v_sub_f32 v232, v20, v100
v_add_f32 v229, v21, v101
v_sub_f32 v233, v21, v101
v_add_f32 v230, v22, v102
v_sub_f32 v234, v22, v102
v_add_f32 v231, v23, v103
v_sub_f32 v235, v23, v103
v_cvt_pk_bf16_f32 v228, v228, v229
v_cvt_pk_bf16_f32 v229, v230, v231
v_cvt_pk_bf16_f32 v232, v232, v233
v_cvt_pk_bf16_f32 v233, v234, v235
ds_write_b64 v7, v[228:229] offset:10240
ds_write_b64 v6, v[232:233] offset:10240
v_add_f32 v236, v24, v104
v_sub_f32 v240, v24, v104
v_add_f32 v237, v25, v105
v_sub_f32 v241, v25, v105
v_add_f32 v238, v26, v106
v_sub_f32 v242, v26, v106
v_add_f32 v239, v27, v107
v_sub_f32 v243, v27, v107
v_cvt_pk_bf16_f32 v236, v236, v237
v_cvt_pk_bf16_f32 v237, v238, v239
v_cvt_pk_bf16_f32 v240, v240, v241
v_cvt_pk_bf16_f32 v241, v242, v243
ds_write_b64 v7, v[236:237] offset:20480
ds_write_b64 v6, v[240:241] offset:20480
v_add_f32 v244, v28, v108
v_sub_f32 v248, v28, v108
v_add_f32 v245, v29, v109
v_sub_f32 v249, v29, v109
v_add_f32 v246, v30, v110
v_sub_f32 v250, v30, v110
v_add_f32 v247, v31, v111
v_sub_f32 v251, v31, v111
v_cvt_pk_bf16_f32 v244, v244, v245
v_cvt_pk_bf16_f32 v245, v246, v247
v_cvt_pk_bf16_f32 v248, v248, v249
v_cvt_pk_bf16_f32 v249, v250, v251
ds_write_b64 v7, v[244:245] offset:30720
ds_write_b64 v6, v[248:249] offset:30720
v_cvt_pk_bf16_f32 v176, v176, v177
v_cvt_pk_bf16_f32 v177, v178, v179
ds_write_b64 v5, v[176:177] offset:0
v_add_f32 v220, v32, v112
v_sub_f32 v224, v32, v112
v_add_f32 v221, v33, v113
v_sub_f32 v225, v33, v113
v_add_f32 v222, v34, v114
v_sub_f32 v226, v34, v114
v_add_f32 v223, v35, v115
v_sub_f32 v227, v35, v115
v_cvt_pk_bf16_f32 v220, v220, v221
v_cvt_pk_bf16_f32 v221, v222, v223
v_cvt_pk_bf16_f32 v224, v224, v225
v_cvt_pk_bf16_f32 v225, v226, v227
ds_write_b64 v4, v[220:221] offset:0
ds_write_b64 v3, v[224:225] offset:0
v_add_f32 v228, v36, v116
v_sub_f32 v232, v36, v116
v_add_f32 v229, v37, v117
v_sub_f32 v233, v37, v117
v_add_f32 v230, v38, v118
v_sub_f32 v234, v38, v118
v_add_f32 v231, v39, v119
v_sub_f32 v235, v39, v119
v_cvt_pk_bf16_f32 v228, v228, v229
v_cvt_pk_bf16_f32 v229, v230, v231
v_cvt_pk_bf16_f32 v232, v232, v233
v_cvt_pk_bf16_f32 v233, v234, v235
ds_write_b64 v4, v[228:229] offset:10240
ds_write_b64 v3, v[232:233] offset:10240
v_add_f32 v236, v40, v120
v_sub_f32 v240, v40, v120
v_add_f32 v237, v41, v121
v_sub_f32 v241, v41, v121
v_add_f32 v238, v42, v122
v_sub_f32 v242, v42, v122
v_add_f32 v239, v43, v123
v_sub_f32 v243, v43, v123
v_cvt_pk_bf16_f32 v236, v236, v237
v_cvt_pk_bf16_f32 v237, v238, v239
v_cvt_pk_bf16_f32 v240, v240, v241
v_cvt_pk_bf16_f32 v241, v242, v243
ds_write_b64 v4, v[236:237] offset:20480
ds_write_b64 v3, v[240:241] offset:20480
v_add_f32 v244, v44, v124
v_sub_f32 v248, v44, v124
v_add_f32 v245, v45, v125
v_sub_f32 v249, v45, v125
v_add_f32 v246, v46, v126
v_sub_f32 v250, v46, v126
v_add_f32 v247, v47, v127
v_sub_f32 v251, v47, v127
v_cvt_pk_bf16_f32 v244, v244, v245
v_cvt_pk_bf16_f32 v245, v246, v247
v_cvt_pk_bf16_f32 v248, v248, v249
v_cvt_pk_bf16_f32 v249, v250, v251
ds_write_b64 v4, v[244:245] offset:30720
ds_write_b64 v3, v[248:249] offset:30720
v_cvt_pk_bf16_f32 v180, v180, v181
v_cvt_pk_bf16_f32 v181, v182, v183
ds_write_b64 v2, v[180:181] offset:0
v_add_f32 v220, v48, v128
v_sub_f32 v224, v48, v128
v_add_f32 v221, v49, v129
v_sub_f32 v225, v49, v129
v_add_f32 v222, v50, v130
v_sub_f32 v226, v50, v130
v_add_f32 v223, v51, v131
v_sub_f32 v227, v51, v131
v_cvt_pk_bf16_f32 v220, v220, v221
v_cvt_pk_bf16_f32 v221, v222, v223
v_cvt_pk_bf16_f32 v224, v224, v225
v_cvt_pk_bf16_f32 v225, v226, v227
ds_write_b64 v7, v[220:221] offset:1024
ds_write_b64 v6, v[224:225] offset:1024
v_add_f32 v228, v52, v132
v_sub_f32 v232, v52, v132
v_add_f32 v229, v53, v133
v_sub_f32 v233, v53, v133
v_add_f32 v230, v54, v134
v_sub_f32 v234, v54, v134
v_add_f32 v231, v55, v135
v_sub_f32 v235, v55, v135
v_cvt_pk_bf16_f32 v228, v228, v229
v_cvt_pk_bf16_f32 v229, v230, v231
v_cvt_pk_bf16_f32 v232, v232, v233
v_cvt_pk_bf16_f32 v233, v234, v235
ds_write_b64 v7, v[228:229] offset:11264
ds_write_b64 v6, v[232:233] offset:11264
v_add_f32 v236, v56, v136
v_sub_f32 v240, v56, v136
v_add_f32 v237, v57, v137
v_sub_f32 v241, v57, v137
v_add_f32 v238, v58, v138
v_sub_f32 v242, v58, v138
v_add_f32 v239, v59, v139
v_sub_f32 v243, v59, v139
v_cvt_pk_bf16_f32 v236, v236, v237
v_cvt_pk_bf16_f32 v237, v238, v239
v_cvt_pk_bf16_f32 v240, v240, v241
v_cvt_pk_bf16_f32 v241, v242, v243
ds_write_b64 v7, v[236:237] offset:21504
ds_write_b64 v6, v[240:241] offset:21504
v_add_f32 v244, v60, v140
v_sub_f32 v248, v60, v140
v_add_f32 v245, v61, v141
v_sub_f32 v249, v61, v141
v_add_f32 v246, v62, v142
v_sub_f32 v250, v62, v142
v_add_f32 v247, v63, v143
v_sub_f32 v251, v63, v143
v_cvt_pk_bf16_f32 v244, v244, v245
v_cvt_pk_bf16_f32 v245, v246, v247
v_cvt_pk_bf16_f32 v248, v248, v249
v_cvt_pk_bf16_f32 v249, v250, v251
ds_write_b64 v7, v[244:245] offset:31744
ds_write_b64 v6, v[248:249] offset:31744
v_cvt_pk_bf16_f32 v184, v184, v185
v_cvt_pk_bf16_f32 v185, v186, v187
ds_write_b64 v5, v[184:185] offset:64
v_add_f32 v220, v64, v144
v_sub_f32 v224, v64, v144
v_add_f32 v221, v65, v145
v_sub_f32 v225, v65, v145
v_add_f32 v222, v66, v146
v_sub_f32 v226, v66, v146
v_add_f32 v223, v67, v147
v_sub_f32 v227, v67, v147
v_cvt_pk_bf16_f32 v220, v220, v221
v_cvt_pk_bf16_f32 v221, v222, v223
v_cvt_pk_bf16_f32 v224, v224, v225
v_cvt_pk_bf16_f32 v225, v226, v227
ds_write_b64 v4, v[220:221] offset:1024
ds_write_b64 v3, v[224:225] offset:1024
v_add_f32 v228, v68, v148
v_sub_f32 v232, v68, v148
v_add_f32 v229, v69, v149
v_sub_f32 v233, v69, v149
v_add_f32 v230, v70, v150
v_sub_f32 v234, v70, v150
v_add_f32 v231, v71, v151
v_sub_f32 v235, v71, v151
v_cvt_pk_bf16_f32 v228, v228, v229
v_cvt_pk_bf16_f32 v229, v230, v231
v_cvt_pk_bf16_f32 v232, v232, v233
v_cvt_pk_bf16_f32 v233, v234, v235
ds_write_b64 v4, v[228:229] offset:11264
ds_write_b64 v3, v[232:233] offset:11264
v_add_f32 v236, v72, v152
v_sub_f32 v240, v72, v152
v_add_f32 v237, v73, v153
v_sub_f32 v241, v73, v153
v_add_f32 v238, v74, v154
v_sub_f32 v242, v74, v154
v_add_f32 v239, v75, v155
v_sub_f32 v243, v75, v155
v_cvt_pk_bf16_f32 v236, v236, v237
v_cvt_pk_bf16_f32 v237, v238, v239
v_cvt_pk_bf16_f32 v240, v240, v241
v_cvt_pk_bf16_f32 v241, v242, v243
ds_write_b64 v4, v[236:237] offset:21504
ds_write_b64 v3, v[240:241] offset:21504
v_add_f32 v244, v76, v156
v_sub_f32 v248, v76, v156
v_add_f32 v245, v77, v157
v_sub_f32 v249, v77, v157
v_add_f32 v246, v78, v158
v_sub_f32 v250, v78, v158
v_add_f32 v247, v79, v159
v_sub_f32 v251, v79, v159
v_cvt_pk_bf16_f32 v244, v244, v245
v_cvt_pk_bf16_f32 v245, v246, v247
v_cvt_pk_bf16_f32 v248, v248, v249
v_cvt_pk_bf16_f32 v249, v250, v251
ds_write_b64 v4, v[244:245] offset:31744
ds_write_b64 v3, v[248:249] offset:31744
v_cvt_pk_bf16_f32 v188, v188, v189
v_cvt_pk_bf16_f32 v189, v190, v191
ds_write_b64 v2, v[188:189] offset:64
v_add_f32 v220, v80, v160
v_sub_f32 v224, v80, v160
v_add_f32 v221, v81, v161
v_sub_f32 v225, v81, v161
v_add_f32 v222, v82, v162
v_sub_f32 v226, v82, v162
v_add_f32 v223, v83, v163
v_sub_f32 v227, v83, v163
v_cvt_pk_bf16_f32 v220, v220, v221
v_cvt_pk_bf16_f32 v221, v222, v223
v_cvt_pk_bf16_f32 v224, v224, v225
v_cvt_pk_bf16_f32 v225, v226, v227
ds_write_b64 v7, v[220:221] offset:2048
ds_write_b64 v6, v[224:225] offset:2048
v_add_f32 v228, v84, v164
v_sub_f32 v232, v84, v164
v_add_f32 v229, v85, v165
v_sub_f32 v233, v85, v165
v_add_f32 v230, v86, v166
v_sub_f32 v234, v86, v166
v_add_f32 v231, v87, v167
v_sub_f32 v235, v87, v167
v_cvt_pk_bf16_f32 v228, v228, v229
v_cvt_pk_bf16_f32 v229, v230, v231
v_cvt_pk_bf16_f32 v232, v232, v233
v_cvt_pk_bf16_f32 v233, v234, v235
ds_write_b64 v7, v[228:229] offset:12288
ds_write_b64 v6, v[232:233] offset:12288
v_add_f32 v236, v88, v168
v_sub_f32 v240, v88, v168
v_add_f32 v237, v89, v169
v_sub_f32 v241, v89, v169
v_add_f32 v238, v90, v170
v_sub_f32 v242, v90, v170
v_add_f32 v239, v91, v171
v_sub_f32 v243, v91, v171
v_cvt_pk_bf16_f32 v236, v236, v237
v_cvt_pk_bf16_f32 v237, v238, v239
v_cvt_pk_bf16_f32 v240, v240, v241
v_cvt_pk_bf16_f32 v241, v242, v243
ds_write_b64 v7, v[236:237] offset:22528
ds_write_b64 v6, v[240:241] offset:22528
v_add_f32 v244, v92, v172
v_sub_f32 v248, v92, v172
v_add_f32 v245, v93, v173
v_sub_f32 v249, v93, v173
v_add_f32 v246, v94, v174
v_sub_f32 v250, v94, v174
v_add_f32 v247, v95, v175
v_sub_f32 v251, v95, v175
v_cvt_pk_bf16_f32 v244, v244, v245
v_cvt_pk_bf16_f32 v245, v246, v247
v_cvt_pk_bf16_f32 v248, v248, v249
v_cvt_pk_bf16_f32 v249, v250, v251
ds_write_b64 v7, v[244:245] offset:32768
ds_write_b64 v6, v[248:249] offset:32768
v_cvt_pk_bf16_f32 v192, v192, v193
v_cvt_pk_bf16_f32 v193, v194, v195
ds_write_b64 v5, v[192:193] offset:128
v_and_b32 v13, 31, v0
v_lshrrev_b32 v14, 4, v13
v_lshlrev_b32 v12, 10, v14
v_bfe_u32 v14, v13, 2, 1
v_lshlrev_b32 v14, 9, v14
v_add_u32 v12, v12, v14
v_bfe_u32 v14, v13, 3, 1
v_lshlrev_b32 v14, 3, v14
v_add_u32 v12, v12, v14
s_add_u32 s38, s28, 32
s_mul_i32 s38, s38, 73728
s_lshl_b32 s3, s26, 12
s_add_u32 s38, s38, s3
s_add_u32 s38, s38, 39583744
s_waitcnt vmcnt(9)
s_waitcnt lgkmcnt(0)
s_barrier
s_mul_i32 s3, s25, 40960
s_add_u32 s3, s3, 73728
v_add_u32 v1, s3, v11
v_lshrrev_b32 v13, 4, v0
v_lshlrev_b32 v13, 4, v13
v_add_u32 v13, 155648, v13
ds_read_b64_tr_b16 v[80:81], v8 offset:0
ds_read_b64_tr_b16 v[82:83], v8 offset:2048
ds_read_b64_tr_b16 v[84:85], v8 offset:4096
ds_read_b64_tr_b16 v[86:87], v8 offset:6144
ds_read_b64_tr_b16 v[88:89], v8 offset:8192
ds_read_b64_tr_b16 v[90:91], v8 offset:10240
ds_read_b64_tr_b16 v[92:93], v9 offset:0
ds_read_b64_tr_b16 v[94:95], v9 offset:2048
ds_read_b64_tr_b16 v[96:97], v9 offset:4096
ds_read_b64_tr_b16 v[98:99], v9 offset:6144
ds_read_b128 a[0:3], v1 offset:0
ds_read_b128 a[16:19], v1 offset:1024
ds_read_b128 a[32:35], v1 offset:2048
ds_read_b128 a[4:7], v1 offset:10240
ds_read_b128 a[20:23], v1 offset:11264
ds_read_b128 a[36:39], v1 offset:12288
ds_read_b128 a[8:11], v1 offset:20480
ds_read_b128 a[24:27], v1 offset:21504
ds_read_b128 a[40:43], v1 offset:22528
ds_read_b128 a[12:15], v1 offset:30720
ds_read_b128 a[28:31], v1 offset:31744
ds_read_b128 a[44:47], v1 offset:32768
ds_read_b128 v[112:115], v13 offset:0
ds_read_b128 v[116:119], v13 offset:64
ds_read_b128 v[120:123], v13 offset:128
ds_read_b128 a[48:51], v1 offset:3072
ds_read_b128 a[64:67], v1 offset:4096
ds_read_b128 a[80:83], v1 offset:5120
ds_read_b128 a[52:55], v1 offset:13312
ds_read_b128 a[68:71], v1 offset:14336
ds_read_b128 a[84:87], v1 offset:15360
ds_read_b128 a[56:59], v1 offset:23552
ds_read_b128 a[72:75], v1 offset:24576
ds_read_b128 a[88:91], v1 offset:25600
ds_read_b128 a[60:63], v1 offset:33792
ds_read_b128 a[76:79], v1 offset:34816
ds_read_b128 a[92:95], v1 offset:35840
ds_read_b128 v[124:127], v13 offset:192
ds_read_b128 v[128:131], v13 offset:256
ds_read_b128 v[132:135], v13 offset:320
ds_read_b128 a[96:99], v1 offset:6144
ds_read_b128 a[112:115], v1 offset:7168
ds_read_b128 a[128:131], v1 offset:8192
ds_read_b128 a[100:103], v1 offset:16384
ds_read_b128 a[116:119], v1 offset:17408
ds_read_b128 a[132:135], v1 offset:18432
ds_read_b128 a[104:107], v1 offset:26624
ds_read_b128 a[120:123], v1 offset:27648
ds_read_b128 a[136:139], v1 offset:28672
ds_read_b128 a[108:111], v1 offset:36864
ds_read_b128 a[124:127], v1 offset:37888
ds_read_b128 a[140:143], v1 offset:38912
ds_read_b128 v[136:139], v13 offset:384
ds_read_b128 v[140:143], v13 offset:448
ds_read_b128 v[144:147], v13 offset:512
ds_read_b128 a[144:147], v1 offset:9216
ds_read_b128 a[148:151], v1 offset:19456
ds_read_b128 a[152:155], v1 offset:29696
ds_read_b128 a[156:159], v1 offset:39936
ds_read_b128 v[148:151], v13 offset:576
v_add_u32 v5, 0x10000, v8
v_add_u32 v6, 0x10000, v9
v_add_u32 v2, 0x20000, v8
v_add_u32 v3, 0x20000, v9
s_waitcnt lgkmcnt(15)
v_mfma_f32_16x16x32_bf16 v[16:19], v[80:83], a[0:3], 0
ds_read_b64_tr_b16 v[100:101], v9 offset:8192
s_waitcnt lgkmcnt(15)
v_mfma_f32_16x16x32_bf16 v[16:19], v[84:87], a[16:19], v[16:19]
s_add_u32 m0, s34, 61440
s_add_u32 s31, s35, 184448
s_waitcnt lgkmcnt(15)
v_mfma_f32_16x16x32_bf16 v[16:19], v[88:91], a[32:35], v[16:19]
ds_read_b64_tr_b16 v[102:103], v9 offset:10240
s_waitcnt lgkmcnt(15)
v_mfma_f32_16x16x32_bf16 v[24:27], v[80:83], a[4:7], 0
buffer_load_dwordx4 v10, s[20:23], s31 offen lds
s_waitcnt lgkmcnt(15)
v_mfma_f32_16x16x32_bf16 v[24:27], v[84:87], a[20:23], v[24:27]
ds_read_b64_tr_b16 v[104:105], v8 offset:12288
s_waitcnt lgkmcnt(15)
v_mfma_f32_16x16x32_bf16 v[24:27], v[88:91], a[36:39], v[24:27]
s_waitcnt lgkmcnt(15)
v_mfma_f32_16x16x32_bf16 v[32:35], v[80:83], a[8:11], 0
ds_read_b64_tr_b16 v[106:107], v8 offset:14336
s_waitcnt lgkmcnt(15)
v_mfma_f32_16x16x32_bf16 v[32:35], v[84:87], a[24:27], v[32:35]
s_waitcnt lgkmcnt(15)
v_mfma_f32_16x16x32_bf16 v[32:35], v[88:91], a[40:43], v[32:35]
ds_read_b64_tr_b16 v[108:109], v8 offset:16384
s_waitcnt lgkmcnt(15)
v_mfma_f32_16x16x32_bf16 v[40:43], v[80:83], a[12:15], 0
s_waitcnt lgkmcnt(15)
v_mfma_f32_16x16x32_bf16 v[40:43], v[84:87], a[28:31], v[40:43]
ds_read_b64_tr_b16 v[110:111], v8 offset:18432
s_waitcnt lgkmcnt(15)
v_mfma_f32_16x16x32_bf16 v[40:43], v[88:91], a[44:47], v[40:43]
s_add_u32 m0, s34, 65536
s_add_u32 s31, s35, 221312
s_waitcnt lgkmcnt(15)
v_mfma_f32_16x16x32_bf16 v[208:211], v[80:83], v[112:115], 0
s_waitcnt lgkmcnt(15)
v_mfma_f32_16x16x32_bf16 v[208:211], v[84:87], v[116:119], v[208:211]
buffer_load_dwordx4 v10, s[20:23], s31 offen lds
s_waitcnt lgkmcnt(15)
v_mfma_f32_16x16x32_bf16 v[208:211], v[88:91], v[120:123], v[208:211]
v_mfma_f32_16x16x32_bf16 v[20:23], v[92:95], a[0:3], 0
ds_read_b64_tr_b16 v[80:81], v8 offset:20480
v_mfma_f32_16x16x32_bf16 v[20:23], v[96:99], a[16:19], v[20:23]
s_waitcnt lgkmcnt(5)
v_mfma_f32_16x16x32_bf16 v[20:23], v[100:103], a[32:35], v[20:23]
ds_read_b64_tr_b16 v[82:83], v8 offset:22528
v_mfma_f32_16x16x32_bf16 v[28:31], v[92:95], a[4:7], 0
v_mfma_f32_16x16x32_bf16 v[28:31], v[96:99], a[20:23], v[28:31]
ds_read_b64_tr_b16 v[84:85], v9 offset:12288
v_mfma_f32_16x16x32_bf16 v[28:31], v[100:103], a[36:39], v[28:31]
v_mfma_f32_16x16x32_bf16 v[36:39], v[92:95], a[8:11], 0
ds_read_b64_tr_b16 v[86:87], v9 offset:14336
s_add_u32 m0, s34, 69632
s_add_u32 s31, s35, 258176
v_mfma_f32_16x16x32_bf16 v[36:39], v[96:99], a[24:27], v[36:39]
v_mfma_f32_16x16x32_bf16 v[36:39], v[100:103], a[40:43], v[36:39]
ds_read_b64_tr_b16 v[88:89], v9 offset:16384
buffer_load_dwordx4 v10, s[20:23], s31 offen lds
v_mfma_f32_16x16x32_bf16 v[44:47], v[92:95], a[12:15], 0
v_mfma_f32_16x16x32_bf16 v[44:47], v[96:99], a[28:31], v[44:47]
ds_read_b64_tr_b16 v[90:91], v9 offset:18432
v_mfma_f32_16x16x32_bf16 v[44:47], v[100:103], a[44:47], v[44:47]
v_mfma_f32_16x16x32_bf16 v[212:215], v[92:95], v[112:115], 0
v_mfma_f32_16x16x32_bf16 v[212:215], v[96:99], v[116:119], v[212:215]
v_mfma_f32_16x16x32_bf16 v[212:215], v[100:103], v[120:123], v[212:215]
s_waitcnt vmcnt(9)
s_barrier
s_waitcnt lgkmcnt(8)
v_mfma_f32_16x16x32_bf16 v[16:19], v[104:107], a[48:51], v[16:19]
ds_read_b64_tr_b16 v[92:93], v9 offset:20480
s_waitcnt lgkmcnt(7)
v_mfma_f32_16x16x32_bf16 v[16:19], v[108:111], a[64:67], v[16:19]
s_add_u32 m0, s34, 73728
s_add_u32 s31, s35, 295040
s_waitcnt lgkmcnt(5)
v_mfma_f32_16x16x32_bf16 v[16:19], v[80:83], a[80:83], v[16:19]
ds_read_b64_tr_b16 v[94:95], v9 offset:22528
v_mfma_f32_16x16x32_bf16 v[24:27], v[104:107], a[52:55], v[24:27]
buffer_load_dwordx4 v10, s[20:23], s31 offen lds
v_mfma_f32_16x16x32_bf16 v[24:27], v[108:111], a[68:71], v[24:27]
ds_read_b64_tr_b16 v[96:97], v8 offset:24576
v_mfma_f32_16x16x32_bf16 v[24:27], v[80:83], a[84:87], v[24:27]
v_mfma_f32_16x16x32_bf16 v[32:35], v[104:107], a[56:59], v[32:35]
ds_read_b64_tr_b16 v[98:99], v8 offset:26624
s_add_u32 m0, s34, 77824
s_add_u32 s31, s35, 331904
v_mfma_f32_16x16x32_bf16 v[32:35], v[108:111], a[72:75], v[32:35]
v_mfma_f32_16x16x32_bf16 v[32:35], v[80:83], a[88:91], v[32:35]
ds_read_b64_tr_b16 v[100:101], v8 offset:28672
buffer_load_dwordx4 v10, s[20:23], s31 offen lds
v_mfma_f32_16x16x32_bf16 v[40:43], v[104:107], a[60:63], v[40:43]
v_mfma_f32_16x16x32_bf16 v[40:43], v[108:111], a[76:79], v[40:43]
ds_read_b64_tr_b16 v[102:103], v8 offset:30720
v_mfma_f32_16x16x32_bf16 v[40:43], v[80:83], a[92:95], v[40:43]
s_add_u32 m0, s34, 81920
s_add_u32 s31, s35, 256
v_mfma_f32_16x16x32_bf16 v[208:211], v[104:107], v[124:127], v[208:211]
v_mfma_f32_16x16x32_bf16 v[208:211], v[108:111], v[128:131], v[208:211]
buffer_load_dwordx4 v10, s[20:23], s31 offen lds
v_mfma_f32_16x16x32_bf16 v[208:211], v[80:83], v[132:135], v[208:211]
s_waitcnt lgkmcnt(8)
v_mfma_f32_16x16x32_bf16 v[20:23], v[84:87], a[48:51], v[20:23]
ds_read_b64_tr_b16 v[104:105], v8 offset:32768
s_waitcnt lgkmcnt(7)
v_mfma_f32_16x16x32_bf16 v[20:23], v[88:91], a[64:67], v[20:23]
s_add_u32 m0, s34, 86016
s_add_u32 s31, s35, 37120
s_waitcnt lgkmcnt(5)
v_mfma_f32_16x16x32_bf16 v[20:23], v[92:95], a[80:83], v[20:23]
ds_read_b64_tr_b16 v[106:107], v8 offset:34816
v_mfma_f32_16x16x32_bf16 v[28:31], v[84:87], a[52:55], v[28:31]
buffer_load_dwordx4 v10, s[20:23], s31 offen lds
v_mfma_f32_16x16x32_bf16 v[28:31], v[88:91], a[68:71], v[28:31]
ds_read_b64_tr_b16 v[108:109], v9 offset:24576
v_mfma_f32_16x16x32_bf16 v[28:31], v[92:95], a[84:87], v[28:31]
v_mfma_f32_16x16x32_bf16 v[36:39], v[84:87], a[56:59], v[36:39]
ds_read_b64_tr_b16 v[110:111], v9 offset:26624
s_add_u32 m0, s34, 90112
s_add_u32 s31, s35, 73984
v_mfma_f32_16x16x32_bf16 v[36:39], v[88:91], a[72:75], v[36:39]
v_mfma_f32_16x16x32_bf16 v[36:39], v[92:95], a[88:91], v[36:39]
ds_read_b64_tr_b16 v[80:81], v9 offset:28672
buffer_load_dwordx4 v10, s[20:23], s31 offen lds
v_mfma_f32_16x16x32_bf16 v[44:47], v[84:87], a[60:63], v[44:47]
v_mfma_f32_16x16x32_bf16 v[44:47], v[88:91], a[76:79], v[44:47]
ds_read_b64_tr_b16 v[82:83], v9 offset:30720
v_mfma_f32_16x16x32_bf16 v[44:47], v[92:95], a[92:95], v[44:47]
s_add_u32 m0, s34, 94208
s_add_u32 s31, s35, 110848
v_mfma_f32_16x16x32_bf16 v[212:215], v[84:87], v[124:127], v[212:215]
v_mfma_f32_16x16x32_bf16 v[212:215], v[88:91], v[128:131], v[212:215]
buffer_load_dwordx4 v10, s[20:23], s31 offen lds
v_mfma_f32_16x16x32_bf16 v[212:215], v[92:95], v[132:135], v[212:215]
s_waitcnt vmcnt(12)
s_barrier
s_waitcnt lgkmcnt(8)
v_mfma_f32_16x16x32_bf16 v[16:19], v[96:99], a[96:99], v[16:19]
ds_read_b64_tr_b16 v[84:85], v9 offset:32768
s_waitcnt lgkmcnt(7)
v_mfma_f32_16x16x32_bf16 v[16:19], v[100:103], a[112:115], v[16:19]
s_add_u32 m0, s34, 98304
s_add_u32 s31, s35, 147712
s_waitcnt lgkmcnt(5)
v_mfma_f32_16x16x32_bf16 v[16:19], v[104:107], a[128:131], v[16:19]
ds_read_b64_tr_b16 v[86:87], v9 offset:34816
v_mfma_f32_16x16x32_bf16 v[24:27], v[96:99], a[100:103], v[24:27]
buffer_load_dwordx4 v10, s[20:23], s31 offen lds
v_mfma_f32_16x16x32_bf16 v[24:27], v[100:103], a[116:119], v[24:27]
ds_read_b64_tr_b16 v[88:89], v8 offset:36864
v_mfma_f32_16x16x32_bf16 v[24:27], v[104:107], a[132:135], v[24:27]
v_mfma_f32_16x16x32_bf16 v[32:35], v[96:99], a[104:107], v[32:35]
ds_read_b64_tr_b16 v[90:91], v8 offset:38912
s_add_u32 m0, s34, 102400
s_add_u32 s31, s35, 184576
v_mfma_f32_16x16x32_bf16 v[32:35], v[100:103], a[120:123], v[32:35]
v_mfma_f32_16x16x32_bf16 v[32:35], v[104:107], a[136:139], v[32:35]
ds_read_b64_tr_b16 v[92:93], v8 offset:40960
buffer_load_dwordx4 v10, s[20:23], s31 offen lds
v_mfma_f32_16x16x32_bf16 v[40:43], v[96:99], a[108:111], v[40:43]
v_mfma_f32_16x16x32_bf16 v[40:43], v[100:103], a[124:127], v[40:43]
ds_read_b64_tr_b16 v[94:95], v8 offset:43008
v_mfma_f32_16x16x32_bf16 v[40:43], v[104:107], a[140:143], v[40:43]
s_add_u32 m0, s34, 106496
s_add_u32 s31, s35, 221440
v_mfma_f32_16x16x32_bf16 v[208:211], v[96:99], v[136:139], v[208:211]
v_mfma_f32_16x16x32_bf16 v[208:211], v[100:103], v[140:143], v[208:211]
buffer_load_dwordx4 v10, s[20:23], s31 offen lds
v_mfma_f32_16x16x32_bf16 v[208:211], v[104:107], v[144:147], v[208:211]
s_waitcnt lgkmcnt(8)
v_mfma_f32_16x16x32_bf16 v[20:23], v[108:111], a[96:99], v[20:23]
ds_read_b64_tr_b16 v[96:97], v8 offset:45056
s_waitcnt lgkmcnt(7)
v_mfma_f32_16x16x32_bf16 v[20:23], v[80:83], a[112:115], v[20:23]
s_add_u32 m0, s34, 110592
s_add_u32 s31, s35, 258304
s_waitcnt lgkmcnt(5)
v_mfma_f32_16x16x32_bf16 v[20:23], v[84:87], a[128:131], v[20:23]
ds_read_b64_tr_b16 v[98:99], v8 offset:47104
v_mfma_f32_16x16x32_bf16 v[28:31], v[108:111], a[100:103], v[28:31]
buffer_load_dwordx4 v10, s[20:23], s31 offen lds
v_mfma_f32_16x16x32_bf16 v[28:31], v[80:83], a[116:119], v[28:31]
ds_read_b64_tr_b16 v[100:101], v9 offset:36864
v_mfma_f32_16x16x32_bf16 v[28:31], v[84:87], a[132:135], v[28:31]
v_mfma_f32_16x16x32_bf16 v[36:39], v[108:111], a[104:107], v[36:39]
ds_read_b64_tr_b16 v[102:103], v9 offset:38912
s_add_u32 m0, s34, 114688
s_add_u32 s31, s35, 295168
v_mfma_f32_16x16x32_bf16 v[36:39], v[80:83], a[120:123], v[36:39]
v_mfma_f32_16x16x32_bf16 v[36:39], v[84:87], a[136:139], v[36:39]
ds_read_b64_tr_b16 v[104:105], v9 offset:40960
buffer_load_dwordx4 v10, s[20:23], s31 offen lds
v_mfma_f32_16x16x32_bf16 v[44:47], v[108:111], a[108:111], v[44:47]
v_mfma_f32_16x16x32_bf16 v[44:47], v[80:83], a[124:127], v[44:47]
ds_read_b64_tr_b16 v[106:107], v9 offset:43008
v_mfma_f32_16x16x32_bf16 v[44:47], v[84:87], a[140:143], v[44:47]
s_add_u32 m0, s34, 118784
s_add_u32 s31, s35, 332032
v_mfma_f32_16x16x32_bf16 v[212:215], v[108:111], v[136:139], v[212:215]
v_mfma_f32_16x16x32_bf16 v[212:215], v[80:83], v[140:143], v[212:215]
buffer_load_dwordx4 v10, s[20:23], s31 offen lds
v_mfma_f32_16x16x32_bf16 v[212:215], v[84:87], v[144:147], v[212:215]
s_waitcnt vmcnt(15)
s_barrier
s_waitcnt lgkmcnt(8)
v_mfma_f32_16x16x32_bf16 v[16:19], v[88:91], a[144:147], v[16:19]
ds_read_b64_tr_b16 v[108:109], v9 offset:45056
s_waitcnt lgkmcnt(7)
v_mfma_f32_16x16x32_bf16 v[48:51], v[92:95], a[0:3], 0
s_add_u32 m0, s34, 122880
s_add_u32 s31, s35, 384
s_waitcnt lgkmcnt(5)
v_mfma_f32_16x16x32_bf16 v[48:51], v[96:99], a[16:19], v[48:51]
ds_read_b64_tr_b16 v[110:111], v9 offset:47104
v_mfma_f32_16x16x32_bf16 v[24:27], v[88:91], a[148:151], v[24:27]
buffer_load_dwordx4 v10, s[20:23], s31 offen lds
v_mfma_f32_16x16x32_bf16 v[56:59], v[92:95], a[4:7], 0
ds_read_b64_tr_b16 v[80:81], v8 offset:49152
v_mfma_f32_16x16x32_bf16 v[56:59], v[96:99], a[20:23], v[56:59]
v_mfma_f32_16x16x32_bf16 v[32:35], v[88:91], a[152:155], v[32:35]
ds_read_b64_tr_b16 v[82:83], v8 offset:51200
s_add_u32 m0, s34, 126976
s_add_u32 s31, s35, 37248
v_mfma_f32_16x16x32_bf16 v[64:67], v[92:95], a[8:11], 0
v_mfma_f32_16x16x32_bf16 v[64:67], v[96:99], a[24:27], v[64:67]
ds_read_b64_tr_b16 v[84:85], v8 offset:53248
buffer_load_dwordx4 v10, s[20:23], s31 offen lds
v_mfma_f32_16x16x32_bf16 v[40:43], v[88:91], a[156:159], v[40:43]
v_mfma_f32_16x16x32_bf16 v[72:75], v[92:95], a[12:15], 0
ds_read_b64_tr_b16 v[86:87], v8 offset:55296
v_mfma_f32_16x16x32_bf16 v[72:75], v[96:99], a[28:31], v[72:75]
s_add_u32 m0, s34, 131072
s_add_u32 s31, s35, 74112
v_mfma_f32_16x16x32_bf16 v[208:211], v[88:91], v[148:151], v[208:211]
v_mfma_f32_16x16x32_bf16 v[216:219], v[92:95], v[112:115], 0
buffer_load_dwordx4 v10, s[20:23], s31 offen lds
v_mfma_f32_16x16x32_bf16 v[216:219], v[96:99], v[116:119], v[216:219]
s_waitcnt lgkmcnt(8)
v_mfma_f32_16x16x32_bf16 v[20:23], v[100:103], a[144:147], v[20:23]
ds_read_b64_tr_b16 v[88:89], v8 offset:57344
s_waitcnt lgkmcnt(7)
v_mfma_f32_16x16x32_bf16 v[52:55], v[104:107], a[0:3], 0
s_add_u32 m0, s34, 135168
s_add_u32 s31, s35, 110976
s_waitcnt lgkmcnt(5)
v_mfma_f32_16x16x32_bf16 v[52:55], v[108:111], a[16:19], v[52:55]
ds_read_b64_tr_b16 v[90:91], v8 offset:59392
v_mfma_f32_16x16x32_bf16 v[28:31], v[100:103], a[148:151], v[28:31]
buffer_load_dwordx4 v10, s[20:23], s31 offen lds
v_mfma_f32_16x16x32_bf16 v[60:63], v[104:107], a[4:7], 0
ds_read_b64_tr_b16 v[92:93], v9 offset:49152
v_mfma_f32_16x16x32_bf16 v[60:63], v[108:111], a[20:23], v[60:63]
v_mfma_f32_16x16x32_bf16 v[36:39], v[100:103], a[152:155], v[36:39]
ds_read_b64_tr_b16 v[94:95], v9 offset:51200
s_add_u32 m0, s34, 139264
s_add_u32 s31, s35, 147840
v_mfma_f32_16x16x32_bf16 v[68:71], v[104:107], a[8:11], 0
v_mfma_f32_16x16x32_bf16 v[68:71], v[108:111], a[24:27], v[68:71]
ds_read_b64_tr_b16 v[96:97], v9 offset:53248
buffer_load_dwordx4 v10, s[20:23], s31 offen lds
v_mfma_f32_16x16x32_bf16 v[44:47], v[100:103], a[156:159], v[44:47]
v_mfma_f32_16x16x32_bf16 v[76:79], v[104:107], a[12:15], 0
ds_read_b64_tr_b16 v[98:99], v9 offset:55296
v_mfma_f32_16x16x32_bf16 v[76:79], v[108:111], a[28:31], v[76:79]
s_add_u32 m0, s34, 143360
s_add_u32 s31, s35, 184704
v_mfma_f32_16x16x32_bf16 v[212:215], v[100:103], v[148:151], v[212:215]
v_mfma_f32_16x16x32_bf16 v[220:223], v[104:107], v[112:115], 0
buffer_load_dwordx4 v10, s[20:23], s31 offen lds
v_mfma_f32_16x16x32_bf16 v[220:223], v[108:111], v[116:119], v[220:223]
s_waitcnt vmcnt(18)
s_barrier
s_waitcnt lgkmcnt(8)
v_mfma_f32_16x16x32_bf16 v[48:51], v[80:83], a[32:35], v[48:51]
ds_read_b64_tr_b16 v[100:101], v9 offset:57344
s_waitcnt lgkmcnt(7)
v_mfma_f32_16x16x32_bf16 v[48:51], v[84:87], a[48:51], v[48:51]
s_add_u32 m0, s34, 0
s_add_u32 s31, s35, 221568
s_waitcnt lgkmcnt(5)
v_mfma_f32_16x16x32_bf16 v[48:51], v[88:91], a[64:67], v[48:51]
ds_read_b64_tr_b16 v[102:103], v9 offset:59392
s_add_u32 s37, s36, 0
v_mfma_f32_16x16x32_bf16 v[56:59], v[80:83], a[36:39], v[56:59]
buffer_load_dwordx4 v10, s[20:23], s31 offen lds
v_cvt_pk_bf16_f32 v176, v16, v17
v_mfma_f32_16x16x32_bf16 v[56:59], v[84:87], a[52:55], v[56:59]
ds_read_b64_tr_b16 v[104:105], v8 offset:61440
v_cvt_pk_bf16_f32 v177, v18, v19
v_mfma_f32_16x16x32_bf16 v[56:59], v[88:91], a[68:71], v[56:59]
v_cvt_pk_bf16_f32 v178, v20, v21
v_mfma_f32_16x16x32_bf16 v[64:67], v[80:83], a[40:43], v[64:67]
ds_read_b64_tr_b16 v[106:107], v8 offset:63488
s_add_u32 m0, s34, 4096
s_add_u32 s31, s35, 258432
v_mfma_f32_16x16x32_bf16 v[64:67], v[84:87], a[56:59], v[64:67]
v_cvt_pk_bf16_f32 v179, v22, v23
buffer_store_dwordx4 v[176:179], v11, s[8:11], s37 offen offset:0 sc1
v_mfma_f32_16x16x32_bf16 v[64:67], v[88:91], a[72:75], v[64:67]
ds_read_b64_tr_b16 v[108:109], v5 offset:0
buffer_load_dwordx4 v10, s[20:23], s31 offen lds
v_mfma_f32_16x16x32_bf16 v[72:75], v[80:83], a[44:47], v[72:75]
v_cvt_pk_bf16_f32 v180, v24, v25
v_mfma_f32_16x16x32_bf16 v[72:75], v[84:87], a[60:63], v[72:75]
ds_read_b64_tr_b16 v[110:111], v5 offset:2048
v_cvt_pk_bf16_f32 v181, v26, v27
v_mfma_f32_16x16x32_bf16 v[72:75], v[88:91], a[76:79], v[72:75]
s_add_u32 m0, s34, 8192
s_add_u32 s31, s35, 295296
v_cvt_pk_bf16_f32 v182, v28, v29
v_mfma_f32_16x16x32_bf16 v[216:219], v[80:83], v[120:123], v[216:219]
v_cvt_pk_bf16_f32 v183, v30, v31
v_mfma_f32_16x16x32_bf16 v[216:219], v[84:87], v[124:127], v[216:219]
buffer_load_dwordx4 v10, s[20:23], s31 offen lds
buffer_store_dwordx4 v[180:183], v11, s[8:11], s37 offen offset:1024 sc1
v_mfma_f32_16x16x32_bf16 v[216:219], v[88:91], v[128:131], v[216:219]
v_cvt_pk_bf16_f32 v184, v32, v33
v_cvt_pk_bf16_f32 v185, v34, v35
s_waitcnt lgkmcnt(8)
v_mfma_f32_16x16x32_bf16 v[52:55], v[92:95], a[32:35], v[52:55]
ds_read_b64_tr_b16 v[80:81], v5 offset:4096
s_waitcnt lgkmcnt(7)
v_mfma_f32_16x16x32_bf16 v[52:55], v[96:99], a[48:51], v[52:55]
s_add_u32 m0, s34, 12288
s_add_u32 s31, s35, 332160
v_cvt_pk_bf16_f32 v186, v36, v37
s_waitcnt lgkmcnt(5)
v_mfma_f32_16x16x32_bf16 v[52:55], v[100:103], a[64:67], v[52:55]
ds_read_b64_tr_b16 v[82:83], v5 offset:6144
v_cvt_pk_bf16_f32 v187, v38, v39
v_mfma_f32_16x16x32_bf16 v[60:63], v[92:95], a[36:39], v[60:63]
buffer_load_dwordx4 v10, s[20:23], s31 offen lds
buffer_store_dwordx4 v[184:187], v11, s[8:11], s37 offen offset:2048 sc1
v_mfma_f32_16x16x32_bf16 v[60:63], v[96:99], a[52:55], v[60:63]
ds_read_b64_tr_b16 v[84:85], v9 offset:61440
v_mfma_f32_16x16x32_bf16 v[60:63], v[100:103], a[68:71], v[60:63]
v_cvt_pk_bf16_f32 v188, v40, v41
v_cvt_pk_bf16_f32 v189, v42, v43
v_mfma_f32_16x16x32_bf16 v[68:71], v[92:95], a[40:43], v[68:71]
ds_read_b64_tr_b16 v[86:87], v9 offset:63488
s_add_u32 m0, s34, 16384
s_add_u32 s31, s35, 512
v_mfma_f32_16x16x32_bf16 v[68:71], v[96:99], a[56:59], v[68:71]
v_cvt_pk_bf16_f32 v190, v44, v45
v_cvt_pk_bf16_f32 v191, v46, v47
v_mfma_f32_16x16x32_bf16 v[68:71], v[100:103], a[72:75], v[68:71]
ds_read_b64_tr_b16 v[88:89], v6 offset:0
buffer_load_dwordx4 v10, s[20:23], s31 offen lds
v_mfma_f32_16x16x32_bf16 v[76:79], v[92:95], a[44:47], v[76:79]
buffer_store_dwordx4 v[188:191], v11, s[8:11], s37 offen offset:3072 sc1
v_mfma_f32_16x16x32_bf16 v[76:79], v[96:99], a[60:63], v[76:79]
ds_read_b64_tr_b16 v[90:91], v6 offset:2048
s_add_u32 s39, s38, 0
v_mfma_f32_16x16x32_bf16 v[76:79], v[100:103], a[76:79], v[76:79]
s_add_u32 m0, s34, 20480
s_add_u32 s31, s35, 37376
v_cvt_pk_bf16_f32 v192, v208, v209
v_mfma_f32_16x16x32_bf16 v[220:223], v[92:95], v[120:123], v[220:223]
v_cvt_pk_bf16_f32 v193, v210, v211
v_cvt_pk_bf16_f32 v194, v212, v213
v_mfma_f32_16x16x32_bf16 v[220:223], v[96:99], v[124:127], v[220:223]
buffer_load_dwordx4 v10, s[20:23], s31 offen lds
v_mfma_f32_16x16x32_bf16 v[220:223], v[100:103], v[128:131], v[220:223]
v_cvt_pk_bf16_f32 v195, v214, v215
buffer_store_dwordx4 v[192:195], v11, s[8:11], s39 offen sc1
s_waitcnt vmcnt(26)
s_barrier
s_waitcnt lgkmcnt(8)
v_mfma_f32_16x16x32_bf16 v[48:51], v[104:107], a[80:83], v[48:51]
ds_read_b64_tr_b16 v[92:93], v6 offset:4096
s_waitcnt lgkmcnt(7)
v_mfma_f32_16x16x32_bf16 v[48:51], v[108:111], a[96:99], v[48:51]
s_add_u32 m0, s34, 24576
s_add_u32 s31, s35, 74240
s_waitcnt lgkmcnt(5)
v_mfma_f32_16x16x32_bf16 v[48:51], v[80:83], a[112:115], v[48:51]
ds_read_b64_tr_b16 v[94:95], v6 offset:6144
v_mfma_f32_16x16x32_bf16 v[56:59], v[104:107], a[84:87], v[56:59]
buffer_load_dwordx4 v10, s[20:23], s31 offen lds
v_mfma_f32_16x16x32_bf16 v[56:59], v[108:111], a[100:103], v[56:59]
ds_read_b64_tr_b16 v[96:97], v5 offset:8192
v_mfma_f32_16x16x32_bf16 v[56:59], v[80:83], a[116:119], v[56:59]
v_mfma_f32_16x16x32_bf16 v[64:67], v[104:107], a[88:91], v[64:67]
ds_read_b64_tr_b16 v[98:99], v5 offset:10240
s_add_u32 m0, s34, 28672
s_add_u32 s31, s35, 111104
v_mfma_f32_16x16x32_bf16 v[64:67], v[108:111], a[104:107], v[64:67]
v_mfma_f32_16x16x32_bf16 v[64:67], v[80:83], a[120:123], v[64:67]
ds_read_b64_tr_b16 v[100:101], v5 offset:12288
buffer_load_dwordx4 v10, s[20:23], s31 offen lds
v_mfma_f32_16x16x32_bf16 v[72:75], v[104:107], a[92:95], v[72:75]
v_mfma_f32_16x16x32_bf16 v[72:75], v[108:111], a[108:111], v[72:75]
ds_read_b64_tr_b16 v[102:103], v5 offset:14336
v_mfma_f32_16x16x32_bf16 v[72:75], v[80:83], a[124:127], v[72:75]
s_add_u32 m0, s34, 32768
s_add_u32 s31, s35, 147968
v_mfma_f32_16x16x32_bf16 v[216:219], v[104:107], v[132:135], v[216:219]
v_mfma_f32_16x16x32_bf16 v[216:219], v[108:111], v[136:139], v[216:219]
buffer_load_dwordx4 v10, s[20:23], s31 offen lds
v_mfma_f32_16x16x32_bf16 v[216:219], v[80:83], v[140:143], v[216:219]
s_waitcnt lgkmcnt(8)
v_mfma_f32_16x16x32_bf16 v[52:55], v[84:87], a[80:83], v[52:55]
ds_read_b64_tr_b16 v[104:105], v5 offset:16384
s_waitcnt lgkmcnt(7)
v_mfma_f32_16x16x32_bf16 v[52:55], v[88:91], a[96:99], v[52:55]
s_add_u32 m0, s34, 36864
s_add_u32 s31, s35, 184832
s_waitcnt lgkmcnt(5)
v_mfma_f32_16x16x32_bf16 v[52:55], v[92:95], a[112:115], v[52:55]
ds_read_b64_tr_b16 v[106:107], v5 offset:18432
v_mfma_f32_16x16x32_bf16 v[60:63], v[84:87], a[84:87], v[60:63]
buffer_load_dwordx4 v10, s[20:23], s31 offen lds
v_mfma_f32_16x16x32_bf16 v[60:63], v[88:91], a[100:103], v[60:63]
ds_read_b64_tr_b16 v[108:109], v6 offset:8192
v_mfma_f32_16x16x32_bf16 v[60:63], v[92:95], a[116:119], v[60:63]
v_mfma_f32_16x16x32_bf16 v[68:71], v[84:87], a[88:91], v[68:71]
ds_read_b64_tr_b16 v[110:111], v6 offset:10240
s_add_u32 m0, s34, 40960
s_add_u32 s31, s35, 221696
v_mfma_f32_16x16x32_bf16 v[68:71], v[88:91], a[104:107], v[68:71]
v_mfma_f32_16x16x32_bf16 v[68:71], v[92:95], a[120:123], v[68:71]
ds_read_b64_tr_b16 v[80:81], v6 offset:12288
buffer_load_dwordx4 v10, s[20:23], s31 offen lds
v_mfma_f32_16x16x32_bf16 v[76:79], v[84:87], a[92:95], v[76:79]
v_mfma_f32_16x16x32_bf16 v[76:79], v[88:91], a[108:111], v[76:79]
ds_read_b64_tr_b16 v[82:83], v6 offset:14336
v_mfma_f32_16x16x32_bf16 v[76:79], v[92:95], a[124:127], v[76:79]
s_add_u32 m0, s34, 45056
s_add_u32 s31, s35, 258560
v_mfma_f32_16x16x32_bf16 v[220:223], v[84:87], v[132:135], v[220:223]
v_mfma_f32_16x16x32_bf16 v[220:223], v[88:91], v[136:139], v[220:223]
buffer_load_dwordx4 v10, s[20:23], s31 offen lds
v_mfma_f32_16x16x32_bf16 v[220:223], v[92:95], v[140:143], v[220:223]
s_waitcnt vmcnt(29)
s_barrier
s_waitcnt lgkmcnt(8)
v_mfma_f32_16x16x32_bf16 v[48:51], v[96:99], a[128:131], v[48:51]
ds_read_b64_tr_b16 v[84:85], v6 offset:16384
s_waitcnt lgkmcnt(7)
v_mfma_f32_16x16x32_bf16 v[48:51], v[100:103], a[144:147], v[48:51]
s_add_u32 m0, s34, 49152
s_add_u32 s31, s35, 295424
s_waitcnt lgkmcnt(5)
v_mfma_f32_16x16x32_bf16 v[16:19], v[104:107], a[0:3], 0
ds_read_b64_tr_b16 v[86:87], v6 offset:18432
v_mfma_f32_16x16x32_bf16 v[56:59], v[96:99], a[132:135], v[56:59]
buffer_load_dwordx4 v10, s[20:23], s31 offen lds
v_mfma_f32_16x16x32_bf16 v[56:59], v[100:103], a[148:151], v[56:59]
ds_read_b64_tr_b16 v[88:89], v5 offset:20480
v_mfma_f32_16x16x32_bf16 v[24:27], v[104:107], a[4:7], 0
v_mfma_f32_16x16x32_bf16 v[64:67], v[96:99], a[136:139], v[64:67]
ds_read_b64_tr_b16 v[90:91], v5 offset:22528
s_add_u32 m0, s34, 53248
s_add_u32 s31, s35, 332288
v_mfma_f32_16x16x32_bf16 v[64:67], v[100:103], a[152:155], v[64:67]
v_mfma_f32_16x16x32_bf16 v[32:35], v[104:107], a[8:11], 0
ds_read_b64_tr_b16 v[92:93], v5 offset:24576
buffer_load_dwordx4 v10, s[20:23], s31 offen lds
v_mfma_f32_16x16x32_bf16 v[72:75], v[96:99], a[140:143], v[72:75]
v_mfma_f32_16x16x32_bf16 v[72:75], v[100:103], a[156:159], v[72:75]
ds_read_b64_tr_b16 v[94:95], v5 offset:26624
v_mfma_f32_16x16x32_bf16 v[40:43], v[104:107], a[12:15], 0
s_add_u32 m0, s34, 57344
s_add_u32 s31, s35, 640
v_mfma_f32_16x16x32_bf16 v[216:219], v[96:99], v[144:147], v[216:219]
v_mfma_f32_16x16x32_bf16 v[216:219], v[100:103], v[148:151], v[216:219]
buffer_load_dwordx4 v10, s[20:23], s31 offen lds
v_mfma_f32_16x16x32_bf16 v[208:211], v[104:107], v[112:115], 0
s_waitcnt lgkmcnt(8)
v_mfma_f32_16x16x32_bf16 v[52:55], v[108:111], a[128:131], v[52:55]
ds_read_b64_tr_b16 v[96:97], v5 offset:28672
s_waitcnt lgkmcnt(7)
v_mfma_f32_16x16x32_bf16 v[52:55], v[80:83], a[144:147], v[52:55]
s_add_u32 m0, s34, 61440
s_add_u32 s31, s35, 37504
s_waitcnt lgkmcnt(5)
v_mfma_f32_16x16x32_bf16 v[20:23], v[84:87], a[0:3], 0
ds_read_b64_tr_b16 v[98:99], v5 offset:30720
v_mfma_f32_16x16x32_bf16 v[60:63], v[108:111], a[132:135], v[60:63]
buffer_load_dwordx4 v10, s[20:23], s31 offen lds
v_mfma_f32_16x16x32_bf16 v[60:63], v[80:83], a[148:151], v[60:63]
ds_read_b64_tr_b16 v[100:101], v6 offset:20480
v_mfma_f32_16x16x32_bf16 v[28:31], v[84:87], a[4:7], 0
v_mfma_f32_16x16x32_bf16 v[68:71], v[108:111], a[136:139], v[68:71]
ds_read_b64_tr_b16 v[102:103], v6 offset:22528
s_add_u32 m0, s34, 65536
s_add_u32 s31, s35, 74368
v_mfma_f32_16x16x32_bf16 v[68:71], v[80:83], a[152:155], v[68:71]
v_mfma_f32_16x16x32_bf16 v[36:39], v[84:87], a[8:11], 0
ds_read_b64_tr_b16 v[104:105], v6 offset:24576
buffer_load_dwordx4 v10, s[20:23], s31 offen lds
v_mfma_f32_16x16x32_bf16 v[76:79], v[108:111], a[140:143], v[76:79]
v_mfma_f32_16x16x32_bf16 v[76:79], v[80:83], a[156:159], v[76:79]
ds_read_b64_tr_b16 v[106:107], v6 offset:26624
v_mfma_f32_16x16x32_bf16 v[44:47], v[84:87], a[12:15], 0
s_add_u32 m0, s34, 69632
s_add_u32 s31, s35, 111232
v_mfma_f32_16x16x32_bf16 v[220:223], v[108:111], v[144:147], v[220:223]
v_mfma_f32_16x16x32_bf16 v[220:223], v[80:83], v[148:151], v[220:223]
buffer_load_dwordx4 v10, s[20:23], s31 offen lds
v_mfma_f32_16x16x32_bf16 v[212:215], v[84:87], v[112:115], 0
s_waitcnt vmcnt(32)
s_barrier
s_waitcnt lgkmcnt(8)
v_mfma_f32_16x16x32_bf16 v[16:19], v[88:91], a[16:19], v[16:19]
ds_read_b64_tr_b16 v[108:109], v6 offset:28672
s_waitcnt lgkmcnt(7)
v_mfma_f32_16x16x32_bf16 v[16:19], v[92:95], a[32:35], v[16:19]
s_add_u32 m0, s34, 73728
s_add_u32 s31, s35, 148096
s_waitcnt lgkmcnt(5)
v_mfma_f32_16x16x32_bf16 v[16:19], v[96:99], a[48:51], v[16:19]
ds_read_b64_tr_b16 v[110:111], v6 offset:30720
s_add_u32 s37, s36, 8192
v_mfma_f32_16x16x32_bf16 v[24:27], v[88:91], a[20:23], v[24:27]
buffer_load_dwordx4 v10, s[20:23], s31 offen lds
v_cvt_pk_bf16_f32 v176, v48, v49
v_mfma_f32_16x16x32_bf16 v[24:27], v[92:95], a[36:39], v[24:27]
ds_read_b64_tr_b16 v[80:81], v5 offset:32768
v_mfma_f32_16x16x32_bf16 v[24:27], v[96:99], a[52:55], v[24:27]
v_cvt_pk_bf16_f32 v177, v50, v51
v_cvt_pk_bf16_f32 v178, v52, v53
v_mfma_f32_16x16x32_bf16 v[32:35], v[88:91], a[24:27], v[32:35]
ds_read_b64_tr_b16 v[82:83], v5 offset:34816
v_mfma_f32_16x16x32_bf16 v[32:35], v[92:95], a[40:43], v[32:35]
v_cvt_pk_bf16_f32 v179, v54, v55
v_mfma_f32_16x16x32_bf16 v[32:35], v[96:99], a[56:59], v[32:35]
ds_read_b64_tr_b16 v[84:85], v5 offset:36864
buffer_store_dwordx4 v[176:179], v11, s[8:11], s37 offen offset:0 sc1
v_mfma_f32_16x16x32_bf16 v[40:43], v[88:91], a[28:31], v[40:43]
v_cvt_pk_bf16_f32 v180, v56, v57
v_mfma_f32_16x16x32_bf16 v[40:43], v[92:95], a[44:47], v[40:43]
ds_read_b64_tr_b16 v[86:87], v5 offset:38912
v_cvt_pk_bf16_f32 v181, v58, v59
v_mfma_f32_16x16x32_bf16 v[40:43], v[96:99], a[60:63], v[40:43]
s_add_u32 m0, s34, 77824
s_add_u32 s31, s35, 184960
v_cvt_pk_bf16_f32 v182, v60, v61
v_mfma_f32_16x16x32_bf16 v[208:211], v[88:91], v[116:119], v[208:211]
v_cvt_pk_bf16_f32 v183, v62, v63
v_mfma_f32_16x16x32_bf16 v[208:211], v[92:95], v[120:123], v[208:211]
buffer_load_dwordx4 v10, s[20:23], s31 offen lds
buffer_store_dwordx4 v[180:183], v11, s[8:11], s37 offen offset:1024 sc1
v_mfma_f32_16x16x32_bf16 v[208:211], v[96:99], v[124:127], v[208:211]
v_cvt_pk_bf16_f32 v184, v64, v65
s_waitcnt lgkmcnt(8)
v_mfma_f32_16x16x32_bf16 v[20:23], v[100:103], a[16:19], v[20:23]
ds_read_b64_tr_b16 v[88:89], v5 offset:40960
v_cvt_pk_bf16_f32 v185, v66, v67
s_waitcnt lgkmcnt(7)
v_mfma_f32_16x16x32_bf16 v[20:23], v[104:107], a[32:35], v[20:23]
v_cvt_pk_bf16_f32 v186, v68, v69
s_waitcnt lgkmcnt(5)
v_mfma_f32_16x16x32_bf16 v[20:23], v[108:111], a[48:51], v[20:23]
ds_read_b64_tr_b16 v[90:91], v5 offset:43008
v_mfma_f32_16x16x32_bf16 v[28:31], v[100:103], a[20:23], v[28:31]
v_cvt_pk_bf16_f32 v187, v70, v71
buffer_store_dwordx4 v[184:187], v11, s[8:11], s37 offen offset:2048 sc1
v_mfma_f32_16x16x32_bf16 v[28:31], v[104:107], a[36:39], v[28:31]
ds_read_b64_tr_b16 v[92:93], v6 offset:32768
v_mfma_f32_16x16x32_bf16 v[28:31], v[108:111], a[52:55], v[28:31]
v_cvt_pk_bf16_f32 v188, v72, v73
v_cvt_pk_bf16_f32 v189, v74, v75
v_mfma_f32_16x16x32_bf16 v[36:39], v[100:103], a[24:27], v[36:39]
ds_read_b64_tr_b16 v[94:95], v6 offset:34816
s_add_u32 m0, s34, 81920
s_add_u32 s31, s35, 221824
v_mfma_f32_16x16x32_bf16 v[36:39], v[104:107], a[40:43], v[36:39]
v_cvt_pk_bf16_f32 v190, v76, v77
v_mfma_f32_16x16x32_bf16 v[36:39], v[108:111], a[56:59], v[36:39]
ds_read_b64_tr_b16 v[96:97], v6 offset:36864
buffer_load_dwordx4 v10, s[20:23], s31 offen lds
v_mfma_f32_16x16x32_bf16 v[44:47], v[100:103], a[28:31], v[44:47]
v_cvt_pk_bf16_f32 v191, v78, v79
v_mfma_f32_16x16x32_bf16 v[44:47], v[104:107], a[44:47], v[44:47]
ds_read_b64_tr_b16 v[98:99], v6 offset:38912
v_mfma_f32_16x16x32_bf16 v[44:47], v[108:111], a[60:63], v[44:47]
buffer_store_dwordx4 v[188:191], v11, s[8:11], s37 offen offset:3072 sc1
s_add_u32 s39, s38, 8192
v_cvt_pk_bf16_f32 v192, v216, v217
v_mfma_f32_16x16x32_bf16 v[212:215], v[100:103], v[116:119], v[212:215]
v_cvt_pk_bf16_f32 v193, v218, v219
v_mfma_f32_16x16x32_bf16 v[212:215], v[104:107], v[120:123], v[212:215]
v_cvt_pk_bf16_f32 v194, v220, v221
v_cvt_pk_bf16_f32 v195, v222, v223
v_mfma_f32_16x16x32_bf16 v[212:215], v[108:111], v[124:127], v[212:215]
buffer_store_dwordx4 v[192:195], v11, s[8:11], s39 offen sc1
s_waitcnt vmcnt(37)
s_barrier
s_waitcnt lgkmcnt(8)
v_mfma_f32_16x16x32_bf16 v[16:19], v[80:83], a[64:67], v[16:19]
ds_read_b64_tr_b16 v[100:101], v6 offset:40960
s_waitcnt lgkmcnt(7)
v_mfma_f32_16x16x32_bf16 v[16:19], v[84:87], a[80:83], v[16:19]
s_add_u32 m0, s34, 86016
s_add_u32 s31, s35, 258688
s_waitcnt lgkmcnt(5)
v_mfma_f32_16x16x32_bf16 v[16:19], v[88:91], a[96:99], v[16:19]
ds_read_b64_tr_b16 v[102:103], v6 offset:43008
v_mfma_f32_16x16x32_bf16 v[24:27], v[80:83], a[68:71], v[24:27]
buffer_load_dwordx4 v10, s[20:23], s31 offen lds
v_mfma_f32_16x16x32_bf16 v[24:27], v[84:87], a[84:87], v[24:27]
ds_read_b64_tr_b16 v[104:105], v5 offset:45056
v_mfma_f32_16x16x32_bf16 v[24:27], v[88:91], a[100:103], v[24:27]
v_mfma_f32_16x16x32_bf16 v[32:35], v[80:83], a[72:75], v[32:35]
ds_read_b64_tr_b16 v[106:107], v5 offset:47104
v_mfma_f32_16x16x32_bf16 v[32:35], v[84:87], a[88:91], v[32:35]
v_mfma_f32_16x16x32_bf16 v[32:35], v[88:91], a[104:107], v[32:35]
ds_read_b64_tr_b16 v[108:109], v5 offset:49152
v_mfma_f32_16x16x32_bf16 v[40:43], v[80:83], a[76:79], v[40:43]
v_mfma_f32_16x16x32_bf16 v[40:43], v[84:87], a[92:95], v[40:43]
ds_read_b64_tr_b16 v[110:111], v5 offset:51200
v_mfma_f32_16x16x32_bf16 v[40:43], v[88:91], a[108:111], v[40:43]
s_add_u32 m0, s34, 90112
s_add_u32 s31, s35, 295552
v_mfma_f32_16x16x32_bf16 v[208:211], v[80:83], v[128:131], v[208:211]
v_mfma_f32_16x16x32_bf16 v[208:211], v[84:87], v[132:135], v[208:211]
buffer_load_dwordx4 v10, s[20:23], s31 offen lds
v_mfma_f32_16x16x32_bf16 v[208:211], v[88:91], v[136:139], v[208:211]
s_waitcnt lgkmcnt(8)
v_mfma_f32_16x16x32_bf16 v[20:23], v[92:95], a[64:67], v[20:23]
ds_read_b64_tr_b16 v[80:81], v5 offset:53248
s_waitcnt lgkmcnt(7)
v_mfma_f32_16x16x32_bf16 v[20:23], v[96:99], a[80:83], v[20:23]
s_waitcnt lgkmcnt(5)
v_mfma_f32_16x16x32_bf16 v[20:23], v[100:103], a[96:99], v[20:23]
ds_read_b64_tr_b16 v[82:83], v5 offset:55296
v_mfma_f32_16x16x32_bf16 v[28:31], v[92:95], a[68:71], v[28:31]
v_mfma_f32_16x16x32_bf16 v[28:31], v[96:99], a[84:87], v[28:31]
ds_read_b64_tr_b16 v[84:85], v6 offset:45056
v_mfma_f32_16x16x32_bf16 v[28:31], v[100:103], a[100:103], v[28:31]
v_mfma_f32_16x16x32_bf16 v[36:39], v[92:95], a[72:75], v[36:39]
ds_read_b64_tr_b16 v[86:87], v6 offset:47104
s_add_u32 m0, s34, 94208
s_add_u32 s31, s35, 332416
v_mfma_f32_16x16x32_bf16 v[36:39], v[96:99], a[88:91], v[36:39]
v_mfma_f32_16x16x32_bf16 v[36:39], v[100:103], a[104:107], v[36:39]
ds_read_b64_tr_b16 v[88:89], v6 offset:49152
buffer_load_dwordx4 v10, s[20:23], s31 offen lds
v_mfma_f32_16x16x32_bf16 v[44:47], v[92:95], a[76:79], v[44:47]
v_mfma_f32_16x16x32_bf16 v[44:47], v[96:99], a[92:95], v[44:47]
ds_read_b64_tr_b16 v[90:91], v6 offset:51200
v_mfma_f32_16x16x32_bf16 v[44:47], v[100:103], a[108:111], v[44:47]
v_mfma_f32_16x16x32_bf16 v[212:215], v[92:95], v[128:131], v[212:215]
v_mfma_f32_16x16x32_bf16 v[212:215], v[96:99], v[132:135], v[212:215]
v_mfma_f32_16x16x32_bf16 v[212:215], v[100:103], v[136:139], v[212:215]
s_waitcnt vmcnt(37)
s_barrier
s_waitcnt lgkmcnt(8)
v_mfma_f32_16x16x32_bf16 v[16:19], v[104:107], a[112:115], v[16:19]
ds_read_b64_tr_b16 v[92:93], v6 offset:53248
s_waitcnt lgkmcnt(7)
v_mfma_f32_16x16x32_bf16 v[16:19], v[108:111], a[128:131], v[16:19]
s_add_u32 m0, s34, 98304
s_add_u32 s31, s35, 768
s_waitcnt lgkmcnt(5)
v_mfma_f32_16x16x32_bf16 v[16:19], v[80:83], a[144:147], v[16:19]
ds_read_b64_tr_b16 v[94:95], v6 offset:55296
v_mfma_f32_16x16x32_bf16 v[24:27], v[104:107], a[116:119], v[24:27]
buffer_load_dwordx4 v10, s[20:23], s31 offen lds
v_mfma_f32_16x16x32_bf16 v[24:27], v[108:111], a[132:135], v[24:27]
ds_read_b64_tr_b16 v[96:97], v5 offset:57344
v_mfma_f32_16x16x32_bf16 v[24:27], v[80:83], a[148:151], v[24:27]
v_mfma_f32_16x16x32_bf16 v[32:35], v[104:107], a[120:123], v[32:35]
ds_read_b64_tr_b16 v[98:99], v5 offset:59392
v_mfma_f32_16x16x32_bf16 v[32:35], v[108:111], a[136:139], v[32:35]
v_mfma_f32_16x16x32_bf16 v[32:35], v[80:83], a[152:155], v[32:35]
ds_read_b64_tr_b16 v[100:101], v5 offset:61440
v_mfma_f32_16x16x32_bf16 v[40:43], v[104:107], a[124:127], v[40:43]
v_mfma_f32_16x16x32_bf16 v[40:43], v[108:111], a[140:143], v[40:43]
ds_read_b64_tr_b16 v[102:103], v5 offset:63488
v_mfma_f32_16x16x32_bf16 v[40:43], v[80:83], a[156:159], v[40:43]
s_add_u32 m0, s34, 102400
s_add_u32 s31, s35, 37632
v_mfma_f32_16x16x32_bf16 v[208:211], v[104:107], v[140:143], v[208:211]
v_mfma_f32_16x16x32_bf16 v[208:211], v[108:111], v[144:147], v[208:211]
buffer_load_dwordx4 v10, s[20:23], s31 offen lds
v_mfma_f32_16x16x32_bf16 v[208:211], v[80:83], v[148:151], v[208:211]
s_waitcnt lgkmcnt(8)
v_mfma_f32_16x16x32_bf16 v[20:23], v[84:87], a[112:115], v[20:23]
ds_read_b64_tr_b16 v[104:105], v2 offset:0
s_waitcnt lgkmcnt(7)
v_mfma_f32_16x16x32_bf16 v[20:23], v[88:91], a[128:131], v[20:23]
s_waitcnt lgkmcnt(5)
v_mfma_f32_16x16x32_bf16 v[20:23], v[92:95], a[144:147], v[20:23]
ds_read_b64_tr_b16 v[106:107], v2 offset:2048
v_mfma_f32_16x16x32_bf16 v[28:31], v[84:87], a[116:119], v[28:31]
v_mfma_f32_16x16x32_bf16 v[28:31], v[88:91], a[132:135], v[28:31]
ds_read_b64_tr_b16 v[108:109], v6 offset:57344
v_mfma_f32_16x16x32_bf16 v[28:31], v[92:95], a[148:151], v[28:31]
v_mfma_f32_16x16x32_bf16 v[36:39], v[84:87], a[120:123], v[36:39]
ds_read_b64_tr_b16 v[110:111], v6 offset:59392
s_add_u32 m0, s34, 106496
s_add_u32 s31, s35, 74496
v_mfma_f32_16x16x32_bf16 v[36:39], v[88:91], a[136:139], v[36:39]
v_mfma_f32_16x16x32_bf16 v[36:39], v[92:95], a[152:155], v[36:39]
ds_read_b64_tr_b16 v[80:81], v6 offset:61440
buffer_load_dwordx4 v10, s[20:23], s31 offen lds
v_mfma_f32_16x16x32_bf16 v[44:47], v[84:87], a[124:127], v[44:47]
v_mfma_f32_16x16x32_bf16 v[44:47], v[88:91], a[140:143], v[44:47]
ds_read_b64_tr_b16 v[82:83], v6 offset:63488
v_mfma_f32_16x16x32_bf16 v[44:47], v[92:95], a[156:159], v[44:47]
v_mfma_f32_16x16x32_bf16 v[212:215], v[84:87], v[140:143], v[212:215]
v_mfma_f32_16x16x32_bf16 v[212:215], v[88:91], v[144:147], v[212:215]
v_mfma_f32_16x16x32_bf16 v[212:215], v[92:95], v[148:151], v[212:215]
s_waitcnt vmcnt(37)
s_barrier
s_waitcnt lgkmcnt(8)
v_mfma_f32_16x16x32_bf16 v[48:51], v[96:99], a[0:3], 0
ds_read_b64_tr_b16 v[84:85], v3 offset:0
s_waitcnt lgkmcnt(7)
v_mfma_f32_16x16x32_bf16 v[48:51], v[100:103], a[16:19], v[48:51]
s_add_u32 m0, s34, 110592
s_add_u32 s31, s35, 111360
s_waitcnt lgkmcnt(5)
v_mfma_f32_16x16x32_bf16 v[48:51], v[104:107], a[32:35], v[48:51]
ds_read_b64_tr_b16 v[86:87], v3 offset:2048
s_add_u32 s37, s36, 16384
v_mfma_f32_16x16x32_bf16 v[56:59], v[96:99], a[4:7], 0
buffer_load_dwordx4 v10, s[20:23], s31 offen lds
v_cvt_pk_bf16_f32 v176, v16, v17
v_mfma_f32_16x16x32_bf16 v[56:59], v[100:103], a[20:23], v[56:59]
ds_read_b64_tr_b16 v[88:89], v2 offset:4096
v_mfma_f32_16x16x32_bf16 v[56:59], v[104:107], a[36:39], v[56:59]
v_cvt_pk_bf16_f32 v177, v18, v19
v_cvt_pk_bf16_f32 v178, v20, v21
v_mfma_f32_16x16x32_bf16 v[64:67], v[96:99], a[8:11], 0
ds_read_b64_tr_b16 v[90:91], v2 offset:6144
v_mfma_f32_16x16x32_bf16 v[64:67], v[100:103], a[24:27], v[64:67]
v_cvt_pk_bf16_f32 v179, v22, v23
v_mfma_f32_16x16x32_bf16 v[64:67], v[104:107], a[40:43], v[64:67]
ds_read_b64_tr_b16 v[92:93], v2 offset:8192
buffer_store_dwordx4 v[176:179], v11, s[8:11], s37 offen offset:0 sc1
v_mfma_f32_16x16x32_bf16 v[72:75], v[96:99], a[12:15], 0
v_cvt_pk_bf16_f32 v180, v24, v25
v_mfma_f32_16x16x32_bf16 v[72:75], v[100:103], a[28:31], v[72:75]
ds_read_b64_tr_b16 v[94:95], v2 offset:10240
v_cvt_pk_bf16_f32 v181, v26, v27
v_mfma_f32_16x16x32_bf16 v[72:75], v[104:107], a[44:47], v[72:75]
s_add_u32 m0, s34, 114688
s_add_u32 s31, s35, 148224
v_cvt_pk_bf16_f32 v182, v28, v29
v_mfma_f32_16x16x32_bf16 v[216:219], v[96:99], v[112:115], 0
v_cvt_pk_bf16_f32 v183, v30, v31
v_mfma_f32_16x16x32_bf16 v[216:219], v[100:103], v[116:119], v[216:219]
buffer_load_dwordx4 v10, s[20:23], s31 offen lds
buffer_store_dwordx4 v[180:183], v11, s[8:11], s37 offen offset:1024 sc1
v_mfma_f32_16x16x32_bf16 v[216:219], v[104:107], v[120:123], v[216:219]
v_cvt_pk_bf16_f32 v184, v32, v33
s_waitcnt lgkmcnt(8)
v_mfma_f32_16x16x32_bf16 v[52:55], v[108:111], a[0:3], 0
ds_read_b64_tr_b16 v[96:97], v2 offset:12288
v_cvt_pk_bf16_f32 v185, v34, v35
s_waitcnt lgkmcnt(7)
v_mfma_f32_16x16x32_bf16 v[52:55], v[80:83], a[16:19], v[52:55]
v_cvt_pk_bf16_f32 v186, v36, v37
s_waitcnt lgkmcnt(5)
v_mfma_f32_16x16x32_bf16 v[52:55], v[84:87], a[32:35], v[52:55]
ds_read_b64_tr_b16 v[98:99], v2 offset:14336
v_mfma_f32_16x16x32_bf16 v[60:63], v[108:111], a[4:7], 0
v_cvt_pk_bf16_f32 v187, v38, v39
buffer_store_dwordx4 v[184:187], v11, s[8:11], s37 offen offset:2048 sc1
v_mfma_f32_16x16x32_bf16 v[60:63], v[80:83], a[20:23], v[60:63]
ds_read_b64_tr_b16 v[100:101], v3 offset:4096
v_mfma_f32_16x16x32_bf16 v[60:63], v[84:87], a[36:39], v[60:63]
v_cvt_pk_bf16_f32 v188, v40, v41
v_cvt_pk_bf16_f32 v189, v42, v43
v_mfma_f32_16x16x32_bf16 v[68:71], v[108:111], a[8:11], 0
ds_read_b64_tr_b16 v[102:103], v3 offset:6144
s_add_u32 m0, s34, 118784
s_add_u32 s31, s35, 185088
v_mfma_f32_16x16x32_bf16 v[68:71], v[80:83], a[24:27], v[68:71]
v_cvt_pk_bf16_f32 v190, v44, v45
v_mfma_f32_16x16x32_bf16 v[68:71], v[84:87], a[40:43], v[68:71]
ds_read_b64_tr_b16 v[104:105], v3 offset:8192
buffer_load_dwordx4 v10, s[20:23], s31 offen lds
v_mfma_f32_16x16x32_bf16 v[76:79], v[108:111], a[12:15], 0
v_cvt_pk_bf16_f32 v191, v46, v47
v_mfma_f32_16x16x32_bf16 v[76:79], v[80:83], a[28:31], v[76:79]
ds_read_b64_tr_b16 v[106:107], v3 offset:10240
v_mfma_f32_16x16x32_bf16 v[76:79], v[84:87], a[44:47], v[76:79]
buffer_store_dwordx4 v[188:191], v11, s[8:11], s37 offen offset:3072 sc1
s_add_u32 s39, s38, 16384
v_cvt_pk_bf16_f32 v192, v208, v209
v_mfma_f32_16x16x32_bf16 v[220:223], v[108:111], v[112:115], 0
v_cvt_pk_bf16_f32 v193, v210, v211
v_mfma_f32_16x16x32_bf16 v[220:223], v[80:83], v[116:119], v[220:223]
v_cvt_pk_bf16_f32 v194, v212, v213
v_cvt_pk_bf16_f32 v195, v214, v215
v_mfma_f32_16x16x32_bf16 v[220:223], v[84:87], v[120:123], v[220:223]
buffer_store_dwordx4 v[192:195], v11, s[8:11], s39 offen sc1
s_waitcnt vmcnt(41)
s_barrier
s_waitcnt lgkmcnt(8)
v_mfma_f32_16x16x32_bf16 v[48:51], v[88:91], a[48:51], v[48:51]
ds_read_b64_tr_b16 v[108:109], v3 offset:12288
s_waitcnt lgkmcnt(7)
v_mfma_f32_16x16x32_bf16 v[48:51], v[92:95], a[64:67], v[48:51]
s_add_u32 m0, s34, 122880
s_add_u32 s31, s35, 221952
s_waitcnt lgkmcnt(5)
v_mfma_f32_16x16x32_bf16 v[48:51], v[96:99], a[80:83], v[48:51]
ds_read_b64_tr_b16 v[110:111], v3 offset:14336
v_mfma_f32_16x16x32_bf16 v[56:59], v[88:91], a[52:55], v[56:59]
buffer_load_dwordx4 v10, s[20:23], s31 offen lds
v_mfma_f32_16x16x32_bf16 v[56:59], v[92:95], a[68:71], v[56:59]
ds_read_b64_tr_b16 v[80:81], v8 offset:0
v_mfma_f32_16x16x32_bf16 v[56:59], v[96:99], a[84:87], v[56:59]
v_mfma_f32_16x16x32_bf16 v[64:67], v[88:91], a[56:59], v[64:67]
ds_read_b64_tr_b16 v[82:83], v8 offset:2048
v_mfma_f32_16x16x32_bf16 v[64:67], v[92:95], a[72:75], v[64:67]
v_mfma_f32_16x16x32_bf16 v[64:67], v[96:99], a[88:91], v[64:67]
ds_read_b64_tr_b16 v[84:85], v8 offset:4096
v_mfma_f32_16x16x32_bf16 v[72:75], v[88:91], a[60:63], v[72:75]
v_mfma_f32_16x16x32_bf16 v[72:75], v[92:95], a[76:79], v[72:75]
ds_read_b64_tr_b16 v[86:87], v8 offset:6144
v_mfma_f32_16x16x32_bf16 v[72:75], v[96:99], a[92:95], v[72:75]
s_add_u32 m0, s34, 126976
s_add_u32 s31, s35, 258816
v_mfma_f32_16x16x32_bf16 v[216:219], v[88:91], v[124:127], v[216:219]
v_mfma_f32_16x16x32_bf16 v[216:219], v[92:95], v[128:131], v[216:219]
buffer_load_dwordx4 v10, s[20:23], s31 offen lds
v_mfma_f32_16x16x32_bf16 v[216:219], v[96:99], v[132:135], v[216:219]
s_waitcnt lgkmcnt(8)
v_mfma_f32_16x16x32_bf16 v[52:55], v[100:103], a[48:51], v[52:55]
ds_read_b64_tr_b16 v[88:89], v8 offset:8192
s_waitcnt lgkmcnt(7)
v_mfma_f32_16x16x32_bf16 v[52:55], v[104:107], a[64:67], v[52:55]
s_waitcnt lgkmcnt(5)
v_mfma_f32_16x16x32_bf16 v[52:55], v[108:111], a[80:83], v[52:55]
ds_read_b64_tr_b16 v[90:91], v8 offset:10240
v_mfma_f32_16x16x32_bf16 v[60:63], v[100:103], a[52:55], v[60:63]
v_mfma_f32_16x16x32_bf16 v[60:63], v[104:107], a[68:71], v[60:63]
ds_read_b64_tr_b16 v[92:93], v9 offset:0
v_mfma_f32_16x16x32_bf16 v[60:63], v[108:111], a[84:87], v[60:63]
v_mfma_f32_16x16x32_bf16 v[68:71], v[100:103], a[56:59], v[68:71]
ds_read_b64_tr_b16 v[94:95], v9 offset:2048
s_add_u32 m0, s34, 131072
s_add_u32 s31, s35, 295680
v_mfma_f32_16x16x32_bf16 v[68:71], v[104:107], a[72:75], v[68:71]
v_mfma_f32_16x16x32_bf16 v[68:71], v[108:111], a[88:91], v[68:71]
ds_read_b64_tr_b16 v[96:97], v9 offset:4096
buffer_load_dwordx4 v10, s[20:23], s31 offen lds
v_mfma_f32_16x16x32_bf16 v[76:79], v[100:103], a[60:63], v[76:79]
v_mfma_f32_16x16x32_bf16 v[76:79], v[104:107], a[76:79], v[76:79]
ds_read_b64_tr_b16 v[98:99], v9 offset:6144
v_mfma_f32_16x16x32_bf16 v[76:79], v[108:111], a[92:95], v[76:79]
v_mfma_f32_16x16x32_bf16 v[220:223], v[100:103], v[124:127], v[220:223]
v_mfma_f32_16x16x32_bf16 v[220:223], v[104:107], v[128:131], v[220:223]
v_mfma_f32_16x16x32_bf16 v[220:223], v[108:111], v[132:135], v[220:223]
s_waitcnt vmcnt(38)
s_barrier
s_waitcnt lgkmcnt(8)
v_mfma_f32_16x16x32_bf16 v[48:51], v[80:83], a[96:99], v[48:51]
ds_read_b64_tr_b16 v[100:101], v9 offset:8192
s_waitcnt lgkmcnt(7)
v_mfma_f32_16x16x32_bf16 v[48:51], v[84:87], a[112:115], v[48:51]
s_add_u32 m0, s34, 135168
s_add_u32 s31, s35, 332544
s_waitcnt lgkmcnt(5)
v_mfma_f32_16x16x32_bf16 v[48:51], v[88:91], a[128:131], v[48:51]
ds_read_b64_tr_b16 v[102:103], v9 offset:10240
v_mfma_f32_16x16x32_bf16 v[56:59], v[80:83], a[100:103], v[56:59]
buffer_load_dwordx4 v10, s[20:23], s31 offen lds
v_mfma_f32_16x16x32_bf16 v[56:59], v[84:87], a[116:119], v[56:59]
ds_read_b64_tr_b16 v[104:105], v8 offset:12288
v_mfma_f32_16x16x32_bf16 v[56:59], v[88:91], a[132:135], v[56:59]
v_mfma_f32_16x16x32_bf16 v[64:67], v[80:83], a[104:107], v[64:67]
ds_read_b64_tr_b16 v[106:107], v8 offset:14336
v_mfma_f32_16x16x32_bf16 v[64:67], v[84:87], a[120:123], v[64:67]
v_mfma_f32_16x16x32_bf16 v[64:67], v[88:91], a[136:139], v[64:67]
ds_read_b64_tr_b16 v[108:109], v8 offset:16384
v_mfma_f32_16x16x32_bf16 v[72:75], v[80:83], a[108:111], v[72:75]
v_mfma_f32_16x16x32_bf16 v[72:75], v[84:87], a[124:127], v[72:75]
ds_read_b64_tr_b16 v[110:111], v8 offset:18432
v_mfma_f32_16x16x32_bf16 v[72:75], v[88:91], a[140:143], v[72:75]
s_add_u32 m0, s34, 139264
s_add_u32 s31, s35, 896
v_mfma_f32_16x16x32_bf16 v[216:219], v[80:83], v[136:139], v[216:219]
v_mfma_f32_16x16x32_bf16 v[216:219], v[84:87], v[140:143], v[216:219]
buffer_load_dwordx4 v10, s[20:23], s31 offen lds
v_mfma_f32_16x16x32_bf16 v[216:219], v[88:91], v[144:147], v[216:219]
s_waitcnt lgkmcnt(8)
v_mfma_f32_16x16x32_bf16 v[52:55], v[92:95], a[96:99], v[52:55]
ds_read_b64_tr_b16 v[80:81], v8 offset:20480
s_waitcnt lgkmcnt(7)
v_mfma_f32_16x16x32_bf16 v[52:55], v[96:99], a[112:115], v[52:55]
s_waitcnt lgkmcnt(5)
v_mfma_f32_16x16x32_bf16 v[52:55], v[100:103], a[128:131], v[52:55]
ds_read_b64_tr_b16 v[82:83], v8 offset:22528
v_mfma_f32_16x16x32_bf16 v[60:63], v[92:95], a[100:103], v[60:63]
v_mfma_f32_16x16x32_bf16 v[60:63], v[96:99], a[116:119], v[60:63]
ds_read_b64_tr_b16 v[84:85], v9 offset:12288
v_mfma_f32_16x16x32_bf16 v[60:63], v[100:103], a[132:135], v[60:63]
v_mfma_f32_16x16x32_bf16 v[68:71], v[92:95], a[104:107], v[68:71]
ds_read_b64_tr_b16 v[86:87], v9 offset:14336
s_add_u32 m0, s34, 143360
s_add_u32 s31, s35, 37760
v_mfma_f32_16x16x32_bf16 v[68:71], v[96:99], a[120:123], v[68:71]
v_mfma_f32_16x16x32_bf16 v[68:71], v[100:103], a[136:139], v[68:71]
ds_read_b64_tr_b16 v[88:89], v9 offset:16384
buffer_load_dwordx4 v10, s[20:23], s31 offen lds
v_mfma_f32_16x16x32_bf16 v[76:79], v[92:95], a[108:111], v[76:79]
v_mfma_f32_16x16x32_bf16 v[76:79], v[96:99], a[124:127], v[76:79]
ds_read_b64_tr_b16 v[90:91], v9 offset:18432
v_mfma_f32_16x16x32_bf16 v[76:79], v[100:103], a[140:143], v[76:79]
v_mfma_f32_16x16x32_bf16 v[220:223], v[92:95], v[136:139], v[220:223]
v_mfma_f32_16x16x32_bf16 v[220:223], v[96:99], v[140:143], v[220:223]
v_mfma_f32_16x16x32_bf16 v[220:223], v[100:103], v[144:147], v[220:223]
s_waitcnt vmcnt(37)
s_barrier
s_waitcnt lgkmcnt(8)
v_mfma_f32_16x16x32_bf16 v[48:51], v[104:107], a[144:147], v[48:51]
ds_read_b64_tr_b16 v[92:93], v9 offset:20480
s_waitcnt lgkmcnt(7)
v_mfma_f32_16x16x32_bf16 v[16:19], v[108:111], a[0:3], 0
s_add_u32 m0, s34, 0
s_add_u32 s31, s35, 74624
s_waitcnt lgkmcnt(5)
v_mfma_f32_16x16x32_bf16 v[16:19], v[80:83], a[16:19], v[16:19]
ds_read_b64_tr_b16 v[94:95], v9 offset:22528
v_mfma_f32_16x16x32_bf16 v[56:59], v[104:107], a[148:151], v[56:59]
buffer_load_dwordx4 v10, s[20:23], s31 offen lds
v_mfma_f32_16x16x32_bf16 v[24:27], v[108:111], a[4:7], 0
ds_read_b64_tr_b16 v[96:97], v8 offset:24576
v_mfma_f32_16x16x32_bf16 v[24:27], v[80:83], a[20:23], v[24:27]
v_mfma_f32_16x16x32_bf16 v[64:67], v[104:107], a[152:155], v[64:67]
ds_read_b64_tr_b16 v[98:99], v8 offset:26624
v_mfma_f32_16x16x32_bf16 v[32:35], v[108:111], a[8:11], 0
v_mfma_f32_16x16x32_bf16 v[32:35], v[80:83], a[24:27], v[32:35]
ds_read_b64_tr_b16 v[100:101], v8 offset:28672
v_mfma_f32_16x16x32_bf16 v[72:75], v[104:107], a[156:159], v[72:75]
v_mfma_f32_16x16x32_bf16 v[40:43], v[108:111], a[12:15], 0
ds_read_b64_tr_b16 v[102:103], v8 offset:30720
v_mfma_f32_16x16x32_bf16 v[40:43], v[80:83], a[28:31], v[40:43]
s_add_u32 m0, s34, 4096
s_add_u32 s31, s35, 111488
v_mfma_f32_16x16x32_bf16 v[216:219], v[104:107], v[148:151], v[216:219]
v_mfma_f32_16x16x32_bf16 v[208:211], v[108:111], v[112:115], 0
buffer_load_dwordx4 v10, s[20:23], s31 offen lds
v_mfma_f32_16x16x32_bf16 v[208:211], v[80:83], v[116:119], v[208:211]
s_waitcnt lgkmcnt(8)
v_mfma_f32_16x16x32_bf16 v[52:55], v[84:87], a[144:147], v[52:55]
ds_read_b64_tr_b16 v[104:105], v8 offset:32768
s_waitcnt lgkmcnt(7)
v_mfma_f32_16x16x32_bf16 v[20:23], v[88:91], a[0:3], 0
s_waitcnt lgkmcnt(5)
v_mfma_f32_16x16x32_bf16 v[20:23], v[92:95], a[16:19], v[20:23]
ds_read_b64_tr_b16 v[106:107], v8 offset:34816
v_mfma_f32_16x16x32_bf16 v[60:63], v[84:87], a[148:151], v[60:63]
v_mfma_f32_16x16x32_bf16 v[28:31], v[88:91], a[4:7], 0
ds_read_b64_tr_b16 v[108:109], v9 offset:24576
v_mfma_f32_16x16x32_bf16 v[28:31], v[92:95], a[20:23], v[28:31]
v_mfma_f32_16x16x32_bf16 v[68:71], v[84:87], a[152:155], v[68:71]
ds_read_b64_tr_b16 v[110:111], v9 offset:26624
s_add_u32 m0, s34, 8192
s_add_u32 s31, s35, 148352
v_mfma_f32_16x16x32_bf16 v[36:39], v[88:91], a[8:11], 0
v_mfma_f32_16x16x32_bf16 v[36:39], v[92:95], a[24:27], v[36:39]
ds_read_b64_tr_b16 v[80:81], v9 offset:28672
buffer_load_dwordx4 v10, s[20:23], s31 offen lds
v_mfma_f32_16x16x32_bf16 v[76:79], v[84:87], a[156:159], v[76:79]
v_mfma_f32_16x16x32_bf16 v[44:47], v[88:91], a[12:15], 0
ds_read_b64_tr_b16 v[82:83], v9 offset:30720
v_mfma_f32_16x16x32_bf16 v[44:47], v[92:95], a[28:31], v[44:47]
v_mfma_f32_16x16x32_bf16 v[220:223], v[84:87], v[148:151], v[220:223]
v_mfma_f32_16x16x32_bf16 v[212:215], v[88:91], v[112:115], 0
v_mfma_f32_16x16x32_bf16 v[212:215], v[92:95], v[116:119], v[212:215]
s_waitcnt vmcnt(37)
s_barrier
s_waitcnt lgkmcnt(8)
v_mfma_f32_16x16x32_bf16 v[16:19], v[96:99], a[32:35], v[16:19]
ds_read_b64_tr_b16 v[84:85], v9 offset:32768
s_waitcnt lgkmcnt(7)
v_mfma_f32_16x16x32_bf16 v[16:19], v[100:103], a[48:51], v[16:19]
s_add_u32 m0, s34, 12288
s_add_u32 s31, s35, 185216
s_waitcnt lgkmcnt(5)
v_mfma_f32_16x16x32_bf16 v[16:19], v[104:107], a[64:67], v[16:19]
ds_read_b64_tr_b16 v[86:87], v9 offset:34816
s_add_u32 s37, s36, 24576
v_mfma_f32_16x16x32_bf16 v[24:27], v[96:99], a[36:39], v[24:27]
buffer_load_dwordx4 v10, s[20:23], s31 offen lds
v_cvt_pk_bf16_f32 v176, v48, v49
v_mfma_f32_16x16x32_bf16 v[24:27], v[100:103], a[52:55], v[24:27]
ds_read_b64_tr_b16 v[88:89], v8 offset:36864
v_mfma_f32_16x16x32_bf16 v[24:27], v[104:107], a[68:71], v[24:27]
v_cvt_pk_bf16_f32 v177, v50, v51
v_cvt_pk_bf16_f32 v178, v52, v53
v_mfma_f32_16x16x32_bf16 v[32:35], v[96:99], a[40:43], v[32:35]
ds_read_b64_tr_b16 v[90:91], v8 offset:38912
v_mfma_f32_16x16x32_bf16 v[32:35], v[100:103], a[56:59], v[32:35]
v_cvt_pk_bf16_f32 v179, v54, v55
v_mfma_f32_16x16x32_bf16 v[32:35], v[104:107], a[72:75], v[32:35]
ds_read_b64_tr_b16 v[92:93], v8 offset:40960
buffer_store_dwordx4 v[176:179], v11, s[8:11], s37 offen offset:0 sc1
v_mfma_f32_16x16x32_bf16 v[40:43], v[96:99], a[44:47], v[40:43]
v_cvt_pk_bf16_f32 v180, v56, v57
v_mfma_f32_16x16x32_bf16 v[40:43], v[100:103], a[60:63], v[40:43]
ds_read_b64_tr_b16 v[94:95], v8 offset:43008
v_cvt_pk_bf16_f32 v181, v58, v59
v_mfma_f32_16x16x32_bf16 v[40:43], v[104:107], a[76:79], v[40:43]
s_add_u32 m0, s34, 16384
s_add_u32 s31, s35, 222080
v_cvt_pk_bf16_f32 v182, v60, v61
v_mfma_f32_16x16x32_bf16 v[208:211], v[96:99], v[120:123], v[208:211]
v_cvt_pk_bf16_f32 v183, v62, v63
v_mfma_f32_16x16x32_bf16 v[208:211], v[100:103], v[124:127], v[208:211]
buffer_load_dwordx4 v10, s[20:23], s31 offen lds
buffer_store_dwordx4 v[180:183], v11, s[8:11], s37 offen offset:1024 sc1
v_mfma_f32_16x16x32_bf16 v[208:211], v[104:107], v[128:131], v[208:211]
v_cvt_pk_bf16_f32 v184, v64, v65
s_waitcnt lgkmcnt(8)
v_mfma_f32_16x16x32_bf16 v[20:23], v[108:111], a[32:35], v[20:23]
ds_read_b64_tr_b16 v[96:97], v8 offset:45056
v_cvt_pk_bf16_f32 v185, v66, v67
s_waitcnt lgkmcnt(7)
v_mfma_f32_16x16x32_bf16 v[20:23], v[80:83], a[48:51], v[20:23]
v_cvt_pk_bf16_f32 v186, v68, v69
s_waitcnt lgkmcnt(5)
v_mfma_f32_16x16x32_bf16 v[20:23], v[84:87], a[64:67], v[20:23]
ds_read_b64_tr_b16 v[98:99], v8 offset:47104
v_mfma_f32_16x16x32_bf16 v[28:31], v[108:111], a[36:39], v[28:31]
v_cvt_pk_bf16_f32 v187, v70, v71
buffer_store_dwordx4 v[184:187], v11, s[8:11], s37 offen offset:2048 sc1
v_mfma_f32_16x16x32_bf16 v[28:31], v[80:83], a[52:55], v[28:31]
ds_read_b64_tr_b16 v[100:101], v9 offset:36864
v_mfma_f32_16x16x32_bf16 v[28:31], v[84:87], a[68:71], v[28:31]
v_cvt_pk_bf16_f32 v188, v72, v73
v_cvt_pk_bf16_f32 v189, v74, v75
v_mfma_f32_16x16x32_bf16 v[36:39], v[108:111], a[40:43], v[36:39]
ds_read_b64_tr_b16 v[102:103], v9 offset:38912
s_add_u32 m0, s34, 20480
s_add_u32 s31, s35, 258944
v_mfma_f32_16x16x32_bf16 v[36:39], v[80:83], a[56:59], v[36:39]
v_cvt_pk_bf16_f32 v190, v76, v77
v_mfma_f32_16x16x32_bf16 v[36:39], v[84:87], a[72:75], v[36:39]
ds_read_b64_tr_b16 v[104:105], v9 offset:40960
buffer_load_dwordx4 v10, s[20:23], s31 offen lds
v_mfma_f32_16x16x32_bf16 v[44:47], v[108:111], a[44:47], v[44:47]
v_cvt_pk_bf16_f32 v191, v78, v79
v_mfma_f32_16x16x32_bf16 v[44:47], v[80:83], a[60:63], v[44:47]
ds_read_b64_tr_b16 v[106:107], v9 offset:43008
v_mfma_f32_16x16x32_bf16 v[44:47], v[84:87], a[76:79], v[44:47]
buffer_store_dwordx4 v[188:191], v11, s[8:11], s37 offen offset:3072 sc1
s_add_u32 s39, s38, 24576
v_cvt_pk_bf16_f32 v192, v216, v217
v_mfma_f32_16x16x32_bf16 v[212:215], v[108:111], v[120:123], v[212:215]
v_cvt_pk_bf16_f32 v193, v218, v219
v_mfma_f32_16x16x32_bf16 v[212:215], v[80:83], v[124:127], v[212:215]
v_cvt_pk_bf16_f32 v194, v220, v221
v_cvt_pk_bf16_f32 v195, v222, v223
v_mfma_f32_16x16x32_bf16 v[212:215], v[84:87], v[128:131], v[212:215]
buffer_store_dwordx4 v[192:195], v11, s[8:11], s39 offen sc1
s_waitcnt vmcnt(42)
s_barrier
s_waitcnt lgkmcnt(8)
v_mfma_f32_16x16x32_bf16 v[16:19], v[88:91], a[80:83], v[16:19]
ds_read_b64_tr_b16 v[108:109], v9 offset:45056
s_waitcnt lgkmcnt(7)
v_mfma_f32_16x16x32_bf16 v[16:19], v[92:95], a[96:99], v[16:19]
s_add_u32 m0, s34, 24576
s_add_u32 s31, s35, 295808
s_waitcnt lgkmcnt(5)
v_mfma_f32_16x16x32_bf16 v[16:19], v[96:99], a[112:115], v[16:19]
ds_read_b64_tr_b16 v[110:111], v9 offset:47104
v_mfma_f32_16x16x32_bf16 v[24:27], v[88:91], a[84:87], v[24:27]
buffer_load_dwordx4 v10, s[20:23], s31 offen lds
v_mfma_f32_16x16x32_bf16 v[24:27], v[92:95], a[100:103], v[24:27]
ds_read_b64_tr_b16 v[80:81], v8 offset:49152
v_mfma_f32_16x16x32_bf16 v[24:27], v[96:99], a[116:119], v[24:27]
v_mfma_f32_16x16x32_bf16 v[32:35], v[88:91], a[88:91], v[32:35]
ds_read_b64_tr_b16 v[82:83], v8 offset:51200
v_mfma_f32_16x16x32_bf16 v[32:35], v[92:95], a[104:107], v[32:35]
v_mfma_f32_16x16x32_bf16 v[32:35], v[96:99], a[120:123], v[32:35]
ds_read_b64_tr_b16 v[84:85], v8 offset:53248
v_mfma_f32_16x16x32_bf16 v[40:43], v[88:91], a[92:95], v[40:43]
v_mfma_f32_16x16x32_bf16 v[40:43], v[92:95], a[108:111], v[40:43]
ds_read_b64_tr_b16 v[86:87], v8 offset:55296
v_mfma_f32_16x16x32_bf16 v[40:43], v[96:99], a[124:127], v[40:43]
s_add_u32 m0, s34, 28672
s_add_u32 s31, s35, 332672
v_mfma_f32_16x16x32_bf16 v[208:211], v[88:91], v[132:135], v[208:211]
v_mfma_f32_16x16x32_bf16 v[208:211], v[92:95], v[136:139], v[208:211]
buffer_load_dwordx4 v10, s[20:23], s31 offen lds
v_mfma_f32_16x16x32_bf16 v[208:211], v[96:99], v[140:143], v[208:211]
s_waitcnt lgkmcnt(8)
v_mfma_f32_16x16x32_bf16 v[20:23], v[100:103], a[80:83], v[20:23]
ds_read_b64_tr_b16 v[88:89], v8 offset:57344
s_waitcnt lgkmcnt(7)
v_mfma_f32_16x16x32_bf16 v[20:23], v[104:107], a[96:99], v[20:23]
s_waitcnt lgkmcnt(5)
v_mfma_f32_16x16x32_bf16 v[20:23], v[108:111], a[112:115], v[20:23]
ds_read_b64_tr_b16 v[90:91], v8 offset:59392
v_mfma_f32_16x16x32_bf16 v[28:31], v[100:103], a[84:87], v[28:31]
v_mfma_f32_16x16x32_bf16 v[28:31], v[104:107], a[100:103], v[28:31]
ds_read_b64_tr_b16 v[92:93], v9 offset:49152
v_mfma_f32_16x16x32_bf16 v[28:31], v[108:111], a[116:119], v[28:31]
v_mfma_f32_16x16x32_bf16 v[36:39], v[100:103], a[88:91], v[36:39]
ds_read_b64_tr_b16 v[94:95], v9 offset:51200
s_add_u32 m0, s34, 32768
s_add_u32 s31, s35, 1024
v_mfma_f32_16x16x32_bf16 v[36:39], v[104:107], a[104:107], v[36:39]
v_mfma_f32_16x16x32_bf16 v[36:39], v[108:111], a[120:123], v[36:39]
ds_read_b64_tr_b16 v[96:97], v9 offset:53248
buffer_load_dwordx4 v10, s[20:23], s31 offen lds
v_mfma_f32_16x16x32_bf16 v[44:47], v[100:103], a[92:95], v[44:47]
v_mfma_f32_16x16x32_bf16 v[44:47], v[104:107], a[108:111], v[44:47]
ds_read_b64_tr_b16 v[98:99], v9 offset:55296
v_mfma_f32_16x16x32_bf16 v[44:47], v[108:111], a[124:127], v[44:47]
v_mfma_f32_16x16x32_bf16 v[212:215], v[100:103], v[132:135], v[212:215]
v_mfma_f32_16x16x32_bf16 v[212:215], v[104:107], v[136:139], v[212:215]
v_mfma_f32_16x16x32_bf16 v[212:215], v[108:111], v[140:143], v[212:215]
s_waitcnt vmcnt(42)
s_barrier
s_waitcnt lgkmcnt(8)
v_mfma_f32_16x16x32_bf16 v[16:19], v[80:83], a[128:131], v[16:19]
ds_read_b64_tr_b16 v[100:101], v9 offset:57344
s_waitcnt lgkmcnt(7)
v_mfma_f32_16x16x32_bf16 v[16:19], v[84:87], a[144:147], v[16:19]
s_add_u32 m0, s34, 36864
s_add_u32 s31, s35, 37888
s_waitcnt lgkmcnt(5)
v_mfma_f32_16x16x32_bf16 v[48:51], v[88:91], a[0:3], 0
ds_read_b64_tr_b16 v[102:103], v9 offset:59392
v_mfma_f32_16x16x32_bf16 v[24:27], v[80:83], a[132:135], v[24:27]
buffer_load_dwordx4 v10, s[20:23], s31 offen lds
v_mfma_f32_16x16x32_bf16 v[24:27], v[84:87], a[148:151], v[24:27]
ds_read_b64_tr_b16 v[104:105], v8 offset:61440
v_mfma_f32_16x16x32_bf16 v[56:59], v[88:91], a[4:7], 0
v_mfma_f32_16x16x32_bf16 v[32:35], v[80:83], a[136:139], v[32:35]
ds_read_b64_tr_b16 v[106:107], v8 offset:63488
v_mfma_f32_16x16x32_bf16 v[32:35], v[84:87], a[152:155], v[32:35]
v_mfma_f32_16x16x32_bf16 v[64:67], v[88:91], a[8:11], 0
ds_read_b64_tr_b16 v[108:109], v5 offset:0
v_mfma_f32_16x16x32_bf16 v[40:43], v[80:83], a[140:143], v[40:43]
v_mfma_f32_16x16x32_bf16 v[40:43], v[84:87], a[156:159], v[40:43]
ds_read_b64_tr_b16 v[110:111], v5 offset:2048
v_mfma_f32_16x16x32_bf16 v[72:75], v[88:91], a[12:15], 0
s_add_u32 m0, s34, 40960
s_add_u32 s31, s35, 74752
v_mfma_f32_16x16x32_bf16 v[208:211], v[80:83], v[144:147], v[208:211]
v_mfma_f32_16x16x32_bf16 v[208:211], v[84:87], v[148:151], v[208:211]
buffer_load_dwordx4 v10, s[20:23], s31 offen lds
v_mfma_f32_16x16x32_bf16 v[216:219], v[88:91], v[112:115], 0
s_waitcnt lgkmcnt(8)
v_mfma_f32_16x16x32_bf16 v[20:23], v[92:95], a[128:131], v[20:23]
ds_read_b64_tr_b16 v[80:81], v5 offset:4096
s_waitcnt lgkmcnt(7)
v_mfma_f32_16x16x32_bf16 v[20:23], v[96:99], a[144:147], v[20:23]
s_waitcnt lgkmcnt(5)
v_mfma_f32_16x16x32_bf16 v[52:55], v[100:103], a[0:3], 0
ds_read_b64_tr_b16 v[82:83], v5 offset:6144
v_mfma_f32_16x16x32_bf16 v[28:31], v[92:95], a[132:135], v[28:31]
v_mfma_f32_16x16x32_bf16 v[28:31], v[96:99], a[148:151], v[28:31]
ds_read_b64_tr_b16 v[84:85], v9 offset:61440
v_mfma_f32_16x16x32_bf16 v[60:63], v[100:103], a[4:7], 0
v_mfma_f32_16x16x32_bf16 v[36:39], v[92:95], a[136:139], v[36:39]
ds_read_b64_tr_b16 v[86:87], v9 offset:63488
s_add_u32 m0, s34, 45056
s_add_u32 s31, s35, 111616
v_mfma_f32_16x16x32_bf16 v[36:39], v[96:99], a[152:155], v[36:39]
v_mfma_f32_16x16x32_bf16 v[68:71], v[100:103], a[8:11], 0
ds_read_b64_tr_b16 v[88:89], v6 offset:0
buffer_load_dwordx4 v10, s[20:23], s31 offen lds
v_mfma_f32_16x16x32_bf16 v[44:47], v[92:95], a[140:143], v[44:47]
v_mfma_f32_16x16x32_bf16 v[44:47], v[96:99], a[156:159], v[44:47]
ds_read_b64_tr_b16 v[90:91], v6 offset:2048
v_mfma_f32_16x16x32_bf16 v[76:79], v[100:103], a[12:15], 0
v_mfma_f32_16x16x32_bf16 v[212:215], v[92:95], v[144:147], v[212:215]
v_mfma_f32_16x16x32_bf16 v[212:215], v[96:99], v[148:151], v[212:215]
v_mfma_f32_16x16x32_bf16 v[220:223], v[100:103], v[112:115], 0
s_waitcnt vmcnt(39)
s_barrier
s_waitcnt lgkmcnt(8)
v_mfma_f32_16x16x32_bf16 v[48:51], v[104:107], a[16:19], v[48:51]
ds_read_b64_tr_b16 v[92:93], v6 offset:4096
s_waitcnt lgkmcnt(7)
v_mfma_f32_16x16x32_bf16 v[48:51], v[108:111], a[32:35], v[48:51]
s_add_u32 m0, s34, 49152
s_add_u32 s31, s35, 148480
s_waitcnt lgkmcnt(5)
v_mfma_f32_16x16x32_bf16 v[48:51], v[80:83], a[48:51], v[48:51]
ds_read_b64_tr_b16 v[94:95], v6 offset:6144
s_add_u32 s37, s36, 32768
v_mfma_f32_16x16x32_bf16 v[56:59], v[104:107], a[20:23], v[56:59]
buffer_load_dwordx4 v10, s[20:23], s31 offen lds
v_cvt_pk_bf16_f32 v176, v16, v17
v_mfma_f32_16x16x32_bf16 v[56:59], v[108:111], a[36:39], v[56:59]
ds_read_b64_tr_b16 v[96:97], v5 offset:8192
v_mfma_f32_16x16x32_bf16 v[56:59], v[80:83], a[52:55], v[56:59]
v_cvt_pk_bf16_f32 v177, v18, v19
v_cvt_pk_bf16_f32 v178, v20, v21
v_mfma_f32_16x16x32_bf16 v[64:67], v[104:107], a[24:27], v[64:67]
ds_read_b64_tr_b16 v[98:99], v5 offset:10240
v_mfma_f32_16x16x32_bf16 v[64:67], v[108:111], a[40:43], v[64:67]
v_cvt_pk_bf16_f32 v179, v22, v23
v_mfma_f32_16x16x32_bf16 v[64:67], v[80:83], a[56:59], v[64:67]
ds_read_b64_tr_b16 v[100:101], v5 offset:12288
buffer_store_dwordx4 v[176:179], v11, s[8:11], s37 offen offset:0 sc1
v_mfma_f32_16x16x32_bf16 v[72:75], v[104:107], a[28:31], v[72:75]
v_cvt_pk_bf16_f32 v180, v24, v25
v_mfma_f32_16x16x32_bf16 v[72:75], v[108:111], a[44:47], v[72:75]
ds_read_b64_tr_b16 v[102:103], v5 offset:14336
v_cvt_pk_bf16_f32 v181, v26, v27
v_mfma_f32_16x16x32_bf16 v[72:75], v[80:83], a[60:63], v[72:75]
s_add_u32 m0, s34, 53248
s_add_u32 s31, s35, 185344
v_cvt_pk_bf16_f32 v182, v28, v29
v_mfma_f32_16x16x32_bf16 v[216:219], v[104:107], v[116:119], v[216:219]
v_cvt_pk_bf16_f32 v183, v30, v31
v_mfma_f32_16x16x32_bf16 v[216:219], v[108:111], v[120:123], v[216:219]
buffer_load_dwordx4 v10, s[20:23], s31 offen lds
buffer_store_dwordx4 v[180:183], v11, s[8:11], s37 offen offset:1024 sc1
v_mfma_f32_16x16x32_bf16 v[216:219], v[80:83], v[124:127], v[216:219]
v_cvt_pk_bf16_f32 v184, v32, v33
s_waitcnt lgkmcnt(8)
v_mfma_f32_16x16x32_bf16 v[52:55], v[84:87], a[16:19], v[52:55]
ds_read_b64_tr_b16 v[104:105], v5 offset:16384
v_cvt_pk_bf16_f32 v185, v34, v35
s_waitcnt lgkmcnt(7)
v_mfma_f32_16x16x32_bf16 v[52:55], v[88:91], a[32:35], v[52:55]
v_cvt_pk_bf16_f32 v186, v36, v37
s_waitcnt lgkmcnt(5)
v_mfma_f32_16x16x32_bf16 v[52:55], v[92:95], a[48:51], v[52:55]
ds_read_b64_tr_b16 v[106:107], v5 offset:18432
v_mfma_f32_16x16x32_bf16 v[60:63], v[84:87], a[20:23], v[60:63]
v_cvt_pk_bf16_f32 v187, v38, v39
buffer_store_dwordx4 v[184:187], v11, s[8:11], s37 offen offset:2048 sc1
v_mfma_f32_16x16x32_bf16 v[60:63], v[88:91], a[36:39], v[60:63]
ds_read_b64_tr_b16 v[108:109], v6 offset:8192
v_mfma_f32_16x16x32_bf16 v[60:63], v[92:95], a[52:55], v[60:63]
v_cvt_pk_bf16_f32 v188, v40, v41
v_cvt_pk_bf16_f32 v189, v42, v43
v_mfma_f32_16x16x32_bf16 v[68:71], v[84:87], a[24:27], v[68:71]
ds_read_b64_tr_b16 v[110:111], v6 offset:10240
s_add_u32 m0, s34, 57344
s_add_u32 s31, s35, 222208
v_mfma_f32_16x16x32_bf16 v[68:71], v[88:91], a[40:43], v[68:71]
v_cvt_pk_bf16_f32 v190, v44, v45
v_mfma_f32_16x16x32_bf16 v[68:71], v[92:95], a[56:59], v[68:71]
ds_read_b64_tr_b16 v[80:81], v6 offset:12288
buffer_load_dwordx4 v10, s[20:23], s31 offen lds
v_mfma_f32_16x16x32_bf16 v[76:79], v[84:87], a[28:31], v[76:79]
v_cvt_pk_bf16_f32 v191, v46, v47
v_mfma_f32_16x16x32_bf16 v[76:79], v[88:91], a[44:47], v[76:79]
ds_read_b64_tr_b16 v[82:83], v6 offset:14336
v_mfma_f32_16x16x32_bf16 v[76:79], v[92:95], a[60:63], v[76:79]
buffer_store_dwordx4 v[188:191], v11, s[8:11], s37 offen offset:3072 sc1
s_add_u32 s39, s38, 32768
v_cvt_pk_bf16_f32 v192, v208, v209
v_mfma_f32_16x16x32_bf16 v[220:223], v[84:87], v[116:119], v[220:223]
v_cvt_pk_bf16_f32 v193, v210, v211
v_mfma_f32_16x16x32_bf16 v[220:223], v[88:91], v[120:123], v[220:223]
v_cvt_pk_bf16_f32 v194, v212, v213
v_cvt_pk_bf16_f32 v195, v214, v215
v_mfma_f32_16x16x32_bf16 v[220:223], v[92:95], v[124:127], v[220:223]
buffer_store_dwordx4 v[192:195], v11, s[8:11], s39 offen sc1
s_waitcnt vmcnt(42)
s_barrier
s_waitcnt lgkmcnt(8)
v_mfma_f32_16x16x32_bf16 v[48:51], v[96:99], a[64:67], v[48:51]
ds_read_b64_tr_b16 v[84:85], v6 offset:16384
s_waitcnt lgkmcnt(7)
v_mfma_f32_16x16x32_bf16 v[48:51], v[100:103], a[80:83], v[48:51]
s_add_u32 m0, s34, 61440
s_add_u32 s31, s35, 259072
s_waitcnt lgkmcnt(5)
v_mfma_f32_16x16x32_bf16 v[48:51], v[104:107], a[96:99], v[48:51]
ds_read_b64_tr_b16 v[86:87], v6 offset:18432
v_mfma_f32_16x16x32_bf16 v[56:59], v[96:99], a[68:71], v[56:59]
buffer_load_dwordx4 v10, s[20:23], s31 offen lds
v_mfma_f32_16x16x32_bf16 v[56:59], v[100:103], a[84:87], v[56:59]
ds_read_b64_tr_b16 v[88:89], v5 offset:20480
v_mfma_f32_16x16x32_bf16 v[56:59], v[104:107], a[100:103], v[56:59]
v_mfma_f32_16x16x32_bf16 v[64:67], v[96:99], a[72:75], v[64:67]
ds_read_b64_tr_b16 v[90:91], v5 offset:22528
v_mfma_f32_16x16x32_bf16 v[64:67], v[100:103], a[88:91], v[64:67]
v_mfma_f32_16x16x32_bf16 v[64:67], v[104:107], a[104:107], v[64:67]
ds_read_b64_tr_b16 v[92:93], v5 offset:24576
v_mfma_f32_16x16x32_bf16 v[72:75], v[96:99], a[76:79], v[72:75]
v_mfma_f32_16x16x32_bf16 v[72:75], v[100:103], a[92:95], v[72:75]
ds_read_b64_tr_b16 v[94:95], v5 offset:26624
v_mfma_f32_16x16x32_bf16 v[72:75], v[104:107], a[108:111], v[72:75]
s_add_u32 m0, s34, 65536
s_add_u32 s31, s35, 295936
v_mfma_f32_16x16x32_bf16 v[216:219], v[96:99], v[128:131], v[216:219]
v_mfma_f32_16x16x32_bf16 v[216:219], v[100:103], v[132:135], v[216:219]
buffer_load_dwordx4 v10, s[20:23], s31 offen lds
v_mfma_f32_16x16x32_bf16 v[216:219], v[104:107], v[136:139], v[216:219]
s_waitcnt lgkmcnt(8)
v_mfma_f32_16x16x32_bf16 v[52:55], v[108:111], a[64:67], v[52:55]
ds_read_b64_tr_b16 v[96:97], v5 offset:28672
s_waitcnt lgkmcnt(7)
v_mfma_f32_16x16x32_bf16 v[52:55], v[80:83], a[80:83], v[52:55]
s_waitcnt lgkmcnt(5)
v_mfma_f32_16x16x32_bf16 v[52:55], v[84:87], a[96:99], v[52:55]
ds_read_b64_tr_b16 v[98:99], v5 offset:30720
v_mfma_f32_16x16x32_bf16 v[60:63], v[108:111], a[68:71], v[60:63]
v_mfma_f32_16x16x32_bf16 v[60:63], v[80:83], a[84:87], v[60:63]
ds_read_b64_tr_b16 v[100:101], v6 offset:20480
v_mfma_f32_16x16x32_bf16 v[60:63], v[84:87], a[100:103], v[60:63]
v_mfma_f32_16x16x32_bf16 v[68:71], v[108:111], a[72:75], v[68:71]
ds_read_b64_tr_b16 v[102:103], v6 offset:22528
s_add_u32 m0, s34, 69632
s_add_u32 s31, s35, 332800
v_mfma_f32_16x16x32_bf16 v[68:71], v[80:83], a[88:91], v[68:71]
v_mfma_f32_16x16x32_bf16 v[68:71], v[84:87], a[104:107], v[68:71]
ds_read_b64_tr_b16 v[104:105], v6 offset:24576
buffer_load_dwordx4 v10, s[20:23], s31 offen lds
v_mfma_f32_16x16x32_bf16 v[76:79], v[108:111], a[76:79], v[76:79]
v_mfma_f32_16x16x32_bf16 v[76:79], v[80:83], a[92:95], v[76:79]
ds_read_b64_tr_b16 v[106:107], v6 offset:26624
v_mfma_f32_16x16x32_bf16 v[76:79], v[84:87], a[108:111], v[76:79]
v_mfma_f32_16x16x32_bf16 v[220:223], v[108:111], v[128:131], v[220:223]
v_mfma_f32_16x16x32_bf16 v[220:223], v[80:83], v[132:135], v[220:223]
v_mfma_f32_16x16x32_bf16 v[220:223], v[84:87], v[136:139], v[220:223]
s_waitcnt vmcnt(42)
s_barrier
s_waitcnt lgkmcnt(8)
v_mfma_f32_16x16x32_bf16 v[48:51], v[88:91], a[112:115], v[48:51]
ds_read_b64_tr_b16 v[108:109], v6 offset:28672
s_waitcnt lgkmcnt(7)
v_mfma_f32_16x16x32_bf16 v[48:51], v[92:95], a[128:131], v[48:51]
s_waitcnt lgkmcnt(5)
v_mfma_f32_16x16x32_bf16 v[48:51], v[96:99], a[144:147], v[48:51]
ds_read_b64_tr_b16 v[110:111], v6 offset:30720
v_mfma_f32_16x16x32_bf16 v[56:59], v[88:91], a[116:119], v[56:59]
v_mfma_f32_16x16x32_bf16 v[56:59], v[92:95], a[132:135], v[56:59]
ds_read_b64_tr_b16 v[80:81], v5 offset:32768
v_mfma_f32_16x16x32_bf16 v[56:59], v[96:99], a[148:151], v[56:59]
v_mfma_f32_16x16x32_bf16 v[64:67], v[88:91], a[120:123], v[64:67]
ds_read_b64_tr_b16 v[82:83], v5 offset:34816
v_mfma_f32_16x16x32_bf16 v[64:67], v[92:95], a[136:139], v[64:67]
v_mfma_f32_16x16x32_bf16 v[64:67], v[96:99], a[152:155], v[64:67]
ds_read_b64_tr_b16 v[84:85], v5 offset:36864
v_mfma_f32_16x16x32_bf16 v[72:75], v[88:91], a[124:127], v[72:75]
v_mfma_f32_16x16x32_bf16 v[72:75], v[92:95], a[140:143], v[72:75]
ds_read_b64_tr_b16 v[86:87], v5 offset:38912
v_mfma_f32_16x16x32_bf16 v[72:75], v[96:99], a[156:159], v[72:75]
v_mfma_f32_16x16x32_bf16 v[216:219], v[88:91], v[140:143], v[216:219]
v_mfma_f32_16x16x32_bf16 v[216:219], v[92:95], v[144:147], v[216:219]
v_mfma_f32_16x16x32_bf16 v[216:219], v[96:99], v[148:151], v[216:219]
s_waitcnt lgkmcnt(8)
v_mfma_f32_16x16x32_bf16 v[52:55], v[100:103], a[112:115], v[52:55]
ds_read_b64_tr_b16 v[88:89], v5 offset:40960
s_waitcnt lgkmcnt(7)
v_mfma_f32_16x16x32_bf16 v[52:55], v[104:107], a[128:131], v[52:55]
s_waitcnt lgkmcnt(5)
v_mfma_f32_16x16x32_bf16 v[52:55], v[108:111], a[144:147], v[52:55]
ds_read_b64_tr_b16 v[90:91], v5 offset:43008
v_mfma_f32_16x16x32_bf16 v[60:63], v[100:103], a[116:119], v[60:63]
v_mfma_f32_16x16x32_bf16 v[60:63], v[104:107], a[132:135], v[60:63]
ds_read_b64_tr_b16 v[92:93], v6 offset:32768
v_mfma_f32_16x16x32_bf16 v[60:63], v[108:111], a[148:151], v[60:63]
v_mfma_f32_16x16x32_bf16 v[68:71], v[100:103], a[120:123], v[68:71]
ds_read_b64_tr_b16 v[94:95], v6 offset:34816
v_mfma_f32_16x16x32_bf16 v[68:71], v[104:107], a[136:139], v[68:71]
v_mfma_f32_16x16x32_bf16 v[68:71], v[108:111], a[152:155], v[68:71]
ds_read_b64_tr_b16 v[96:97], v6 offset:36864
v_mfma_f32_16x16x32_bf16 v[76:79], v[100:103], a[124:127], v[76:79]
v_mfma_f32_16x16x32_bf16 v[76:79], v[104:107], a[140:143], v[76:79]
ds_read_b64_tr_b16 v[98:99], v6 offset:38912
v_mfma_f32_16x16x32_bf16 v[76:79], v[108:111], a[156:159], v[76:79]
v_mfma_f32_16x16x32_bf16 v[220:223], v[100:103], v[140:143], v[220:223]
v_mfma_f32_16x16x32_bf16 v[220:223], v[104:107], v[144:147], v[220:223]
v_mfma_f32_16x16x32_bf16 v[220:223], v[108:111], v[148:151], v[220:223]
s_waitcnt vmcnt(36)
s_barrier
s_waitcnt lgkmcnt(8)
v_mfma_f32_16x16x32_bf16 v[16:19], v[80:83], a[0:3], 0
ds_read_b64_tr_b16 v[100:101], v6 offset:40960
s_waitcnt lgkmcnt(7)
v_mfma_f32_16x16x32_bf16 v[16:19], v[84:87], a[16:19], v[16:19]
s_waitcnt lgkmcnt(5)
v_mfma_f32_16x16x32_bf16 v[16:19], v[88:91], a[32:35], v[16:19]
ds_read_b64_tr_b16 v[102:103], v6 offset:43008
s_add_u32 s37, s36, 40960
v_mfma_f32_16x16x32_bf16 v[24:27], v[80:83], a[4:7], 0
v_cvt_pk_bf16_f32 v176, v48, v49
v_mfma_f32_16x16x32_bf16 v[24:27], v[84:87], a[20:23], v[24:27]
ds_read_b64_tr_b16 v[104:105], v5 offset:45056
v_cvt_pk_bf16_f32 v177, v50, v51
v_mfma_f32_16x16x32_bf16 v[24:27], v[88:91], a[36:39], v[24:27]
v_cvt_pk_bf16_f32 v178, v52, v53
v_mfma_f32_16x16x32_bf16 v[32:35], v[80:83], a[8:11], 0
ds_read_b64_tr_b16 v[106:107], v5 offset:47104
v_mfma_f32_16x16x32_bf16 v[32:35], v[84:87], a[24:27], v[32:35]
v_cvt_pk_bf16_f32 v179, v54, v55
buffer_store_dwordx4 v[176:179], v11, s[8:11], s37 offen offset:0 sc1
v_mfma_f32_16x16x32_bf16 v[32:35], v[88:91], a[40:43], v[32:35]
ds_read_b64_tr_b16 v[108:109], v5 offset:49152
v_mfma_f32_16x16x32_bf16 v[40:43], v[80:83], a[12:15], 0
v_cvt_pk_bf16_f32 v180, v56, v57
v_mfma_f32_16x16x32_bf16 v[40:43], v[84:87], a[28:31], v[40:43]
ds_read_b64_tr_b16 v[110:111], v5 offset:51200
v_mfma_f32_16x16x32_bf16 v[40:43], v[88:91], a[44:47], v[40:43]
v_cvt_pk_bf16_f32 v181, v58, v59
v_cvt_pk_bf16_f32 v182, v60, v61
v_mfma_f32_16x16x32_bf16 v[208:211], v[80:83], v[112:115], 0
v_cvt_pk_bf16_f32 v183, v62, v63
v_mfma_f32_16x16x32_bf16 v[208:211], v[84:87], v[116:119], v[208:211]
buffer_store_dwordx4 v[180:183], v11, s[8:11], s37 offen offset:1024 sc1
v_mfma_f32_16x16x32_bf16 v[208:211], v[88:91], v[120:123], v[208:211]
v_cvt_pk_bf16_f32 v184, v64, v65
v_cvt_pk_bf16_f32 v185, v66, v67
s_waitcnt lgkmcnt(8)
v_mfma_f32_16x16x32_bf16 v[20:23], v[92:95], a[0:3], 0
ds_read_b64_tr_b16 v[80:81], v5 offset:53248
s_waitcnt lgkmcnt(7)
v_mfma_f32_16x16x32_bf16 v[20:23], v[96:99], a[16:19], v[20:23]
v_cvt_pk_bf16_f32 v186, v68, v69
s_waitcnt lgkmcnt(5)
v_mfma_f32_16x16x32_bf16 v[20:23], v[100:103], a[32:35], v[20:23]
ds_read_b64_tr_b16 v[82:83], v5 offset:55296
v_cvt_pk_bf16_f32 v187, v70, v71
v_mfma_f32_16x16x32_bf16 v[28:31], v[92:95], a[4:7], 0
buffer_store_dwordx4 v[184:187], v11, s[8:11], s37 offen offset:2048 sc1
v_mfma_f32_16x16x32_bf16 v[28:31], v[96:99], a[20:23], v[28:31]
ds_read_b64_tr_b16 v[84:85], v6 offset:45056
v_mfma_f32_16x16x32_bf16 v[28:31], v[100:103], a[36:39], v[28:31]
v_cvt_pk_bf16_f32 v188, v72, v73
v_cvt_pk_bf16_f32 v189, v74, v75
v_mfma_f32_16x16x32_bf16 v[36:39], v[92:95], a[8:11], 0
ds_read_b64_tr_b16 v[86:87], v6 offset:47104
v_mfma_f32_16x16x32_bf16 v[36:39], v[96:99], a[24:27], v[36:39]
v_cvt_pk_bf16_f32 v190, v76, v77
v_mfma_f32_16x16x32_bf16 v[36:39], v[100:103], a[40:43], v[36:39]
ds_read_b64_tr_b16 v[88:89], v6 offset:49152
v_mfma_f32_16x16x32_bf16 v[44:47], v[92:95], a[12:15], 0
v_cvt_pk_bf16_f32 v191, v78, v79
buffer_store_dwordx4 v[188:191], v11, s[8:11], s37 offen offset:3072 sc1
v_mfma_f32_16x16x32_bf16 v[44:47], v[96:99], a[28:31], v[44:47]
ds_read_b64_tr_b16 v[90:91], v6 offset:51200
v_mfma_f32_16x16x32_bf16 v[44:47], v[100:103], a[44:47], v[44:47]
s_add_u32 s39, s38, 40960
v_cvt_pk_bf16_f32 v192, v216, v217
v_mfma_f32_16x16x32_bf16 v[212:215], v[92:95], v[112:115], 0
v_cvt_pk_bf16_f32 v193, v218, v219
v_mfma_f32_16x16x32_bf16 v[212:215], v[96:99], v[116:119], v[212:215]
v_cvt_pk_bf16_f32 v194, v220, v221
v_cvt_pk_bf16_f32 v195, v222, v223
v_mfma_f32_16x16x32_bf16 v[212:215], v[100:103], v[120:123], v[212:215]
buffer_store_dwordx4 v[192:195], v11, s[8:11], s39 offen sc1
s_waitcnt vmcnt(36)
s_barrier
s_waitcnt lgkmcnt(8)
v_mfma_f32_16x16x32_bf16 v[16:19], v[104:107], a[48:51], v[16:19]
ds_read_b64_tr_b16 v[92:93], v6 offset:53248
s_waitcnt lgkmcnt(7)
v_mfma_f32_16x16x32_bf16 v[16:19], v[108:111], a[64:67], v[16:19]
s_waitcnt lgkmcnt(5)
v_mfma_f32_16x16x32_bf16 v[16:19], v[80:83], a[80:83], v[16:19]
ds_read_b64_tr_b16 v[94:95], v6 offset:55296
v_mfma_f32_16x16x32_bf16 v[24:27], v[104:107], a[52:55], v[24:27]
v_mfma_f32_16x16x32_bf16 v[24:27], v[108:111], a[68:71], v[24:27]
ds_read_b64_tr_b16 v[96:97], v5 offset:57344
v_mfma_f32_16x16x32_bf16 v[24:27], v[80:83], a[84:87], v[24:27]
v_mfma_f32_16x16x32_bf16 v[32:35], v[104:107], a[56:59], v[32:35]
ds_read_b64_tr_b16 v[98:99], v5 offset:59392
v_mfma_f32_16x16x32_bf16 v[32:35], v[108:111], a[72:75], v[32:35]
v_mfma_f32_16x16x32_bf16 v[32:35], v[80:83], a[88:91], v[32:35]
ds_read_b64_tr_b16 v[100:101], v5 offset:61440
v_mfma_f32_16x16x32_bf16 v[40:43], v[104:107], a[60:63], v[40:43]
v_mfma_f32_16x16x32_bf16 v[40:43], v[108:111], a[76:79], v[40:43]
ds_read_b64_tr_b16 v[102:103], v5 offset:63488
v_mfma_f32_16x16x32_bf16 v[40:43], v[80:83], a[92:95], v[40:43]
v_mfma_f32_16x16x32_bf16 v[208:211], v[104:107], v[124:127], v[208:211]
v_mfma_f32_16x16x32_bf16 v[208:211], v[108:111], v[128:131], v[208:211]
v_mfma_f32_16x16x32_bf16 v[208:211], v[80:83], v[132:135], v[208:211]
s_waitcnt lgkmcnt(8)
v_mfma_f32_16x16x32_bf16 v[20:23], v[84:87], a[48:51], v[20:23]
ds_read_b64_tr_b16 v[104:105], v2 offset:0
s_waitcnt lgkmcnt(7)
v_mfma_f32_16x16x32_bf16 v[20:23], v[88:91], a[64:67], v[20:23]
s_waitcnt lgkmcnt(5)
v_mfma_f32_16x16x32_bf16 v[20:23], v[92:95], a[80:83], v[20:23]
ds_read_b64_tr_b16 v[106:107], v2 offset:2048
v_mfma_f32_16x16x32_bf16 v[28:31], v[84:87], a[52:55], v[28:31]
v_mfma_f32_16x16x32_bf16 v[28:31], v[88:91], a[68:71], v[28:31]
ds_read_b64_tr_b16 v[108:109], v6 offset:57344
v_mfma_f32_16x16x32_bf16 v[28:31], v[92:95], a[84:87], v[28:31]
v_mfma_f32_16x16x32_bf16 v[36:39], v[84:87], a[56:59], v[36:39]
ds_read_b64_tr_b16 v[110:111], v6 offset:59392
v_mfma_f32_16x16x32_bf16 v[36:39], v[88:91], a[72:75], v[36:39]
v_mfma_f32_16x16x32_bf16 v[36:39], v[92:95], a[88:91], v[36:39]
ds_read_b64_tr_b16 v[80:81], v6 offset:61440
v_mfma_f32_16x16x32_bf16 v[44:47], v[84:87], a[60:63], v[44:47]
v_mfma_f32_16x16x32_bf16 v[44:47], v[88:91], a[76:79], v[44:47]
ds_read_b64_tr_b16 v[82:83], v6 offset:63488
v_mfma_f32_16x16x32_bf16 v[44:47], v[92:95], a[92:95], v[44:47]
v_mfma_f32_16x16x32_bf16 v[212:215], v[84:87], v[124:127], v[212:215]
v_mfma_f32_16x16x32_bf16 v[212:215], v[88:91], v[128:131], v[212:215]
v_mfma_f32_16x16x32_bf16 v[212:215], v[92:95], v[132:135], v[212:215]
s_waitcnt vmcnt(33)
s_barrier
s_waitcnt lgkmcnt(8)
v_mfma_f32_16x16x32_bf16 v[16:19], v[96:99], a[96:99], v[16:19]
ds_read_b64_tr_b16 v[84:85], v3 offset:0
s_waitcnt lgkmcnt(7)
v_mfma_f32_16x16x32_bf16 v[16:19], v[100:103], a[112:115], v[16:19]
s_waitcnt lgkmcnt(5)
v_mfma_f32_16x16x32_bf16 v[16:19], v[104:107], a[128:131], v[16:19]
ds_read_b64_tr_b16 v[86:87], v3 offset:2048
v_mfma_f32_16x16x32_bf16 v[24:27], v[96:99], a[100:103], v[24:27]
v_mfma_f32_16x16x32_bf16 v[24:27], v[100:103], a[116:119], v[24:27]
ds_read_b64_tr_b16 v[88:89], v2 offset:4096
v_mfma_f32_16x16x32_bf16 v[24:27], v[104:107], a[132:135], v[24:27]
v_mfma_f32_16x16x32_bf16 v[32:35], v[96:99], a[104:107], v[32:35]
ds_read_b64_tr_b16 v[90:91], v2 offset:6144
v_mfma_f32_16x16x32_bf16 v[32:35], v[100:103], a[120:123], v[32:35]
v_mfma_f32_16x16x32_bf16 v[32:35], v[104:107], a[136:139], v[32:35]
ds_read_b64_tr_b16 v[92:93], v2 offset:8192
v_mfma_f32_16x16x32_bf16 v[40:43], v[96:99], a[108:111], v[40:43]
v_mfma_f32_16x16x32_bf16 v[40:43], v[100:103], a[124:127], v[40:43]
ds_read_b64_tr_b16 v[94:95], v2 offset:10240
v_mfma_f32_16x16x32_bf16 v[40:43], v[104:107], a[140:143], v[40:43]
v_mfma_f32_16x16x32_bf16 v[208:211], v[96:99], v[136:139], v[208:211]
v_mfma_f32_16x16x32_bf16 v[208:211], v[100:103], v[140:143], v[208:211]
v_mfma_f32_16x16x32_bf16 v[208:211], v[104:107], v[144:147], v[208:211]
s_waitcnt lgkmcnt(8)
v_mfma_f32_16x16x32_bf16 v[20:23], v[108:111], a[96:99], v[20:23]
ds_read_b64_tr_b16 v[96:97], v2 offset:12288
s_waitcnt lgkmcnt(7)
v_mfma_f32_16x16x32_bf16 v[20:23], v[80:83], a[112:115], v[20:23]
s_waitcnt lgkmcnt(5)
v_mfma_f32_16x16x32_bf16 v[20:23], v[84:87], a[128:131], v[20:23]
ds_read_b64_tr_b16 v[98:99], v2 offset:14336
v_mfma_f32_16x16x32_bf16 v[28:31], v[108:111], a[100:103], v[28:31]
v_mfma_f32_16x16x32_bf16 v[28:31], v[80:83], a[116:119], v[28:31]
ds_read_b64_tr_b16 v[100:101], v3 offset:4096
v_mfma_f32_16x16x32_bf16 v[28:31], v[84:87], a[132:135], v[28:31]
v_mfma_f32_16x16x32_bf16 v[36:39], v[108:111], a[104:107], v[36:39]
ds_read_b64_tr_b16 v[102:103], v3 offset:6144
v_mfma_f32_16x16x32_bf16 v[36:39], v[80:83], a[120:123], v[36:39]
v_mfma_f32_16x16x32_bf16 v[36:39], v[84:87], a[136:139], v[36:39]
ds_read_b64_tr_b16 v[104:105], v3 offset:8192
v_mfma_f32_16x16x32_bf16 v[44:47], v[108:111], a[108:111], v[44:47]
v_mfma_f32_16x16x32_bf16 v[44:47], v[80:83], a[124:127], v[44:47]
ds_read_b64_tr_b16 v[106:107], v3 offset:10240
v_mfma_f32_16x16x32_bf16 v[44:47], v[84:87], a[140:143], v[44:47]
v_mfma_f32_16x16x32_bf16 v[212:215], v[108:111], v[136:139], v[212:215]
v_mfma_f32_16x16x32_bf16 v[212:215], v[80:83], v[140:143], v[212:215]
v_mfma_f32_16x16x32_bf16 v[212:215], v[84:87], v[144:147], v[212:215]
s_waitcnt vmcnt(30)
s_barrier
s_waitcnt lgkmcnt(8)
v_mfma_f32_16x16x32_bf16 v[16:19], v[88:91], a[144:147], v[16:19]
ds_read_b64_tr_b16 v[108:109], v3 offset:12288
s_waitcnt lgkmcnt(7)
v_mfma_f32_16x16x32_bf16 v[48:51], v[92:95], a[0:3], 0
s_waitcnt lgkmcnt(5)
v_mfma_f32_16x16x32_bf16 v[48:51], v[96:99], a[16:19], v[48:51]
ds_read_b64_tr_b16 v[110:111], v3 offset:14336
v_mfma_f32_16x16x32_bf16 v[24:27], v[88:91], a[148:151], v[24:27]
v_mfma_f32_16x16x32_bf16 v[56:59], v[92:95], a[4:7], 0
ds_read_b64_tr_b16 v[80:81], v8 offset:0
v_mfma_f32_16x16x32_bf16 v[56:59], v[96:99], a[20:23], v[56:59]
v_mfma_f32_16x16x32_bf16 v[32:35], v[88:91], a[152:155], v[32:35]
ds_read_b64_tr_b16 v[82:83], v8 offset:2048
v_mfma_f32_16x16x32_bf16 v[64:67], v[92:95], a[8:11], 0
v_mfma_f32_16x16x32_bf16 v[64:67], v[96:99], a[24:27], v[64:67]
ds_read_b64_tr_b16 v[84:85], v8 offset:4096
v_mfma_f32_16x16x32_bf16 v[40:43], v[88:91], a[156:159], v[40:43]
v_mfma_f32_16x16x32_bf16 v[72:75], v[92:95], a[12:15], 0
ds_read_b64_tr_b16 v[86:87], v8 offset:6144
v_mfma_f32_16x16x32_bf16 v[72:75], v[96:99], a[28:31], v[72:75]
v_mfma_f32_16x16x32_bf16 v[208:211], v[88:91], v[148:151], v[208:211]
v_mfma_f32_16x16x32_bf16 v[216:219], v[92:95], v[112:115], 0
v_mfma_f32_16x16x32_bf16 v[216:219], v[96:99], v[116:119], v[216:219]
s_waitcnt lgkmcnt(8)
v_mfma_f32_16x16x32_bf16 v[20:23], v[100:103], a[144:147], v[20:23]
ds_read_b64_tr_b16 v[88:89], v8 offset:8192
s_waitcnt lgkmcnt(7)
v_mfma_f32_16x16x32_bf16 v[52:55], v[104:107], a[0:3], 0
s_waitcnt lgkmcnt(5)
v_mfma_f32_16x16x32_bf16 v[52:55], v[108:111], a[16:19], v[52:55]
ds_read_b64_tr_b16 v[90:91], v8 offset:10240
v_mfma_f32_16x16x32_bf16 v[28:31], v[100:103], a[148:151], v[28:31]
v_mfma_f32_16x16x32_bf16 v[60:63], v[104:107], a[4:7], 0
ds_read_b64_tr_b16 v[92:93], v9 offset:0
v_mfma_f32_16x16x32_bf16 v[60:63], v[108:111], a[20:23], v[60:63]
v_mfma_f32_16x16x32_bf16 v[36:39], v[100:103], a[152:155], v[36:39]
ds_read_b64_tr_b16 v[94:95], v9 offset:2048
v_mfma_f32_16x16x32_bf16 v[68:71], v[104:107], a[8:11], 0
v_mfma_f32_16x16x32_bf16 v[68:71], v[108:111], a[24:27], v[68:71]
ds_read_b64_tr_b16 v[96:97], v9 offset:4096
v_mfma_f32_16x16x32_bf16 v[44:47], v[100:103], a[156:159], v[44:47]
v_mfma_f32_16x16x32_bf16 v[76:79], v[104:107], a[12:15], 0
ds_read_b64_tr_b16 v[98:99], v9 offset:6144
v_mfma_f32_16x16x32_bf16 v[76:79], v[108:111], a[28:31], v[76:79]
v_mfma_f32_16x16x32_bf16 v[212:215], v[100:103], v[148:151], v[212:215]
v_mfma_f32_16x16x32_bf16 v[220:223], v[104:107], v[112:115], 0
v_mfma_f32_16x16x32_bf16 v[220:223], v[108:111], v[116:119], v[220:223]
s_waitcnt vmcnt(24)
s_barrier
s_waitcnt lgkmcnt(8)
v_mfma_f32_16x16x32_bf16 v[48:51], v[80:83], a[32:35], v[48:51]
ds_read_b64_tr_b16 v[100:101], v9 offset:8192
s_waitcnt lgkmcnt(7)
v_mfma_f32_16x16x32_bf16 v[48:51], v[84:87], a[48:51], v[48:51]
s_waitcnt lgkmcnt(5)
v_mfma_f32_16x16x32_bf16 v[48:51], v[88:91], a[64:67], v[48:51]
ds_read_b64_tr_b16 v[102:103], v9 offset:10240
s_add_u32 s37, s36, 49152
v_mfma_f32_16x16x32_bf16 v[56:59], v[80:83], a[36:39], v[56:59]
v_cvt_pk_bf16_f32 v176, v16, v17
v_mfma_f32_16x16x32_bf16 v[56:59], v[84:87], a[52:55], v[56:59]
ds_read_b64_tr_b16 v[104:105], v8 offset:12288
v_cvt_pk_bf16_f32 v177, v18, v19
v_mfma_f32_16x16x32_bf16 v[56:59], v[88:91], a[68:71], v[56:59]
v_cvt_pk_bf16_f32 v178, v20, v21
v_mfma_f32_16x16x32_bf16 v[64:67], v[80:83], a[40:43], v[64:67]
ds_read_b64_tr_b16 v[106:107], v8 offset:14336
v_mfma_f32_16x16x32_bf16 v[64:67], v[84:87], a[56:59], v[64:67]
v_cvt_pk_bf16_f32 v179, v22, v23
buffer_store_dwordx4 v[176:179], v11, s[8:11], s37 offen offset:0 sc1
v_mfma_f32_16x16x32_bf16 v[64:67], v[88:91], a[72:75], v[64:67]
ds_read_b64_tr_b16 v[108:109], v8 offset:16384
v_mfma_f32_16x16x32_bf16 v[72:75], v[80:83], a[44:47], v[72:75]
v_cvt_pk_bf16_f32 v180, v24, v25
v_mfma_f32_16x16x32_bf16 v[72:75], v[84:87], a[60:63], v[72:75]
ds_read_b64_tr_b16 v[110:111], v8 offset:18432
v_mfma_f32_16x16x32_bf16 v[72:75], v[88:91], a[76:79], v[72:75]
v_cvt_pk_bf16_f32 v181, v26, v27
v_cvt_pk_bf16_f32 v182, v28, v29
v_mfma_f32_16x16x32_bf16 v[216:219], v[80:83], v[120:123], v[216:219]
v_cvt_pk_bf16_f32 v183, v30, v31
v_mfma_f32_16x16x32_bf16 v[216:219], v[84:87], v[124:127], v[216:219]
buffer_store_dwordx4 v[180:183], v11, s[8:11], s37 offen offset:1024 sc1
v_mfma_f32_16x16x32_bf16 v[216:219], v[88:91], v[128:131], v[216:219]
v_cvt_pk_bf16_f32 v184, v32, v33
v_cvt_pk_bf16_f32 v185, v34, v35
s_waitcnt lgkmcnt(8)
v_mfma_f32_16x16x32_bf16 v[52:55], v[92:95], a[32:35], v[52:55]
ds_read_b64_tr_b16 v[80:81], v8 offset:20480
s_waitcnt lgkmcnt(7)
v_mfma_f32_16x16x32_bf16 v[52:55], v[96:99], a[48:51], v[52:55]
v_cvt_pk_bf16_f32 v186, v36, v37
s_waitcnt lgkmcnt(5)
v_mfma_f32_16x16x32_bf16 v[52:55], v[100:103], a[64:67], v[52:55]
ds_read_b64_tr_b16 v[82:83], v8 offset:22528
v_cvt_pk_bf16_f32 v187, v38, v39
v_mfma_f32_16x16x32_bf16 v[60:63], v[92:95], a[36:39], v[60:63]
buffer_store_dwordx4 v[184:187], v11, s[8:11], s37 offen offset:2048 sc1
v_mfma_f32_16x16x32_bf16 v[60:63], v[96:99], a[52:55], v[60:63]
ds_read_b64_tr_b16 v[84:85], v9 offset:12288
v_mfma_f32_16x16x32_bf16 v[60:63], v[100:103], a[68:71], v[60:63]
v_cvt_pk_bf16_f32 v188, v40, v41
v_cvt_pk_bf16_f32 v189, v42, v43
v_mfma_f32_16x16x32_bf16 v[68:71], v[92:95], a[40:43], v[68:71]
ds_read_b64_tr_b16 v[86:87], v9 offset:14336
v_mfma_f32_16x16x32_bf16 v[68:71], v[96:99], a[56:59], v[68:71]
v_cvt_pk_bf16_f32 v190, v44, v45
v_mfma_f32_16x16x32_bf16 v[68:71], v[100:103], a[72:75], v[68:71]
ds_read_b64_tr_b16 v[88:89], v9 offset:16384
v_mfma_f32_16x16x32_bf16 v[76:79], v[92:95], a[44:47], v[76:79]
v_cvt_pk_bf16_f32 v191, v46, v47
buffer_store_dwordx4 v[188:191], v11, s[8:11], s37 offen offset:3072 sc1
v_mfma_f32_16x16x32_bf16 v[76:79], v[96:99], a[60:63], v[76:79]
ds_read_b64_tr_b16 v[90:91], v9 offset:18432
v_mfma_f32_16x16x32_bf16 v[76:79], v[100:103], a[76:79], v[76:79]
s_add_u32 s39, s38, 49152
v_cvt_pk_bf16_f32 v192, v208, v209
v_mfma_f32_16x16x32_bf16 v[220:223], v[92:95], v[120:123], v[220:223]
v_cvt_pk_bf16_f32 v193, v210, v211
v_mfma_f32_16x16x32_bf16 v[220:223], v[96:99], v[124:127], v[220:223]
v_cvt_pk_bf16_f32 v194, v212, v213
v_cvt_pk_bf16_f32 v195, v214, v215
v_mfma_f32_16x16x32_bf16 v[220:223], v[100:103], v[128:131], v[220:223]
buffer_store_dwordx4 v[192:195], v11, s[8:11], s39 offen sc1
s_waitcnt vmcnt(24)
s_barrier
s_waitcnt lgkmcnt(8)
v_mfma_f32_16x16x32_bf16 v[48:51], v[104:107], a[80:83], v[48:51]
ds_read_b64_tr_b16 v[92:93], v9 offset:20480
s_waitcnt lgkmcnt(7)
v_mfma_f32_16x16x32_bf16 v[48:51], v[108:111], a[96:99], v[48:51]
s_waitcnt lgkmcnt(5)
v_mfma_f32_16x16x32_bf16 v[48:51], v[80:83], a[112:115], v[48:51]
ds_read_b64_tr_b16 v[94:95], v9 offset:22528
v_mfma_f32_16x16x32_bf16 v[56:59], v[104:107], a[84:87], v[56:59]
v_mfma_f32_16x16x32_bf16 v[56:59], v[108:111], a[100:103], v[56:59]
ds_read_b64_tr_b16 v[96:97], v8 offset:24576
v_mfma_f32_16x16x32_bf16 v[56:59], v[80:83], a[116:119], v[56:59]
v_mfma_f32_16x16x32_bf16 v[64:67], v[104:107], a[88:91], v[64:67]
ds_read_b64_tr_b16 v[98:99], v8 offset:26624
v_mfma_f32_16x16x32_bf16 v[64:67], v[108:111], a[104:107], v[64:67]
v_mfma_f32_16x16x32_bf16 v[64:67], v[80:83], a[120:123], v[64:67]
ds_read_b64_tr_b16 v[100:101], v8 offset:28672
v_mfma_f32_16x16x32_bf16 v[72:75], v[104:107], a[92:95], v[72:75]
v_mfma_f32_16x16x32_bf16 v[72:75], v[108:111], a[108:111], v[72:75]
ds_read_b64_tr_b16 v[102:103], v8 offset:30720
v_mfma_f32_16x16x32_bf16 v[72:75], v[80:83], a[124:127], v[72:75]
v_mfma_f32_16x16x32_bf16 v[216:219], v[104:107], v[132:135], v[216:219]
v_mfma_f32_16x16x32_bf16 v[216:219], v[108:111], v[136:139], v[216:219]
v_mfma_f32_16x16x32_bf16 v[216:219], v[80:83], v[140:143], v[216:219]
s_waitcnt lgkmcnt(8)
v_mfma_f32_16x16x32_bf16 v[52:55], v[84:87], a[80:83], v[52:55]
ds_read_b64_tr_b16 v[104:105], v8 offset:32768
s_waitcnt lgkmcnt(7)
v_mfma_f32_16x16x32_bf16 v[52:55], v[88:91], a[96:99], v[52:55]
s_waitcnt lgkmcnt(5)
v_mfma_f32_16x16x32_bf16 v[52:55], v[92:95], a[112:115], v[52:55]
ds_read_b64_tr_b16 v[106:107], v8 offset:34816
v_mfma_f32_16x16x32_bf16 v[60:63], v[84:87], a[84:87], v[60:63]
v_mfma_f32_16x16x32_bf16 v[60:63], v[88:91], a[100:103], v[60:63]
ds_read_b64_tr_b16 v[108:109], v9 offset:24576
v_mfma_f32_16x16x32_bf16 v[60:63], v[92:95], a[116:119], v[60:63]
v_mfma_f32_16x16x32_bf16 v[68:71], v[84:87], a[88:91], v[68:71]
ds_read_b64_tr_b16 v[110:111], v9 offset:26624
v_mfma_f32_16x16x32_bf16 v[68:71], v[88:91], a[104:107], v[68:71]
v_mfma_f32_16x16x32_bf16 v[68:71], v[92:95], a[120:123], v[68:71]
ds_read_b64_tr_b16 v[80:81], v9 offset:28672
v_mfma_f32_16x16x32_bf16 v[76:79], v[84:87], a[92:95], v[76:79]
v_mfma_f32_16x16x32_bf16 v[76:79], v[88:91], a[108:111], v[76:79]
ds_read_b64_tr_b16 v[82:83], v9 offset:30720
v_mfma_f32_16x16x32_bf16 v[76:79], v[92:95], a[124:127], v[76:79]
v_mfma_f32_16x16x32_bf16 v[220:223], v[84:87], v[132:135], v[220:223]
v_mfma_f32_16x16x32_bf16 v[220:223], v[88:91], v[136:139], v[220:223]
v_mfma_f32_16x16x32_bf16 v[220:223], v[92:95], v[140:143], v[220:223]
s_waitcnt vmcnt(21)
s_barrier
s_waitcnt lgkmcnt(8)
v_mfma_f32_16x16x32_bf16 v[48:51], v[96:99], a[128:131], v[48:51]
ds_read_b64_tr_b16 v[84:85], v9 offset:32768
s_waitcnt lgkmcnt(7)
v_mfma_f32_16x16x32_bf16 v[48:51], v[100:103], a[144:147], v[48:51]
s_waitcnt lgkmcnt(5)
v_mfma_f32_16x16x32_bf16 v[16:19], v[104:107], a[0:3], 0
ds_read_b64_tr_b16 v[86:87], v9 offset:34816
v_mfma_f32_16x16x32_bf16 v[56:59], v[96:99], a[132:135], v[56:59]
global_load_dword v254, v[252:253], off
v_mfma_f32_16x16x32_bf16 v[56:59], v[100:103], a[148:151], v[56:59]
ds_read_b64_tr_b16 v[88:89], v8 offset:36864
v_mfma_f32_16x16x32_bf16 v[24:27], v[104:107], a[4:7], 0
v_mfma_f32_16x16x32_bf16 v[64:67], v[96:99], a[136:139], v[64:67]
ds_read_b64_tr_b16 v[90:91], v8 offset:38912
v_mfma_f32_16x16x32_bf16 v[64:67], v[100:103], a[152:155], v[64:67]
v_mfma_f32_16x16x32_bf16 v[32:35], v[104:107], a[8:11], 0
ds_read_b64_tr_b16 v[92:93], v8 offset:40960
v_mfma_f32_16x16x32_bf16 v[72:75], v[96:99], a[140:143], v[72:75]
v_mfma_f32_16x16x32_bf16 v[72:75], v[100:103], a[156:159], v[72:75]
ds_read_b64_tr_b16 v[94:95], v8 offset:43008
v_mfma_f32_16x16x32_bf16 v[40:43], v[104:107], a[12:15], 0
v_mfma_f32_16x16x32_bf16 v[216:219], v[96:99], v[144:147], v[216:219]
v_mfma_f32_16x16x32_bf16 v[216:219], v[100:103], v[148:151], v[216:219]
v_mfma_f32_16x16x32_bf16 v[208:211], v[104:107], v[112:115], 0
s_waitcnt lgkmcnt(8)
v_mfma_f32_16x16x32_bf16 v[52:55], v[108:111], a[128:131], v[52:55]
ds_read_b64_tr_b16 v[96:97], v8 offset:45056
s_waitcnt lgkmcnt(7)
v_mfma_f32_16x16x32_bf16 v[52:55], v[80:83], a[144:147], v[52:55]
s_waitcnt lgkmcnt(5)
v_mfma_f32_16x16x32_bf16 v[20:23], v[84:87], a[0:3], 0
ds_read_b64_tr_b16 v[98:99], v8 offset:47104
v_mfma_f32_16x16x32_bf16 v[60:63], v[108:111], a[132:135], v[60:63]
v_mfma_f32_16x16x32_bf16 v[60:63], v[80:83], a[148:151], v[60:63]
ds_read_b64_tr_b16 v[100:101], v9 offset:36864
v_mfma_f32_16x16x32_bf16 v[28:31], v[84:87], a[4:7], 0
v_mfma_f32_16x16x32_bf16 v[68:71], v[108:111], a[136:139], v[68:71]
ds_read_b64_tr_b16 v[102:103], v9 offset:38912
v_mfma_f32_16x16x32_bf16 v[68:71], v[80:83], a[152:155], v[68:71]
v_mfma_f32_16x16x32_bf16 v[36:39], v[84:87], a[8:11], 0
ds_read_b64_tr_b16 v[104:105], v9 offset:40960
v_mfma_f32_16x16x32_bf16 v[76:79], v[108:111], a[140:143], v[76:79]
v_mfma_f32_16x16x32_bf16 v[76:79], v[80:83], a[156:159], v[76:79]
ds_read_b64_tr_b16 v[106:107], v9 offset:43008
v_mfma_f32_16x16x32_bf16 v[44:47], v[84:87], a[12:15], 0
v_mfma_f32_16x16x32_bf16 v[220:223], v[108:111], v[144:147], v[220:223]
v_mfma_f32_16x16x32_bf16 v[220:223], v[80:83], v[148:151], v[220:223]
v_mfma_f32_16x16x32_bf16 v[212:215], v[84:87], v[112:115], 0
s_waitcnt vmcnt(16)
s_barrier
s_waitcnt lgkmcnt(8)
v_mfma_f32_16x16x32_bf16 v[16:19], v[88:91], a[16:19], v[16:19]
ds_read_b64_tr_b16 v[108:109], v9 offset:45056
s_waitcnt lgkmcnt(7)
v_mfma_f32_16x16x32_bf16 v[16:19], v[92:95], a[32:35], v[16:19]
s_waitcnt lgkmcnt(5)
v_mfma_f32_16x16x32_bf16 v[16:19], v[96:99], a[48:51], v[16:19]
ds_read_b64_tr_b16 v[110:111], v9 offset:47104
s_add_u32 s37, s36, 57344
v_mfma_f32_16x16x32_bf16 v[24:27], v[88:91], a[20:23], v[24:27]
v_cvt_pk_bf16_f32 v176, v48, v49
v_mfma_f32_16x16x32_bf16 v[24:27], v[92:95], a[36:39], v[24:27]
ds_read_b64_tr_b16 v[80:81], v8 offset:49152
v_cvt_pk_bf16_f32 v177, v50, v51
v_mfma_f32_16x16x32_bf16 v[24:27], v[96:99], a[52:55], v[24:27]
v_cvt_pk_bf16_f32 v178, v52, v53
v_mfma_f32_16x16x32_bf16 v[32:35], v[88:91], a[24:27], v[32:35]
ds_read_b64_tr_b16 v[82:83], v8 offset:51200
v_mfma_f32_16x16x32_bf16 v[32:35], v[92:95], a[40:43], v[32:35]
v_cvt_pk_bf16_f32 v179, v54, v55
buffer_store_dwordx4 v[176:179], v11, s[8:11], s37 offen offset:0 sc1
v_mfma_f32_16x16x32_bf16 v[32:35], v[96:99], a[56:59], v[32:35]
ds_read_b64_tr_b16 v[84:85], v8 offset:53248
v_mfma_f32_16x16x32_bf16 v[40:43], v[88:91], a[28:31], v[40:43]
v_cvt_pk_bf16_f32 v180, v56, v57
v_mfma_f32_16x16x32_bf16 v[40:43], v[92:95], a[44:47], v[40:43]
ds_read_b64_tr_b16 v[86:87], v8 offset:55296
v_mfma_f32_16x16x32_bf16 v[40:43], v[96:99], a[60:63], v[40:43]
v_cvt_pk_bf16_f32 v181, v58, v59
v_cvt_pk_bf16_f32 v182, v60, v61
v_mfma_f32_16x16x32_bf16 v[208:211], v[88:91], v[116:119], v[208:211]
v_cvt_pk_bf16_f32 v183, v62, v63
v_mfma_f32_16x16x32_bf16 v[208:211], v[92:95], v[120:123], v[208:211]
buffer_store_dwordx4 v[180:183], v11, s[8:11], s37 offen offset:1024 sc1
v_mfma_f32_16x16x32_bf16 v[208:211], v[96:99], v[124:127], v[208:211]
v_cvt_pk_bf16_f32 v184, v64, v65
v_cvt_pk_bf16_f32 v185, v66, v67
s_waitcnt lgkmcnt(8)
v_mfma_f32_16x16x32_bf16 v[20:23], v[100:103], a[16:19], v[20:23]
ds_read_b64_tr_b16 v[88:89], v8 offset:57344
s_waitcnt lgkmcnt(7)
v_mfma_f32_16x16x32_bf16 v[20:23], v[104:107], a[32:35], v[20:23]
v_cvt_pk_bf16_f32 v186, v68, v69
s_waitcnt lgkmcnt(5)
v_mfma_f32_16x16x32_bf16 v[20:23], v[108:111], a[48:51], v[20:23]
ds_read_b64_tr_b16 v[90:91], v8 offset:59392
v_cvt_pk_bf16_f32 v187, v70, v71
v_mfma_f32_16x16x32_bf16 v[28:31], v[100:103], a[20:23], v[28:31]
buffer_store_dwordx4 v[184:187], v11, s[8:11], s37 offen offset:2048 sc1
v_mfma_f32_16x16x32_bf16 v[28:31], v[104:107], a[36:39], v[28:31]
ds_read_b64_tr_b16 v[92:93], v9 offset:49152
v_mfma_f32_16x16x32_bf16 v[28:31], v[108:111], a[52:55], v[28:31]
v_cvt_pk_bf16_f32 v188, v72, v73
v_cvt_pk_bf16_f32 v189, v74, v75
v_mfma_f32_16x16x32_bf16 v[36:39], v[100:103], a[24:27], v[36:39]
ds_read_b64_tr_b16 v[94:95], v9 offset:51200
v_mfma_f32_16x16x32_bf16 v[36:39], v[104:107], a[40:43], v[36:39]
v_cvt_pk_bf16_f32 v190, v76, v77
v_mfma_f32_16x16x32_bf16 v[36:39], v[108:111], a[56:59], v[36:39]
ds_read_b64_tr_b16 v[96:97], v9 offset:53248
v_mfma_f32_16x16x32_bf16 v[44:47], v[100:103], a[28:31], v[44:47]
v_cvt_pk_bf16_f32 v191, v78, v79
buffer_store_dwordx4 v[188:191], v11, s[8:11], s37 offen offset:3072 sc1
v_mfma_f32_16x16x32_bf16 v[44:47], v[104:107], a[44:47], v[44:47]
ds_read_b64_tr_b16 v[98:99], v9 offset:55296
v_mfma_f32_16x16x32_bf16 v[44:47], v[108:111], a[60:63], v[44:47]
s_add_u32 s39, s38, 57344
v_cvt_pk_bf16_f32 v192, v216, v217
v_mfma_f32_16x16x32_bf16 v[212:215], v[100:103], v[116:119], v[212:215]
v_cvt_pk_bf16_f32 v193, v218, v219
v_mfma_f32_16x16x32_bf16 v[212:215], v[104:107], v[120:123], v[212:215]
v_cvt_pk_bf16_f32 v194, v220, v221
v_cvt_pk_bf16_f32 v195, v222, v223
v_mfma_f32_16x16x32_bf16 v[212:215], v[108:111], v[124:127], v[212:215]
buffer_store_dwordx4 v[192:195], v11, s[8:11], s39 offen sc1
s_waitcnt vmcnt(16)
s_barrier
s_waitcnt lgkmcnt(8)
v_mfma_f32_16x16x32_bf16 v[16:19], v[80:83], a[64:67], v[16:19]
ds_read_b64_tr_b16 v[100:101], v9 offset:57344
s_waitcnt lgkmcnt(7)
v_mfma_f32_16x16x32_bf16 v[16:19], v[84:87], a[80:83], v[16:19]
s_waitcnt lgkmcnt(5)
v_mfma_f32_16x16x32_bf16 v[16:19], v[88:91], a[96:99], v[16:19]
ds_read_b64_tr_b16 v[102:103], v9 offset:59392
v_mfma_f32_16x16x32_bf16 v[24:27], v[80:83], a[68:71], v[24:27]
v_mfma_f32_16x16x32_bf16 v[24:27], v[84:87], a[84:87], v[24:27]
ds_read_b64_tr_b16 v[104:105], v8 offset:61440
v_mfma_f32_16x16x32_bf16 v[24:27], v[88:91], a[100:103], v[24:27]
v_mfma_f32_16x16x32_bf16 v[32:35], v[80:83], a[72:75], v[32:35]
ds_read_b64_tr_b16 v[106:107], v8 offset:63488
v_mfma_f32_16x16x32_bf16 v[32:35], v[84:87], a[88:91], v[32:35]
v_mfma_f32_16x16x32_bf16 v[32:35], v[88:91], a[104:107], v[32:35]
ds_read_b64_tr_b16 v[108:109], v5 offset:0
v_mfma_f32_16x16x32_bf16 v[40:43], v[80:83], a[76:79], v[40:43]
v_mfma_f32_16x16x32_bf16 v[40:43], v[84:87], a[92:95], v[40:43]
ds_read_b64_tr_b16 v[110:111], v5 offset:2048
v_mfma_f32_16x16x32_bf16 v[40:43], v[88:91], a[108:111], v[40:43]
v_mfma_f32_16x16x32_bf16 v[208:211], v[80:83], v[128:131], v[208:211]
v_mfma_f32_16x16x32_bf16 v[208:211], v[84:87], v[132:135], v[208:211]
v_mfma_f32_16x16x32_bf16 v[208:211], v[88:91], v[136:139], v[208:211]
s_waitcnt lgkmcnt(8)
v_mfma_f32_16x16x32_bf16 v[20:23], v[92:95], a[64:67], v[20:23]
ds_read_b64_tr_b16 v[80:81], v5 offset:4096
s_waitcnt lgkmcnt(7)
v_mfma_f32_16x16x32_bf16 v[20:23], v[96:99], a[80:83], v[20:23]
s_waitcnt lgkmcnt(5)
v_mfma_f32_16x16x32_bf16 v[20:23], v[100:103], a[96:99], v[20:23]
ds_read_b64_tr_b16 v[82:83], v5 offset:6144
v_mfma_f32_16x16x32_bf16 v[28:31], v[92:95], a[68:71], v[28:31]
v_mfma_f32_16x16x32_bf16 v[28:31], v[96:99], a[84:87], v[28:31]
ds_read_b64_tr_b16 v[84:85], v9 offset:61440
v_mfma_f32_16x16x32_bf16 v[28:31], v[100:103], a[100:103], v[28:31]
v_mfma_f32_16x16x32_bf16 v[36:39], v[92:95], a[72:75], v[36:39]
ds_read_b64_tr_b16 v[86:87], v9 offset:63488
v_mfma_f32_16x16x32_bf16 v[36:39], v[96:99], a[88:91], v[36:39]
v_mfma_f32_16x16x32_bf16 v[36:39], v[100:103], a[104:107], v[36:39]
ds_read_b64_tr_b16 v[88:89], v6 offset:0
v_mfma_f32_16x16x32_bf16 v[44:47], v[92:95], a[76:79], v[44:47]
v_mfma_f32_16x16x32_bf16 v[44:47], v[96:99], a[92:95], v[44:47]
ds_read_b64_tr_b16 v[90:91], v6 offset:2048
v_mfma_f32_16x16x32_bf16 v[44:47], v[100:103], a[108:111], v[44:47]
v_mfma_f32_16x16x32_bf16 v[212:215], v[92:95], v[128:131], v[212:215]
v_mfma_f32_16x16x32_bf16 v[212:215], v[96:99], v[132:135], v[212:215]
v_mfma_f32_16x16x32_bf16 v[212:215], v[100:103], v[136:139], v[212:215]
s_waitcnt lgkmcnt(8)
v_mfma_f32_16x16x32_bf16 v[16:19], v[104:107], a[112:115], v[16:19]
ds_read_b64_tr_b16 v[92:93], v6 offset:4096
s_waitcnt lgkmcnt(7)
v_mfma_f32_16x16x32_bf16 v[16:19], v[108:111], a[128:131], v[16:19]
s_waitcnt lgkmcnt(5)
v_mfma_f32_16x16x32_bf16 v[16:19], v[80:83], a[144:147], v[16:19]
ds_read_b64_tr_b16 v[94:95], v6 offset:6144
v_mfma_f32_16x16x32_bf16 v[24:27], v[104:107], a[116:119], v[24:27]
v_mfma_f32_16x16x32_bf16 v[24:27], v[108:111], a[132:135], v[24:27]
v_mfma_f32_16x16x32_bf16 v[24:27], v[80:83], a[148:151], v[24:27]
v_mfma_f32_16x16x32_bf16 v[32:35], v[104:107], a[120:123], v[32:35]
v_mfma_f32_16x16x32_bf16 v[32:35], v[108:111], a[136:139], v[32:35]
v_mfma_f32_16x16x32_bf16 v[32:35], v[80:83], a[152:155], v[32:35]
v_mfma_f32_16x16x32_bf16 v[40:43], v[104:107], a[124:127], v[40:43]
v_mfma_f32_16x16x32_bf16 v[40:43], v[108:111], a[140:143], v[40:43]
v_mfma_f32_16x16x32_bf16 v[40:43], v[80:83], a[156:159], v[40:43]
v_mfma_f32_16x16x32_bf16 v[208:211], v[104:107], v[140:143], v[208:211]
v_mfma_f32_16x16x32_bf16 v[208:211], v[108:111], v[144:147], v[208:211]
v_mfma_f32_16x16x32_bf16 v[208:211], v[80:83], v[148:151], v[208:211]
s_waitcnt lgkmcnt(4)
v_mfma_f32_16x16x32_bf16 v[20:23], v[84:87], a[112:115], v[20:23]
s_waitcnt lgkmcnt(2)
v_mfma_f32_16x16x32_bf16 v[20:23], v[88:91], a[128:131], v[20:23]
s_waitcnt lgkmcnt(0)
v_mfma_f32_16x16x32_bf16 v[20:23], v[92:95], a[144:147], v[20:23]
v_mfma_f32_16x16x32_bf16 v[28:31], v[84:87], a[116:119], v[28:31]
v_mfma_f32_16x16x32_bf16 v[28:31], v[88:91], a[132:135], v[28:31]
v_mfma_f32_16x16x32_bf16 v[28:31], v[92:95], a[148:151], v[28:31]
v_mfma_f32_16x16x32_bf16 v[36:39], v[84:87], a[120:123], v[36:39]
v_mfma_f32_16x16x32_bf16 v[36:39], v[88:91], a[136:139], v[36:39]
v_mfma_f32_16x16x32_bf16 v[36:39], v[92:95], a[152:155], v[36:39]
v_mfma_f32_16x16x32_bf16 v[44:47], v[84:87], a[124:127], v[44:47]
v_mfma_f32_16x16x32_bf16 v[44:47], v[88:91], a[140:143], v[44:47]
v_mfma_f32_16x16x32_bf16 v[44:47], v[92:95], a[156:159], v[44:47]
v_mfma_f32_16x16x32_bf16 v[212:215], v[84:87], v[140:143], v[212:215]
v_mfma_f32_16x16x32_bf16 v[212:215], v[88:91], v[144:147], v[212:215]
v_mfma_f32_16x16x32_bf16 v[212:215], v[92:95], v[148:151], v[212:215]
s_add_u32 s37, s36, 65536
v_cvt_pk_bf16_f32 v176, v16, v17
v_cvt_pk_bf16_f32 v177, v18, v19
v_cvt_pk_bf16_f32 v178, v20, v21
v_cvt_pk_bf16_f32 v179, v22, v23
buffer_store_dwordx4 v[176:179], v11, s[8:11], s37 offen offset:0 sc1
v_cvt_pk_bf16_f32 v180, v24, v25
v_cvt_pk_bf16_f32 v181, v26, v27
v_cvt_pk_bf16_f32 v182, v28, v29
v_cvt_pk_bf16_f32 v183, v30, v31
buffer_store_dwordx4 v[180:183], v11, s[8:11], s37 offen offset:1024 sc1
v_cvt_pk_bf16_f32 v184, v32, v33
v_cvt_pk_bf16_f32 v185, v34, v35
v_cvt_pk_bf16_f32 v186, v36, v37
v_cvt_pk_bf16_f32 v187, v38, v39
buffer_store_dwordx4 v[184:187], v11, s[8:11], s37 offen offset:2048 sc1
v_cvt_pk_bf16_f32 v188, v40, v41
v_cvt_pk_bf16_f32 v189, v42, v43
v_cvt_pk_bf16_f32 v190, v44, v45
v_cvt_pk_bf16_f32 v191, v46, v47
buffer_store_dwordx4 v[188:191], v11, s[8:11], s37 offen offset:3072 sc1
s_add_u32 s39, s38, 65536
v_cvt_pk_bf16_f32 v192, v208, v209
v_cvt_pk_bf16_f32 v193, v210, v211
v_cvt_pk_bf16_f32 v194, v212, v213
v_cvt_pk_bf16_f32 v195, v214, v215
buffer_store_dwordx4 v[192:195], v11, s[8:11], s39 offen sc1
K2_dft3:
s_endpgm
K2_end:
s_endpgm
.globl final_kernel
.p2align 8
.type final_kernel,@function
final_kernel:
s_cmp_ge_u32 s2, 256
s_cbranch_scc1 K3_end
s_load_dwordx2 s[6:7], s[0:1], 88
s_load_dwordx2 s[4:5], s[0:1], 0
s_load_dwordx2 s[16:17], s[0:1], 72
v_lshrrev_b32 v1, 6, v0
v_and_b32 v0, 63, v0
v_readfirstlane_b32 s20, v1
s_lshr_b32 s21, s2, 3
s_bfe_u32 s22, s2, 0x20001
s_and_b32 s23, s2, 1
s_mul_i32 s23, s23, 9
s_add_u32 s23, s23, s20
s_lshl_b32 s24, s23, 12
s_mul_i32 s26, s21, 73728
s_lshl_b32 s25, s22, 10
s_add_u32 s26, s26, s25
s_add_u32 s26, s26, s24
s_add_u32 s26, s26, 4194304
v_lshlrev_b32 v5, 4, v0
s_add_u32 s40, s26, 0
s_add_u32 s41, s26, 2359296
s_add_u32 s42, s26, 4718592
s_add_u32 s43, s26, 7077888
s_add_u32 s44, s26, 9437184
s_add_u32 s45, s26, 11796480
s_add_u32 s46, s26, 14155776
s_add_u32 s47, s26, 16515072
s_add_u32 s48, s26, 18874368
s_add_u32 s49, s26, 21233664
s_add_u32 s50, s26, 23592960
s_add_u32 s51, s26, 25952256
s_add_u32 s52, s26, 28311552
s_add_u32 s53, s26, 30670848
s_add_u32 s54, s26, 33030144
s_waitcnt lgkmcnt(0)
s_mov_b32 s12, s6
s_mov_b32 s13, s7
s_mov_b32 s14, 0x4000000
s_mov_b32 s15, 0x00020000
buffer_load_dwordx4 v[32:35], v5, s[12:15], s40 offen
buffer_load_dwordx4 v[36:39], v5, s[12:15], s41 offen
buffer_load_dwordx4 v[40:43], v5, s[12:15], s42 offen
buffer_load_dwordx4 v[44:47], v5, s[12:15], s43 offen
buffer_load_dwordx4 v[48:51], v5, s[12:15], s44 offen
buffer_load_dwordx4 v[52:55], v5, s[12:15], s45 offen
buffer_load_dwordx4 v[56:59], v5, s[12:15], s46 offen
buffer_load_dwordx4 v[60:63], v5, s[12:15], s47 offen
buffer_load_dwordx4 v[64:67], v5, s[12:15], s48 offen
buffer_load_dwordx4 v[68:71], v5, s[12:15], s49 offen
buffer_load_dwordx4 v[72:75], v5, s[12:15], s50 offen
buffer_load_dwordx4 v[76:79], v5, s[12:15], s51 offen
buffer_load_dwordx4 v[80:83], v5, s[12:15], s52 offen
buffer_load_dwordx4 v[84:87], v5, s[12:15], s53 offen
buffer_load_dwordx4 v[88:91], v5, s[12:15], s54 offen
s_mov_b32 s8, s4
s_mov_b32 s9, s5
s_mov_b32 s10, 0x240000
s_mov_b32 s11, 0x00020000
s_mov_b32 s28, s16
s_mov_b32 s29, s17
s_mov_b32 s30, 0x240000
s_mov_b32 s31, 0x00020000
v_and_b32 v3, 15, v0
v_lshrrev_b32 v4, 4, v0
s_lshl_b32 s25, s21, 6
s_lshl_b32 s27, s22, 4
s_add_u32 s25, s25, s27
v_add_u32 v2, s25, v3
s_movk_i32 s27, 1152
v_mul_lo_u32 v8, v2, s27
v_lshlrev_b32 v9, 4, v4
v_add_u32 v8, v8, v9
s_lshl_b32 s27, s23, 6
v_add_u32 v8, s27, v8
v_lshlrev_b32 v4, 8, v4
v_add_u32 v4, s24, v4
s_mov_b32 s26, 73728
v_sub_u32 v9, 2048, v2
v_cmp_ge_u32 vcc, 1024, v2
s_nop 1
v_cndmask_b32 v9, v9, v2, vcc
v_mov_b32 v10, -1.0
v_mov_b32 v11, 1.0
v_cndmask_b32 v10, v10, v11, vcc
v_sub_u32 v11, 1024, v9
v_cmp_gt_u32 vcc, 512, v9
s_nop 1
v_cndmask_b32 v12, v11, v9, vcc
v_cndmask_b32 v13, 1, 0, vcc
v_lshrrev_b32 v14, 6, v12
v_lshlrev_b32 v14, 1, v14
v_add_u32 v14, v14, v13
v_and_b32 v12, 63, v12
v_cmp_eq_u32 vcc, 512, v9
s_nop 1
v_cndmask_b32 v14, v14, 32, vcc
v_cndmask_b32 v12, v12, 0, vcc
v_mul_lo_u32 v15, v14, s26
v_bfe_u32 v7, v12, 4, 2
v_lshlrev_b32 v7, 10, v7
v_add_u32 v15, v15, v7
v_and_b32 v7, 15, v12
v_lshlrev_b32 v7, 4, v7
v_add_u32 v15, v15, v7
v_add_u32 v15, v15, v4
s_mov_b32 s55, 39583744
buffer_load_dwordx4 v[92:95], v15, s[12:15], s55 offen
v_sub_u32 v11, 512, v9
v_subrev_u32 v12, 512, v9
v_cmp_ge_u32 vcc, 512, v9
s_nop 1
v_cndmask_b32 v12, v12, v11, vcc
v_cndmask_b32 v13, 1, 0, vcc
v_mov_b32 v11, -1.0
v_cndmask_b32 v11, v11, 1.0, vcc
v_mul_f32 v10, v10, v11
v_lshrrev_b32 v14, 6, v12
v_lshlrev_b32 v14, 1, v14
v_add_u32 v14, v14, v13
v_add_u32 v14, 16, v14
v_and_b32 v12, 63, v12
v_and_b32 v11, 1023, v9
v_cmp_eq_u32 vcc, 0, v11
s_nop 1
v_cndmask_b32 v14, v14, 40, vcc
v_cndmask_b32 v12, v12, 0, vcc
v_mul_lo_u32 v16, v14, s26
v_bfe_u32 v7, v12, 4, 2
v_lshlrev_b32 v7, 10, v7
v_add_u32 v16, v16, v7
v_and_b32 v7, 15, v12
v_lshlrev_b32 v7, 4, v7
v_add_u32 v16, v16, v7
v_add_u32 v16, v16, v4
buffer_load_dwordx4 v[96:99], v16, s[12:15], s55 offen
buffer_load_dwordx4 v[100:103], v8, s[8:11], 0 offen
s_mov_b32 s56, 0x00003f80
s_mov_b32 s57, 0x3f800000
s_waitcnt vmcnt(17)
v_lshlrev_b32 v20, 16, v32
v_and_b32 v21, 0xffff0000, v32
v_lshlrev_b32 v22, 16, v33
v_and_b32 v23, 0xffff0000, v33
v_lshlrev_b32 v24, 16, v34
v_and_b32 v25, 0xffff0000, v34
v_lshlrev_b32 v26, 16, v35
v_and_b32 v27, 0xffff0000, v35
s_waitcnt vmcnt(16)
v_dot2_f32_bf16 v20, v36, s56, v20
v_dot2_f32_bf16 v21, v36, s57, v21
v_dot2_f32_bf16 v22, v37, s56, v22
v_dot2_f32_bf16 v23, v37, s57, v23
v_dot2_f32_bf16 v24, v38, s56, v24
v_dot2_f32_bf16 v25, v38, s57, v25
v_dot2_f32_bf16 v26, v39, s56, v26
v_dot2_f32_bf16 v27, v39, s57, v27
s_waitcnt vmcnt(15)
v_dot2_f32_bf16 v20, v40, s56, v20
v_dot2_f32_bf16 v21, v40, s57, v21
v_dot2_f32_bf16 v22, v41, s56, v22
v_dot2_f32_bf16 v23, v41, s57, v23
v_dot2_f32_bf16 v24, v42, s56, v24
v_dot2_f32_bf16 v25, v42, s57, v25
v_dot2_f32_bf16 v26, v43, s56, v26
v_dot2_f32_bf16 v27, v43, s57, v27
s_waitcnt vmcnt(14)
v_dot2_f32_bf16 v20, v44, s56, v20
v_dot2_f32_bf16 v21, v44, s57, v21
v_dot2_f32_bf16 v22, v45, s56, v22
v_dot2_f32_bf16 v23, v45, s57, v23
v_dot2_f32_bf16 v24, v46, s56, v24
v_dot2_f32_bf16 v25, v46, s57, v25
v_dot2_f32_bf16 v26, v47, s56, v26
v_dot2_f32_bf16 v27, v47, s57, v27
s_waitcnt vmcnt(13)
v_dot2_f32_bf16 v20, v48, s56, v20
v_dot2_f32_bf16 v21, v48, s57, v21
v_dot2_f32_bf16 v22, v49, s56, v22
v_dot2_f32_bf16 v23, v49, s57, v23
v_dot2_f32_bf16 v24, v50, s56, v24
v_dot2_f32_bf16 v25, v50, s57, v25
v_dot2_f32_bf16 v26, v51, s56, v26
v_dot2_f32_bf16 v27, v51, s57, v27
s_waitcnt vmcnt(12)
v_dot2_f32_bf16 v20, v52, s56, v20
v_dot2_f32_bf16 v21, v52, s57, v21
v_dot2_f32_bf16 v22, v53, s56, v22
v_dot2_f32_bf16 v23, v53, s57, v23
v_dot2_f32_bf16 v24, v54, s56, v24
v_dot2_f32_bf16 v25, v54, s57, v25
v_dot2_f32_bf16 v26, v55, s56, v26
v_dot2_f32_bf16 v27, v55, s57, v27
s_waitcnt vmcnt(11)
v_dot2_f32_bf16 v20, v56, s56, v20
v_dot2_f32_bf16 v21, v56, s57, v21
v_dot2_f32_bf16 v22, v57, s56, v22
v_dot2_f32_bf16 v23, v57, s57, v23
v_dot2_f32_bf16 v24, v58, s56, v24
v_dot2_f32_bf16 v25, v58, s57, v25
v_dot2_f32_bf16 v26, v59, s56, v26
v_dot2_f32_bf16 v27, v59, s57, v27
s_waitcnt vmcnt(10)
v_dot2_f32_bf16 v20, v60, s56, v20
v_dot2_f32_bf16 v21, v60, s57, v21
v_dot2_f32_bf16 v22, v61, s56, v22
v_dot2_f32_bf16 v23, v61, s57, v23
v_dot2_f32_bf16 v24, v62, s56, v24
v_dot2_f32_bf16 v25, v62, s57, v25
v_dot2_f32_bf16 v26, v63, s56, v26
v_dot2_f32_bf16 v27, v63, s57, v27
s_waitcnt vmcnt(9)
v_dot2_f32_bf16 v20, v64, s56, v20
v_dot2_f32_bf16 v21, v64, s57, v21
v_dot2_f32_bf16 v22, v65, s56, v22
v_dot2_f32_bf16 v23, v65, s57, v23
v_dot2_f32_bf16 v24, v66, s56, v24
v_dot2_f32_bf16 v25, v66, s57, v25
v_dot2_f32_bf16 v26, v67, s56, v26
v_dot2_f32_bf16 v27, v67, s57, v27
s_waitcnt vmcnt(8)
v_dot2_f32_bf16 v20, v68, s56, v20
v_dot2_f32_bf16 v21, v68, s57, v21
v_dot2_f32_bf16 v22, v69, s56, v22
v_dot2_f32_bf16 v23, v69, s57, v23
v_dot2_f32_bf16 v24, v70, s56, v24
v_dot2_f32_bf16 v25, v70, s57, v25
v_dot2_f32_bf16 v26, v71, s56, v26
v_dot2_f32_bf16 v27, v71, s57, v27
s_waitcnt vmcnt(7)
v_dot2_f32_bf16 v20, v72, s56, v20
v_dot2_f32_bf16 v21, v72, s57, v21
v_dot2_f32_bf16 v22, v73, s56, v22
v_dot2_f32_bf16 v23, v73, s57, v23
v_dot2_f32_bf16 v24, v74, s56, v24
v_dot2_f32_bf16 v25, v74, s57, v25
v_dot2_f32_bf16 v26, v75, s56, v26
v_dot2_f32_bf16 v27, v75, s57, v27
s_waitcnt vmcnt(6)
v_dot2_f32_bf16 v20, v76, s56, v20
v_dot2_f32_bf16 v21, v76, s57, v21
v_dot2_f32_bf16 v22, v77, s56, v22
v_dot2_f32_bf16 v23, v77, s57, v23
v_dot2_f32_bf16 v24, v78, s56, v24
v_dot2_f32_bf16 v25, v78, s57, v25
v_dot2_f32_bf16 v26, v79, s56, v26
v_dot2_f32_bf16 v27, v79, s57, v27
s_waitcnt vmcnt(5)
v_dot2_f32_bf16 v20, v80, s56, v20
v_dot2_f32_bf16 v21, v80, s57, v21
v_dot2_f32_bf16 v22, v81, s56, v22
v_dot2_f32_bf16 v23, v81, s57, v23
v_dot2_f32_bf16 v24, v82, s56, v24
v_dot2_f32_bf16 v25, v82, s57, v25
v_dot2_f32_bf16 v26, v83, s56, v26
v_dot2_f32_bf16 v27, v83, s57, v27
s_waitcnt vmcnt(4)
v_dot2_f32_bf16 v20, v84, s56, v20
v_dot2_f32_bf16 v21, v84, s57, v21
v_dot2_f32_bf16 v22, v85, s56, v22
v_dot2_f32_bf16 v23, v85, s57, v23
v_dot2_f32_bf16 v24, v86, s56, v24
v_dot2_f32_bf16 v25, v86, s57, v25
v_dot2_f32_bf16 v26, v87, s56, v26
v_dot2_f32_bf16 v27, v87, s57, v27
s_waitcnt vmcnt(3)
v_dot2_f32_bf16 v20, v88, s56, v20
v_dot2_f32_bf16 v21, v88, s57, v21
v_dot2_f32_bf16 v22, v89, s56, v22
v_dot2_f32_bf16 v23, v89, s57, v23
v_dot2_f32_bf16 v24, v90, s56, v24
v_dot2_f32_bf16 v25, v90, s57, v25
v_dot2_f32_bf16 v26, v91, s56, v26
v_dot2_f32_bf16 v27, v91, s57, v27
v_cvt_pk_bf16_f32 v32, v20, v21
v_cvt_pk_bf16_f32 v33, v22, v23
v_cvt_pk_bf16_f32 v34, v24, v25
v_cvt_pk_bf16_f32 v35, v26, v27
v_lshlrev_b32 v20, 16, v32
v_and_b32 v21, 0xffff0000, v32
v_lshlrev_b32 v22, 16, v33
v_and_b32 v23, 0xffff0000, v33
v_lshlrev_b32 v24, 16, v34
v_and_b32 v25, 0xffff0000, v34
v_lshlrev_b32 v26, 16, v35
v_and_b32 v27, 0xffff0000, v35
s_mov_b32 s58, 0xbfb8aa3b
v_mul_f32 v40, s58, v20
v_mul_f32 v41, s58, v21
v_mul_f32 v42, s58, v22
v_mul_f32 v43, s58, v23
v_mul_f32 v44, s58, v24
v_mul_f32 v45, s58, v25
v_mul_f32 v46, s58, v26
v_mul_f32 v47, s58, v27
v_exp_f32 v40, v40
v_exp_f32 v41, v41
v_exp_f32 v42, v42
v_exp_f32 v43, v43
v_exp_f32 v44, v44
v_exp_f32 v45, v45
v_exp_f32 v46, v46
v_exp_f32 v47, v47
v_add_f32 v40, 1.0, v40
v_add_f32 v41, 1.0, v41
v_add_f32 v42, 1.0, v42
v_add_f32 v43, 1.0, v43
v_add_f32 v44, 1.0, v44
v_add_f32 v45, 1.0, v45
v_add_f32 v46, 1.0, v46
v_add_f32 v47, 1.0, v47
v_rcp_f32 v40, v40
v_rcp_f32 v41, v41
v_rcp_f32 v42, v42
v_rcp_f32 v43, v43
v_rcp_f32 v44, v44
v_rcp_f32 v45, v45
v_rcp_f32 v46, v46
v_rcp_f32 v47, v47
v_mul_f32 v20, v20, v40
v_mul_f32 v21, v21, v41
v_mul_f32 v22, v22, v42
v_mul_f32 v23, v23, v43
v_mul_f32 v24, v24, v44
v_mul_f32 v25, v25, v45
v_mul_f32 v26, v26, v46
v_mul_f32 v27, v27, v47
v_cvt_pk_bf16_f32 v32, v20, v21
v_cvt_pk_bf16_f32 v33, v22, v23
v_cvt_pk_bf16_f32 v34, v24, v25
v_cvt_pk_bf16_f32 v35, v26, v27
v_lshlrev_b32 v20, 16, v32
v_and_b32 v21, 0xffff0000, v32
v_lshlrev_b32 v22, 16, v33
v_and_b32 v23, 0xffff0000, v33
v_lshlrev_b32 v24, 16, v34
v_and_b32 v25, 0xffff0000, v34
v_lshlrev_b32 v26, 16, v35
v_and_b32 v27, 0xffff0000, v35
s_waitcnt vmcnt(2)
v_lshlrev_b32 v40, 16, v92
v_and_b32 v41, 0xffff0000, v92
s_waitcnt vmcnt(1)
v_lshlrev_b32 v48, 16, v96
v_and_b32 v49, 0xffff0000, v96
v_lshlrev_b32 v42, 16, v93
v_and_b32 v43, 0xffff0000, v93
v_lshlrev_b32 v50, 16, v97
v_and_b32 v51, 0xffff0000, v97
v_lshlrev_b32 v44, 16, v94
v_and_b32 v45, 0xffff0000, v94
v_lshlrev_b32 v52, 16, v98
v_and_b32 v53, 0xffff0000, v98
v_lshlrev_b32 v46, 16, v95
v_and_b32 v47, 0xffff0000, v95
v_lshlrev_b32 v54, 16, v99
v_and_b32 v55, 0xffff0000, v99
v_fma_f32 v40, v48, v10, v40
v_fma_f32 v41, v49, v10, v41
v_fma_f32 v42, v50, v10, v42
v_fma_f32 v43, v51, v10, v43
v_fma_f32 v44, v52, v10, v44
v_fma_f32 v45, v53, v10, v45
v_fma_f32 v46, v54, v10, v46
v_fma_f32 v47, v55, v10, v47
v_cvt_pk_bf16_f32 v36, v40, v41
v_cvt_pk_bf16_f32 v37, v42, v43
v_cvt_pk_bf16_f32 v38, v44, v45
v_cvt_pk_bf16_f32 v39, v46, v47
v_lshlrev_b32 v40, 16, v36
v_and_b32 v41, 0xffff0000, v36
v_lshlrev_b32 v42, 16, v37
v_and_b32 v43, 0xffff0000, v37
v_lshlrev_b32 v44, 16, v38
v_and_b32 v45, 0xffff0000, v38
v_lshlrev_b32 v46, 16, v39
v_and_b32 v47, 0xffff0000, v39
v_mul_f32 v40, v40, v20
v_mul_f32 v41, v41, v21
v_mul_f32 v42, v42, v22
v_mul_f32 v43, v43, v23
v_mul_f32 v44, v44, v24
v_mul_f32 v45, v45, v25
v_mul_f32 v46, v46, v26
v_mul_f32 v47, v47, v27
v_cvt_pk_bf16_f32 v36, v40, v41
v_cvt_pk_bf16_f32 v37, v42, v43
v_cvt_pk_bf16_f32 v38, v44, v45
v_cvt_pk_bf16_f32 v39, v46, v47
s_nop 0
v_permlane32_swap_b32 v36, v38
v_permlane32_swap_b32 v37, v39
s_nop 0
v_permlane16_swap_b32 v36, v38
v_permlane16_swap_b32 v37, v39
v_lshlrev_b32 v40, 16, v36
v_and_b32 v41, 0xffff0000, v36
s_waitcnt vmcnt(0)
v_lshlrev_b32 v48, 16, v100
v_and_b32 v49, 0xffff0000, v100
v_lshlrev_b32 v42, 16, v37
v_and_b32 v43, 0xffff0000, v37
v_lshlrev_b32 v50, 16, v101
v_and_b32 v51, 0xffff0000, v101
v_lshlrev_b32 v44, 16, v38
v_and_b32 v45, 0xffff0000, v38
v_lshlrev_b32 v52, 16, v102
v_and_b32 v53, 0xffff0000, v102
v_lshlrev_b32 v46, 16, v39
v_and_b32 v47, 0xffff0000, v39
v_lshlrev_b32 v54, 16, v103
v_and_b32 v55, 0xffff0000, v103
v_add_f32 v40, v40, v48
v_add_f32 v41, v41, v49
v_add_f32 v42, v42, v50
v_add_f32 v43, v43, v51
v_add_f32 v44, v44, v52
v_add_f32 v45, v45, v53
v_add_f32 v46, v46, v54
v_add_f32 v47, v47, v55
v_cvt_pk_bf16_f32 v36, v40, v41
v_cvt_pk_bf16_f32 v37, v42, v43
v_cvt_pk_bf16_f32 v38, v44, v45
v_cvt_pk_bf16_f32 v39, v46, v47
buffer_store_dwordx4 v[36:39], v8, s[28:31], 0 offen
K3_end:
s_endpgm
.section .rodata,"a"
.p2align 6
.amdhsa_kernel prep_kernel
  .amdhsa_next_free_vgpr 104
  .amdhsa_next_free_sgpr 102
  .amdhsa_accum_offset 104
  .amdhsa_group_segment_fixed_size 0
  .amdhsa_kernarg_size 96
  .amdhsa_user_sgpr_count 2
  .amdhsa_user_sgpr_kernarg_segment_ptr 1
  .amdhsa_system_sgpr_workgroup_id_x 1
.end_amdhsa_kernel
.p2align 6
.amdhsa_kernel main_kernel
  .amdhsa_next_free_vgpr 512
  .amdhsa_next_free_sgpr 102
  .amdhsa_accum_offset 256
  .amdhsa_group_segment_fixed_size 0
  .amdhsa_kernarg_size 96
  .amdhsa_user_sgpr_count 2
  .amdhsa_user_sgpr_kernarg_segment_ptr 1
  .amdhsa_system_sgpr_workgroup_id_x 1
.end_amdhsa_kernel
.p2align 6
.amdhsa_kernel final_kernel
  .amdhsa_next_free_vgpr 128
  .amdhsa_next_free_sgpr 102
  .amdhsa_accum_offset 128
  .amdhsa_group_segment_fixed_size 0
  .amdhsa_kernarg_size 96
  .amdhsa_user_sgpr_count 2
  .amdhsa_user_sgpr_kernarg_segment_ptr 1
  .amdhsa_system_sgpr_workgroup_id_x 1
.end_amdhsa_kernel
```
